```python
import torch

def _softmax(x, axis=-1):
    return torch.softmax(x, dim=axis)

def _gelu(x):
    return torch.nn.functional.gelu(x, approximate='tanh')

def _silu(x):
    return torch.nn.functional.silu(x)

def _sigmoid(x):
    return torch.sigmoid(x)

def _layernorm(x, axis=-1, eps=1e-05):
    m = x.mean(dim=axis, keepdim=True)
    v = x.var(dim=axis, keepdim=True, unbiased=False)
    return (x - m) / torch.sqrt(v + eps)

def _scatter_add(tgt, idx, src, axis=0):
    return tgt.clone().index_add_(axis, idx, src)

def _segment_sum(src, seg, n):
    out = torch.zeros((n,) + src.shape[1:], dtype=src.dtype)
    return out.index_add_(0, seg, src)

def _pad(x, pw):
    flat = tuple((v for pair in reversed(pw) for v in pair))
    return torch.nn.functional.pad(x, flat)
kernel_name = 'sequential_preLN__memory_aug_recurrent_mem_tr__glu_gated_bilinear__prompt'

def setup_inputs():

    _w = lambda a: (lambda t: t.to(torch.bfloat16) if t.is_floating_point() else t)(torch.as_tensor(a))

    def _A_setup():
        B, S, Dm = (1, 2048, 448)
        H, Dh = (16, 256)
        M, seg = (8, 32)
        seg = min(seg, S)
        S = S // seg * seg
        return {'x': _w((lambda *s: torch.randn(*s, dtype=torch.bfloat16) * 0.05)(B, S, Dm)), 'mem0': _w((lambda *s: torch.randn(*s, dtype=torch.bfloat16) * 0.2)(B, M, Dm)), 'Wq': _w((lambda *s: torch.randn(*s, dtype=torch.bfloat16) * 1.6)(Dm, H, Dh) * Dm ** (-0.5)), 'Wk': _w((lambda *s: torch.randn(*s, dtype=torch.bfloat16) * 1.6)(Dm, H, Dh) * Dm ** (-0.5)), 'Wv': _w((lambda *s: torch.randn(*s, dtype=torch.bfloat16) * 0.2)(Dm, H, Dh) * Dm ** (-0.5)), 'Wo': _w((lambda *s: torch.randn(*s, dtype=torch.bfloat16) * 0.2)(H, Dh, Dm) * (H * Dh) ** (-0.5)), 'seg_len': seg}
    _A_in = _A_setup()

    def _B_setup():
        B, S, D, F = (1, 2048, 448, 1792)
        return {'x': _w((lambda *s: torch.randn(*s, dtype=torch.bfloat16) * 0.05)(B, S, D)), 'w_gate': _w((lambda *s: torch.randn(*s, dtype=torch.bfloat16) * 0.2)(D, F) * D ** (-0.5)), 'w_up': _w((lambda *s: torch.randn(*s, dtype=torch.bfloat16) * 0.2)(D, F) * D ** (-0.5)), 'w_down': _w((lambda *s: torch.randn(*s, dtype=torch.bfloat16) * 0.2)(F, D) * F ** (-0.5))}
    _B_in = _B_setup()
    return {'A_x': _A_in['x'], 'A_mem0': _A_in['mem0'], 'A_Wq': _A_in['Wq'], 'A_Wk': _A_in['Wk'], 'A_Wv': _A_in['Wv'], 'A_Wo': _A_in['Wo'], 'A_seg_len': _A_in['seg_len'], 'B_x': _B_in['x'], 'B_w_gate': _B_in['w_gate'], 'B_w_up': _B_in['w_up'], 'B_w_down': _B_in['w_down']}

def reference(A_x, A_mem0, A_Wq, A_Wk, A_Wv, A_Wo, A_seg_len, B_x, B_w_gate, B_w_up, B_w_down):

    def _A_ref(x, mem0, Wq, Wk, Wv, Wo, seg_len):
        B, S, Dm = x.shape
        H, Dh = (Wq.shape[1], Wq.shape[2])
        M = mem0.shape[1]
        scale = Dh ** (-0.5)
        n_seg = S // seg_len
        L = M + seg_len
        idx = torch.arange(L)
        mask = (idx[:, None] < M) | (idx[:, None] >= idx[None, :])
        mem = mem0
        outs = []
        for s in range(n_seg):
            xs = x[:, s * seg_len:(s + 1) * seg_len, :].clone()
            h = torch.concatenate([mem, xs], axis=1)
            q = torch.einsum('btd,dhe->bhte', h, Wq)
            k = torch.einsum('btd,dhe->bhte', h, Wk)
            v = torch.einsum('btd,dhe->bhte', h, Wv)
            scores = torch.einsum('bhqe,bhke->bhqk', q, k) * scale
            scores = torch.where(mask[None, None], scores, -1000000000.0)
            p = _softmax(scores, axis=-1)
            o = torch.einsum('bhqk,bhke->bhqe', p, v)
            o = torch.einsum('bhte,hed->btd', o, Wo)
            mem = o[:, :M, :].clone()
            outs.append(o[:, M:, :])
        return torch.concatenate(outs, axis=1)

    def _B_ref(x, w_gate, w_up, w_down):
        g = torch.einsum('bsd,df->bsf', x, w_gate)
        u = torch.einsum('bsd,df->bsf', x, w_up)
        h = g * u
        return torch.einsum('bsf,fd->bsd', h, w_down)
    x = A_x
    h = x + _A_ref(_layernorm(x, axis=-1), A_mem0, A_Wq, A_Wk, A_Wv, A_Wo, A_seg_len)
    h2 = h + _B_ref(_layernorm(h, axis=-1), B_w_gate, B_w_up, B_w_down)
    return h2
```

```asm
; @launch kernel=prep2_kernel grid=(256,1,1) block=(256,1,1) lds=114688
; @launch kernel=chain_kernel grid=(256,1,1) block=(256,1,1) lds=131072
.amdgcn_target "amdgcn-amd-amdhsa--gfx950"
.text
.globl prep2_kernel
.p2align 8
.type prep2_kernel,@function
prep2_kernel:
    s_cmp_ge_u32 s2, 256
    s_cbranch_scc1 prep2_kernel_end
    s_load_dwordx2 s[4:5], s[0:1], 104
    s_mov_b32 s6, 268435456
    s_mov_b32 s7, 0x00020000
    s_load_dwordx2 s[8:9], s[0:1], 16
    s_mov_b32 s10, 3670016
    s_mov_b32 s11, 0x00020000
    s_load_dwordx2 s[92:93], s[0:1], 24
    s_mov_b32 s94, 3670016
    s_mov_b32 s95, 0x00020000
    s_load_dwordx2 s[16:17], s[0:1], 32
    s_mov_b32 s18, 3670016
    s_mov_b32 s19, 0x00020000
    s_load_dwordx2 s[84:85], s[0:1], 0
    s_mov_b32 s86, 1835008
    s_mov_b32 s87, 0x00020000
    s_load_dwordx2 s[88:89], s[0:1], 8
    s_mov_b32 s90, 7168
    s_mov_b32 s91, 0x00020000
    s_load_dwordx2 s[96:97], s[0:1], 40
    s_mov_b32 s98, 3670016
    s_mov_b32 s99, 0x00020000
    v_and_b32 v1, 63, v0
    v_lshrrev_b32 v2, 6, v0
    v_and_b32 v3, 15, v1
    v_lshrrev_b32 v4, 4, v1
    s_nop 0
    v_readfirstlane_b32 s14, v2
    s_waitcnt lgkmcnt(0)
    s_cmp_lt_u32 s2, 128
    s_cbranch_scc1 prep2_kernel_gemm
    s_sub_u32 s19, s2, 128
    s_lshl_b32 s3, s19, 4
    v_lshlrev_b32 v3, 2, v2
    v_add_u32 v3, s3, v3
    v_mul_u32_u24 v3, 896, v3
    v_lshlrev_b32 v4, 4, v1
    v_add_u32 v3, v3, v4
    v_mov_b32 v5, 0x7ffffff0
    v_cmp_gt_u32 vcc, 56, v1
    s_nop 1
    v_cndmask_b32 v3, v5, v3, vcc
    buffer_load_dwordx4 v[8:11], v3, s[84:87], 0 offen offset:0
    buffer_load_dwordx4 v[12:15], v3, s[84:87], 0 offen offset:896
    buffer_load_dwordx4 v[16:19], v3, s[84:87], 0 offen offset:1792
    buffer_load_dwordx4 v[20:23], v3, s[84:87], 0 offen offset:2688
    s_waitcnt vmcnt(3)
    v_lshlrev_b32 v24, 16, v8
    v_and_b32 v25, 0xffff0000, v8
    v_lshlrev_b32 v26, 16, v9
    v_and_b32 v27, 0xffff0000, v9
    v_lshlrev_b32 v28, 16, v10
    v_and_b32 v29, 0xffff0000, v10
    v_lshlrev_b32 v30, 16, v11
    v_and_b32 v31, 0xffff0000, v11
    v_add_f32 v32, v24, v25
    v_add_f32 v32, v32, v26
    v_add_f32 v32, v32, v27
    v_add_f32 v32, v32, v28
    v_add_f32 v32, v32, v29
    v_add_f32 v32, v32, v30
    v_add_f32 v32, v32, v31
    s_nop 1
    v_add_f32_dpp v32, v32, v32 quad_perm:[1,0,3,2] row_mask:0xf bank_mask:0xf
    s_nop 1
    v_add_f32_dpp v32, v32, v32 quad_perm:[2,3,0,1] row_mask:0xf bank_mask:0xf
    s_nop 1
    v_add_f32_dpp v32, v32, v32 row_half_mirror row_mask:0xf bank_mask:0xf
    s_nop 1
    v_add_f32_dpp v32, v32, v32 row_mirror row_mask:0xf bank_mask:0xf
    v_mov_b32 v33, v32
    s_nop 1
    v_permlane16_swap_b32 v33, v32
    s_nop 1
    v_add_f32 v32, v32, v33
    v_mov_b32 v33, v32
    s_nop 1
    v_permlane32_swap_b32 v33, v32
    s_nop 1
    v_add_f32 v32, v32, v33
    v_mul_f32 v32, 0.002232142857142857, v32
    v_sub_f32 v24, v24, v32
    v_sub_f32 v25, v25, v32
    v_sub_f32 v26, v26, v32
    v_sub_f32 v27, v27, v32
    v_sub_f32 v28, v28, v32
    v_sub_f32 v29, v29, v32
    v_sub_f32 v30, v30, v32
    v_sub_f32 v31, v31, v32
    v_mul_f32 v34, v24, v24
    v_fma_f32 v34, v25, v25, v34
    v_fma_f32 v34, v26, v26, v34
    v_fma_f32 v34, v27, v27, v34
    v_fma_f32 v34, v28, v28, v34
    v_fma_f32 v34, v29, v29, v34
    v_fma_f32 v34, v30, v30, v34
    v_fma_f32 v34, v31, v31, v34
    v_cndmask_b32 v34, 0, v34, vcc
    s_nop 1
    v_add_f32_dpp v34, v34, v34 quad_perm:[1,0,3,2] row_mask:0xf bank_mask:0xf
    s_nop 1
    v_add_f32_dpp v34, v34, v34 quad_perm:[2,3,0,1] row_mask:0xf bank_mask:0xf
    s_nop 1
    v_add_f32_dpp v34, v34, v34 row_half_mirror row_mask:0xf bank_mask:0xf
    s_nop 1
    v_add_f32_dpp v34, v34, v34 row_mirror row_mask:0xf bank_mask:0xf
    v_mov_b32 v33, v34
    s_nop 1
    v_permlane16_swap_b32 v33, v34
    s_nop 1
    v_add_f32 v34, v34, v33
    v_mov_b32 v33, v34
    s_nop 1
    v_permlane32_swap_b32 v33, v34
    s_nop 1
    v_add_f32 v34, v34, v33
    v_mov_b32 v35, 1e-05
    v_fmac_f32 v35, 0.002232142857142857, v34
    v_rsq_f32 v35, v35
    s_nop 0
    v_mul_f32 v24, v24, v35
    v_mul_f32 v25, v25, v35
    v_mul_f32 v26, v26, v35
    v_mul_f32 v27, v27, v35
    v_mul_f32 v28, v28, v35
    v_mul_f32 v29, v29, v35
    v_mul_f32 v30, v30, v35
    v_mul_f32 v31, v31, v35
    v_cvt_pk_bf16_f32 v8, v24, v25
    v_cvt_pk_bf16_f32 v9, v26, v27
    v_cvt_pk_bf16_f32 v10, v28, v29
    v_cvt_pk_bf16_f32 v11, v30, v31
    buffer_store_dwordx4 v[8:11], v3, s[4:7], 0 offen offset:0
    s_waitcnt vmcnt(2)
    v_lshlrev_b32 v24, 16, v12
    v_and_b32 v25, 0xffff0000, v12
    v_lshlrev_b32 v26, 16, v13
    v_and_b32 v27, 0xffff0000, v13
    v_lshlrev_b32 v28, 16, v14
    v_and_b32 v29, 0xffff0000, v14
    v_lshlrev_b32 v30, 16, v15
    v_and_b32 v31, 0xffff0000, v15
    v_add_f32 v32, v24, v25
    v_add_f32 v32, v32, v26
    v_add_f32 v32, v32, v27
    v_add_f32 v32, v32, v28
    v_add_f32 v32, v32, v29
    v_add_f32 v32, v32, v30
    v_add_f32 v32, v32, v31
    s_nop 1
    v_add_f32_dpp v32, v32, v32 quad_perm:[1,0,3,2] row_mask:0xf bank_mask:0xf
    s_nop 1
    v_add_f32_dpp v32, v32, v32 quad_perm:[2,3,0,1] row_mask:0xf bank_mask:0xf
    s_nop 1
    v_add_f32_dpp v32, v32, v32 row_half_mirror row_mask:0xf bank_mask:0xf
    s_nop 1
    v_add_f32_dpp v32, v32, v32 row_mirror row_mask:0xf bank_mask:0xf
    v_mov_b32 v33, v32
    s_nop 1
    v_permlane16_swap_b32 v33, v32
    s_nop 1
    v_add_f32 v32, v32, v33
    v_mov_b32 v33, v32
    s_nop 1
    v_permlane32_swap_b32 v33, v32
    s_nop 1
    v_add_f32 v32, v32, v33
    v_mul_f32 v32, 0.002232142857142857, v32
    v_sub_f32 v24, v24, v32
    v_sub_f32 v25, v25, v32
    v_sub_f32 v26, v26, v32
    v_sub_f32 v27, v27, v32
    v_sub_f32 v28, v28, v32
    v_sub_f32 v29, v29, v32
    v_sub_f32 v30, v30, v32
    v_sub_f32 v31, v31, v32
    v_mul_f32 v34, v24, v24
    v_fma_f32 v34, v25, v25, v34
    v_fma_f32 v34, v26, v26, v34
    v_fma_f32 v34, v27, v27, v34
    v_fma_f32 v34, v28, v28, v34
    v_fma_f32 v34, v29, v29, v34
    v_fma_f32 v34, v30, v30, v34
    v_fma_f32 v34, v31, v31, v34
    v_cndmask_b32 v34, 0, v34, vcc
    s_nop 1
    v_add_f32_dpp v34, v34, v34 quad_perm:[1,0,3,2] row_mask:0xf bank_mask:0xf
    s_nop 1
    v_add_f32_dpp v34, v34, v34 quad_perm:[2,3,0,1] row_mask:0xf bank_mask:0xf
    s_nop 1
    v_add_f32_dpp v34, v34, v34 row_half_mirror row_mask:0xf bank_mask:0xf
    s_nop 1
    v_add_f32_dpp v34, v34, v34 row_mirror row_mask:0xf bank_mask:0xf
    v_mov_b32 v33, v34
    s_nop 1
    v_permlane16_swap_b32 v33, v34
    s_nop 1
    v_add_f32 v34, v34, v33
    v_mov_b32 v33, v34
    s_nop 1
    v_permlane32_swap_b32 v33, v34
    s_nop 1
    v_add_f32 v34, v34, v33
    v_mov_b32 v35, 1e-05
    v_fmac_f32 v35, 0.002232142857142857, v34
    v_rsq_f32 v35, v35
    s_nop 0
    v_mul_f32 v24, v24, v35
    v_mul_f32 v25, v25, v35
    v_mul_f32 v26, v26, v35
    v_mul_f32 v27, v27, v35
    v_mul_f32 v28, v28, v35
    v_mul_f32 v29, v29, v35
    v_mul_f32 v30, v30, v35
    v_mul_f32 v31, v31, v35
    v_cvt_pk_bf16_f32 v12, v24, v25
    v_cvt_pk_bf16_f32 v13, v26, v27
    v_cvt_pk_bf16_f32 v14, v28, v29
    v_cvt_pk_bf16_f32 v15, v30, v31
    buffer_store_dwordx4 v[12:15], v3, s[4:7], 0 offen offset:896
    s_waitcnt vmcnt(1)
    v_lshlrev_b32 v24, 16, v16
    v_and_b32 v25, 0xffff0000, v16
    v_lshlrev_b32 v26, 16, v17
    v_and_b32 v27, 0xffff0000, v17
    v_lshlrev_b32 v28, 16, v18
    v_and_b32 v29, 0xffff0000, v18
    v_lshlrev_b32 v30, 16, v19
    v_and_b32 v31, 0xffff0000, v19
    v_add_f32 v32, v24, v25
    v_add_f32 v32, v32, v26
    v_add_f32 v32, v32, v27
    v_add_f32 v32, v32, v28
    v_add_f32 v32, v32, v29
    v_add_f32 v32, v32, v30
    v_add_f32 v32, v32, v31
    s_nop 1
    v_add_f32_dpp v32, v32, v32 quad_perm:[1,0,3,2] row_mask:0xf bank_mask:0xf
    s_nop 1
    v_add_f32_dpp v32, v32, v32 quad_perm:[2,3,0,1] row_mask:0xf bank_mask:0xf
    s_nop 1
    v_add_f32_dpp v32, v32, v32 row_half_mirror row_mask:0xf bank_mask:0xf
    s_nop 1
    v_add_f32_dpp v32, v32, v32 row_mirror row_mask:0xf bank_mask:0xf
    v_mov_b32 v33, v32
    s_nop 1
    v_permlane16_swap_b32 v33, v32
    s_nop 1
    v_add_f32 v32, v32, v33
    v_mov_b32 v33, v32
    s_nop 1
    v_permlane32_swap_b32 v33, v32
    s_nop 1
    v_add_f32 v32, v32, v33
    v_mul_f32 v32, 0.002232142857142857, v32
    v_sub_f32 v24, v24, v32
    v_sub_f32 v25, v25, v32
    v_sub_f32 v26, v26, v32
    v_sub_f32 v27, v27, v32
    v_sub_f32 v28, v28, v32
    v_sub_f32 v29, v29, v32
    v_sub_f32 v30, v30, v32
    v_sub_f32 v31, v31, v32
    v_mul_f32 v34, v24, v24
    v_fma_f32 v34, v25, v25, v34
    v_fma_f32 v34, v26, v26, v34
    v_fma_f32 v34, v27, v27, v34
    v_fma_f32 v34, v28, v28, v34
    v_fma_f32 v34, v29, v29, v34
    v_fma_f32 v34, v30, v30, v34
    v_fma_f32 v34, v31, v31, v34
    v_cndmask_b32 v34, 0, v34, vcc
    s_nop 1
    v_add_f32_dpp v34, v34, v34 quad_perm:[1,0,3,2] row_mask:0xf bank_mask:0xf
    s_nop 1
    v_add_f32_dpp v34, v34, v34 quad_perm:[2,3,0,1] row_mask:0xf bank_mask:0xf
    s_nop 1
    v_add_f32_dpp v34, v34, v34 row_half_mirror row_mask:0xf bank_mask:0xf
    s_nop 1
    v_add_f32_dpp v34, v34, v34 row_mirror row_mask:0xf bank_mask:0xf
    v_mov_b32 v33, v34
    s_nop 1
    v_permlane16_swap_b32 v33, v34
    s_nop 1
    v_add_f32 v34, v34, v33
    v_mov_b32 v33, v34
    s_nop 1
    v_permlane32_swap_b32 v33, v34
    s_nop 1
    v_add_f32 v34, v34, v33
    v_mov_b32 v35, 1e-05
    v_fmac_f32 v35, 0.002232142857142857, v34
    v_rsq_f32 v35, v35
    s_nop 0
    v_mul_f32 v24, v24, v35
    v_mul_f32 v25, v25, v35
    v_mul_f32 v26, v26, v35
    v_mul_f32 v27, v27, v35
    v_mul_f32 v28, v28, v35
    v_mul_f32 v29, v29, v35
    v_mul_f32 v30, v30, v35
    v_mul_f32 v31, v31, v35
    v_cvt_pk_bf16_f32 v16, v24, v25
    v_cvt_pk_bf16_f32 v17, v26, v27
    v_cvt_pk_bf16_f32 v18, v28, v29
    v_cvt_pk_bf16_f32 v19, v30, v31
    buffer_store_dwordx4 v[16:19], v3, s[4:7], 0 offen offset:1792
    s_waitcnt vmcnt(0)
    v_lshlrev_b32 v24, 16, v20
    v_and_b32 v25, 0xffff0000, v20
    v_lshlrev_b32 v26, 16, v21
    v_and_b32 v27, 0xffff0000, v21
    v_lshlrev_b32 v28, 16, v22
    v_and_b32 v29, 0xffff0000, v22
    v_lshlrev_b32 v30, 16, v23
    v_and_b32 v31, 0xffff0000, v23
    v_add_f32 v32, v24, v25
    v_add_f32 v32, v32, v26
    v_add_f32 v32, v32, v27
    v_add_f32 v32, v32, v28
    v_add_f32 v32, v32, v29
    v_add_f32 v32, v32, v30
    v_add_f32 v32, v32, v31
    s_nop 1
    v_add_f32_dpp v32, v32, v32 quad_perm:[1,0,3,2] row_mask:0xf bank_mask:0xf
    s_nop 1
    v_add_f32_dpp v32, v32, v32 quad_perm:[2,3,0,1] row_mask:0xf bank_mask:0xf
    s_nop 1
    v_add_f32_dpp v32, v32, v32 row_half_mirror row_mask:0xf bank_mask:0xf
    s_nop 1
    v_add_f32_dpp v32, v32, v32 row_mirror row_mask:0xf bank_mask:0xf
    v_mov_b32 v33, v32
    s_nop 1
    v_permlane16_swap_b32 v33, v32
    s_nop 1
    v_add_f32 v32, v32, v33
    v_mov_b32 v33, v32
    s_nop 1
    v_permlane32_swap_b32 v33, v32
    s_nop 1
    v_add_f32 v32, v32, v33
    v_mul_f32 v32, 0.002232142857142857, v32
    v_sub_f32 v24, v24, v32
    v_sub_f32 v25, v25, v32
    v_sub_f32 v26, v26, v32
    v_sub_f32 v27, v27, v32
    v_sub_f32 v28, v28, v32
    v_sub_f32 v29, v29, v32
    v_sub_f32 v30, v30, v32
    v_sub_f32 v31, v31, v32
    v_mul_f32 v34, v24, v24
    v_fma_f32 v34, v25, v25, v34
    v_fma_f32 v34, v26, v26, v34
    v_fma_f32 v34, v27, v27, v34
    v_fma_f32 v34, v28, v28, v34
    v_fma_f32 v34, v29, v29, v34
    v_fma_f32 v34, v30, v30, v34
    v_fma_f32 v34, v31, v31, v34
    v_cndmask_b32 v34, 0, v34, vcc
    s_nop 1
    v_add_f32_dpp v34, v34, v34 quad_perm:[1,0,3,2] row_mask:0xf bank_mask:0xf
    s_nop 1
    v_add_f32_dpp v34, v34, v34 quad_perm:[2,3,0,1] row_mask:0xf bank_mask:0xf
    s_nop 1
    v_add_f32_dpp v34, v34, v34 row_half_mirror row_mask:0xf bank_mask:0xf
    s_nop 1
    v_add_f32_dpp v34, v34, v34 row_mirror row_mask:0xf bank_mask:0xf
    v_mov_b32 v33, v34
    s_nop 1
    v_permlane16_swap_b32 v33, v34
    s_nop 1
    v_add_f32 v34, v34, v33
    v_mov_b32 v33, v34
    s_nop 1
    v_permlane32_swap_b32 v33, v34
    s_nop 1
    v_add_f32 v34, v34, v33
    v_mov_b32 v35, 1e-05
    v_fmac_f32 v35, 0.002232142857142857, v34
    v_rsq_f32 v35, v35
    s_nop 0
    v_mul_f32 v24, v24, v35
    v_mul_f32 v25, v25, v35
    v_mul_f32 v26, v26, v35
    v_mul_f32 v27, v27, v35
    v_mul_f32 v28, v28, v35
    v_mul_f32 v29, v29, v35
    v_mul_f32 v30, v30, v35
    v_mul_f32 v31, v31, v35
    v_cvt_pk_bf16_f32 v20, v24, v25
    v_cvt_pk_bf16_f32 v21, v26, v27
    v_cvt_pk_bf16_f32 v22, v28, v29
    v_cvt_pk_bf16_f32 v23, v30, v31
    buffer_store_dwordx4 v[20:23], v3, s[4:7], 0 offen offset:2688
    v_mov_b32 v8, -1
    v_mov_b32 v9, -1
    v_mov_b32 v10, -1
    v_mov_b32 v11, -1
    s_add_u32 s40, s19, 0
    s_cmp_ge_u32 s40, 272
    s_cbranch_scc1 prep2_kernel_fl1
    s_mov_b32 s41, 26221568
    s_mov_b32 s42, 26804224
    s_cmp_ge_u32 s40, 112
    s_cselect_b32 s41, s42, s41
    s_lshl_b32 s40, s40, 12
    v_lshl_add_u32 v3, v0, 4, s40
    buffer_store_dwordx4 v[8:11], v3, s[4:7], s41 offen
prep2_kernel_fl1:
    s_add_u32 s40, s19, 128
    s_cmp_ge_u32 s40, 272
    s_cbranch_scc1 prep2_kernel_fl2
    s_mov_b32 s41, 26221568
    s_mov_b32 s42, 26804224
    s_cmp_ge_u32 s40, 112
    s_cselect_b32 s41, s42, s41
    s_lshl_b32 s40, s40, 12
    v_lshl_add_u32 v3, v0, 4, s40
    buffer_store_dwordx4 v[8:11], v3, s[4:7], s41 offen
prep2_kernel_fl2:
    s_add_u32 s40, s19, 256
    s_cmp_ge_u32 s40, 272
    s_cbranch_scc1 prep2_kernel_fl3
    s_mov_b32 s41, 26221568
    s_mov_b32 s42, 26804224
    s_cmp_ge_u32 s40, 112
    s_cselect_b32 s41, s42, s41
    s_lshl_b32 s40, s40, 12
    v_lshl_add_u32 v3, v0, 4, s40
    buffer_store_dwordx4 v[8:11], v3, s[4:7], s41 offen
prep2_kernel_fl3:
    s_cmp_lg_u32 s19, 0
    s_cbranch_scc1 prep2_kernel_mc4
    v_lshlrev_b32 v3, 4, v0
    v_add_u32 v4, 4096, v3
    buffer_load_dwordx4 v[8:11], v3, s[88:91], 0 offen
    buffer_load_dwordx4 v[12:15], v4, s[88:91], 0 offen
    s_mov_b32 s41, 26214400
    s_mov_b32 s42, 36175872
    v_cmp_gt_u32 vcc, 192, v0
    s_waitcnt vmcnt(0)
    v_min_u32 v8, 0xfffffffe, v8
    v_min_u32 v9, 0xfffffffe, v9
    v_min_u32 v10, 0xfffffffe, v10
    v_min_u32 v11, 0xfffffffe, v11
    v_min_u32 v12, 0xfffffffe, v12
    v_min_u32 v13, 0xfffffffe, v13
    v_min_u32 v14, 0xfffffffe, v14
    v_min_u32 v15, 0xfffffffe, v15
    buffer_store_dwordx4 v[8:11], v3, s[4:7], s41 offen
    buffer_store_dwordx4 v[8:11], v3, s[4:7], s42 offen
    s_and_saveexec_b64 s[44:45], vcc
    s_cbranch_execz prep2_kernel_mc4_x
    buffer_store_dwordx4 v[12:15], v4, s[4:7], s41 offen
    buffer_store_dwordx4 v[12:15], v4, s[4:7], s42 offen
prep2_kernel_mc4_x:
    s_mov_b64 exec, -1
prep2_kernel_mc4:
    s_endpgm
prep2_kernel_gemm:
    s_lshr_b32 s21, s2, 2
    s_and_b32 s22, s2, 1
    s_bfe_u32 s23, s2, 0x10001
    s_and_b32 s37, s21, 15
    s_lshl_b32 s38, s37, 9
    s_mul_i32 s24, s22, 1835008
    s_add_u32 s24, s24, s38
    s_cmp_lt_u32 s21, 16
    s_cbranch_scc0 prep2_kernel_bpart
    s_mul_i32 s25, s23, 1835008
    s_add_u32 s25, s25, s38
    s_mov_b32 s40, 0x3d800000
    v_lshrrev_b32 v6, 3, v1
    v_and_b32 v5, 7, v1
    v_xor_b32 v5, v5, v6
    v_lshl_add_u32 v6, v2, 3, v6
    v_mul_u32_u24 v16, 8192, v6
    v_lshl_add_u32 v16, v5, 4, v16
    v_mul_u32_u24 v17, 8192, v6
    v_lshl_add_u32 v17, v5, 4, v17
    s_add_u32 s60, s24, 0
    s_add_u32 s61, s24, 262144
    s_add_u32 s62, s24, 524288
    s_add_u32 s63, s24, 786432
    s_add_u32 s64, s24, 1048576
    s_add_u32 s65, s24, 1310720
    s_add_u32 s66, s24, 1572864
    s_add_u32 s67, s25, 0
    s_add_u32 s68, s25, 262144
    s_add_u32 s69, s25, 524288
    s_add_u32 s70, s25, 786432
    s_add_u32 s71, s25, 1048576
    s_add_u32 s72, s25, 1310720
    s_add_u32 s73, s25, 1572864
    s_lshl_b32 s74, s14, 10
    v_and_b32 v7, 7, v3
    v_xor_b32 v7, v7, v4
    v_lshlrev_b32 v7, 4, v7
    v_lshl_add_u32 v7, v3, 7, v7
    v_lshrrev_b32 v8, 1, v2
    v_and_b32 v9, 1, v2
    v_mul_u32_u24 v10, 14336, v8
    v_mul_u32_u24 v11, 14336, v9
    v_add_u32 v10, v10, v7
    v_add_u32 v11, v11, v7
    v_add_u32 v11, 28672, v11
    v_mov_b32 v18, v10
    v_xor_b32 v20, 64, v10
    v_add_u32 v19, 57344, v18
    v_add_u32 v21, 57344, v20
    v_mov_b32 v22, v11
    v_xor_b32 v24, 64, v11
    v_add_u32 v23, 57344, v22
    v_add_u32 v25, 57344, v24
    s_add_u32 m0, s74, 0
    s_nop 0
    buffer_load_dwordx4 v16, s[8:11], s60 offen  lds
    s_add_u32 s60, s60, 128
    s_add_u32 m0, s74, 4096
    s_nop 0
    buffer_load_dwordx4 v16, s[8:11], s61 offen  lds
    s_add_u32 s61, s61, 128
    s_add_u32 m0, s74, 8192
    s_nop 0
    buffer_load_dwordx4 v16, s[8:11], s62 offen  lds
    s_add_u32 s62, s62, 128
    s_add_u32 m0, s74, 12288
    s_nop 0
    buffer_load_dwordx4 v16, s[8:11], s63 offen  lds
    s_add_u32 s63, s63, 128
    s_add_u32 m0, s74, 16384
    s_nop 0
    buffer_load_dwordx4 v16, s[8:11], s64 offen  lds
    s_add_u32 s64, s64, 128
    s_add_u32 m0, s74, 20480
    s_nop 0
    buffer_load_dwordx4 v16, s[8:11], s65 offen  lds
    s_add_u32 s65, s65, 128
    s_add_u32 m0, s74, 24576
    s_nop 0
    buffer_load_dwordx4 v16, s[8:11], s66 offen  lds
    s_add_u32 s66, s66, 128
    s_add_u32 m0, s74, 28672
    s_nop 0
    buffer_load_dwordx4 v17, s[92:95], s67 offen  lds
    s_add_u32 s67, s67, 128
    s_add_u32 m0, s74, 32768
    s_nop 0
    buffer_load_dwordx4 v17, s[92:95], s68 offen  lds
    s_add_u32 s68, s68, 128
    s_add_u32 m0, s74, 36864
    s_nop 0
    buffer_load_dwordx4 v17, s[92:95], s69 offen  lds
    s_add_u32 s69, s69, 128
    s_add_u32 m0, s74, 40960
    s_nop 0
    buffer_load_dwordx4 v17, s[92:95], s70 offen  lds
    s_add_u32 s70, s70, 128
    s_add_u32 m0, s74, 45056
    s_nop 0
    buffer_load_dwordx4 v17, s[92:95], s71 offen  lds
    s_add_u32 s71, s71, 128
    s_add_u32 m0, s74, 49152
    s_nop 0
    buffer_load_dwordx4 v17, s[92:95], s72 offen  lds
    s_add_u32 s72, s72, 128
    s_add_u32 m0, s74, 53248
    s_nop 0
    buffer_load_dwordx4 v17, s[92:95], s73 offen  lds
    s_add_u32 s73, s73, 128
    s_add_u32 m0, s74, 57344
    s_nop 0
    buffer_load_dwordx4 v16, s[8:11], s60 offen  lds
    s_add_u32 s60, s60, 128
    s_add_u32 m0, s74, 61440
    s_nop 0
    buffer_load_dwordx4 v16, s[8:11], s61 offen  lds
    s_add_u32 s61, s61, 128
    s_add_u32 m0, s74, 65536
    s_nop 0
    buffer_load_dwordx4 v16, s[8:11], s62 offen  lds
    s_add_u32 s62, s62, 128
    s_add_u32 m0, s74, 69632
    s_nop 0
    buffer_load_dwordx4 v16, s[8:11], s63 offen  lds
    s_add_u32 s63, s63, 128
    s_add_u32 m0, s74, 73728
    s_nop 0
    buffer_load_dwordx4 v16, s[8:11], s64 offen  lds
    s_add_u32 s64, s64, 128
    s_add_u32 m0, s74, 77824
    s_nop 0
    buffer_load_dwordx4 v16, s[8:11], s65 offen  lds
    s_add_u32 s65, s65, 128
    s_add_u32 m0, s74, 81920
    s_nop 0
    buffer_load_dwordx4 v16, s[8:11], s66 offen  lds
    s_add_u32 s66, s66, 128
    s_add_u32 m0, s74, 86016
    s_nop 0
    buffer_load_dwordx4 v17, s[92:95], s67 offen  lds
    s_add_u32 s67, s67, 128
    s_add_u32 m0, s74, 90112
    s_nop 0
    buffer_load_dwordx4 v17, s[92:95], s68 offen  lds
    s_add_u32 s68, s68, 128
    s_add_u32 m0, s74, 94208
    s_nop 0
    buffer_load_dwordx4 v17, s[92:95], s69 offen  lds
    s_add_u32 s69, s69, 128
    s_add_u32 m0, s74, 98304
    s_nop 0
    buffer_load_dwordx4 v17, s[92:95], s70 offen  lds
    s_add_u32 s70, s70, 128
    s_add_u32 m0, s74, 102400
    s_nop 0
    buffer_load_dwordx4 v17, s[92:95], s71 offen  lds
    s_add_u32 s71, s71, 128
    s_add_u32 m0, s74, 106496
    s_nop 0
    buffer_load_dwordx4 v17, s[92:95], s72 offen  lds
    s_add_u32 s72, s72, 128
    s_add_u32 m0, s74, 110592
    s_nop 0
    buffer_load_dwordx4 v17, s[92:95], s73 offen  lds
    s_add_u32 s73, s73, 128
    s_waitcnt vmcnt(14)
    s_barrier
    ds_read_b128 v[56:59], v22 offset:0
    ds_read_b128 v[60:63], v22 offset:2048
    ds_read_b128 v[64:67], v22 offset:4096
    ds_read_b128 v[68:71], v22 offset:6144
    ds_read_b128 v[72:75], v22 offset:8192
    ds_read_b128 v[76:79], v22 offset:10240
    ds_read_b128 v[80:83], v22 offset:12288
    ds_read_b128 v[28:31], v18 offset:0
    ds_read_b128 v[32:35], v18 offset:2048
    ds_read_b128 v[36:39], v18 offset:4096
    ds_read_b128 v[40:43], v18 offset:6144
    ds_read_b128 v[44:47], v18 offset:8192
    ds_read_b128 v[48:51], v18 offset:10240
    ds_read_b128 v[52:55], v18 offset:12288
    s_waitcnt lgkmcnt(0)
    v_mfma_f32_16x16x32_bf16 a[0:3], v[28:31], v[56:59], 0
    v_mfma_f32_16x16x32_bf16 a[4:7], v[28:31], v[60:63], 0
    v_mfma_f32_16x16x32_bf16 a[8:11], v[28:31], v[64:67], 0
    v_mfma_f32_16x16x32_bf16 a[12:15], v[28:31], v[68:71], 0
    ds_read_b128 v[112:115], v24 offset:0
    v_mfma_f32_16x16x32_bf16 a[16:19], v[28:31], v[72:75], 0
    v_mfma_f32_16x16x32_bf16 a[20:23], v[28:31], v[76:79], 0
    v_mfma_f32_16x16x32_bf16 a[24:27], v[28:31], v[80:83], 0
    ds_read_b128 v[116:119], v24 offset:2048
    v_mfma_f32_16x16x32_bf16 a[28:31], v[32:35], v[56:59], 0
    v_mfma_f32_16x16x32_bf16 a[32:35], v[32:35], v[60:63], 0
    v_mfma_f32_16x16x32_bf16 a[36:39], v[32:35], v[64:67], 0
    v_mfma_f32_16x16x32_bf16 a[40:43], v[32:35], v[68:71], 0
    ds_read_b128 v[120:123], v24 offset:4096
    v_mfma_f32_16x16x32_bf16 a[44:47], v[32:35], v[72:75], 0
    v_mfma_f32_16x16x32_bf16 a[48:51], v[32:35], v[76:79], 0
    v_mfma_f32_16x16x32_bf16 a[52:55], v[32:35], v[80:83], 0
    ds_read_b128 v[124:127], v24 offset:6144
    v_mfma_f32_16x16x32_bf16 a[56:59], v[36:39], v[56:59], 0
    v_mfma_f32_16x16x32_bf16 a[60:63], v[36:39], v[60:63], 0
    v_mfma_f32_16x16x32_bf16 a[64:67], v[36:39], v[64:67], 0
    v_mfma_f32_16x16x32_bf16 a[68:71], v[36:39], v[68:71], 0
    ds_read_b128 v[128:131], v24 offset:8192
    v_mfma_f32_16x16x32_bf16 a[72:75], v[36:39], v[72:75], 0
    v_mfma_f32_16x16x32_bf16 a[76:79], v[36:39], v[76:79], 0
    v_mfma_f32_16x16x32_bf16 a[80:83], v[36:39], v[80:83], 0
    ds_read_b128 v[132:135], v24 offset:10240
    v_mfma_f32_16x16x32_bf16 a[84:87], v[40:43], v[56:59], 0
    v_mfma_f32_16x16x32_bf16 a[88:91], v[40:43], v[60:63], 0
    v_mfma_f32_16x16x32_bf16 a[92:95], v[40:43], v[64:67], 0
    v_mfma_f32_16x16x32_bf16 a[96:99], v[40:43], v[68:71], 0
    ds_read_b128 v[136:139], v24 offset:12288
    v_mfma_f32_16x16x32_bf16 a[100:103], v[40:43], v[72:75], 0
    v_mfma_f32_16x16x32_bf16 a[104:107], v[40:43], v[76:79], 0
    v_mfma_f32_16x16x32_bf16 a[108:111], v[40:43], v[80:83], 0
    ds_read_b128 v[84:87], v20 offset:0
    v_mfma_f32_16x16x32_bf16 a[112:115], v[44:47], v[56:59], 0
    v_mfma_f32_16x16x32_bf16 a[116:119], v[44:47], v[60:63], 0
    v_mfma_f32_16x16x32_bf16 a[120:123], v[44:47], v[64:67], 0
    v_mfma_f32_16x16x32_bf16 a[124:127], v[44:47], v[68:71], 0
    ds_read_b128 v[88:91], v20 offset:2048
    v_mfma_f32_16x16x32_bf16 a[128:131], v[44:47], v[72:75], 0
    v_mfma_f32_16x16x32_bf16 a[132:135], v[44:47], v[76:79], 0
    v_mfma_f32_16x16x32_bf16 a[136:139], v[44:47], v[80:83], 0
    ds_read_b128 v[92:95], v20 offset:4096
    v_mfma_f32_16x16x32_bf16 a[140:143], v[48:51], v[56:59], 0
    v_mfma_f32_16x16x32_bf16 a[144:147], v[48:51], v[60:63], 0
    v_mfma_f32_16x16x32_bf16 a[148:151], v[48:51], v[64:67], 0
    v_mfma_f32_16x16x32_bf16 a[152:155], v[48:51], v[68:71], 0
    ds_read_b128 v[96:99], v20 offset:6144
    v_mfma_f32_16x16x32_bf16 a[156:159], v[48:51], v[72:75], 0
    v_mfma_f32_16x16x32_bf16 a[160:163], v[48:51], v[76:79], 0
    v_mfma_f32_16x16x32_bf16 a[164:167], v[48:51], v[80:83], 0
    ds_read_b128 v[100:103], v20 offset:8192
    v_mfma_f32_16x16x32_bf16 a[168:171], v[52:55], v[56:59], 0
    v_mfma_f32_16x16x32_bf16 a[172:175], v[52:55], v[60:63], 0
    v_mfma_f32_16x16x32_bf16 a[176:179], v[52:55], v[64:67], 0
    v_mfma_f32_16x16x32_bf16 a[180:183], v[52:55], v[68:71], 0
    ds_read_b128 v[104:107], v20 offset:10240
    v_mfma_f32_16x16x32_bf16 a[184:187], v[52:55], v[72:75], 0
    v_mfma_f32_16x16x32_bf16 a[188:191], v[52:55], v[76:79], 0
    v_mfma_f32_16x16x32_bf16 a[192:195], v[52:55], v[80:83], 0
    ds_read_b128 v[108:111], v20 offset:12288
    s_waitcnt lgkmcnt(0) vmcnt(0)
    s_barrier
    v_mfma_f32_16x16x32_bf16 a[0:3], v[84:87], v[112:115], a[0:3]
    v_mfma_f32_16x16x32_bf16 a[4:7], v[84:87], v[116:119], a[4:7]
    ds_read_b128 v[56:59], v23 offset:0
    v_mfma_f32_16x16x32_bf16 a[8:11], v[84:87], v[120:123], a[8:11]
    v_mfma_f32_16x16x32_bf16 a[12:15], v[84:87], v[124:127], a[12:15]
    s_add_u32 m0, s74, 0
    s_nop 0
    buffer_load_dwordx4 v16, s[8:11], s60 offen  lds
    s_add_u32 s60, s60, 128
    v_mfma_f32_16x16x32_bf16 a[16:19], v[84:87], v[128:131], a[16:19]
    v_mfma_f32_16x16x32_bf16 a[20:23], v[84:87], v[132:135], a[20:23]
    ds_read_b128 v[60:63], v23 offset:2048
    v_mfma_f32_16x16x32_bf16 a[24:27], v[84:87], v[136:139], a[24:27]
    s_add_u32 m0, s74, 4096
    s_nop 0
    buffer_load_dwordx4 v16, s[8:11], s61 offen  lds
    s_add_u32 s61, s61, 128
    v_mfma_f32_16x16x32_bf16 a[28:31], v[88:91], v[112:115], a[28:31]
    v_mfma_f32_16x16x32_bf16 a[32:35], v[88:91], v[116:119], a[32:35]
    ds_read_b128 v[64:67], v23 offset:4096
    v_mfma_f32_16x16x32_bf16 a[36:39], v[88:91], v[120:123], a[36:39]
    v_mfma_f32_16x16x32_bf16 a[40:43], v[88:91], v[124:127], a[40:43]
    s_add_u32 m0, s74, 8192
    s_nop 0
    buffer_load_dwordx4 v16, s[8:11], s62 offen  lds
    s_add_u32 s62, s62, 128
    v_mfma_f32_16x16x32_bf16 a[44:47], v[88:91], v[128:131], a[44:47]
    v_mfma_f32_16x16x32_bf16 a[48:51], v[88:91], v[132:135], a[48:51]
    ds_read_b128 v[68:71], v23 offset:6144
    v_mfma_f32_16x16x32_bf16 a[52:55], v[88:91], v[136:139], a[52:55]
    s_add_u32 m0, s74, 12288
    s_nop 0
    buffer_load_dwordx4 v16, s[8:11], s63 offen  lds
    s_add_u32 s63, s63, 128
    v_mfma_f32_16x16x32_bf16 a[56:59], v[92:95], v[112:115], a[56:59]
    v_mfma_f32_16x16x32_bf16 a[60:63], v[92:95], v[116:119], a[60:63]
    ds_read_b128 v[72:75], v23 offset:8192
    v_mfma_f32_16x16x32_bf16 a[64:67], v[92:95], v[120:123], a[64:67]
    v_mfma_f32_16x16x32_bf16 a[68:71], v[92:95], v[124:127], a[68:71]
    s_add_u32 m0, s74, 16384
    s_nop 0
    buffer_load_dwordx4 v16, s[8:11], s64 offen  lds
    s_add_u32 s64, s64, 128
    v_mfma_f32_16x16x32_bf16 a[72:75], v[92:95], v[128:131], a[72:75]
    v_mfma_f32_16x16x32_bf16 a[76:79], v[92:95], v[132:135], a[76:79]
    ds_read_b128 v[76:79], v23 offset:10240
    v_mfma_f32_16x16x32_bf16 a[80:83], v[92:95], v[136:139], a[80:83]
    s_add_u32 m0, s74, 20480
    s_nop 0
    buffer_load_dwordx4 v16, s[8:11], s65 offen  lds
    s_add_u32 s65, s65, 128
    v_mfma_f32_16x16x32_bf16 a[84:87], v[96:99], v[112:115], a[84:87]
    v_mfma_f32_16x16x32_bf16 a[88:91], v[96:99], v[116:119], a[88:91]
    ds_read_b128 v[80:83], v23 offset:12288
    v_mfma_f32_16x16x32_bf16 a[92:95], v[96:99], v[120:123], a[92:95]
    v_mfma_f32_16x16x32_bf16 a[96:99], v[96:99], v[124:127], a[96:99]
    s_add_u32 m0, s74, 24576
    s_nop 0
    buffer_load_dwordx4 v16, s[8:11], s66 offen  lds
    s_add_u32 s66, s66, 128
    v_mfma_f32_16x16x32_bf16 a[100:103], v[96:99], v[128:131], a[100:103]
    v_mfma_f32_16x16x32_bf16 a[104:107], v[96:99], v[132:135], a[104:107]
    ds_read_b128 v[28:31], v19 offset:0
    v_mfma_f32_16x16x32_bf16 a[108:111], v[96:99], v[136:139], a[108:111]
    s_add_u32 m0, s74, 28672
    s_nop 0
    buffer_load_dwordx4 v17, s[92:95], s67 offen  lds
    s_add_u32 s67, s67, 128
    v_mfma_f32_16x16x32_bf16 a[112:115], v[100:103], v[112:115], a[112:115]
    v_mfma_f32_16x16x32_bf16 a[116:119], v[100:103], v[116:119], a[116:119]
    ds_read_b128 v[32:35], v19 offset:2048
    v_mfma_f32_16x16x32_bf16 a[120:123], v[100:103], v[120:123], a[120:123]
    v_mfma_f32_16x16x32_bf16 a[124:127], v[100:103], v[124:127], a[124:127]
    s_add_u32 m0, s74, 32768
    s_nop 0
    buffer_load_dwordx4 v17, s[92:95], s68 offen  lds
    s_add_u32 s68, s68, 128
    v_mfma_f32_16x16x32_bf16 a[128:131], v[100:103], v[128:131], a[128:131]
    v_mfma_f32_16x16x32_bf16 a[132:135], v[100:103], v[132:135], a[132:135]
    ds_read_b128 v[36:39], v19 offset:4096
    v_mfma_f32_16x16x32_bf16 a[136:139], v[100:103], v[136:139], a[136:139]
    s_add_u32 m0, s74, 36864
    s_nop 0
    buffer_load_dwordx4 v17, s[92:95], s69 offen  lds
    s_add_u32 s69, s69, 128
    v_mfma_f32_16x16x32_bf16 a[140:143], v[104:107], v[112:115], a[140:143]
    v_mfma_f32_16x16x32_bf16 a[144:147], v[104:107], v[116:119], a[144:147]
    ds_read_b128 v[40:43], v19 offset:6144
    v_mfma_f32_16x16x32_bf16 a[148:151], v[104:107], v[120:123], a[148:151]
    v_mfma_f32_16x16x32_bf16 a[152:155], v[104:107], v[124:127], a[152:155]
    s_add_u32 m0, s74, 40960
    s_nop 0
    buffer_load_dwordx4 v17, s[92:95], s70 offen  lds
    s_add_u32 s70, s70, 128
    v_mfma_f32_16x16x32_bf16 a[156:159], v[104:107], v[128:131], a[156:159]
    v_mfma_f32_16x16x32_bf16 a[160:163], v[104:107], v[132:135], a[160:163]
    ds_read_b128 v[44:47], v19 offset:8192
    v_mfma_f32_16x16x32_bf16 a[164:167], v[104:107], v[136:139], a[164:167]
    s_add_u32 m0, s74, 45056
    s_nop 0
    buffer_load_dwordx4 v17, s[92:95], s71 offen  lds
    s_add_u32 s71, s71, 128
    v_mfma_f32_16x16x32_bf16 a[168:171], v[108:111], v[112:115], a[168:171]
    v_mfma_f32_16x16x32_bf16 a[172:175], v[108:111], v[116:119], a[172:175]
    ds_read_b128 v[48:51], v19 offset:10240
    v_mfma_f32_16x16x32_bf16 a[176:179], v[108:111], v[120:123], a[176:179]
    v_mfma_f32_16x16x32_bf16 a[180:183], v[108:111], v[124:127], a[180:183]
    s_add_u32 m0, s74, 49152
    s_nop 0
    buffer_load_dwordx4 v17, s[92:95], s72 offen  lds
    s_add_u32 s72, s72, 128
    v_mfma_f32_16x16x32_bf16 a[184:187], v[108:111], v[128:131], a[184:187]
    v_mfma_f32_16x16x32_bf16 a[188:191], v[108:111], v[132:135], a[188:191]
    ds_read_b128 v[52:55], v19 offset:12288
    v_mfma_f32_16x16x32_bf16 a[192:195], v[108:111], v[136:139], a[192:195]
    s_add_u32 m0, s74, 53248
    s_nop 0
    buffer_load_dwordx4 v17, s[92:95], s73 offen  lds
    s_add_u32 s73, s73, 128
    s_waitcnt lgkmcnt(0)
    v_mfma_f32_16x16x32_bf16 a[0:3], v[28:31], v[56:59], a[0:3]
    v_mfma_f32_16x16x32_bf16 a[4:7], v[28:31], v[60:63], a[4:7]
    v_mfma_f32_16x16x32_bf16 a[8:11], v[28:31], v[64:67], a[8:11]
    v_mfma_f32_16x16x32_bf16 a[12:15], v[28:31], v[68:71], a[12:15]
    ds_read_b128 v[112:115], v25 offset:0
    v_mfma_f32_16x16x32_bf16 a[16:19], v[28:31], v[72:75], a[16:19]
    v_mfma_f32_16x16x32_bf16 a[20:23], v[28:31], v[76:79], a[20:23]
    v_mfma_f32_16x16x32_bf16 a[24:27], v[28:31], v[80:83], a[24:27]
    ds_read_b128 v[116:119], v25 offset:2048
    v_mfma_f32_16x16x32_bf16 a[28:31], v[32:35], v[56:59], a[28:31]
    v_mfma_f32_16x16x32_bf16 a[32:35], v[32:35], v[60:63], a[32:35]
    v_mfma_f32_16x16x32_bf16 a[36:39], v[32:35], v[64:67], a[36:39]
    v_mfma_f32_16x16x32_bf16 a[40:43], v[32:35], v[68:71], a[40:43]
    ds_read_b128 v[120:123], v25 offset:4096
    v_mfma_f32_16x16x32_bf16 a[44:47], v[32:35], v[72:75], a[44:47]
    v_mfma_f32_16x16x32_bf16 a[48:51], v[32:35], v[76:79], a[48:51]
    v_mfma_f32_16x16x32_bf16 a[52:55], v[32:35], v[80:83], a[52:55]
    ds_read_b128 v[124:127], v25 offset:6144
    v_mfma_f32_16x16x32_bf16 a[56:59], v[36:39], v[56:59], a[56:59]
    v_mfma_f32_16x16x32_bf16 a[60:63], v[36:39], v[60:63], a[60:63]
    v_mfma_f32_16x16x32_bf16 a[64:67], v[36:39], v[64:67], a[64:67]
    v_mfma_f32_16x16x32_bf16 a[68:71], v[36:39], v[68:71], a[68:71]
    ds_read_b128 v[128:131], v25 offset:8192
    v_mfma_f32_16x16x32_bf16 a[72:75], v[36:39], v[72:75], a[72:75]
    v_mfma_f32_16x16x32_bf16 a[76:79], v[36:39], v[76:79], a[76:79]
    v_mfma_f32_16x16x32_bf16 a[80:83], v[36:39], v[80:83], a[80:83]
    ds_read_b128 v[132:135], v25 offset:10240
    v_mfma_f32_16x16x32_bf16 a[84:87], v[40:43], v[56:59], a[84:87]
    v_mfma_f32_16x16x32_bf16 a[88:91], v[40:43], v[60:63], a[88:91]
    v_mfma_f32_16x16x32_bf16 a[92:95], v[40:43], v[64:67], a[92:95]
    v_mfma_f32_16x16x32_bf16 a[96:99], v[40:43], v[68:71], a[96:99]
    ds_read_b128 v[136:139], v25 offset:12288
    v_mfma_f32_16x16x32_bf16 a[100:103], v[40:43], v[72:75], a[100:103]
    v_mfma_f32_16x16x32_bf16 a[104:107], v[40:43], v[76:79], a[104:107]
    v_mfma_f32_16x16x32_bf16 a[108:111], v[40:43], v[80:83], a[108:111]
    ds_read_b128 v[84:87], v21 offset:0
    v_mfma_f32_16x16x32_bf16 a[112:115], v[44:47], v[56:59], a[112:115]
    v_mfma_f32_16x16x32_bf16 a[116:119], v[44:47], v[60:63], a[116:119]
    v_mfma_f32_16x16x32_bf16 a[120:123], v[44:47], v[64:67], a[120:123]
    v_mfma_f32_16x16x32_bf16 a[124:127], v[44:47], v[68:71], a[124:127]
    ds_read_b128 v[88:91], v21 offset:2048
    v_mfma_f32_16x16x32_bf16 a[128:131], v[44:47], v[72:75], a[128:131]
    v_mfma_f32_16x16x32_bf16 a[132:135], v[44:47], v[76:79], a[132:135]
    v_mfma_f32_16x16x32_bf16 a[136:139], v[44:47], v[80:83], a[136:139]
    ds_read_b128 v[92:95], v21 offset:4096
    v_mfma_f32_16x16x32_bf16 a[140:143], v[48:51], v[56:59], a[140:143]
    v_mfma_f32_16x16x32_bf16 a[144:147], v[48:51], v[60:63], a[144:147]
    v_mfma_f32_16x16x32_bf16 a[148:151], v[48:51], v[64:67], a[148:151]
    v_mfma_f32_16x16x32_bf16 a[152:155], v[48:51], v[68:71], a[152:155]
    ds_read_b128 v[96:99], v21 offset:6144
    v_mfma_f32_16x16x32_bf16 a[156:159], v[48:51], v[72:75], a[156:159]
    v_mfma_f32_16x16x32_bf16 a[160:163], v[48:51], v[76:79], a[160:163]
    v_mfma_f32_16x16x32_bf16 a[164:167], v[48:51], v[80:83], a[164:167]
    ds_read_b128 v[100:103], v21 offset:8192
    v_mfma_f32_16x16x32_bf16 a[168:171], v[52:55], v[56:59], a[168:171]
    v_mfma_f32_16x16x32_bf16 a[172:175], v[52:55], v[60:63], a[172:175]
    v_mfma_f32_16x16x32_bf16 a[176:179], v[52:55], v[64:67], a[176:179]
    v_mfma_f32_16x16x32_bf16 a[180:183], v[52:55], v[68:71], a[180:183]
    ds_read_b128 v[104:107], v21 offset:10240
    v_mfma_f32_16x16x32_bf16 a[184:187], v[52:55], v[72:75], a[184:187]
    v_mfma_f32_16x16x32_bf16 a[188:191], v[52:55], v[76:79], a[188:191]
    v_mfma_f32_16x16x32_bf16 a[192:195], v[52:55], v[80:83], a[192:195]
    ds_read_b128 v[108:111], v21 offset:12288
    s_waitcnt lgkmcnt(0) vmcnt(0)
    s_barrier
    v_mfma_f32_16x16x32_bf16 a[0:3], v[84:87], v[112:115], a[0:3]
    v_mfma_f32_16x16x32_bf16 a[4:7], v[84:87], v[116:119], a[4:7]
    ds_read_b128 v[56:59], v22 offset:0
    v_mfma_f32_16x16x32_bf16 a[8:11], v[84:87], v[120:123], a[8:11]
    v_mfma_f32_16x16x32_bf16 a[12:15], v[84:87], v[124:127], a[12:15]
    s_add_u32 m0, s74, 57344
    s_nop 0
    buffer_load_dwordx4 v16, s[8:11], s60 offen  lds
    s_add_u32 s60, s60, 128
    v_mfma_f32_16x16x32_bf16 a[16:19], v[84:87], v[128:131], a[16:19]
    v_mfma_f32_16x16x32_bf16 a[20:23], v[84:87], v[132:135], a[20:23]
    ds_read_b128 v[60:63], v22 offset:2048
    v_mfma_f32_16x16x32_bf16 a[24:27], v[84:87], v[136:139], a[24:27]
    s_add_u32 m0, s74, 61440
    s_nop 0
    buffer_load_dwordx4 v16, s[8:11], s61 offen  lds
    s_add_u32 s61, s61, 128
    v_mfma_f32_16x16x32_bf16 a[28:31], v[88:91], v[112:115], a[28:31]
    v_mfma_f32_16x16x32_bf16 a[32:35], v[88:91], v[116:119], a[32:35]
    ds_read_b128 v[64:67], v22 offset:4096
    v_mfma_f32_16x16x32_bf16 a[36:39], v[88:91], v[120:123], a[36:39]
    v_mfma_f32_16x16x32_bf16 a[40:43], v[88:91], v[124:127], a[40:43]
    s_add_u32 m0, s74, 65536
    s_nop 0
    buffer_load_dwordx4 v16, s[8:11], s62 offen  lds
    s_add_u32 s62, s62, 128
    v_mfma_f32_16x16x32_bf16 a[44:47], v[88:91], v[128:131], a[44:47]
    v_mfma_f32_16x16x32_bf16 a[48:51], v[88:91], v[132:135], a[48:51]
    ds_read_b128 v[68:71], v22 offset:6144
    v_mfma_f32_16x16x32_bf16 a[52:55], v[88:91], v[136:139], a[52:55]
    s_add_u32 m0, s74, 69632
    s_nop 0
    buffer_load_dwordx4 v16, s[8:11], s63 offen  lds
    s_add_u32 s63, s63, 128
    v_mfma_f32_16x16x32_bf16 a[56:59], v[92:95], v[112:115], a[56:59]
    v_mfma_f32_16x16x32_bf16 a[60:63], v[92:95], v[116:119], a[60:63]
    ds_read_b128 v[72:75], v22 offset:8192
    v_mfma_f32_16x16x32_bf16 a[64:67], v[92:95], v[120:123], a[64:67]
    v_mfma_f32_16x16x32_bf16 a[68:71], v[92:95], v[124:127], a[68:71]
    s_add_u32 m0, s74, 73728
    s_nop 0
    buffer_load_dwordx4 v16, s[8:11], s64 offen  lds
    s_add_u32 s64, s64, 128
    v_mfma_f32_16x16x32_bf16 a[72:75], v[92:95], v[128:131], a[72:75]
    v_mfma_f32_16x16x32_bf16 a[76:79], v[92:95], v[132:135], a[76:79]
    ds_read_b128 v[76:79], v22 offset:10240
    v_mfma_f32_16x16x32_bf16 a[80:83], v[92:95], v[136:139], a[80:83]
    s_add_u32 m0, s74, 77824
    s_nop 0
    buffer_load_dwordx4 v16, s[8:11], s65 offen  lds
    s_add_u32 s65, s65, 128
    v_mfma_f32_16x16x32_bf16 a[84:87], v[96:99], v[112:115], a[84:87]
    v_mfma_f32_16x16x32_bf16 a[88:91], v[96:99], v[116:119], a[88:91]
    ds_read_b128 v[80:83], v22 offset:12288
    v_mfma_f32_16x16x32_bf16 a[92:95], v[96:99], v[120:123], a[92:95]
    v_mfma_f32_16x16x32_bf16 a[96:99], v[96:99], v[124:127], a[96:99]
    s_add_u32 m0, s74, 81920
    s_nop 0
    buffer_load_dwordx4 v16, s[8:11], s66 offen  lds
    s_add_u32 s66, s66, 128
    v_mfma_f32_16x16x32_bf16 a[100:103], v[96:99], v[128:131], a[100:103]
    v_mfma_f32_16x16x32_bf16 a[104:107], v[96:99], v[132:135], a[104:107]
    ds_read_b128 v[28:31], v18 offset:0
    v_mfma_f32_16x16x32_bf16 a[108:111], v[96:99], v[136:139], a[108:111]
    s_add_u32 m0, s74, 86016
    s_nop 0
    buffer_load_dwordx4 v17, s[92:95], s67 offen  lds
    s_add_u32 s67, s67, 128
    v_mfma_f32_16x16x32_bf16 a[112:115], v[100:103], v[112:115], a[112:115]
    v_mfma_f32_16x16x32_bf16 a[116:119], v[100:103], v[116:119], a[116:119]
    ds_read_b128 v[32:35], v18 offset:2048
    v_mfma_f32_16x16x32_bf16 a[120:123], v[100:103], v[120:123], a[120:123]
    v_mfma_f32_16x16x32_bf16 a[124:127], v[100:103], v[124:127], a[124:127]
    s_add_u32 m0, s74, 90112
    s_nop 0
    buffer_load_dwordx4 v17, s[92:95], s68 offen  lds
    s_add_u32 s68, s68, 128
    v_mfma_f32_16x16x32_bf16 a[128:131], v[100:103], v[128:131], a[128:131]
    v_mfma_f32_16x16x32_bf16 a[132:135], v[100:103], v[132:135], a[132:135]
    ds_read_b128 v[36:39], v18 offset:4096
    v_mfma_f32_16x16x32_bf16 a[136:139], v[100:103], v[136:139], a[136:139]
    s_add_u32 m0, s74, 94208
    s_nop 0
    buffer_load_dwordx4 v17, s[92:95], s69 offen  lds
    s_add_u32 s69, s69, 128
    v_mfma_f32_16x16x32_bf16 a[140:143], v[104:107], v[112:115], a[140:143]
    v_mfma_f32_16x16x32_bf16 a[144:147], v[104:107], v[116:119], a[144:147]
    ds_read_b128 v[40:43], v18 offset:6144
    v_mfma_f32_16x16x32_bf16 a[148:151], v[104:107], v[120:123], a[148:151]
    v_mfma_f32_16x16x32_bf16 a[152:155], v[104:107], v[124:127], a[152:155]
    s_add_u32 m0, s74, 98304
    s_nop 0
    buffer_load_dwordx4 v17, s[92:95], s70 offen  lds
    s_add_u32 s70, s70, 128
    v_mfma_f32_16x16x32_bf16 a[156:159], v[104:107], v[128:131], a[156:159]
    v_mfma_f32_16x16x32_bf16 a[160:163], v[104:107], v[132:135], a[160:163]
    ds_read_b128 v[44:47], v18 offset:8192
    v_mfma_f32_16x16x32_bf16 a[164:167], v[104:107], v[136:139], a[164:167]
    s_add_u32 m0, s74, 102400
    s_nop 0
    buffer_load_dwordx4 v17, s[92:95], s71 offen  lds
    s_add_u32 s71, s71, 128
    v_mfma_f32_16x16x32_bf16 a[168:171], v[108:111], v[112:115], a[168:171]
    v_mfma_f32_16x16x32_bf16 a[172:175], v[108:111], v[116:119], a[172:175]
    ds_read_b128 v[48:51], v18 offset:10240
    v_mfma_f32_16x16x32_bf16 a[176:179], v[108:111], v[120:123], a[176:179]
    v_mfma_f32_16x16x32_bf16 a[180:183], v[108:111], v[124:127], a[180:183]
    s_add_u32 m0, s74, 106496
    s_nop 0
    buffer_load_dwordx4 v17, s[92:95], s72 offen  lds
    s_add_u32 s72, s72, 128
    v_mfma_f32_16x16x32_bf16 a[184:187], v[108:111], v[128:131], a[184:187]
    v_mfma_f32_16x16x32_bf16 a[188:191], v[108:111], v[132:135], a[188:191]
    ds_read_b128 v[52:55], v18 offset:12288
    v_mfma_f32_16x16x32_bf16 a[192:195], v[108:111], v[136:139], a[192:195]
    s_add_u32 m0, s74, 110592
    s_nop 0
    buffer_load_dwordx4 v17, s[92:95], s73 offen  lds
    s_add_u32 s73, s73, 128
    s_waitcnt lgkmcnt(0)
    v_mfma_f32_16x16x32_bf16 a[0:3], v[28:31], v[56:59], a[0:3]
    v_mfma_f32_16x16x32_bf16 a[4:7], v[28:31], v[60:63], a[4:7]
    v_mfma_f32_16x16x32_bf16 a[8:11], v[28:31], v[64:67], a[8:11]
    v_mfma_f32_16x16x32_bf16 a[12:15], v[28:31], v[68:71], a[12:15]
    ds_read_b128 v[112:115], v24 offset:0
    v_mfma_f32_16x16x32_bf16 a[16:19], v[28:31], v[72:75], a[16:19]
    v_mfma_f32_16x16x32_bf16 a[20:23], v[28:31], v[76:79], a[20:23]
    v_mfma_f32_16x16x32_bf16 a[24:27], v[28:31], v[80:83], a[24:27]
    ds_read_b128 v[116:119], v24 offset:2048
    v_mfma_f32_16x16x32_bf16 a[28:31], v[32:35], v[56:59], a[28:31]
    v_mfma_f32_16x16x32_bf16 a[32:35], v[32:35], v[60:63], a[32:35]
    v_mfma_f32_16x16x32_bf16 a[36:39], v[32:35], v[64:67], a[36:39]
    v_mfma_f32_16x16x32_bf16 a[40:43], v[32:35], v[68:71], a[40:43]
    ds_read_b128 v[120:123], v24 offset:4096
    v_mfma_f32_16x16x32_bf16 a[44:47], v[32:35], v[72:75], a[44:47]
    v_mfma_f32_16x16x32_bf16 a[48:51], v[32:35], v[76:79], a[48:51]
    v_mfma_f32_16x16x32_bf16 a[52:55], v[32:35], v[80:83], a[52:55]
    ds_read_b128 v[124:127], v24 offset:6144
    v_mfma_f32_16x16x32_bf16 a[56:59], v[36:39], v[56:59], a[56:59]
    v_mfma_f32_16x16x32_bf16 a[60:63], v[36:39], v[60:63], a[60:63]
    v_mfma_f32_16x16x32_bf16 a[64:67], v[36:39], v[64:67], a[64:67]
    v_mfma_f32_16x16x32_bf16 a[68:71], v[36:39], v[68:71], a[68:71]
    ds_read_b128 v[128:131], v24 offset:8192
    v_mfma_f32_16x16x32_bf16 a[72:75], v[36:39], v[72:75], a[72:75]
    v_mfma_f32_16x16x32_bf16 a[76:79], v[36:39], v[76:79], a[76:79]
    v_mfma_f32_16x16x32_bf16 a[80:83], v[36:39], v[80:83], a[80:83]
    ds_read_b128 v[132:135], v24 offset:10240
    v_mfma_f32_16x16x32_bf16 a[84:87], v[40:43], v[56:59], a[84:87]
    v_mfma_f32_16x16x32_bf16 a[88:91], v[40:43], v[60:63], a[88:91]
    v_mfma_f32_16x16x32_bf16 a[92:95], v[40:43], v[64:67], a[92:95]
    v_mfma_f32_16x16x32_bf16 a[96:99], v[40:43], v[68:71], a[96:99]
    ds_read_b128 v[136:139], v24 offset:12288
    v_mfma_f32_16x16x32_bf16 a[100:103], v[40:43], v[72:75], a[100:103]
    v_mfma_f32_16x16x32_bf16 a[104:107], v[40:43], v[76:79], a[104:107]
    v_mfma_f32_16x16x32_bf16 a[108:111], v[40:43], v[80:83], a[108:111]
    ds_read_b128 v[84:87], v20 offset:0
    v_mfma_f32_16x16x32_bf16 a[112:115], v[44:47], v[56:59], a[112:115]
    v_mfma_f32_16x16x32_bf16 a[116:119], v[44:47], v[60:63], a[116:119]
    v_mfma_f32_16x16x32_bf16 a[120:123], v[44:47], v[64:67], a[120:123]
    v_mfma_f32_16x16x32_bf16 a[124:127], v[44:47], v[68:71], a[124:127]
    ds_read_b128 v[88:91], v20 offset:2048
    v_mfma_f32_16x16x32_bf16 a[128:131], v[44:47], v[72:75], a[128:131]
    v_mfma_f32_16x16x32_bf16 a[132:135], v[44:47], v[76:79], a[132:135]
    v_mfma_f32_16x16x32_bf16 a[136:139], v[44:47], v[80:83], a[136:139]
    ds_read_b128 v[92:95], v20 offset:4096
    v_mfma_f32_16x16x32_bf16 a[140:143], v[48:51], v[56:59], a[140:143]
    v_mfma_f32_16x16x32_bf16 a[144:147], v[48:51], v[60:63], a[144:147]
    v_mfma_f32_16x16x32_bf16 a[148:151], v[48:51], v[64:67], a[148:151]
    v_mfma_f32_16x16x32_bf16 a[152:155], v[48:51], v[68:71], a[152:155]
    ds_read_b128 v[96:99], v20 offset:6144
    v_mfma_f32_16x16x32_bf16 a[156:159], v[48:51], v[72:75], a[156:159]
    v_mfma_f32_16x16x32_bf16 a[160:163], v[48:51], v[76:79], a[160:163]
    v_mfma_f32_16x16x32_bf16 a[164:167], v[48:51], v[80:83], a[164:167]
    ds_read_b128 v[100:103], v20 offset:8192
    v_mfma_f32_16x16x32_bf16 a[168:171], v[52:55], v[56:59], a[168:171]
    v_mfma_f32_16x16x32_bf16 a[172:175], v[52:55], v[60:63], a[172:175]
    v_mfma_f32_16x16x32_bf16 a[176:179], v[52:55], v[64:67], a[176:179]
    v_mfma_f32_16x16x32_bf16 a[180:183], v[52:55], v[68:71], a[180:183]
    ds_read_b128 v[104:107], v20 offset:10240
    v_mfma_f32_16x16x32_bf16 a[184:187], v[52:55], v[72:75], a[184:187]
    v_mfma_f32_16x16x32_bf16 a[188:191], v[52:55], v[76:79], a[188:191]
    v_mfma_f32_16x16x32_bf16 a[192:195], v[52:55], v[80:83], a[192:195]
    ds_read_b128 v[108:111], v20 offset:12288
    s_waitcnt lgkmcnt(0) vmcnt(0)
    s_barrier
    v_mfma_f32_16x16x32_bf16 a[0:3], v[84:87], v[112:115], a[0:3]
    v_mfma_f32_16x16x32_bf16 a[4:7], v[84:87], v[116:119], a[4:7]
    v_mfma_f32_16x16x32_bf16 a[8:11], v[84:87], v[120:123], a[8:11]
    v_mfma_f32_16x16x32_bf16 a[12:15], v[84:87], v[124:127], a[12:15]
    ds_read_b128 v[56:59], v23 offset:0
    v_mfma_f32_16x16x32_bf16 a[16:19], v[84:87], v[128:131], a[16:19]
    v_mfma_f32_16x16x32_bf16 a[20:23], v[84:87], v[132:135], a[20:23]
    v_mfma_f32_16x16x32_bf16 a[24:27], v[84:87], v[136:139], a[24:27]
    ds_read_b128 v[60:63], v23 offset:2048
    v_mfma_f32_16x16x32_bf16 a[28:31], v[88:91], v[112:115], a[28:31]
    v_mfma_f32_16x16x32_bf16 a[32:35], v[88:91], v[116:119], a[32:35]
    v_mfma_f32_16x16x32_bf16 a[36:39], v[88:91], v[120:123], a[36:39]
    v_mfma_f32_16x16x32_bf16 a[40:43], v[88:91], v[124:127], a[40:43]
    ds_read_b128 v[64:67], v23 offset:4096
    v_mfma_f32_16x16x32_bf16 a[44:47], v[88:91], v[128:131], a[44:47]
    v_mfma_f32_16x16x32_bf16 a[48:51], v[88:91], v[132:135], a[48:51]
    v_mfma_f32_16x16x32_bf16 a[52:55], v[88:91], v[136:139], a[52:55]
    ds_read_b128 v[68:71], v23 offset:6144
    v_mfma_f32_16x16x32_bf16 a[56:59], v[92:95], v[112:115], a[56:59]
    v_mfma_f32_16x16x32_bf16 a[60:63], v[92:95], v[116:119], a[60:63]
    v_mfma_f32_16x16x32_bf16 a[64:67], v[92:95], v[120:123], a[64:67]
    v_mfma_f32_16x16x32_bf16 a[68:71], v[92:95], v[124:127], a[68:71]
    ds_read_b128 v[72:75], v23 offset:8192
    v_mfma_f32_16x16x32_bf16 a[72:75], v[92:95], v[128:131], a[72:75]
    v_mfma_f32_16x16x32_bf16 a[76:79], v[92:95], v[132:135], a[76:79]
    v_mfma_f32_16x16x32_bf16 a[80:83], v[92:95], v[136:139], a[80:83]
    ds_read_b128 v[76:79], v23 offset:10240
    v_mfma_f32_16x16x32_bf16 a[84:87], v[96:99], v[112:115], a[84:87]
    v_mfma_f32_16x16x32_bf16 a[88:91], v[96:99], v[116:119], a[88:91]
    v_mfma_f32_16x16x32_bf16 a[92:95], v[96:99], v[120:123], a[92:95]
    v_mfma_f32_16x16x32_bf16 a[96:99], v[96:99], v[124:127], a[96:99]
    ds_read_b128 v[80:83], v23 offset:12288
    v_mfma_f32_16x16x32_bf16 a[100:103], v[96:99], v[128:131], a[100:103]
    v_mfma_f32_16x16x32_bf16 a[104:107], v[96:99], v[132:135], a[104:107]
    v_mfma_f32_16x16x32_bf16 a[108:111], v[96:99], v[136:139], a[108:111]
    ds_read_b128 v[28:31], v19 offset:0
    v_mfma_f32_16x16x32_bf16 a[112:115], v[100:103], v[112:115], a[112:115]
    v_mfma_f32_16x16x32_bf16 a[116:119], v[100:103], v[116:119], a[116:119]
    v_mfma_f32_16x16x32_bf16 a[120:123], v[100:103], v[120:123], a[120:123]
    v_mfma_f32_16x16x32_bf16 a[124:127], v[100:103], v[124:127], a[124:127]
    ds_read_b128 v[32:35], v19 offset:2048
    v_mfma_f32_16x16x32_bf16 a[128:131], v[100:103], v[128:131], a[128:131]
    v_mfma_f32_16x16x32_bf16 a[132:135], v[100:103], v[132:135], a[132:135]
    v_mfma_f32_16x16x32_bf16 a[136:139], v[100:103], v[136:139], a[136:139]
    ds_read_b128 v[36:39], v19 offset:4096
    v_mfma_f32_16x16x32_bf16 a[140:143], v[104:107], v[112:115], a[140:143]
    v_mfma_f32_16x16x32_bf16 a[144:147], v[104:107], v[116:119], a[144:147]
    v_mfma_f32_16x16x32_bf16 a[148:151], v[104:107], v[120:123], a[148:151]
    v_mfma_f32_16x16x32_bf16 a[152:155], v[104:107], v[124:127], a[152:155]
    ds_read_b128 v[40:43], v19 offset:6144
    v_mfma_f32_16x16x32_bf16 a[156:159], v[104:107], v[128:131], a[156:159]
    v_mfma_f32_16x16x32_bf16 a[160:163], v[104:107], v[132:135], a[160:163]
    v_mfma_f32_16x16x32_bf16 a[164:167], v[104:107], v[136:139], a[164:167]
    ds_read_b128 v[44:47], v19 offset:8192
    v_mfma_f32_16x16x32_bf16 a[168:171], v[108:111], v[112:115], a[168:171]
    v_mfma_f32_16x16x32_bf16 a[172:175], v[108:111], v[116:119], a[172:175]
    v_mfma_f32_16x16x32_bf16 a[176:179], v[108:111], v[120:123], a[176:179]
    v_mfma_f32_16x16x32_bf16 a[180:183], v[108:111], v[124:127], a[180:183]
    ds_read_b128 v[48:51], v19 offset:10240
    v_mfma_f32_16x16x32_bf16 a[184:187], v[108:111], v[128:131], a[184:187]
    v_mfma_f32_16x16x32_bf16 a[188:191], v[108:111], v[132:135], a[188:191]
    v_mfma_f32_16x16x32_bf16 a[192:195], v[108:111], v[136:139], a[192:195]
    ds_read_b128 v[52:55], v19 offset:12288
    s_waitcnt lgkmcnt(0)
    v_mfma_f32_16x16x32_bf16 a[0:3], v[28:31], v[56:59], a[0:3]
    v_mfma_f32_16x16x32_bf16 a[4:7], v[28:31], v[60:63], a[4:7]
    v_mfma_f32_16x16x32_bf16 a[8:11], v[28:31], v[64:67], a[8:11]
    v_mfma_f32_16x16x32_bf16 a[12:15], v[28:31], v[68:71], a[12:15]
    ds_read_b128 v[112:115], v25 offset:0
    v_mfma_f32_16x16x32_bf16 a[16:19], v[28:31], v[72:75], a[16:19]
    v_mfma_f32_16x16x32_bf16 a[20:23], v[28:31], v[76:79], a[20:23]
    v_mfma_f32_16x16x32_bf16 a[24:27], v[28:31], v[80:83], a[24:27]
    ds_read_b128 v[116:119], v25 offset:2048
    v_mfma_f32_16x16x32_bf16 a[28:31], v[32:35], v[56:59], a[28:31]
    v_mfma_f32_16x16x32_bf16 a[32:35], v[32:35], v[60:63], a[32:35]
    v_mfma_f32_16x16x32_bf16 a[36:39], v[32:35], v[64:67], a[36:39]
    v_mfma_f32_16x16x32_bf16 a[40:43], v[32:35], v[68:71], a[40:43]
    ds_read_b128 v[120:123], v25 offset:4096
    v_mfma_f32_16x16x32_bf16 a[44:47], v[32:35], v[72:75], a[44:47]
    v_mfma_f32_16x16x32_bf16 a[48:51], v[32:35], v[76:79], a[48:51]
    v_mfma_f32_16x16x32_bf16 a[52:55], v[32:35], v[80:83], a[52:55]
    ds_read_b128 v[124:127], v25 offset:6144
    v_mfma_f32_16x16x32_bf16 a[56:59], v[36:39], v[56:59], a[56:59]
    v_mfma_f32_16x16x32_bf16 a[60:63], v[36:39], v[60:63], a[60:63]
    v_mfma_f32_16x16x32_bf16 a[64:67], v[36:39], v[64:67], a[64:67]
    v_mfma_f32_16x16x32_bf16 a[68:71], v[36:39], v[68:71], a[68:71]
    ds_read_b128 v[128:131], v25 offset:8192
    v_mfma_f32_16x16x32_bf16 a[72:75], v[36:39], v[72:75], a[72:75]
    v_mfma_f32_16x16x32_bf16 a[76:79], v[36:39], v[76:79], a[76:79]
    v_mfma_f32_16x16x32_bf16 a[80:83], v[36:39], v[80:83], a[80:83]
    ds_read_b128 v[132:135], v25 offset:10240
    v_mfma_f32_16x16x32_bf16 a[84:87], v[40:43], v[56:59], a[84:87]
    v_mfma_f32_16x16x32_bf16 a[88:91], v[40:43], v[60:63], a[88:91]
    v_mfma_f32_16x16x32_bf16 a[92:95], v[40:43], v[64:67], a[92:95]
    v_mfma_f32_16x16x32_bf16 a[96:99], v[40:43], v[68:71], a[96:99]
    ds_read_b128 v[136:139], v25 offset:12288
    v_mfma_f32_16x16x32_bf16 a[100:103], v[40:43], v[72:75], a[100:103]
    v_mfma_f32_16x16x32_bf16 a[104:107], v[40:43], v[76:79], a[104:107]
    v_mfma_f32_16x16x32_bf16 a[108:111], v[40:43], v[80:83], a[108:111]
    ds_read_b128 v[84:87], v21 offset:0
    v_mfma_f32_16x16x32_bf16 a[112:115], v[44:47], v[56:59], a[112:115]
    v_mfma_f32_16x16x32_bf16 a[116:119], v[44:47], v[60:63], a[116:119]
    v_mfma_f32_16x16x32_bf16 a[120:123], v[44:47], v[64:67], a[120:123]
    v_mfma_f32_16x16x32_bf16 a[124:127], v[44:47], v[68:71], a[124:127]
    ds_read_b128 v[88:91], v21 offset:2048
    v_mfma_f32_16x16x32_bf16 a[128:131], v[44:47], v[72:75], a[128:131]
    v_mfma_f32_16x16x32_bf16 a[132:135], v[44:47], v[76:79], a[132:135]
    v_mfma_f32_16x16x32_bf16 a[136:139], v[44:47], v[80:83], a[136:139]
    ds_read_b128 v[92:95], v21 offset:4096
    v_mfma_f32_16x16x32_bf16 a[140:143], v[48:51], v[56:59], a[140:143]
    v_mfma_f32_16x16x32_bf16 a[144:147], v[48:51], v[60:63], a[144:147]
    v_mfma_f32_16x16x32_bf16 a[148:151], v[48:51], v[64:67], a[148:151]
    v_mfma_f32_16x16x32_bf16 a[152:155], v[48:51], v[68:71], a[152:155]
    ds_read_b128 v[96:99], v21 offset:6144
    v_mfma_f32_16x16x32_bf16 a[156:159], v[48:51], v[72:75], a[156:159]
    v_mfma_f32_16x16x32_bf16 a[160:163], v[48:51], v[76:79], a[160:163]
    v_mfma_f32_16x16x32_bf16 a[164:167], v[48:51], v[80:83], a[164:167]
    ds_read_b128 v[100:103], v21 offset:8192
    v_mfma_f32_16x16x32_bf16 a[168:171], v[52:55], v[56:59], a[168:171]
    v_mfma_f32_16x16x32_bf16 a[172:175], v[52:55], v[60:63], a[172:175]
    v_mfma_f32_16x16x32_bf16 a[176:179], v[52:55], v[64:67], a[176:179]
    v_mfma_f32_16x16x32_bf16 a[180:183], v[52:55], v[68:71], a[180:183]
    ds_read_b128 v[104:107], v21 offset:10240
    v_mfma_f32_16x16x32_bf16 a[184:187], v[52:55], v[72:75], a[184:187]
    v_mfma_f32_16x16x32_bf16 a[188:191], v[52:55], v[76:79], a[188:191]
    v_mfma_f32_16x16x32_bf16 a[192:195], v[52:55], v[80:83], a[192:195]
    ds_read_b128 v[108:111], v21 offset:12288
    s_waitcnt lgkmcnt(0)
    v_mfma_f32_16x16x32_bf16 a[0:3], v[84:87], v[112:115], a[0:3]
    v_mfma_f32_16x16x32_bf16 a[4:7], v[84:87], v[116:119], a[4:7]
    v_mfma_f32_16x16x32_bf16 a[8:11], v[84:87], v[120:123], a[8:11]
    v_mfma_f32_16x16x32_bf16 a[12:15], v[84:87], v[124:127], a[12:15]
    v_mfma_f32_16x16x32_bf16 a[16:19], v[84:87], v[128:131], a[16:19]
    v_mfma_f32_16x16x32_bf16 a[20:23], v[84:87], v[132:135], a[20:23]
    v_mfma_f32_16x16x32_bf16 a[24:27], v[84:87], v[136:139], a[24:27]
    v_mfma_f32_16x16x32_bf16 a[28:31], v[88:91], v[112:115], a[28:31]
    v_mfma_f32_16x16x32_bf16 a[32:35], v[88:91], v[116:119], a[32:35]
    v_mfma_f32_16x16x32_bf16 a[36:39], v[88:91], v[120:123], a[36:39]
    v_mfma_f32_16x16x32_bf16 a[40:43], v[88:91], v[124:127], a[40:43]
    v_mfma_f32_16x16x32_bf16 a[44:47], v[88:91], v[128:131], a[44:47]
    v_mfma_f32_16x16x32_bf16 a[48:51], v[88:91], v[132:135], a[48:51]
    v_mfma_f32_16x16x32_bf16 a[52:55], v[88:91], v[136:139], a[52:55]
    v_mfma_f32_16x16x32_bf16 a[56:59], v[92:95], v[112:115], a[56:59]
    v_mfma_f32_16x16x32_bf16 a[60:63], v[92:95], v[116:119], a[60:63]
    v_mfma_f32_16x16x32_bf16 a[64:67], v[92:95], v[120:123], a[64:67]
    v_mfma_f32_16x16x32_bf16 a[68:71], v[92:95], v[124:127], a[68:71]
    v_mfma_f32_16x16x32_bf16 a[72:75], v[92:95], v[128:131], a[72:75]
    v_mfma_f32_16x16x32_bf16 a[76:79], v[92:95], v[132:135], a[76:79]
    v_mfma_f32_16x16x32_bf16 a[80:83], v[92:95], v[136:139], a[80:83]
    v_mfma_f32_16x16x32_bf16 a[84:87], v[96:99], v[112:115], a[84:87]
    v_mfma_f32_16x16x32_bf16 a[88:91], v[96:99], v[116:119], a[88:91]
    v_mfma_f32_16x16x32_bf16 a[92:95], v[96:99], v[120:123], a[92:95]
    v_mfma_f32_16x16x32_bf16 a[96:99], v[96:99], v[124:127], a[96:99]
    v_mfma_f32_16x16x32_bf16 a[100:103], v[96:99], v[128:131], a[100:103]
    v_mfma_f32_16x16x32_bf16 a[104:107], v[96:99], v[132:135], a[104:107]
    v_mfma_f32_16x16x32_bf16 a[108:111], v[96:99], v[136:139], a[108:111]
    v_mfma_f32_16x16x32_bf16 a[112:115], v[100:103], v[112:115], a[112:115]
    v_mfma_f32_16x16x32_bf16 a[116:119], v[100:103], v[116:119], a[116:119]
    v_mfma_f32_16x16x32_bf16 a[120:123], v[100:103], v[120:123], a[120:123]
    v_mfma_f32_16x16x32_bf16 a[124:127], v[100:103], v[124:127], a[124:127]
    v_mfma_f32_16x16x32_bf16 a[128:131], v[100:103], v[128:131], a[128:131]
    v_mfma_f32_16x16x32_bf16 a[132:135], v[100:103], v[132:135], a[132:135]
    v_mfma_f32_16x16x32_bf16 a[136:139], v[100:103], v[136:139], a[136:139]
    v_mfma_f32_16x16x32_bf16 a[140:143], v[104:107], v[112:115], a[140:143]
    v_mfma_f32_16x16x32_bf16 a[144:147], v[104:107], v[116:119], a[144:147]
    v_mfma_f32_16x16x32_bf16 a[148:151], v[104:107], v[120:123], a[148:151]
    v_mfma_f32_16x16x32_bf16 a[152:155], v[104:107], v[124:127], a[152:155]
    v_mfma_f32_16x16x32_bf16 a[156:159], v[104:107], v[128:131], a[156:159]
    v_mfma_f32_16x16x32_bf16 a[160:163], v[104:107], v[132:135], a[160:163]
    v_mfma_f32_16x16x32_bf16 a[164:167], v[104:107], v[136:139], a[164:167]
    v_mfma_f32_16x16x32_bf16 a[168:171], v[108:111], v[112:115], a[168:171]
    v_mfma_f32_16x16x32_bf16 a[172:175], v[108:111], v[116:119], a[172:175]
    v_mfma_f32_16x16x32_bf16 a[176:179], v[108:111], v[120:123], a[176:179]
    v_mfma_f32_16x16x32_bf16 a[180:183], v[108:111], v[124:127], a[180:183]
    v_mfma_f32_16x16x32_bf16 a[184:187], v[108:111], v[128:131], a[184:187]
    v_mfma_f32_16x16x32_bf16 a[188:191], v[108:111], v[132:135], a[188:191]
    v_mfma_f32_16x16x32_bf16 a[192:195], v[108:111], v[136:139], a[192:195]
    s_nop 7
    s_nop 7
    s_barrier
    v_mul_u32_u24 v12, 240, v3
    v_lshl_add_u32 v12, v4, 3, v12
    v_mul_u32_u24 v13, 26880, v2
    v_add_u32 v12, v12, v13
    v_accvgpr_read_b32 v28, a0
    v_accvgpr_read_b32 v29, a1
    v_accvgpr_read_b32 v30, a2
    v_accvgpr_read_b32 v31, a3
    v_mul_f32 v28, s40, v28
    v_mul_f32 v29, s40, v29
    v_mul_f32 v30, s40, v30
    v_mul_f32 v31, s40, v31
    v_cvt_pk_bf16_f32 v32, v28, v29
    v_cvt_pk_bf16_f32 v33, v30, v31
    ds_write_b64 v12, v[32:33] offset:0
    v_accvgpr_read_b32 v44, a28
    v_accvgpr_read_b32 v45, a29
    v_accvgpr_read_b32 v46, a30
    v_accvgpr_read_b32 v47, a31
    v_mul_f32 v44, s40, v44
    v_mul_f32 v45, s40, v45
    v_mul_f32 v46, s40, v46
    v_mul_f32 v47, s40, v47
    v_cvt_pk_bf16_f32 v48, v44, v45
    v_cvt_pk_bf16_f32 v49, v46, v47
    ds_write_b64 v12, v[48:49] offset:32
    v_accvgpr_read_b32 v60, a56
    v_accvgpr_read_b32 v61, a57
    v_accvgpr_read_b32 v62, a58
    v_accvgpr_read_b32 v63, a59
    v_mul_f32 v60, s40, v60
    v_mul_f32 v61, s40, v61
    v_mul_f32 v62, s40, v62
    v_mul_f32 v63, s40, v63
    v_cvt_pk_bf16_f32 v64, v60, v61
    v_cvt_pk_bf16_f32 v65, v62, v63
    ds_write_b64 v12, v[64:65] offset:64
    v_accvgpr_read_b32 v76, a84
    v_accvgpr_read_b32 v77, a85
    v_accvgpr_read_b32 v78, a86
    v_accvgpr_read_b32 v79, a87
    v_mul_f32 v76, s40, v76
    v_mul_f32 v77, s40, v77
    v_mul_f32 v78, s40, v78
    v_mul_f32 v79, s40, v79
    v_cvt_pk_bf16_f32 v80, v76, v77
    v_cvt_pk_bf16_f32 v81, v78, v79
    ds_write_b64 v12, v[80:81] offset:96
    v_accvgpr_read_b32 v28, a112
    v_accvgpr_read_b32 v29, a113
    v_accvgpr_read_b32 v30, a114
    v_accvgpr_read_b32 v31, a115
    v_mul_f32 v28, s40, v28
    v_mul_f32 v29, s40, v29
    v_mul_f32 v30, s40, v30
    v_mul_f32 v31, s40, v31
    v_cvt_pk_bf16_f32 v32, v28, v29
    v_cvt_pk_bf16_f32 v33, v30, v31
    ds_write_b64 v12, v[32:33] offset:128
    v_accvgpr_read_b32 v44, a140
    v_accvgpr_read_b32 v45, a141
    v_accvgpr_read_b32 v46, a142
    v_accvgpr_read_b32 v47, a143
    v_mul_f32 v44, s40, v44
    v_mul_f32 v45, s40, v45
    v_mul_f32 v46, s40, v46
    v_mul_f32 v47, s40, v47
    v_cvt_pk_bf16_f32 v48, v44, v45
    v_cvt_pk_bf16_f32 v49, v46, v47
    ds_write_b64 v12, v[48:49] offset:160
    v_accvgpr_read_b32 v60, a168
    v_accvgpr_read_b32 v61, a169
    v_accvgpr_read_b32 v62, a170
    v_accvgpr_read_b32 v63, a171
    v_mul_f32 v60, s40, v60
    v_mul_f32 v61, s40, v61
    v_mul_f32 v62, s40, v62
    v_mul_f32 v63, s40, v63
    v_cvt_pk_bf16_f32 v64, v60, v61
    v_cvt_pk_bf16_f32 v65, v62, v63
    ds_write_b64 v12, v[64:65] offset:192
    v_accvgpr_read_b32 v76, a4
    v_accvgpr_read_b32 v77, a5
    v_accvgpr_read_b32 v78, a6
    v_accvgpr_read_b32 v79, a7
    v_mul_f32 v76, s40, v76
    v_mul_f32 v77, s40, v77
    v_mul_f32 v78, s40, v78
    v_mul_f32 v79, s40, v79
    v_cvt_pk_bf16_f32 v80, v76, v77
    v_cvt_pk_bf16_f32 v81, v78, v79
    ds_write_b64 v12, v[80:81] offset:3840
    v_accvgpr_read_b32 v28, a32
    v_accvgpr_read_b32 v29, a33
    v_accvgpr_read_b32 v30, a34
    v_accvgpr_read_b32 v31, a35
    v_mul_f32 v28, s40, v28
    v_mul_f32 v29, s40, v29
    v_mul_f32 v30, s40, v30
    v_mul_f32 v31, s40, v31
    v_cvt_pk_bf16_f32 v32, v28, v29
    v_cvt_pk_bf16_f32 v33, v30, v31
    ds_write_b64 v12, v[32:33] offset:3872
    v_accvgpr_read_b32 v44, a60
    v_accvgpr_read_b32 v45, a61
    v_accvgpr_read_b32 v46, a62
    v_accvgpr_read_b32 v47, a63
    v_mul_f32 v44, s40, v44
    v_mul_f32 v45, s40, v45
    v_mul_f32 v46, s40, v46
    v_mul_f32 v47, s40, v47
    v_cvt_pk_bf16_f32 v48, v44, v45
    v_cvt_pk_bf16_f32 v49, v46, v47
    ds_write_b64 v12, v[48:49] offset:3904
    v_accvgpr_read_b32 v60, a88
    v_accvgpr_read_b32 v61, a89
    v_accvgpr_read_b32 v62, a90
    v_accvgpr_read_b32 v63, a91
    v_mul_f32 v60, s40, v60
    v_mul_f32 v61, s40, v61
    v_mul_f32 v62, s40, v62
    v_mul_f32 v63, s40, v63
    v_cvt_pk_bf16_f32 v64, v60, v61
    v_cvt_pk_bf16_f32 v65, v62, v63
    ds_write_b64 v12, v[64:65] offset:3936
    v_accvgpr_read_b32 v76, a116
    v_accvgpr_read_b32 v77, a117
    v_accvgpr_read_b32 v78, a118
    v_accvgpr_read_b32 v79, a119
    v_mul_f32 v76, s40, v76
    v_mul_f32 v77, s40, v77
    v_mul_f32 v78, s40, v78
    v_mul_f32 v79, s40, v79
    v_cvt_pk_bf16_f32 v80, v76, v77
    v_cvt_pk_bf16_f32 v81, v78, v79
    ds_write_b64 v12, v[80:81] offset:3968
    v_accvgpr_read_b32 v28, a144
    v_accvgpr_read_b32 v29, a145
    v_accvgpr_read_b32 v30, a146
    v_accvgpr_read_b32 v31, a147
    v_mul_f32 v28, s40, v28
    v_mul_f32 v29, s40, v29
    v_mul_f32 v30, s40, v30
    v_mul_f32 v31, s40, v31
    v_cvt_pk_bf16_f32 v32, v28, v29
    v_cvt_pk_bf16_f32 v33, v30, v31
    ds_write_b64 v12, v[32:33] offset:4000
    v_accvgpr_read_b32 v44, a172
    v_accvgpr_read_b32 v45, a173
    v_accvgpr_read_b32 v46, a174
    v_accvgpr_read_b32 v47, a175
    v_mul_f32 v44, s40, v44
    v_mul_f32 v45, s40, v45
    v_mul_f32 v46, s40, v46
    v_mul_f32 v47, s40, v47
    v_cvt_pk_bf16_f32 v48, v44, v45
    v_cvt_pk_bf16_f32 v49, v46, v47
    ds_write_b64 v12, v[48:49] offset:4032
    v_accvgpr_read_b32 v60, a8
    v_accvgpr_read_b32 v61, a9
    v_accvgpr_read_b32 v62, a10
    v_accvgpr_read_b32 v63, a11
    v_mul_f32 v60, s40, v60
    v_mul_f32 v61, s40, v61
    v_mul_f32 v62, s40, v62
    v_mul_f32 v63, s40, v63
    v_cvt_pk_bf16_f32 v64, v60, v61
    v_cvt_pk_bf16_f32 v65, v62, v63
    ds_write_b64 v12, v[64:65] offset:7680
    v_accvgpr_read_b32 v76, a36
    v_accvgpr_read_b32 v77, a37
    v_accvgpr_read_b32 v78, a38
    v_accvgpr_read_b32 v79, a39
    v_mul_f32 v76, s40, v76
    v_mul_f32 v77, s40, v77
    v_mul_f32 v78, s40, v78
    v_mul_f32 v79, s40, v79
    v_cvt_pk_bf16_f32 v80, v76, v77
    v_cvt_pk_bf16_f32 v81, v78, v79
    ds_write_b64 v12, v[80:81] offset:7712
    v_accvgpr_read_b32 v28, a64
    v_accvgpr_read_b32 v29, a65
    v_accvgpr_read_b32 v30, a66
    v_accvgpr_read_b32 v31, a67
    v_mul_f32 v28, s40, v28
    v_mul_f32 v29, s40, v29
    v_mul_f32 v30, s40, v30
    v_mul_f32 v31, s40, v31
    v_cvt_pk_bf16_f32 v32, v28, v29
    v_cvt_pk_bf16_f32 v33, v30, v31
    ds_write_b64 v12, v[32:33] offset:7744
    v_accvgpr_read_b32 v44, a92
    v_accvgpr_read_b32 v45, a93
    v_accvgpr_read_b32 v46, a94
    v_accvgpr_read_b32 v47, a95
    v_mul_f32 v44, s40, v44
    v_mul_f32 v45, s40, v45
    v_mul_f32 v46, s40, v46
    v_mul_f32 v47, s40, v47
    v_cvt_pk_bf16_f32 v48, v44, v45
    v_cvt_pk_bf16_f32 v49, v46, v47
    ds_write_b64 v12, v[48:49] offset:7776
    v_accvgpr_read_b32 v60, a120
    v_accvgpr_read_b32 v61, a121
    v_accvgpr_read_b32 v62, a122
    v_accvgpr_read_b32 v63, a123
    v_mul_f32 v60, s40, v60
    v_mul_f32 v61, s40, v61
    v_mul_f32 v62, s40, v62
    v_mul_f32 v63, s40, v63
    v_cvt_pk_bf16_f32 v64, v60, v61
    v_cvt_pk_bf16_f32 v65, v62, v63
    ds_write_b64 v12, v[64:65] offset:7808
    v_accvgpr_read_b32 v76, a148
    v_accvgpr_read_b32 v77, a149
    v_accvgpr_read_b32 v78, a150
    v_accvgpr_read_b32 v79, a151
    v_mul_f32 v76, s40, v76
    v_mul_f32 v77, s40, v77
    v_mul_f32 v78, s40, v78
    v_mul_f32 v79, s40, v79
    v_cvt_pk_bf16_f32 v80, v76, v77
    v_cvt_pk_bf16_f32 v81, v78, v79
    ds_write_b64 v12, v[80:81] offset:7840
    v_accvgpr_read_b32 v28, a176
    v_accvgpr_read_b32 v29, a177
    v_accvgpr_read_b32 v30, a178
    v_accvgpr_read_b32 v31, a179
    v_mul_f32 v28, s40, v28
    v_mul_f32 v29, s40, v29
    v_mul_f32 v30, s40, v30
    v_mul_f32 v31, s40, v31
    v_cvt_pk_bf16_f32 v32, v28, v29
    v_cvt_pk_bf16_f32 v33, v30, v31
    ds_write_b64 v12, v[32:33] offset:7872
    v_accvgpr_read_b32 v44, a12
    v_accvgpr_read_b32 v45, a13
    v_accvgpr_read_b32 v46, a14
    v_accvgpr_read_b32 v47, a15
    v_mul_f32 v44, s40, v44
    v_mul_f32 v45, s40, v45
    v_mul_f32 v46, s40, v46
    v_mul_f32 v47, s40, v47
    v_cvt_pk_bf16_f32 v48, v44, v45
    v_cvt_pk_bf16_f32 v49, v46, v47
    ds_write_b64 v12, v[48:49] offset:11520
    v_accvgpr_read_b32 v60, a40
    v_accvgpr_read_b32 v61, a41
    v_accvgpr_read_b32 v62, a42
    v_accvgpr_read_b32 v63, a43
    v_mul_f32 v60, s40, v60
    v_mul_f32 v61, s40, v61
    v_mul_f32 v62, s40, v62
    v_mul_f32 v63, s40, v63
    v_cvt_pk_bf16_f32 v64, v60, v61
    v_cvt_pk_bf16_f32 v65, v62, v63
    ds_write_b64 v12, v[64:65] offset:11552
    v_accvgpr_read_b32 v76, a68
    v_accvgpr_read_b32 v77, a69
    v_accvgpr_read_b32 v78, a70
    v_accvgpr_read_b32 v79, a71
    v_mul_f32 v76, s40, v76
    v_mul_f32 v77, s40, v77
    v_mul_f32 v78, s40, v78
    v_mul_f32 v79, s40, v79
    v_cvt_pk_bf16_f32 v80, v76, v77
    v_cvt_pk_bf16_f32 v81, v78, v79
    ds_write_b64 v12, v[80:81] offset:11584
    v_accvgpr_read_b32 v28, a96
    v_accvgpr_read_b32 v29, a97
    v_accvgpr_read_b32 v30, a98
    v_accvgpr_read_b32 v31, a99
    v_mul_f32 v28, s40, v28
    v_mul_f32 v29, s40, v29
    v_mul_f32 v30, s40, v30
    v_mul_f32 v31, s40, v31
    v_cvt_pk_bf16_f32 v32, v28, v29
    v_cvt_pk_bf16_f32 v33, v30, v31
    ds_write_b64 v12, v[32:33] offset:11616
    v_accvgpr_read_b32 v44, a124
    v_accvgpr_read_b32 v45, a125
    v_accvgpr_read_b32 v46, a126
    v_accvgpr_read_b32 v47, a127
    v_mul_f32 v44, s40, v44
    v_mul_f32 v45, s40, v45
    v_mul_f32 v46, s40, v46
    v_mul_f32 v47, s40, v47
    v_cvt_pk_bf16_f32 v48, v44, v45
    v_cvt_pk_bf16_f32 v49, v46, v47
    ds_write_b64 v12, v[48:49] offset:11648
    v_accvgpr_read_b32 v60, a152
    v_accvgpr_read_b32 v61, a153
    v_accvgpr_read_b32 v62, a154
    v_accvgpr_read_b32 v63, a155
    v_mul_f32 v60, s40, v60
    v_mul_f32 v61, s40, v61
    v_mul_f32 v62, s40, v62
    v_mul_f32 v63, s40, v63
    v_cvt_pk_bf16_f32 v64, v60, v61
    v_cvt_pk_bf16_f32 v65, v62, v63
    ds_write_b64 v12, v[64:65] offset:11680
    v_accvgpr_read_b32 v76, a180
    v_accvgpr_read_b32 v77, a181
    v_accvgpr_read_b32 v78, a182
    v_accvgpr_read_b32 v79, a183
    v_mul_f32 v76, s40, v76
    v_mul_f32 v77, s40, v77
    v_mul_f32 v78, s40, v78
    v_mul_f32 v79, s40, v79
    v_cvt_pk_bf16_f32 v80, v76, v77
    v_cvt_pk_bf16_f32 v81, v78, v79
    ds_write_b64 v12, v[80:81] offset:11712
    v_accvgpr_read_b32 v28, a16
    v_accvgpr_read_b32 v29, a17
    v_accvgpr_read_b32 v30, a18
    v_accvgpr_read_b32 v31, a19
    v_mul_f32 v28, s40, v28
    v_mul_f32 v29, s40, v29
    v_mul_f32 v30, s40, v30
    v_mul_f32 v31, s40, v31
    v_cvt_pk_bf16_f32 v32, v28, v29
    v_cvt_pk_bf16_f32 v33, v30, v31
    ds_write_b64 v12, v[32:33] offset:15360
    v_accvgpr_read_b32 v44, a44
    v_accvgpr_read_b32 v45, a45
    v_accvgpr_read_b32 v46, a46
    v_accvgpr_read_b32 v47, a47
    v_mul_f32 v44, s40, v44
    v_mul_f32 v45, s40, v45
    v_mul_f32 v46, s40, v46
    v_mul_f32 v47, s40, v47
    v_cvt_pk_bf16_f32 v48, v44, v45
    v_cvt_pk_bf16_f32 v49, v46, v47
    ds_write_b64 v12, v[48:49] offset:15392
    v_accvgpr_read_b32 v60, a72
    v_accvgpr_read_b32 v61, a73
    v_accvgpr_read_b32 v62, a74
    v_accvgpr_read_b32 v63, a75
    v_mul_f32 v60, s40, v60
    v_mul_f32 v61, s40, v61
    v_mul_f32 v62, s40, v62
    v_mul_f32 v63, s40, v63
    v_cvt_pk_bf16_f32 v64, v60, v61
    v_cvt_pk_bf16_f32 v65, v62, v63
    ds_write_b64 v12, v[64:65] offset:15424
    v_accvgpr_read_b32 v76, a100
    v_accvgpr_read_b32 v77, a101
    v_accvgpr_read_b32 v78, a102
    v_accvgpr_read_b32 v79, a103
    v_mul_f32 v76, s40, v76
    v_mul_f32 v77, s40, v77
    v_mul_f32 v78, s40, v78
    v_mul_f32 v79, s40, v79
    v_cvt_pk_bf16_f32 v80, v76, v77
    v_cvt_pk_bf16_f32 v81, v78, v79
    ds_write_b64 v12, v[80:81] offset:15456
    v_accvgpr_read_b32 v28, a128
    v_accvgpr_read_b32 v29, a129
    v_accvgpr_read_b32 v30, a130
    v_accvgpr_read_b32 v31, a131
    v_mul_f32 v28, s40, v28
    v_mul_f32 v29, s40, v29
    v_mul_f32 v30, s40, v30
    v_mul_f32 v31, s40, v31
    v_cvt_pk_bf16_f32 v32, v28, v29
    v_cvt_pk_bf16_f32 v33, v30, v31
    ds_write_b64 v12, v[32:33] offset:15488
    v_accvgpr_read_b32 v44, a156
    v_accvgpr_read_b32 v45, a157
    v_accvgpr_read_b32 v46, a158
    v_accvgpr_read_b32 v47, a159
    v_mul_f32 v44, s40, v44
    v_mul_f32 v45, s40, v45
    v_mul_f32 v46, s40, v46
    v_mul_f32 v47, s40, v47
    v_cvt_pk_bf16_f32 v48, v44, v45
    v_cvt_pk_bf16_f32 v49, v46, v47
    ds_write_b64 v12, v[48:49] offset:15520
    v_accvgpr_read_b32 v60, a184
    v_accvgpr_read_b32 v61, a185
    v_accvgpr_read_b32 v62, a186
    v_accvgpr_read_b32 v63, a187
    v_mul_f32 v60, s40, v60
    v_mul_f32 v61, s40, v61
    v_mul_f32 v62, s40, v62
    v_mul_f32 v63, s40, v63
    v_cvt_pk_bf16_f32 v64, v60, v61
    v_cvt_pk_bf16_f32 v65, v62, v63
    ds_write_b64 v12, v[64:65] offset:15552
    v_accvgpr_read_b32 v76, a20
    v_accvgpr_read_b32 v77, a21
    v_accvgpr_read_b32 v78, a22
    v_accvgpr_read_b32 v79, a23
    v_mul_f32 v76, s40, v76
    v_mul_f32 v77, s40, v77
    v_mul_f32 v78, s40, v78
    v_mul_f32 v79, s40, v79
    v_cvt_pk_bf16_f32 v80, v76, v77
    v_cvt_pk_bf16_f32 v81, v78, v79
    ds_write_b64 v12, v[80:81] offset:19200
    v_accvgpr_read_b32 v28, a48
    v_accvgpr_read_b32 v29, a49
    v_accvgpr_read_b32 v30, a50
    v_accvgpr_read_b32 v31, a51
    v_mul_f32 v28, s40, v28
    v_mul_f32 v29, s40, v29
    v_mul_f32 v30, s40, v30
    v_mul_f32 v31, s40, v31
    v_cvt_pk_bf16_f32 v32, v28, v29
    v_cvt_pk_bf16_f32 v33, v30, v31
    ds_write_b64 v12, v[32:33] offset:19232
    v_accvgpr_read_b32 v44, a76
    v_accvgpr_read_b32 v45, a77
    v_accvgpr_read_b32 v46, a78
    v_accvgpr_read_b32 v47, a79
    v_mul_f32 v44, s40, v44
    v_mul_f32 v45, s40, v45
    v_mul_f32 v46, s40, v46
    v_mul_f32 v47, s40, v47
    v_cvt_pk_bf16_f32 v48, v44, v45
    v_cvt_pk_bf16_f32 v49, v46, v47
    ds_write_b64 v12, v[48:49] offset:19264
    v_accvgpr_read_b32 v60, a104
    v_accvgpr_read_b32 v61, a105
    v_accvgpr_read_b32 v62, a106
    v_accvgpr_read_b32 v63, a107
    v_mul_f32 v60, s40, v60
    v_mul_f32 v61, s40, v61
    v_mul_f32 v62, s40, v62
    v_mul_f32 v63, s40, v63
    v_cvt_pk_bf16_f32 v64, v60, v61
    v_cvt_pk_bf16_f32 v65, v62, v63
    ds_write_b64 v12, v[64:65] offset:19296
    v_accvgpr_read_b32 v76, a132
    v_accvgpr_read_b32 v77, a133
    v_accvgpr_read_b32 v78, a134
    v_accvgpr_read_b32 v79, a135
    v_mul_f32 v76, s40, v76
    v_mul_f32 v77, s40, v77
    v_mul_f32 v78, s40, v78
    v_mul_f32 v79, s40, v79
    v_cvt_pk_bf16_f32 v80, v76, v77
    v_cvt_pk_bf16_f32 v81, v78, v79
    ds_write_b64 v12, v[80:81] offset:19328
    v_accvgpr_read_b32 v28, a160
    v_accvgpr_read_b32 v29, a161
    v_accvgpr_read_b32 v30, a162
    v_accvgpr_read_b32 v31, a163
    v_mul_f32 v28, s40, v28
    v_mul_f32 v29, s40, v29
    v_mul_f32 v30, s40, v30
    v_mul_f32 v31, s40, v31
    v_cvt_pk_bf16_f32 v32, v28, v29
    v_cvt_pk_bf16_f32 v33, v30, v31
    ds_write_b64 v12, v[32:33] offset:19360
    v_accvgpr_read_b32 v44, a188
    v_accvgpr_read_b32 v45, a189
    v_accvgpr_read_b32 v46, a190
    v_accvgpr_read_b32 v47, a191
    v_mul_f32 v44, s40, v44
    v_mul_f32 v45, s40, v45
    v_mul_f32 v46, s40, v46
    v_mul_f32 v47, s40, v47
    v_cvt_pk_bf16_f32 v48, v44, v45
    v_cvt_pk_bf16_f32 v49, v46, v47
    ds_write_b64 v12, v[48:49] offset:19392
    v_accvgpr_read_b32 v60, a24
    v_accvgpr_read_b32 v61, a25
    v_accvgpr_read_b32 v62, a26
    v_accvgpr_read_b32 v63, a27
    v_mul_f32 v60, s40, v60
    v_mul_f32 v61, s40, v61
    v_mul_f32 v62, s40, v62
    v_mul_f32 v63, s40, v63
    v_cvt_pk_bf16_f32 v64, v60, v61
    v_cvt_pk_bf16_f32 v65, v62, v63
    ds_write_b64 v12, v[64:65] offset:23040
    v_accvgpr_read_b32 v76, a52
    v_accvgpr_read_b32 v77, a53
    v_accvgpr_read_b32 v78, a54
    v_accvgpr_read_b32 v79, a55
    v_mul_f32 v76, s40, v76
    v_mul_f32 v77, s40, v77
    v_mul_f32 v78, s40, v78
    v_mul_f32 v79, s40, v79
    v_cvt_pk_bf16_f32 v80, v76, v77
    v_cvt_pk_bf16_f32 v81, v78, v79
    ds_write_b64 v12, v[80:81] offset:23072
    v_accvgpr_read_b32 v28, a80
    v_accvgpr_read_b32 v29, a81
    v_accvgpr_read_b32 v30, a82
    v_accvgpr_read_b32 v31, a83
    v_mul_f32 v28, s40, v28
    v_mul_f32 v29, s40, v29
    v_mul_f32 v30, s40, v30
    v_mul_f32 v31, s40, v31
    v_cvt_pk_bf16_f32 v32, v28, v29
    v_cvt_pk_bf16_f32 v33, v30, v31
    ds_write_b64 v12, v[32:33] offset:23104
    v_accvgpr_read_b32 v44, a108
    v_accvgpr_read_b32 v45, a109
    v_accvgpr_read_b32 v46, a110
    v_accvgpr_read_b32 v47, a111
    v_mul_f32 v44, s40, v44
    v_mul_f32 v45, s40, v45
    v_mul_f32 v46, s40, v46
    v_mul_f32 v47, s40, v47
    v_cvt_pk_bf16_f32 v48, v44, v45
    v_cvt_pk_bf16_f32 v49, v46, v47
    ds_write_b64 v12, v[48:49] offset:23136
    v_accvgpr_read_b32 v60, a136
    v_accvgpr_read_b32 v61, a137
    v_accvgpr_read_b32 v62, a138
    v_accvgpr_read_b32 v63, a139
    v_mul_f32 v60, s40, v60
    v_mul_f32 v61, s40, v61
    v_mul_f32 v62, s40, v62
    v_mul_f32 v63, s40, v63
    v_cvt_pk_bf16_f32 v64, v60, v61
    v_cvt_pk_bf16_f32 v65, v62, v63
    ds_write_b64 v12, v[64:65] offset:23168
    v_accvgpr_read_b32 v76, a164
    v_accvgpr_read_b32 v77, a165
    v_accvgpr_read_b32 v78, a166
    v_accvgpr_read_b32 v79, a167
    v_mul_f32 v76, s40, v76
    v_mul_f32 v77, s40, v77
    v_mul_f32 v78, s40, v78
    v_mul_f32 v79, s40, v79
    v_cvt_pk_bf16_f32 v80, v76, v77
    v_cvt_pk_bf16_f32 v81, v78, v79
    ds_write_b64 v12, v[80:81] offset:23200
    v_accvgpr_read_b32 v28, a192
    v_accvgpr_read_b32 v29, a193
    v_accvgpr_read_b32 v30, a194
    v_accvgpr_read_b32 v31, a195
    v_mul_f32 v28, s40, v28
    v_mul_f32 v29, s40, v29
    v_mul_f32 v30, s40, v30
    v_mul_f32 v31, s40, v31
    v_cvt_pk_bf16_f32 v32, v28, v29
    v_cvt_pk_bf16_f32 v33, v30, v31
    ds_write_b64 v12, v[32:33] offset:23232
    s_mul_i32 s41, s21, 448
    s_mul_i32 s42, s23, 224
    s_add_u32 s41, s41, s42
    v_mul_u32_u24 v10, 112, v9
    v_add_u32 v10, s41, v10
    v_mul_u32_u24 v10, 896, v10
    s_mul_i32 s42, s22, 448
    v_mul_u32_u24 v11, 224, v8
    v_add3_u32 v10, v10, v11, s42
    s_mov_b32 s43, 12582912
    v_mul_u32_u24 v5, 4682, v1
    v_lshrrev_b32 v5, 16, v5
    v_mul_u32_u24 v6, 14, v5
    v_sub_u32 v6, v1, v6
    v_mul_u32_u24 v7, 240, v5
    v_lshl_add_u32 v7, v6, 4, v7
    v_mul_u32_u24 v13, 26880, v2
    v_add_u32 v7, v7, v13
    v_mul_u32_u24 v5, 896, v5
    v_lshl_add_u32 v5, v6, 4, v5
    v_add_u32 v5, v5, v10
    v_cmp_gt_u32 vcc, 56, v1
    s_waitcnt lgkmcnt(0)
    s_and_saveexec_b64 s[44:45], vcc
    ds_read_b128 v[28:31], v7 offset:0
    ds_read_b128 v[32:35], v7 offset:960
    ds_read_b128 v[36:39], v7 offset:1920
    ds_read_b128 v[40:43], v7 offset:2880
    ds_read_b128 v[44:47], v7 offset:3840
    ds_read_b128 v[48:51], v7 offset:4800
    ds_read_b128 v[52:55], v7 offset:5760
    ds_read_b128 v[56:59], v7 offset:6720
    s_waitcnt lgkmcnt(7)
    s_add_u32 s46, s43, 0
    buffer_store_dwordx4 v[28:31], v5, s[4:7], s46 offen
    s_waitcnt lgkmcnt(6)
    s_add_u32 s46, s43, 3584
    buffer_store_dwordx4 v[32:35], v5, s[4:7], s46 offen
    s_waitcnt lgkmcnt(5)
    s_add_u32 s46, s43, 7168
    buffer_store_dwordx4 v[36:39], v5, s[4:7], s46 offen
    s_waitcnt lgkmcnt(4)
    s_add_u32 s46, s43, 10752
    buffer_store_dwordx4 v[40:43], v5, s[4:7], s46 offen
    s_waitcnt lgkmcnt(3)
    s_add_u32 s46, s43, 14336
    buffer_store_dwordx4 v[44:47], v5, s[4:7], s46 offen
    s_waitcnt lgkmcnt(2)
    s_add_u32 s46, s43, 17920
    buffer_store_dwordx4 v[48:51], v5, s[4:7], s46 offen
    s_waitcnt lgkmcnt(1)
    s_add_u32 s46, s43, 21504
    buffer_store_dwordx4 v[52:55], v5, s[4:7], s46 offen
    s_waitcnt lgkmcnt(0)
    s_add_u32 s46, s43, 25088
    buffer_store_dwordx4 v[56:59], v5, s[4:7], s46 offen
    ds_read_b128 v[28:31], v7 offset:7680
    ds_read_b128 v[32:35], v7 offset:8640
    ds_read_b128 v[36:39], v7 offset:9600
    ds_read_b128 v[40:43], v7 offset:10560
    ds_read_b128 v[44:47], v7 offset:11520
    ds_read_b128 v[48:51], v7 offset:12480
    ds_read_b128 v[52:55], v7 offset:13440
    ds_read_b128 v[56:59], v7 offset:14400
    s_waitcnt lgkmcnt(7)
    s_add_u32 s46, s43, 28672
    buffer_store_dwordx4 v[28:31], v5, s[4:7], s46 offen
    s_waitcnt lgkmcnt(6)
    s_add_u32 s46, s43, 32256
    buffer_store_dwordx4 v[32:35], v5, s[4:7], s46 offen
    s_waitcnt lgkmcnt(5)
    s_add_u32 s46, s43, 35840
    buffer_store_dwordx4 v[36:39], v5, s[4:7], s46 offen
    s_waitcnt lgkmcnt(4)
    s_add_u32 s46, s43, 39424
    buffer_store_dwordx4 v[40:43], v5, s[4:7], s46 offen
    s_waitcnt lgkmcnt(3)
    s_add_u32 s46, s43, 43008
    buffer_store_dwordx4 v[44:47], v5, s[4:7], s46 offen
    s_waitcnt lgkmcnt(2)
    s_add_u32 s46, s43, 46592
    buffer_store_dwordx4 v[48:51], v5, s[4:7], s46 offen
    s_waitcnt lgkmcnt(1)
    s_add_u32 s46, s43, 50176
    buffer_store_dwordx4 v[52:55], v5, s[4:7], s46 offen
    s_waitcnt lgkmcnt(0)
    s_add_u32 s46, s43, 53760
    buffer_store_dwordx4 v[56:59], v5, s[4:7], s46 offen
    ds_read_b128 v[28:31], v7 offset:15360
    ds_read_b128 v[32:35], v7 offset:16320
    ds_read_b128 v[36:39], v7 offset:17280
    ds_read_b128 v[40:43], v7 offset:18240
    ds_read_b128 v[44:47], v7 offset:19200
    ds_read_b128 v[48:51], v7 offset:20160
    ds_read_b128 v[52:55], v7 offset:21120
    ds_read_b128 v[56:59], v7 offset:22080
    s_waitcnt lgkmcnt(7)
    s_add_u32 s46, s43, 57344
    buffer_store_dwordx4 v[28:31], v5, s[4:7], s46 offen
    s_waitcnt lgkmcnt(6)
    s_add_u32 s46, s43, 60928
    buffer_store_dwordx4 v[32:35], v5, s[4:7], s46 offen
    s_waitcnt lgkmcnt(5)
    s_add_u32 s46, s43, 64512
    buffer_store_dwordx4 v[36:39], v5, s[4:7], s46 offen
    s_waitcnt lgkmcnt(4)
    s_add_u32 s46, s43, 68096
    buffer_store_dwordx4 v[40:43], v5, s[4:7], s46 offen
    s_waitcnt lgkmcnt(3)
    s_add_u32 s46, s43, 71680
    buffer_store_dwordx4 v[44:47], v5, s[4:7], s46 offen
    s_waitcnt lgkmcnt(2)
    s_add_u32 s46, s43, 75264
    buffer_store_dwordx4 v[48:51], v5, s[4:7], s46 offen
    s_waitcnt lgkmcnt(1)
    s_add_u32 s46, s43, 78848
    buffer_store_dwordx4 v[52:55], v5, s[4:7], s46 offen
    s_waitcnt lgkmcnt(0)
    s_add_u32 s46, s43, 82432
    buffer_store_dwordx4 v[56:59], v5, s[4:7], s46 offen
    ds_read_b128 v[28:31], v7 offset:23040
    ds_read_b128 v[32:35], v7 offset:24000
    ds_read_b128 v[36:39], v7 offset:24960
    ds_read_b128 v[40:43], v7 offset:25920
    s_waitcnt lgkmcnt(3)
    s_add_u32 s46, s43, 86016
    buffer_store_dwordx4 v[28:31], v5, s[4:7], s46 offen
    s_waitcnt lgkmcnt(2)
    s_add_u32 s46, s43, 89600
    buffer_store_dwordx4 v[32:35], v5, s[4:7], s46 offen
    s_waitcnt lgkmcnt(1)
    s_add_u32 s46, s43, 93184
    buffer_store_dwordx4 v[36:39], v5, s[4:7], s46 offen
    s_waitcnt lgkmcnt(0)
    s_add_u32 s46, s43, 96768
    buffer_store_dwordx4 v[40:43], v5, s[4:7], s46 offen
    s_mov_b64 exec, s[44:45]
    s_branch prep2_kernel_gdone
prep2_kernel_bpart:
    s_mul_i32 s25, s37, 229376
    s_mul_i32 s39, s23, 448
    s_add_u32 s25, s25, s39
    s_mov_b32 s40, 1.0
    v_lshrrev_b32 v6, 3, v1
    v_and_b32 v5, 7, v1
    v_xor_b32 v5, v5, v6
    v_lshl_add_u32 v6, v2, 3, v6
    v_mul_u32_u24 v16, 8192, v6
    v_lshl_add_u32 v16, v5, 4, v16
    v_mul_u32_u24 v17, 896, v6
    v_lshl_add_u32 v17, v5, 4, v17
    s_add_u32 s60, s24, 0
    s_add_u32 s61, s24, 262144
    s_add_u32 s62, s24, 524288
    s_add_u32 s63, s24, 786432
    s_add_u32 s64, s24, 1048576
    s_add_u32 s65, s24, 1310720
    s_add_u32 s66, s24, 1572864
    s_add_u32 s67, s25, 0
    s_add_u32 s68, s25, 28672
    s_add_u32 s69, s25, 57344
    s_add_u32 s70, s25, 86016
    s_add_u32 s71, s25, 114688
    s_add_u32 s72, s25, 143360
    s_add_u32 s73, s25, 172032
    s_lshl_b32 s74, s14, 10
    v_and_b32 v7, 7, v3
    v_xor_b32 v7, v7, v4
    v_lshlrev_b32 v7, 4, v7
    v_lshl_add_u32 v7, v3, 7, v7
    v_lshrrev_b32 v8, 1, v2
    v_and_b32 v9, 1, v2
    v_mul_u32_u24 v10, 14336, v8
    v_mul_u32_u24 v11, 14336, v9
    v_add_u32 v10, v10, v7
    v_add_u32 v11, v11, v7
    v_add_u32 v11, 28672, v11
    v_mov_b32 v18, v10
    v_xor_b32 v20, 64, v10
    v_add_u32 v19, 57344, v18
    v_add_u32 v21, 57344, v20
    v_mov_b32 v22, v11
    v_xor_b32 v24, 64, v11
    v_add_u32 v23, 57344, v22
    v_add_u32 v25, 57344, v24
    v_lshlrev_b32 v5, 4, v1
    v_lshl_add_u32 v5, v2, 10, v5
    v_add_u32 v5, 0, v5
    s_mov_b32 s3, 9586981
    v_mul_hi_u32 v6, v5, s3
    v_mul_u32_u24 v7, 448, v6
    v_sub_u32 v7, v5, v7
    v_mul_u32_u24 v6, 896, v6
    v_add_u32 v26, v6, v7
    v_lshlrev_b32 v5, 4, v1
    v_lshl_add_u32 v5, v2, 10, v5
    v_add_u32 v5, 4096, v5
    s_mov_b32 s3, 9586981
    v_mul_hi_u32 v6, v5, s3
    v_mul_u32_u24 v7, 448, v6
    v_sub_u32 v7, v5, v7
    v_mul_u32_u24 v6, 896, v6
    v_add_u32 v27, v6, v7
    v_lshlrev_b32 v5, 4, v1
    v_lshl_add_u32 v5, v2, 10, v5
    v_add_u32 v5, 8192, v5
    s_mov_b32 s3, 9586981
    v_mul_hi_u32 v6, v5, s3
    v_mul_u32_u24 v7, 448, v6
    v_sub_u32 v7, v5, v7
    v_mul_u32_u24 v6, 896, v6
    v_add_u32 v28, v6, v7
    v_lshlrev_b32 v5, 4, v1
    v_lshl_add_u32 v5, v2, 10, v5
    v_add_u32 v5, 12288, v5
    s_mov_b32 s3, 9586981
    v_mul_hi_u32 v6, v5, s3
    v_mul_u32_u24 v7, 448, v6
    v_sub_u32 v7, v5, v7
    v_mul_u32_u24 v6, 896, v6
    v_add_u32 v29, v6, v7
    v_lshlrev_b32 v5, 4, v1
    v_lshl_add_u32 v5, v2, 10, v5
    v_add_u32 v5, 16384, v5
    s_mov_b32 s3, 9586981
    v_mul_hi_u32 v6, v5, s3
    v_mul_u32_u24 v7, 448, v6
    v_sub_u32 v7, v5, v7
    v_mul_u32_u24 v6, 896, v6
    v_add_u32 v30, v6, v7
    v_lshlrev_b32 v5, 4, v1
    v_lshl_add_u32 v5, v2, 10, v5
    v_add_u32 v5, 20480, v5
    s_mov_b32 s3, 9586981
    v_mul_hi_u32 v6, v5, s3
    v_mul_u32_u24 v7, 448, v6
    v_sub_u32 v7, v5, v7
    v_mul_u32_u24 v6, 896, v6
    v_add_u32 v31, v6, v7
    v_lshlrev_b32 v5, 4, v1
    v_lshl_add_u32 v5, v2, 10, v5
    v_add_u32 v5, 24576, v5
    s_mov_b32 s3, 9586981
    v_mul_hi_u32 v6, v5, s3
    v_mul_u32_u24 v7, 448, v6
    v_sub_u32 v7, v5, v7
    v_mul_u32_u24 v6, 896, v6
    v_add_u32 v32, v6, v7
    s_mov_b32 s67, s25
    s_mov_b32 s68, s25
    s_mov_b32 s69, s25
    s_mov_b32 s70, s25
    s_mov_b32 s71, s25
    s_mov_b32 s72, s25
    s_mov_b32 s73, s25
    v_lshrrev_b32 v5, 2, v3
    v_lshl_add_u32 v5, v4, 3, v5
    v_mul_u32_u24 v5, 448, v5
    v_and_b32 v6, 3, v3
    v_lshl_add_u32 v5, v6, 3, v5
    v_mul_u32_u24 v6, 224, v9
    v_add_u32 v5, v5, v6
    v_add_u32 v5, 28672, v5
    v_add_u32 v22, 0, v5
    v_add_u32 v24, 14336, v5
    v_add_u32 v23, 57344, v5
    v_add_u32 v25, 71680, v5
    s_add_u32 m0, s74, 0
    s_nop 0
    buffer_load_dwordx4 v16, s[16:19], s60 offen  lds
    s_add_u32 s60, s60, 128
    s_add_u32 m0, s74, 4096
    s_nop 0
    buffer_load_dwordx4 v16, s[16:19], s61 offen  lds
    s_add_u32 s61, s61, 128
    s_add_u32 m0, s74, 8192
    s_nop 0
    buffer_load_dwordx4 v16, s[16:19], s62 offen  lds
    s_add_u32 s62, s62, 128
    s_add_u32 m0, s74, 12288
    s_nop 0
    buffer_load_dwordx4 v16, s[16:19], s63 offen  lds
    s_add_u32 s63, s63, 128
    s_add_u32 m0, s74, 16384
    s_nop 0
    buffer_load_dwordx4 v16, s[16:19], s64 offen  lds
    s_add_u32 s64, s64, 128
    s_add_u32 m0, s74, 20480
    s_nop 0
    buffer_load_dwordx4 v16, s[16:19], s65 offen  lds
    s_add_u32 s65, s65, 128
    s_add_u32 m0, s74, 24576
    s_nop 0
    buffer_load_dwordx4 v16, s[16:19], s66 offen  lds
    s_add_u32 s66, s66, 128
    s_add_u32 m0, s74, 28672
    s_nop 0
    buffer_load_dwordx4 v26, s[96:99], s67 offen  lds
    s_add_u32 s67, s67, 57344
    s_add_u32 m0, s74, 32768
    s_nop 0
    buffer_load_dwordx4 v27, s[96:99], s68 offen  lds
    s_add_u32 s68, s68, 57344
    s_add_u32 m0, s74, 36864
    s_nop 0
    buffer_load_dwordx4 v28, s[96:99], s69 offen  lds
    s_add_u32 s69, s69, 57344
    s_add_u32 m0, s74, 40960
    s_nop 0
    buffer_load_dwordx4 v29, s[96:99], s70 offen  lds
    s_add_u32 s70, s70, 57344
    s_add_u32 m0, s74, 45056
    s_nop 0
    buffer_load_dwordx4 v30, s[96:99], s71 offen  lds
    s_add_u32 s71, s71, 57344
    s_add_u32 m0, s74, 49152
    s_nop 0
    buffer_load_dwordx4 v31, s[96:99], s72 offen  lds
    s_add_u32 s72, s72, 57344
    s_add_u32 m0, s74, 53248
    s_nop 0
    buffer_load_dwordx4 v32, s[96:99], s73 offen  lds
    s_add_u32 s73, s73, 57344
    s_add_u32 m0, s74, 57344
    s_nop 0
    buffer_load_dwordx4 v16, s[16:19], s60 offen  lds
    s_add_u32 s60, s60, 128
    s_add_u32 m0, s74, 61440
    s_nop 0
    buffer_load_dwordx4 v16, s[16:19], s61 offen  lds
    s_add_u32 s61, s61, 128
    s_add_u32 m0, s74, 65536
    s_nop 0
    buffer_load_dwordx4 v16, s[16:19], s62 offen  lds
    s_add_u32 s62, s62, 128
    s_add_u32 m0, s74, 69632
    s_nop 0
    buffer_load_dwordx4 v16, s[16:19], s63 offen  lds
    s_add_u32 s63, s63, 128
    s_add_u32 m0, s74, 73728
    s_nop 0
    buffer_load_dwordx4 v16, s[16:19], s64 offen  lds
    s_add_u32 s64, s64, 128
    s_add_u32 m0, s74, 77824
    s_nop 0
    buffer_load_dwordx4 v16, s[16:19], s65 offen  lds
    s_add_u32 s65, s65, 128
    s_add_u32 m0, s74, 81920
    s_nop 0
    buffer_load_dwordx4 v16, s[16:19], s66 offen  lds
    s_add_u32 s66, s66, 128
    s_add_u32 m0, s74, 86016
    s_nop 0
    buffer_load_dwordx4 v26, s[96:99], s67 offen  lds
    s_add_u32 s67, s67, 57344
    s_add_u32 m0, s74, 90112
    s_nop 0
    buffer_load_dwordx4 v27, s[96:99], s68 offen  lds
    s_add_u32 s68, s68, 57344
    s_add_u32 m0, s74, 94208
    s_nop 0
    buffer_load_dwordx4 v28, s[96:99], s69 offen  lds
    s_add_u32 s69, s69, 57344
    s_add_u32 m0, s74, 98304
    s_nop 0
    buffer_load_dwordx4 v29, s[96:99], s70 offen  lds
    s_add_u32 s70, s70, 57344
    s_add_u32 m0, s74, 102400
    s_nop 0
    buffer_load_dwordx4 v30, s[96:99], s71 offen  lds
    s_add_u32 s71, s71, 57344
    s_add_u32 m0, s74, 106496
    s_nop 0
    buffer_load_dwordx4 v31, s[96:99], s72 offen  lds
    s_add_u32 s72, s72, 57344
    s_add_u32 m0, s74, 110592
    s_nop 0
    buffer_load_dwordx4 v32, s[96:99], s73 offen  lds
    s_add_u32 s73, s73, 57344
    s_waitcnt vmcnt(14)
    s_barrier
    ds_read_b64_tr_b16 v[64:65], v22 offset:0
    ds_read_b64_tr_b16 v[66:67], v22 offset:1792
    ds_read_b64_tr_b16 v[68:69], v22 offset:32
    ds_read_b64_tr_b16 v[70:71], v22 offset:1824
    ds_read_b64_tr_b16 v[72:73], v22 offset:64
    ds_read_b64_tr_b16 v[74:75], v22 offset:1856
    ds_read_b64_tr_b16 v[76:77], v22 offset:96
    ds_read_b64_tr_b16 v[78:79], v22 offset:1888
    ds_read_b64_tr_b16 v[80:81], v22 offset:128
    ds_read_b64_tr_b16 v[82:83], v22 offset:1920
    ds_read_b64_tr_b16 v[84:85], v22 offset:160
    ds_read_b64_tr_b16 v[86:87], v22 offset:1952
    ds_read_b64_tr_b16 v[88:89], v22 offset:192
    ds_read_b64_tr_b16 v[90:91], v22 offset:1984
    ds_read_b128 v[36:39], v18 offset:0
    ds_read_b128 v[40:43], v18 offset:2048
    ds_read_b128 v[44:47], v18 offset:4096
    ds_read_b128 v[48:51], v18 offset:6144
    ds_read_b128 v[52:55], v18 offset:8192
    ds_read_b128 v[56:59], v18 offset:10240
    ds_read_b128 v[60:63], v18 offset:12288
    s_waitcnt lgkmcnt(0)
    v_mfma_f32_16x16x32_bf16 a[0:3], v[36:39], v[64:67], 0
    v_mfma_f32_16x16x32_bf16 a[4:7], v[36:39], v[68:71], 0
    v_mfma_f32_16x16x32_bf16 a[8:11], v[36:39], v[72:75], 0
    ds_read_b64_tr_b16 v[120:121], v24 offset:0
    v_mfma_f32_16x16x32_bf16 a[12:15], v[36:39], v[76:79], 0
    v_mfma_f32_16x16x32_bf16 a[16:19], v[36:39], v[80:83], 0
    ds_read_b64_tr_b16 v[122:123], v24 offset:1792
    v_mfma_f32_16x16x32_bf16 a[20:23], v[36:39], v[84:87], 0
    v_mfma_f32_16x16x32_bf16 a[24:27], v[36:39], v[88:91], 0
    ds_read_b64_tr_b16 v[124:125], v24 offset:32
    v_mfma_f32_16x16x32_bf16 a[28:31], v[40:43], v[64:67], 0
    v_mfma_f32_16x16x32_bf16 a[32:35], v[40:43], v[68:71], 0
    v_mfma_f32_16x16x32_bf16 a[36:39], v[40:43], v[72:75], 0
    ds_read_b64_tr_b16 v[126:127], v24 offset:1824
    v_mfma_f32_16x16x32_bf16 a[40:43], v[40:43], v[76:79], 0
    v_mfma_f32_16x16x32_bf16 a[44:47], v[40:43], v[80:83], 0
    ds_read_b64_tr_b16 v[128:129], v24 offset:64
    v_mfma_f32_16x16x32_bf16 a[48:51], v[40:43], v[84:87], 0
    v_mfma_f32_16x16x32_bf16 a[52:55], v[40:43], v[88:91], 0
    ds_read_b64_tr_b16 v[130:131], v24 offset:1856
    v_mfma_f32_16x16x32_bf16 a[56:59], v[44:47], v[64:67], 0
    v_mfma_f32_16x16x32_bf16 a[60:63], v[44:47], v[68:71], 0
    v_mfma_f32_16x16x32_bf16 a[64:67], v[44:47], v[72:75], 0
    ds_read_b64_tr_b16 v[132:133], v24 offset:96
    v_mfma_f32_16x16x32_bf16 a[68:71], v[44:47], v[76:79], 0
    v_mfma_f32_16x16x32_bf16 a[72:75], v[44:47], v[80:83], 0
    ds_read_b64_tr_b16 v[134:135], v24 offset:1888
    v_mfma_f32_16x16x32_bf16 a[76:79], v[44:47], v[84:87], 0
    v_mfma_f32_16x16x32_bf16 a[80:83], v[44:47], v[88:91], 0
    ds_read_b64_tr_b16 v[136:137], v24 offset:128
    v_mfma_f32_16x16x32_bf16 a[84:87], v[48:51], v[64:67], 0
    v_mfma_f32_16x16x32_bf16 a[88:91], v[48:51], v[68:71], 0
    v_mfma_f32_16x16x32_bf16 a[92:95], v[48:51], v[72:75], 0
    ds_read_b64_tr_b16 v[138:139], v24 offset:1920
    v_mfma_f32_16x16x32_bf16 a[96:99], v[48:51], v[76:79], 0
    v_mfma_f32_16x16x32_bf16 a[100:103], v[48:51], v[80:83], 0
    ds_read_b64_tr_b16 v[140:141], v24 offset:160
    v_mfma_f32_16x16x32_bf16 a[104:107], v[48:51], v[84:87], 0
    v_mfma_f32_16x16x32_bf16 a[108:111], v[48:51], v[88:91], 0
    ds_read_b64_tr_b16 v[142:143], v24 offset:1952
    v_mfma_f32_16x16x32_bf16 a[112:115], v[52:55], v[64:67], 0
    v_mfma_f32_16x16x32_bf16 a[116:119], v[52:55], v[68:71], 0
    v_mfma_f32_16x16x32_bf16 a[120:123], v[52:55], v[72:75], 0
    ds_read_b64_tr_b16 v[144:145], v24 offset:192
    v_mfma_f32_16x16x32_bf16 a[124:127], v[52:55], v[76:79], 0
    v_mfma_f32_16x16x32_bf16 a[128:131], v[52:55], v[80:83], 0
    ds_read_b64_tr_b16 v[146:147], v24 offset:1984
    v_mfma_f32_16x16x32_bf16 a[132:135], v[52:55], v[84:87], 0
    v_mfma_f32_16x16x32_bf16 a[136:139], v[52:55], v[88:91], 0
    ds_read_b128 v[92:95], v20 offset:0
    v_mfma_f32_16x16x32_bf16 a[140:143], v[56:59], v[64:67], 0
    v_mfma_f32_16x16x32_bf16 a[144:147], v[56:59], v[68:71], 0
    v_mfma_f32_16x16x32_bf16 a[148:151], v[56:59], v[72:75], 0
    ds_read_b128 v[96:99], v20 offset:2048
    v_mfma_f32_16x16x32_bf16 a[152:155], v[56:59], v[76:79], 0
    v_mfma_f32_16x16x32_bf16 a[156:159], v[56:59], v[80:83], 0
    ds_read_b128 v[100:103], v20 offset:4096
    v_mfma_f32_16x16x32_bf16 a[160:163], v[56:59], v[84:87], 0
    v_mfma_f32_16x16x32_bf16 a[164:167], v[56:59], v[88:91], 0
    ds_read_b128 v[104:107], v20 offset:6144
    v_mfma_f32_16x16x32_bf16 a[168:171], v[60:63], v[64:67], 0
    v_mfma_f32_16x16x32_bf16 a[172:175], v[60:63], v[68:71], 0
    v_mfma_f32_16x16x32_bf16 a[176:179], v[60:63], v[72:75], 0
    ds_read_b128 v[108:111], v20 offset:8192
    v_mfma_f32_16x16x32_bf16 a[180:183], v[60:63], v[76:79], 0
    v_mfma_f32_16x16x32_bf16 a[184:187], v[60:63], v[80:83], 0
    ds_read_b128 v[112:115], v20 offset:10240
    v_mfma_f32_16x16x32_bf16 a[188:191], v[60:63], v[84:87], 0
    v_mfma_f32_16x16x32_bf16 a[192:195], v[60:63], v[88:91], 0
    ds_read_b128 v[116:119], v20 offset:12288
    s_waitcnt lgkmcnt(0) vmcnt(0)
    s_barrier
    v_mfma_f32_16x16x32_bf16 a[0:3], v[92:95], v[120:123], a[0:3]
    v_mfma_f32_16x16x32_bf16 a[4:7], v[92:95], v[124:127], a[4:7]
    ds_read_b64_tr_b16 v[64:65], v23 offset:0
    v_mfma_f32_16x16x32_bf16 a[8:11], v[92:95], v[128:131], a[8:11]
    ds_read_b64_tr_b16 v[66:67], v23 offset:1792
    v_mfma_f32_16x16x32_bf16 a[12:15], v[92:95], v[132:135], a[12:15]
    v_mfma_f32_16x16x32_bf16 a[16:19], v[92:95], v[136:139], a[16:19]
    s_add_u32 m0, s74, 0
    s_nop 0
    buffer_load_dwordx4 v16, s[16:19], s60 offen  lds
    s_add_u32 s60, s60, 128
    v_mfma_f32_16x16x32_bf16 a[20:23], v[92:95], v[140:143], a[20:23]
    ds_read_b64_tr_b16 v[68:69], v23 offset:32
    v_mfma_f32_16x16x32_bf16 a[24:27], v[92:95], v[144:147], a[24:27]
    s_add_u32 m0, s74, 4096
    s_nop 0
    buffer_load_dwordx4 v16, s[16:19], s61 offen  lds
    s_add_u32 s61, s61, 128
    v_mfma_f32_16x16x32_bf16 a[28:31], v[96:99], v[120:123], a[28:31]
    v_mfma_f32_16x16x32_bf16 a[32:35], v[96:99], v[124:127], a[32:35]
    ds_read_b64_tr_b16 v[70:71], v23 offset:1824
    v_mfma_f32_16x16x32_bf16 a[36:39], v[96:99], v[128:131], a[36:39]
    ds_read_b64_tr_b16 v[72:73], v23 offset:64
    v_mfma_f32_16x16x32_bf16 a[40:43], v[96:99], v[132:135], a[40:43]
    v_mfma_f32_16x16x32_bf16 a[44:47], v[96:99], v[136:139], a[44:47]
    s_add_u32 m0, s74, 8192
    s_nop 0
    buffer_load_dwordx4 v16, s[16:19], s62 offen  lds
    s_add_u32 s62, s62, 128
    v_mfma_f32_16x16x32_bf16 a[48:51], v[96:99], v[140:143], a[48:51]
    ds_read_b64_tr_b16 v[74:75], v23 offset:1856
    v_mfma_f32_16x16x32_bf16 a[52:55], v[96:99], v[144:147], a[52:55]
    s_add_u32 m0, s74, 12288
    s_nop 0
    buffer_load_dwordx4 v16, s[16:19], s63 offen  lds
    s_add_u32 s63, s63, 128
    v_mfma_f32_16x16x32_bf16 a[56:59], v[100:103], v[120:123], a[56:59]
    v_mfma_f32_16x16x32_bf16 a[60:63], v[100:103], v[124:127], a[60:63]
    ds_read_b64_tr_b16 v[76:77], v23 offset:96
    v_mfma_f32_16x16x32_bf16 a[64:67], v[100:103], v[128:131], a[64:67]
    ds_read_b64_tr_b16 v[78:79], v23 offset:1888
    v_mfma_f32_16x16x32_bf16 a[68:71], v[100:103], v[132:135], a[68:71]
    v_mfma_f32_16x16x32_bf16 a[72:75], v[100:103], v[136:139], a[72:75]
    s_add_u32 m0, s74, 16384
    s_nop 0
    buffer_load_dwordx4 v16, s[16:19], s64 offen  lds
    s_add_u32 s64, s64, 128
    v_mfma_f32_16x16x32_bf16 a[76:79], v[100:103], v[140:143], a[76:79]
    ds_read_b64_tr_b16 v[80:81], v23 offset:128
    v_mfma_f32_16x16x32_bf16 a[80:83], v[100:103], v[144:147], a[80:83]
    s_add_u32 m0, s74, 20480
    s_nop 0
    buffer_load_dwordx4 v16, s[16:19], s65 offen  lds
    s_add_u32 s65, s65, 128
    v_mfma_f32_16x16x32_bf16 a[84:87], v[104:107], v[120:123], a[84:87]
    v_mfma_f32_16x16x32_bf16 a[88:91], v[104:107], v[124:127], a[88:91]
    ds_read_b64_tr_b16 v[82:83], v23 offset:1920
    v_mfma_f32_16x16x32_bf16 a[92:95], v[104:107], v[128:131], a[92:95]
    ds_read_b64_tr_b16 v[84:85], v23 offset:160
    v_mfma_f32_16x16x32_bf16 a[96:99], v[104:107], v[132:135], a[96:99]
    v_mfma_f32_16x16x32_bf16 a[100:103], v[104:107], v[136:139], a[100:103]
    s_add_u32 m0, s74, 24576
    s_nop 0
    buffer_load_dwordx4 v16, s[16:19], s66 offen  lds
    s_add_u32 s66, s66, 128
    v_mfma_f32_16x16x32_bf16 a[104:107], v[104:107], v[140:143], a[104:107]
    ds_read_b64_tr_b16 v[86:87], v23 offset:1952
    v_mfma_f32_16x16x32_bf16 a[108:111], v[104:107], v[144:147], a[108:111]
    s_add_u32 m0, s74, 28672
    s_nop 0
    buffer_load_dwordx4 v26, s[96:99], s67 offen  lds
    s_add_u32 s67, s67, 57344
    v_mfma_f32_16x16x32_bf16 a[112:115], v[108:111], v[120:123], a[112:115]
    v_mfma_f32_16x16x32_bf16 a[116:119], v[108:111], v[124:127], a[116:119]
    ds_read_b64_tr_b16 v[88:89], v23 offset:192
    v_mfma_f32_16x16x32_bf16 a[120:123], v[108:111], v[128:131], a[120:123]
    ds_read_b64_tr_b16 v[90:91], v23 offset:1984
    v_mfma_f32_16x16x32_bf16 a[124:127], v[108:111], v[132:135], a[124:127]
    v_mfma_f32_16x16x32_bf16 a[128:131], v[108:111], v[136:139], a[128:131]
    s_add_u32 m0, s74, 32768
    s_nop 0
    buffer_load_dwordx4 v27, s[96:99], s68 offen  lds
    s_add_u32 s68, s68, 57344
    v_mfma_f32_16x16x32_bf16 a[132:135], v[108:111], v[140:143], a[132:135]
    ds_read_b128 v[36:39], v19 offset:0
    v_mfma_f32_16x16x32_bf16 a[136:139], v[108:111], v[144:147], a[136:139]
    s_add_u32 m0, s74, 36864
    s_nop 0
    buffer_load_dwordx4 v28, s[96:99], s69 offen  lds
    s_add_u32 s69, s69, 57344
    v_mfma_f32_16x16x32_bf16 a[140:143], v[112:115], v[120:123], a[140:143]
    v_mfma_f32_16x16x32_bf16 a[144:147], v[112:115], v[124:127], a[144:147]
    ds_read_b128 v[40:43], v19 offset:2048
    v_mfma_f32_16x16x32_bf16 a[148:151], v[112:115], v[128:131], a[148:151]
    ds_read_b128 v[44:47], v19 offset:4096
    v_mfma_f32_16x16x32_bf16 a[152:155], v[112:115], v[132:135], a[152:155]
    v_mfma_f32_16x16x32_bf16 a[156:159], v[112:115], v[136:139], a[156:159]
    s_add_u32 m0, s74, 40960
    s_nop 0
    buffer_load_dwordx4 v29, s[96:99], s70 offen  lds
    s_add_u32 s70, s70, 57344
    v_mfma_f32_16x16x32_bf16 a[160:163], v[112:115], v[140:143], a[160:163]
    ds_read_b128 v[48:51], v19 offset:6144
    v_mfma_f32_16x16x32_bf16 a[164:167], v[112:115], v[144:147], a[164:167]
    s_add_u32 m0, s74, 45056
    s_nop 0
    buffer_load_dwordx4 v30, s[96:99], s71 offen  lds
    s_add_u32 s71, s71, 57344
    v_mfma_f32_16x16x32_bf16 a[168:171], v[116:119], v[120:123], a[168:171]
    v_mfma_f32_16x16x32_bf16 a[172:175], v[116:119], v[124:127], a[172:175]
    ds_read_b128 v[52:55], v19 offset:8192
    v_mfma_f32_16x16x32_bf16 a[176:179], v[116:119], v[128:131], a[176:179]
    ds_read_b128 v[56:59], v19 offset:10240
    v_mfma_f32_16x16x32_bf16 a[180:183], v[116:119], v[132:135], a[180:183]
    v_mfma_f32_16x16x32_bf16 a[184:187], v[116:119], v[136:139], a[184:187]
    s_add_u32 m0, s74, 49152
    s_nop 0
    buffer_load_dwordx4 v31, s[96:99], s72 offen  lds
    s_add_u32 s72, s72, 57344
    v_mfma_f32_16x16x32_bf16 a[188:191], v[116:119], v[140:143], a[188:191]
    ds_read_b128 v[60:63], v19 offset:12288
    v_mfma_f32_16x16x32_bf16 a[192:195], v[116:119], v[144:147], a[192:195]
    s_add_u32 m0, s74, 53248
    s_nop 0
    buffer_load_dwordx4 v32, s[96:99], s73 offen  lds
    s_add_u32 s73, s73, 57344
    s_waitcnt lgkmcnt(0)
    v_mfma_f32_16x16x32_bf16 a[0:3], v[36:39], v[64:67], a[0:3]
    v_mfma_f32_16x16x32_bf16 a[4:7], v[36:39], v[68:71], a[4:7]
    v_mfma_f32_16x16x32_bf16 a[8:11], v[36:39], v[72:75], a[8:11]
    ds_read_b64_tr_b16 v[120:121], v25 offset:0
    v_mfma_f32_16x16x32_bf16 a[12:15], v[36:39], v[76:79], a[12:15]
    v_mfma_f32_16x16x32_bf16 a[16:19], v[36:39], v[80:83], a[16:19]
    ds_read_b64_tr_b16 v[122:123], v25 offset:1792
    v_mfma_f32_16x16x32_bf16 a[20:23], v[36:39], v[84:87], a[20:23]
    v_mfma_f32_16x16x32_bf16 a[24:27], v[36:39], v[88:91], a[24:27]
    ds_read_b64_tr_b16 v[124:125], v25 offset:32
    v_mfma_f32_16x16x32_bf16 a[28:31], v[40:43], v[64:67], a[28:31]
    v_mfma_f32_16x16x32_bf16 a[32:35], v[40:43], v[68:71], a[32:35]
    v_mfma_f32_16x16x32_bf16 a[36:39], v[40:43], v[72:75], a[36:39]
    ds_read_b64_tr_b16 v[126:127], v25 offset:1824
    v_mfma_f32_16x16x32_bf16 a[40:43], v[40:43], v[76:79], a[40:43]
    v_mfma_f32_16x16x32_bf16 a[44:47], v[40:43], v[80:83], a[44:47]
    ds_read_b64_tr_b16 v[128:129], v25 offset:64
    v_mfma_f32_16x16x32_bf16 a[48:51], v[40:43], v[84:87], a[48:51]
    v_mfma_f32_16x16x32_bf16 a[52:55], v[40:43], v[88:91], a[52:55]
    ds_read_b64_tr_b16 v[130:131], v25 offset:1856
    v_mfma_f32_16x16x32_bf16 a[56:59], v[44:47], v[64:67], a[56:59]
    v_mfma_f32_16x16x32_bf16 a[60:63], v[44:47], v[68:71], a[60:63]
    v_mfma_f32_16x16x32_bf16 a[64:67], v[44:47], v[72:75], a[64:67]
    ds_read_b64_tr_b16 v[132:133], v25 offset:96
    v_mfma_f32_16x16x32_bf16 a[68:71], v[44:47], v[76:79], a[68:71]
    v_mfma_f32_16x16x32_bf16 a[72:75], v[44:47], v[80:83], a[72:75]
    ds_read_b64_tr_b16 v[134:135], v25 offset:1888
    v_mfma_f32_16x16x32_bf16 a[76:79], v[44:47], v[84:87], a[76:79]
    v_mfma_f32_16x16x32_bf16 a[80:83], v[44:47], v[88:91], a[80:83]
    ds_read_b64_tr_b16 v[136:137], v25 offset:128
    v_mfma_f32_16x16x32_bf16 a[84:87], v[48:51], v[64:67], a[84:87]
    v_mfma_f32_16x16x32_bf16 a[88:91], v[48:51], v[68:71], a[88:91]
    v_mfma_f32_16x16x32_bf16 a[92:95], v[48:51], v[72:75], a[92:95]
    ds_read_b64_tr_b16 v[138:139], v25 offset:1920
    v_mfma_f32_16x16x32_bf16 a[96:99], v[48:51], v[76:79], a[96:99]
    v_mfma_f32_16x16x32_bf16 a[100:103], v[48:51], v[80:83], a[100:103]
    ds_read_b64_tr_b16 v[140:141], v25 offset:160
    v_mfma_f32_16x16x32_bf16 a[104:107], v[48:51], v[84:87], a[104:107]
    v_mfma_f32_16x16x32_bf16 a[108:111], v[48:51], v[88:91], a[108:111]
    ds_read_b64_tr_b16 v[142:143], v25 offset:1952
    v_mfma_f32_16x16x32_bf16 a[112:115], v[52:55], v[64:67], a[112:115]
    v_mfma_f32_16x16x32_bf16 a[116:119], v[52:55], v[68:71], a[116:119]
    v_mfma_f32_16x16x32_bf16 a[120:123], v[52:55], v[72:75], a[120:123]
    ds_read_b64_tr_b16 v[144:145], v25 offset:192
    v_mfma_f32_16x16x32_bf16 a[124:127], v[52:55], v[76:79], a[124:127]
    v_mfma_f32_16x16x32_bf16 a[128:131], v[52:55], v[80:83], a[128:131]
    ds_read_b64_tr_b16 v[146:147], v25 offset:1984
    v_mfma_f32_16x16x32_bf16 a[132:135], v[52:55], v[84:87], a[132:135]
    v_mfma_f32_16x16x32_bf16 a[136:139], v[52:55], v[88:91], a[136:139]
    ds_read_b128 v[92:95], v21 offset:0
    v_mfma_f32_16x16x32_bf16 a[140:143], v[56:59], v[64:67], a[140:143]
    v_mfma_f32_16x16x32_bf16 a[144:147], v[56:59], v[68:71], a[144:147]
    v_mfma_f32_16x16x32_bf16 a[148:151], v[56:59], v[72:75], a[148:151]
    ds_read_b128 v[96:99], v21 offset:2048
    v_mfma_f32_16x16x32_bf16 a[152:155], v[56:59], v[76:79], a[152:155]
    v_mfma_f32_16x16x32_bf16 a[156:159], v[56:59], v[80:83], a[156:159]
    ds_read_b128 v[100:103], v21 offset:4096
    v_mfma_f32_16x16x32_bf16 a[160:163], v[56:59], v[84:87], a[160:163]
    v_mfma_f32_16x16x32_bf16 a[164:167], v[56:59], v[88:91], a[164:167]
    ds_read_b128 v[104:107], v21 offset:6144
    v_mfma_f32_16x16x32_bf16 a[168:171], v[60:63], v[64:67], a[168:171]
    v_mfma_f32_16x16x32_bf16 a[172:175], v[60:63], v[68:71], a[172:175]
    v_mfma_f32_16x16x32_bf16 a[176:179], v[60:63], v[72:75], a[176:179]
    ds_read_b128 v[108:111], v21 offset:8192
    v_mfma_f32_16x16x32_bf16 a[180:183], v[60:63], v[76:79], a[180:183]
    v_mfma_f32_16x16x32_bf16 a[184:187], v[60:63], v[80:83], a[184:187]
    ds_read_b128 v[112:115], v21 offset:10240
    v_mfma_f32_16x16x32_bf16 a[188:191], v[60:63], v[84:87], a[188:191]
    v_mfma_f32_16x16x32_bf16 a[192:195], v[60:63], v[88:91], a[192:195]
    ds_read_b128 v[116:119], v21 offset:12288
    s_waitcnt lgkmcnt(0) vmcnt(0)
    s_barrier
    v_mfma_f32_16x16x32_bf16 a[0:3], v[92:95], v[120:123], a[0:3]
    v_mfma_f32_16x16x32_bf16 a[4:7], v[92:95], v[124:127], a[4:7]
    ds_read_b64_tr_b16 v[64:65], v22 offset:0
    v_mfma_f32_16x16x32_bf16 a[8:11], v[92:95], v[128:131], a[8:11]
    ds_read_b64_tr_b16 v[66:67], v22 offset:1792
    v_mfma_f32_16x16x32_bf16 a[12:15], v[92:95], v[132:135], a[12:15]
    v_mfma_f32_16x16x32_bf16 a[16:19], v[92:95], v[136:139], a[16:19]
    s_add_u32 m0, s74, 57344
    s_nop 0
    buffer_load_dwordx4 v16, s[16:19], s60 offen  lds
    s_add_u32 s60, s60, 128
    v_mfma_f32_16x16x32_bf16 a[20:23], v[92:95], v[140:143], a[20:23]
    ds_read_b64_tr_b16 v[68:69], v22 offset:32
    v_mfma_f32_16x16x32_bf16 a[24:27], v[92:95], v[144:147], a[24:27]
    s_add_u32 m0, s74, 61440
    s_nop 0
    buffer_load_dwordx4 v16, s[16:19], s61 offen  lds
    s_add_u32 s61, s61, 128
    v_mfma_f32_16x16x32_bf16 a[28:31], v[96:99], v[120:123], a[28:31]
    v_mfma_f32_16x16x32_bf16 a[32:35], v[96:99], v[124:127], a[32:35]
    ds_read_b64_tr_b16 v[70:71], v22 offset:1824
    v_mfma_f32_16x16x32_bf16 a[36:39], v[96:99], v[128:131], a[36:39]
    ds_read_b64_tr_b16 v[72:73], v22 offset:64
    v_mfma_f32_16x16x32_bf16 a[40:43], v[96:99], v[132:135], a[40:43]
    v_mfma_f32_16x16x32_bf16 a[44:47], v[96:99], v[136:139], a[44:47]
    s_add_u32 m0, s74, 65536
    s_nop 0
    buffer_load_dwordx4 v16, s[16:19], s62 offen  lds
    s_add_u32 s62, s62, 128
    v_mfma_f32_16x16x32_bf16 a[48:51], v[96:99], v[140:143], a[48:51]
    ds_read_b64_tr_b16 v[74:75], v22 offset:1856
    v_mfma_f32_16x16x32_bf16 a[52:55], v[96:99], v[144:147], a[52:55]
    s_add_u32 m0, s74, 69632
    s_nop 0
    buffer_load_dwordx4 v16, s[16:19], s63 offen  lds
    s_add_u32 s63, s63, 128
    v_mfma_f32_16x16x32_bf16 a[56:59], v[100:103], v[120:123], a[56:59]
    v_mfma_f32_16x16x32_bf16 a[60:63], v[100:103], v[124:127], a[60:63]
    ds_read_b64_tr_b16 v[76:77], v22 offset:96
    v_mfma_f32_16x16x32_bf16 a[64:67], v[100:103], v[128:131], a[64:67]
    ds_read_b64_tr_b16 v[78:79], v22 offset:1888
    v_mfma_f32_16x16x32_bf16 a[68:71], v[100:103], v[132:135], a[68:71]
    v_mfma_f32_16x16x32_bf16 a[72:75], v[100:103], v[136:139], a[72:75]
    s_add_u32 m0, s74, 73728
    s_nop 0
    buffer_load_dwordx4 v16, s[16:19], s64 offen  lds
    s_add_u32 s64, s64, 128
    v_mfma_f32_16x16x32_bf16 a[76:79], v[100:103], v[140:143], a[76:79]
    ds_read_b64_tr_b16 v[80:81], v22 offset:128
    v_mfma_f32_16x16x32_bf16 a[80:83], v[100:103], v[144:147], a[80:83]
    s_add_u32 m0, s74, 77824
    s_nop 0
    buffer_load_dwordx4 v16, s[16:19], s65 offen  lds
    s_add_u32 s65, s65, 128
    v_mfma_f32_16x16x32_bf16 a[84:87], v[104:107], v[120:123], a[84:87]
    v_mfma_f32_16x16x32_bf16 a[88:91], v[104:107], v[124:127], a[88:91]
    ds_read_b64_tr_b16 v[82:83], v22 offset:1920
    v_mfma_f32_16x16x32_bf16 a[92:95], v[104:107], v[128:131], a[92:95]
    ds_read_b64_tr_b16 v[84:85], v22 offset:160
    v_mfma_f32_16x16x32_bf16 a[96:99], v[104:107], v[132:135], a[96:99]
    v_mfma_f32_16x16x32_bf16 a[100:103], v[104:107], v[136:139], a[100:103]
    s_add_u32 m0, s74, 81920
    s_nop 0
    buffer_load_dwordx4 v16, s[16:19], s66 offen  lds
    s_add_u32 s66, s66, 128
    v_mfma_f32_16x16x32_bf16 a[104:107], v[104:107], v[140:143], a[104:107]
    ds_read_b64_tr_b16 v[86:87], v22 offset:1952
    v_mfma_f32_16x16x32_bf16 a[108:111], v[104:107], v[144:147], a[108:111]
    s_add_u32 m0, s74, 86016
    s_nop 0
    buffer_load_dwordx4 v26, s[96:99], s67 offen  lds
    s_add_u32 s67, s67, 57344
    v_mfma_f32_16x16x32_bf16 a[112:115], v[108:111], v[120:123], a[112:115]
    v_mfma_f32_16x16x32_bf16 a[116:119], v[108:111], v[124:127], a[116:119]
    ds_read_b64_tr_b16 v[88:89], v22 offset:192
    v_mfma_f32_16x16x32_bf16 a[120:123], v[108:111], v[128:131], a[120:123]
    ds_read_b64_tr_b16 v[90:91], v22 offset:1984
    v_mfma_f32_16x16x32_bf16 a[124:127], v[108:111], v[132:135], a[124:127]
    v_mfma_f32_16x16x32_bf16 a[128:131], v[108:111], v[136:139], a[128:131]
    s_add_u32 m0, s74, 90112
    s_nop 0
    buffer_load_dwordx4 v27, s[96:99], s68 offen  lds
    s_add_u32 s68, s68, 57344
    v_mfma_f32_16x16x32_bf16 a[132:135], v[108:111], v[140:143], a[132:135]
    ds_read_b128 v[36:39], v18 offset:0
    v_mfma_f32_16x16x32_bf16 a[136:139], v[108:111], v[144:147], a[136:139]
    s_add_u32 m0, s74, 94208
    s_nop 0
    buffer_load_dwordx4 v28, s[96:99], s69 offen  lds
    s_add_u32 s69, s69, 57344
    v_mfma_f32_16x16x32_bf16 a[140:143], v[112:115], v[120:123], a[140:143]
    v_mfma_f32_16x16x32_bf16 a[144:147], v[112:115], v[124:127], a[144:147]
    ds_read_b128 v[40:43], v18 offset:2048
    v_mfma_f32_16x16x32_bf16 a[148:151], v[112:115], v[128:131], a[148:151]
    ds_read_b128 v[44:47], v18 offset:4096
    v_mfma_f32_16x16x32_bf16 a[152:155], v[112:115], v[132:135], a[152:155]
    v_mfma_f32_16x16x32_bf16 a[156:159], v[112:115], v[136:139], a[156:159]
    s_add_u32 m0, s74, 98304
    s_nop 0
    buffer_load_dwordx4 v29, s[96:99], s70 offen  lds
    s_add_u32 s70, s70, 57344
    v_mfma_f32_16x16x32_bf16 a[160:163], v[112:115], v[140:143], a[160:163]
    ds_read_b128 v[48:51], v18 offset:6144
    v_mfma_f32_16x16x32_bf16 a[164:167], v[112:115], v[144:147], a[164:167]
    s_add_u32 m0, s74, 102400
    s_nop 0
    buffer_load_dwordx4 v30, s[96:99], s71 offen  lds
    s_add_u32 s71, s71, 57344
    v_mfma_f32_16x16x32_bf16 a[168:171], v[116:119], v[120:123], a[168:171]
    v_mfma_f32_16x16x32_bf16 a[172:175], v[116:119], v[124:127], a[172:175]
    ds_read_b128 v[52:55], v18 offset:8192
    v_mfma_f32_16x16x32_bf16 a[176:179], v[116:119], v[128:131], a[176:179]
    ds_read_b128 v[56:59], v18 offset:10240
    v_mfma_f32_16x16x32_bf16 a[180:183], v[116:119], v[132:135], a[180:183]
    v_mfma_f32_16x16x32_bf16 a[184:187], v[116:119], v[136:139], a[184:187]
    s_add_u32 m0, s74, 106496
    s_nop 0
    buffer_load_dwordx4 v31, s[96:99], s72 offen  lds
    s_add_u32 s72, s72, 57344
    v_mfma_f32_16x16x32_bf16 a[188:191], v[116:119], v[140:143], a[188:191]
    ds_read_b128 v[60:63], v18 offset:12288
    v_mfma_f32_16x16x32_bf16 a[192:195], v[116:119], v[144:147], a[192:195]
    s_add_u32 m0, s74, 110592
    s_nop 0
    buffer_load_dwordx4 v32, s[96:99], s73 offen  lds
    s_add_u32 s73, s73, 57344
    s_waitcnt lgkmcnt(0)
    v_mfma_f32_16x16x32_bf16 a[0:3], v[36:39], v[64:67], a[0:3]
    v_mfma_f32_16x16x32_bf16 a[4:7], v[36:39], v[68:71], a[4:7]
    v_mfma_f32_16x16x32_bf16 a[8:11], v[36:39], v[72:75], a[8:11]
    ds_read_b64_tr_b16 v[120:121], v24 offset:0
    v_mfma_f32_16x16x32_bf16 a[12:15], v[36:39], v[76:79], a[12:15]
    v_mfma_f32_16x16x32_bf16 a[16:19], v[36:39], v[80:83], a[16:19]
    ds_read_b64_tr_b16 v[122:123], v24 offset:1792
    v_mfma_f32_16x16x32_bf16 a[20:23], v[36:39], v[84:87], a[20:23]
    v_mfma_f32_16x16x32_bf16 a[24:27], v[36:39], v[88:91], a[24:27]
    ds_read_b64_tr_b16 v[124:125], v24 offset:32
    v_mfma_f32_16x16x32_bf16 a[28:31], v[40:43], v[64:67], a[28:31]
    v_mfma_f32_16x16x32_bf16 a[32:35], v[40:43], v[68:71], a[32:35]
    v_mfma_f32_16x16x32_bf16 a[36:39], v[40:43], v[72:75], a[36:39]
    ds_read_b64_tr_b16 v[126:127], v24 offset:1824
    v_mfma_f32_16x16x32_bf16 a[40:43], v[40:43], v[76:79], a[40:43]
    v_mfma_f32_16x16x32_bf16 a[44:47], v[40:43], v[80:83], a[44:47]
    ds_read_b64_tr_b16 v[128:129], v24 offset:64
    v_mfma_f32_16x16x32_bf16 a[48:51], v[40:43], v[84:87], a[48:51]
    v_mfma_f32_16x16x32_bf16 a[52:55], v[40:43], v[88:91], a[52:55]
    ds_read_b64_tr_b16 v[130:131], v24 offset:1856
    v_mfma_f32_16x16x32_bf16 a[56:59], v[44:47], v[64:67], a[56:59]
    v_mfma_f32_16x16x32_bf16 a[60:63], v[44:47], v[68:71], a[60:63]
    v_mfma_f32_16x16x32_bf16 a[64:67], v[44:47], v[72:75], a[64:67]
    ds_read_b64_tr_b16 v[132:133], v24 offset:96
    v_mfma_f32_16x16x32_bf16 a[68:71], v[44:47], v[76:79], a[68:71]
    v_mfma_f32_16x16x32_bf16 a[72:75], v[44:47], v[80:83], a[72:75]
    ds_read_b64_tr_b16 v[134:135], v24 offset:1888
    v_mfma_f32_16x16x32_bf16 a[76:79], v[44:47], v[84:87], a[76:79]
    v_mfma_f32_16x16x32_bf16 a[80:83], v[44:47], v[88:91], a[80:83]
    ds_read_b64_tr_b16 v[136:137], v24 offset:128
    v_mfma_f32_16x16x32_bf16 a[84:87], v[48:51], v[64:67], a[84:87]
    v_mfma_f32_16x16x32_bf16 a[88:91], v[48:51], v[68:71], a[88:91]
    v_mfma_f32_16x16x32_bf16 a[92:95], v[48:51], v[72:75], a[92:95]
    ds_read_b64_tr_b16 v[138:139], v24 offset:1920
    v_mfma_f32_16x16x32_bf16 a[96:99], v[48:51], v[76:79], a[96:99]
    v_mfma_f32_16x16x32_bf16 a[100:103], v[48:51], v[80:83], a[100:103]
    ds_read_b64_tr_b16 v[140:141], v24 offset:160
    v_mfma_f32_16x16x32_bf16 a[104:107], v[48:51], v[84:87], a[104:107]
    v_mfma_f32_16x16x32_bf16 a[108:111], v[48:51], v[88:91], a[108:111]
    ds_read_b64_tr_b16 v[142:143], v24 offset:1952
    v_mfma_f32_16x16x32_bf16 a[112:115], v[52:55], v[64:67], a[112:115]
    v_mfma_f32_16x16x32_bf16 a[116:119], v[52:55], v[68:71], a[116:119]
    v_mfma_f32_16x16x32_bf16 a[120:123], v[52:55], v[72:75], a[120:123]
    ds_read_b64_tr_b16 v[144:145], v24 offset:192
    v_mfma_f32_16x16x32_bf16 a[124:127], v[52:55], v[76:79], a[124:127]
    v_mfma_f32_16x16x32_bf16 a[128:131], v[52:55], v[80:83], a[128:131]
    ds_read_b64_tr_b16 v[146:147], v24 offset:1984
    v_mfma_f32_16x16x32_bf16 a[132:135], v[52:55], v[84:87], a[132:135]
    v_mfma_f32_16x16x32_bf16 a[136:139], v[52:55], v[88:91], a[136:139]
    ds_read_b128 v[92:95], v20 offset:0
    v_mfma_f32_16x16x32_bf16 a[140:143], v[56:59], v[64:67], a[140:143]
    v_mfma_f32_16x16x32_bf16 a[144:147], v[56:59], v[68:71], a[144:147]
    v_mfma_f32_16x16x32_bf16 a[148:151], v[56:59], v[72:75], a[148:151]
    ds_read_b128 v[96:99], v20 offset:2048
    v_mfma_f32_16x16x32_bf16 a[152:155], v[56:59], v[76:79], a[152:155]
    v_mfma_f32_16x16x32_bf16 a[156:159], v[56:59], v[80:83], a[156:159]
    ds_read_b128 v[100:103], v20 offset:4096
    v_mfma_f32_16x16x32_bf16 a[160:163], v[56:59], v[84:87], a[160:163]
    v_mfma_f32_16x16x32_bf16 a[164:167], v[56:59], v[88:91], a[164:167]
    ds_read_b128 v[104:107], v20 offset:6144
    v_mfma_f32_16x16x32_bf16 a[168:171], v[60:63], v[64:67], a[168:171]
    v_mfma_f32_16x16x32_bf16 a[172:175], v[60:63], v[68:71], a[172:175]
    v_mfma_f32_16x16x32_bf16 a[176:179], v[60:63], v[72:75], a[176:179]
    ds_read_b128 v[108:111], v20 offset:8192
    v_mfma_f32_16x16x32_bf16 a[180:183], v[60:63], v[76:79], a[180:183]
    v_mfma_f32_16x16x32_bf16 a[184:187], v[60:63], v[80:83], a[184:187]
    ds_read_b128 v[112:115], v20 offset:10240
    v_mfma_f32_16x16x32_bf16 a[188:191], v[60:63], v[84:87], a[188:191]
    v_mfma_f32_16x16x32_bf16 a[192:195], v[60:63], v[88:91], a[192:195]
    ds_read_b128 v[116:119], v20 offset:12288
    s_waitcnt lgkmcnt(0) vmcnt(0)
    s_barrier
    v_mfma_f32_16x16x32_bf16 a[0:3], v[92:95], v[120:123], a[0:3]
    v_mfma_f32_16x16x32_bf16 a[4:7], v[92:95], v[124:127], a[4:7]
    v_mfma_f32_16x16x32_bf16 a[8:11], v[92:95], v[128:131], a[8:11]
    ds_read_b64_tr_b16 v[64:65], v23 offset:0
    v_mfma_f32_16x16x32_bf16 a[12:15], v[92:95], v[132:135], a[12:15]
    v_mfma_f32_16x16x32_bf16 a[16:19], v[92:95], v[136:139], a[16:19]
    ds_read_b64_tr_b16 v[66:67], v23 offset:1792
    v_mfma_f32_16x16x32_bf16 a[20:23], v[92:95], v[140:143], a[20:23]
    v_mfma_f32_16x16x32_bf16 a[24:27], v[92:95], v[144:147], a[24:27]
    ds_read_b64_tr_b16 v[68:69], v23 offset:32
    v_mfma_f32_16x16x32_bf16 a[28:31], v[96:99], v[120:123], a[28:31]
    v_mfma_f32_16x16x32_bf16 a[32:35], v[96:99], v[124:127], a[32:35]
    v_mfma_f32_16x16x32_bf16 a[36:39], v[96:99], v[128:131], a[36:39]
    ds_read_b64_tr_b16 v[70:71], v23 offset:1824
    v_mfma_f32_16x16x32_bf16 a[40:43], v[96:99], v[132:135], a[40:43]
    v_mfma_f32_16x16x32_bf16 a[44:47], v[96:99], v[136:139], a[44:47]
    ds_read_b64_tr_b16 v[72:73], v23 offset:64
    v_mfma_f32_16x16x32_bf16 a[48:51], v[96:99], v[140:143], a[48:51]
    v_mfma_f32_16x16x32_bf16 a[52:55], v[96:99], v[144:147], a[52:55]
    ds_read_b64_tr_b16 v[74:75], v23 offset:1856
    v_mfma_f32_16x16x32_bf16 a[56:59], v[100:103], v[120:123], a[56:59]
    v_mfma_f32_16x16x32_bf16 a[60:63], v[100:103], v[124:127], a[60:63]
    v_mfma_f32_16x16x32_bf16 a[64:67], v[100:103], v[128:131], a[64:67]
    ds_read_b64_tr_b16 v[76:77], v23 offset:96
    v_mfma_f32_16x16x32_bf16 a[68:71], v[100:103], v[132:135], a[68:71]
    v_mfma_f32_16x16x32_bf16 a[72:75], v[100:103], v[136:139], a[72:75]
    ds_read_b64_tr_b16 v[78:79], v23 offset:1888
    v_mfma_f32_16x16x32_bf16 a[76:79], v[100:103], v[140:143], a[76:79]
    v_mfma_f32_16x16x32_bf16 a[80:83], v[100:103], v[144:147], a[80:83]
    ds_read_b64_tr_b16 v[80:81], v23 offset:128
    v_mfma_f32_16x16x32_bf16 a[84:87], v[104:107], v[120:123], a[84:87]
    v_mfma_f32_16x16x32_bf16 a[88:91], v[104:107], v[124:127], a[88:91]
    v_mfma_f32_16x16x32_bf16 a[92:95], v[104:107], v[128:131], a[92:95]
    ds_read_b64_tr_b16 v[82:83], v23 offset:1920
    v_mfma_f32_16x16x32_bf16 a[96:99], v[104:107], v[132:135], a[96:99]
    v_mfma_f32_16x16x32_bf16 a[100:103], v[104:107], v[136:139], a[100:103]
    ds_read_b64_tr_b16 v[84:85], v23 offset:160
    v_mfma_f32_16x16x32_bf16 a[104:107], v[104:107], v[140:143], a[104:107]
    v_mfma_f32_16x16x32_bf16 a[108:111], v[104:107], v[144:147], a[108:111]
    ds_read_b64_tr_b16 v[86:87], v23 offset:1952
    v_mfma_f32_16x16x32_bf16 a[112:115], v[108:111], v[120:123], a[112:115]
    v_mfma_f32_16x16x32_bf16 a[116:119], v[108:111], v[124:127], a[116:119]
    v_mfma_f32_16x16x32_bf16 a[120:123], v[108:111], v[128:131], a[120:123]
    ds_read_b64_tr_b16 v[88:89], v23 offset:192
    v_mfma_f32_16x16x32_bf16 a[124:127], v[108:111], v[132:135], a[124:127]
    v_mfma_f32_16x16x32_bf16 a[128:131], v[108:111], v[136:139], a[128:131]
    ds_read_b64_tr_b16 v[90:91], v23 offset:1984
    v_mfma_f32_16x16x32_bf16 a[132:135], v[108:111], v[140:143], a[132:135]
    v_mfma_f32_16x16x32_bf16 a[136:139], v[108:111], v[144:147], a[136:139]
    ds_read_b128 v[36:39], v19 offset:0
    v_mfma_f32_16x16x32_bf16 a[140:143], v[112:115], v[120:123], a[140:143]
    v_mfma_f32_16x16x32_bf16 a[144:147], v[112:115], v[124:127], a[144:147]
    v_mfma_f32_16x16x32_bf16 a[148:151], v[112:115], v[128:131], a[148:151]
    ds_read_b128 v[40:43], v19 offset:2048
    v_mfma_f32_16x16x32_bf16 a[152:155], v[112:115], v[132:135], a[152:155]
    v_mfma_f32_16x16x32_bf16 a[156:159], v[112:115], v[136:139], a[156:159]
    ds_read_b128 v[44:47], v19 offset:4096
    v_mfma_f32_16x16x32_bf16 a[160:163], v[112:115], v[140:143], a[160:163]
    v_mfma_f32_16x16x32_bf16 a[164:167], v[112:115], v[144:147], a[164:167]
    ds_read_b128 v[48:51], v19 offset:6144
    v_mfma_f32_16x16x32_bf16 a[168:171], v[116:119], v[120:123], a[168:171]
    v_mfma_f32_16x16x32_bf16 a[172:175], v[116:119], v[124:127], a[172:175]
    v_mfma_f32_16x16x32_bf16 a[176:179], v[116:119], v[128:131], a[176:179]
    ds_read_b128 v[52:55], v19 offset:8192
    v_mfma_f32_16x16x32_bf16 a[180:183], v[116:119], v[132:135], a[180:183]
    v_mfma_f32_16x16x32_bf16 a[184:187], v[116:119], v[136:139], a[184:187]
    ds_read_b128 v[56:59], v19 offset:10240
    v_mfma_f32_16x16x32_bf16 a[188:191], v[116:119], v[140:143], a[188:191]
    v_mfma_f32_16x16x32_bf16 a[192:195], v[116:119], v[144:147], a[192:195]
    ds_read_b128 v[60:63], v19 offset:12288
    s_waitcnt lgkmcnt(0)
    v_mfma_f32_16x16x32_bf16 a[0:3], v[36:39], v[64:67], a[0:3]
    v_mfma_f32_16x16x32_bf16 a[4:7], v[36:39], v[68:71], a[4:7]
    v_mfma_f32_16x16x32_bf16 a[8:11], v[36:39], v[72:75], a[8:11]
    ds_read_b64_tr_b16 v[120:121], v25 offset:0
    v_mfma_f32_16x16x32_bf16 a[12:15], v[36:39], v[76:79], a[12:15]
    v_mfma_f32_16x16x32_bf16 a[16:19], v[36:39], v[80:83], a[16:19]
    ds_read_b64_tr_b16 v[122:123], v25 offset:1792
    v_mfma_f32_16x16x32_bf16 a[20:23], v[36:39], v[84:87], a[20:23]
    v_mfma_f32_16x16x32_bf16 a[24:27], v[36:39], v[88:91], a[24:27]
    ds_read_b64_tr_b16 v[124:125], v25 offset:32
    v_mfma_f32_16x16x32_bf16 a[28:31], v[40:43], v[64:67], a[28:31]
    v_mfma_f32_16x16x32_bf16 a[32:35], v[40:43], v[68:71], a[32:35]
    v_mfma_f32_16x16x32_bf16 a[36:39], v[40:43], v[72:75], a[36:39]
    ds_read_b64_tr_b16 v[126:127], v25 offset:1824
    v_mfma_f32_16x16x32_bf16 a[40:43], v[40:43], v[76:79], a[40:43]
    v_mfma_f32_16x16x32_bf16 a[44:47], v[40:43], v[80:83], a[44:47]
    ds_read_b64_tr_b16 v[128:129], v25 offset:64
    v_mfma_f32_16x16x32_bf16 a[48:51], v[40:43], v[84:87], a[48:51]
    v_mfma_f32_16x16x32_bf16 a[52:55], v[40:43], v[88:91], a[52:55]
    ds_read_b64_tr_b16 v[130:131], v25 offset:1856
    v_mfma_f32_16x16x32_bf16 a[56:59], v[44:47], v[64:67], a[56:59]
    v_mfma_f32_16x16x32_bf16 a[60:63], v[44:47], v[68:71], a[60:63]
    v_mfma_f32_16x16x32_bf16 a[64:67], v[44:47], v[72:75], a[64:67]
    ds_read_b64_tr_b16 v[132:133], v25 offset:96
    v_mfma_f32_16x16x32_bf16 a[68:71], v[44:47], v[76:79], a[68:71]
    v_mfma_f32_16x16x32_bf16 a[72:75], v[44:47], v[80:83], a[72:75]
    ds_read_b64_tr_b16 v[134:135], v25 offset:1888
    v_mfma_f32_16x16x32_bf16 a[76:79], v[44:47], v[84:87], a[76:79]
    v_mfma_f32_16x16x32_bf16 a[80:83], v[44:47], v[88:91], a[80:83]
    ds_read_b64_tr_b16 v[136:137], v25 offset:128
    v_mfma_f32_16x16x32_bf16 a[84:87], v[48:51], v[64:67], a[84:87]
    v_mfma_f32_16x16x32_bf16 a[88:91], v[48:51], v[68:71], a[88:91]
    v_mfma_f32_16x16x32_bf16 a[92:95], v[48:51], v[72:75], a[92:95]
    ds_read_b64_tr_b16 v[138:139], v25 offset:1920
    v_mfma_f32_16x16x32_bf16 a[96:99], v[48:51], v[76:79], a[96:99]
    v_mfma_f32_16x16x32_bf16 a[100:103], v[48:51], v[80:83], a[100:103]
    ds_read_b64_tr_b16 v[140:141], v25 offset:160
    v_mfma_f32_16x16x32_bf16 a[104:107], v[48:51], v[84:87], a[104:107]
    v_mfma_f32_16x16x32_bf16 a[108:111], v[48:51], v[88:91], a[108:111]
    ds_read_b64_tr_b16 v[142:143], v25 offset:1952
    v_mfma_f32_16x16x32_bf16 a[112:115], v[52:55], v[64:67], a[112:115]
    v_mfma_f32_16x16x32_bf16 a[116:119], v[52:55], v[68:71], a[116:119]
    v_mfma_f32_16x16x32_bf16 a[120:123], v[52:55], v[72:75], a[120:123]
    ds_read_b64_tr_b16 v[144:145], v25 offset:192
    v_mfma_f32_16x16x32_bf16 a[124:127], v[52:55], v[76:79], a[124:127]
    v_mfma_f32_16x16x32_bf16 a[128:131], v[52:55], v[80:83], a[128:131]
    ds_read_b64_tr_b16 v[146:147], v25 offset:1984
    v_mfma_f32_16x16x32_bf16 a[132:135], v[52:55], v[84:87], a[132:135]
    v_mfma_f32_16x16x32_bf16 a[136:139], v[52:55], v[88:91], a[136:139]
    ds_read_b128 v[92:95], v21 offset:0
    v_mfma_f32_16x16x32_bf16 a[140:143], v[56:59], v[64:67], a[140:143]
    v_mfma_f32_16x16x32_bf16 a[144:147], v[56:59], v[68:71], a[144:147]
    v_mfma_f32_16x16x32_bf16 a[148:151], v[56:59], v[72:75], a[148:151]
    ds_read_b128 v[96:99], v21 offset:2048
    v_mfma_f32_16x16x32_bf16 a[152:155], v[56:59], v[76:79], a[152:155]
    v_mfma_f32_16x16x32_bf16 a[156:159], v[56:59], v[80:83], a[156:159]
    ds_read_b128 v[100:103], v21 offset:4096
    v_mfma_f32_16x16x32_bf16 a[160:163], v[56:59], v[84:87], a[160:163]
    v_mfma_f32_16x16x32_bf16 a[164:167], v[56:59], v[88:91], a[164:167]
    ds_read_b128 v[104:107], v21 offset:6144
    v_mfma_f32_16x16x32_bf16 a[168:171], v[60:63], v[64:67], a[168:171]
    v_mfma_f32_16x16x32_bf16 a[172:175], v[60:63], v[68:71], a[172:175]
    v_mfma_f32_16x16x32_bf16 a[176:179], v[60:63], v[72:75], a[176:179]
    ds_read_b128 v[108:111], v21 offset:8192
    v_mfma_f32_16x16x32_bf16 a[180:183], v[60:63], v[76:79], a[180:183]
    v_mfma_f32_16x16x32_bf16 a[184:187], v[60:63], v[80:83], a[184:187]
    ds_read_b128 v[112:115], v21 offset:10240
    v_mfma_f32_16x16x32_bf16 a[188:191], v[60:63], v[84:87], a[188:191]
    v_mfma_f32_16x16x32_bf16 a[192:195], v[60:63], v[88:91], a[192:195]
    ds_read_b128 v[116:119], v21 offset:12288
    s_waitcnt lgkmcnt(0)
    v_mfma_f32_16x16x32_bf16 a[0:3], v[92:95], v[120:123], a[0:3]
    v_mfma_f32_16x16x32_bf16 a[4:7], v[92:95], v[124:127], a[4:7]
    v_mfma_f32_16x16x32_bf16 a[8:11], v[92:95], v[128:131], a[8:11]
    v_mfma_f32_16x16x32_bf16 a[12:15], v[92:95], v[132:135], a[12:15]
    v_mfma_f32_16x16x32_bf16 a[16:19], v[92:95], v[136:139], a[16:19]
    v_mfma_f32_16x16x32_bf16 a[20:23], v[92:95], v[140:143], a[20:23]
    v_mfma_f32_16x16x32_bf16 a[24:27], v[92:95], v[144:147], a[24:27]
    v_mfma_f32_16x16x32_bf16 a[28:31], v[96:99], v[120:123], a[28:31]
    v_mfma_f32_16x16x32_bf16 a[32:35], v[96:99], v[124:127], a[32:35]
    v_mfma_f32_16x16x32_bf16 a[36:39], v[96:99], v[128:131], a[36:39]
    v_mfma_f32_16x16x32_bf16 a[40:43], v[96:99], v[132:135], a[40:43]
    v_mfma_f32_16x16x32_bf16 a[44:47], v[96:99], v[136:139], a[44:47]
    v_mfma_f32_16x16x32_bf16 a[48:51], v[96:99], v[140:143], a[48:51]
    v_mfma_f32_16x16x32_bf16 a[52:55], v[96:99], v[144:147], a[52:55]
    v_mfma_f32_16x16x32_bf16 a[56:59], v[100:103], v[120:123], a[56:59]
    v_mfma_f32_16x16x32_bf16 a[60:63], v[100:103], v[124:127], a[60:63]
    v_mfma_f32_16x16x32_bf16 a[64:67], v[100:103], v[128:131], a[64:67]
    v_mfma_f32_16x16x32_bf16 a[68:71], v[100:103], v[132:135], a[68:71]
    v_mfma_f32_16x16x32_bf16 a[72:75], v[100:103], v[136:139], a[72:75]
    v_mfma_f32_16x16x32_bf16 a[76:79], v[100:103], v[140:143], a[76:79]
    v_mfma_f32_16x16x32_bf16 a[80:83], v[100:103], v[144:147], a[80:83]
    v_mfma_f32_16x16x32_bf16 a[84:87], v[104:107], v[120:123], a[84:87]
    v_mfma_f32_16x16x32_bf16 a[88:91], v[104:107], v[124:127], a[88:91]
    v_mfma_f32_16x16x32_bf16 a[92:95], v[104:107], v[128:131], a[92:95]
    v_mfma_f32_16x16x32_bf16 a[96:99], v[104:107], v[132:135], a[96:99]
    v_mfma_f32_16x16x32_bf16 a[100:103], v[104:107], v[136:139], a[100:103]
    v_mfma_f32_16x16x32_bf16 a[104:107], v[104:107], v[140:143], a[104:107]
    v_mfma_f32_16x16x32_bf16 a[108:111], v[104:107], v[144:147], a[108:111]
    v_mfma_f32_16x16x32_bf16 a[112:115], v[108:111], v[120:123], a[112:115]
    v_mfma_f32_16x16x32_bf16 a[116:119], v[108:111], v[124:127], a[116:119]
    v_mfma_f32_16x16x32_bf16 a[120:123], v[108:111], v[128:131], a[120:123]
    v_mfma_f32_16x16x32_bf16 a[124:127], v[108:111], v[132:135], a[124:127]
    v_mfma_f32_16x16x32_bf16 a[128:131], v[108:111], v[136:139], a[128:131]
    v_mfma_f32_16x16x32_bf16 a[132:135], v[108:111], v[140:143], a[132:135]
    v_mfma_f32_16x16x32_bf16 a[136:139], v[108:111], v[144:147], a[136:139]
    v_mfma_f32_16x16x32_bf16 a[140:143], v[112:115], v[120:123], a[140:143]
    v_mfma_f32_16x16x32_bf16 a[144:147], v[112:115], v[124:127], a[144:147]
    v_mfma_f32_16x16x32_bf16 a[148:151], v[112:115], v[128:131], a[148:151]
    v_mfma_f32_16x16x32_bf16 a[152:155], v[112:115], v[132:135], a[152:155]
    v_mfma_f32_16x16x32_bf16 a[156:159], v[112:115], v[136:139], a[156:159]
    v_mfma_f32_16x16x32_bf16 a[160:163], v[112:115], v[140:143], a[160:163]
    v_mfma_f32_16x16x32_bf16 a[164:167], v[112:115], v[144:147], a[164:167]
    v_mfma_f32_16x16x32_bf16 a[168:171], v[116:119], v[120:123], a[168:171]
    v_mfma_f32_16x16x32_bf16 a[172:175], v[116:119], v[124:127], a[172:175]
    v_mfma_f32_16x16x32_bf16 a[176:179], v[116:119], v[128:131], a[176:179]
    v_mfma_f32_16x16x32_bf16 a[180:183], v[116:119], v[132:135], a[180:183]
    v_mfma_f32_16x16x32_bf16 a[184:187], v[116:119], v[136:139], a[184:187]
    v_mfma_f32_16x16x32_bf16 a[188:191], v[116:119], v[140:143], a[188:191]
    v_mfma_f32_16x16x32_bf16 a[192:195], v[116:119], v[144:147], a[192:195]
    s_nop 7
    s_nop 7
    s_barrier
    v_mul_u32_u24 v12, 240, v3
    v_lshl_add_u32 v12, v4, 3, v12
    v_mul_u32_u24 v13, 26880, v2
    v_add_u32 v12, v12, v13
    v_accvgpr_read_b32 v36, a0
    v_accvgpr_read_b32 v37, a1
    v_accvgpr_read_b32 v38, a2
    v_accvgpr_read_b32 v39, a3
    v_mul_f32 v36, s40, v36
    v_mul_f32 v37, s40, v37
    v_mul_f32 v38, s40, v38
    v_mul_f32 v39, s40, v39
    v_cvt_pk_bf16_f32 v40, v36, v37
    v_cvt_pk_bf16_f32 v41, v38, v39
    ds_write_b64 v12, v[40:41] offset:0
    v_accvgpr_read_b32 v52, a28
    v_accvgpr_read_b32 v53, a29
    v_accvgpr_read_b32 v54, a30
    v_accvgpr_read_b32 v55, a31
    v_mul_f32 v52, s40, v52
    v_mul_f32 v53, s40, v53
    v_mul_f32 v54, s40, v54
    v_mul_f32 v55, s40, v55
    v_cvt_pk_bf16_f32 v56, v52, v53
    v_cvt_pk_bf16_f32 v57, v54, v55
    ds_write_b64 v12, v[56:57] offset:32
    v_accvgpr_read_b32 v68, a56
    v_accvgpr_read_b32 v69, a57
    v_accvgpr_read_b32 v70, a58
    v_accvgpr_read_b32 v71, a59
    v_mul_f32 v68, s40, v68
    v_mul_f32 v69, s40, v69
    v_mul_f32 v70, s40, v70
    v_mul_f32 v71, s40, v71
    v_cvt_pk_bf16_f32 v72, v68, v69
    v_cvt_pk_bf16_f32 v73, v70, v71
    ds_write_b64 v12, v[72:73] offset:64
    v_accvgpr_read_b32 v84, a84
    v_accvgpr_read_b32 v85, a85
    v_accvgpr_read_b32 v86, a86
    v_accvgpr_read_b32 v87, a87
    v_mul_f32 v84, s40, v84
    v_mul_f32 v85, s40, v85
    v_mul_f32 v86, s40, v86
    v_mul_f32 v87, s40, v87
    v_cvt_pk_bf16_f32 v88, v84, v85
    v_cvt_pk_bf16_f32 v89, v86, v87
    ds_write_b64 v12, v[88:89] offset:96
    v_accvgpr_read_b32 v36, a112
    v_accvgpr_read_b32 v37, a113
    v_accvgpr_read_b32 v38, a114
    v_accvgpr_read_b32 v39, a115
    v_mul_f32 v36, s40, v36
    v_mul_f32 v37, s40, v37
    v_mul_f32 v38, s40, v38
    v_mul_f32 v39, s40, v39
    v_cvt_pk_bf16_f32 v40, v36, v37
    v_cvt_pk_bf16_f32 v41, v38, v39
    ds_write_b64 v12, v[40:41] offset:128
    v_accvgpr_read_b32 v52, a140
    v_accvgpr_read_b32 v53, a141
    v_accvgpr_read_b32 v54, a142
    v_accvgpr_read_b32 v55, a143
    v_mul_f32 v52, s40, v52
    v_mul_f32 v53, s40, v53
    v_mul_f32 v54, s40, v54
    v_mul_f32 v55, s40, v55
    v_cvt_pk_bf16_f32 v56, v52, v53
    v_cvt_pk_bf16_f32 v57, v54, v55
    ds_write_b64 v12, v[56:57] offset:160
    v_accvgpr_read_b32 v68, a168
    v_accvgpr_read_b32 v69, a169
    v_accvgpr_read_b32 v70, a170
    v_accvgpr_read_b32 v71, a171
    v_mul_f32 v68, s40, v68
    v_mul_f32 v69, s40, v69
    v_mul_f32 v70, s40, v70
    v_mul_f32 v71, s40, v71
    v_cvt_pk_bf16_f32 v72, v68, v69
    v_cvt_pk_bf16_f32 v73, v70, v71
    ds_write_b64 v12, v[72:73] offset:192
    v_accvgpr_read_b32 v84, a4
    v_accvgpr_read_b32 v85, a5
    v_accvgpr_read_b32 v86, a6
    v_accvgpr_read_b32 v87, a7
    v_mul_f32 v84, s40, v84
    v_mul_f32 v85, s40, v85
    v_mul_f32 v86, s40, v86
    v_mul_f32 v87, s40, v87
    v_cvt_pk_bf16_f32 v88, v84, v85
    v_cvt_pk_bf16_f32 v89, v86, v87
    ds_write_b64 v12, v[88:89] offset:3840
    v_accvgpr_read_b32 v36, a32
    v_accvgpr_read_b32 v37, a33
    v_accvgpr_read_b32 v38, a34
    v_accvgpr_read_b32 v39, a35
    v_mul_f32 v36, s40, v36
    v_mul_f32 v37, s40, v37
    v_mul_f32 v38, s40, v38
    v_mul_f32 v39, s40, v39
    v_cvt_pk_bf16_f32 v40, v36, v37
    v_cvt_pk_bf16_f32 v41, v38, v39
    ds_write_b64 v12, v[40:41] offset:3872
    v_accvgpr_read_b32 v52, a60
    v_accvgpr_read_b32 v53, a61
    v_accvgpr_read_b32 v54, a62
    v_accvgpr_read_b32 v55, a63
    v_mul_f32 v52, s40, v52
    v_mul_f32 v53, s40, v53
    v_mul_f32 v54, s40, v54
    v_mul_f32 v55, s40, v55
    v_cvt_pk_bf16_f32 v56, v52, v53
    v_cvt_pk_bf16_f32 v57, v54, v55
    ds_write_b64 v12, v[56:57] offset:3904
    v_accvgpr_read_b32 v68, a88
    v_accvgpr_read_b32 v69, a89
    v_accvgpr_read_b32 v70, a90
    v_accvgpr_read_b32 v71, a91
    v_mul_f32 v68, s40, v68
    v_mul_f32 v69, s40, v69
    v_mul_f32 v70, s40, v70
    v_mul_f32 v71, s40, v71
    v_cvt_pk_bf16_f32 v72, v68, v69
    v_cvt_pk_bf16_f32 v73, v70, v71
    ds_write_b64 v12, v[72:73] offset:3936
    v_accvgpr_read_b32 v84, a116
    v_accvgpr_read_b32 v85, a117
    v_accvgpr_read_b32 v86, a118
    v_accvgpr_read_b32 v87, a119
    v_mul_f32 v84, s40, v84
    v_mul_f32 v85, s40, v85
    v_mul_f32 v86, s40, v86
    v_mul_f32 v87, s40, v87
    v_cvt_pk_bf16_f32 v88, v84, v85
    v_cvt_pk_bf16_f32 v89, v86, v87
    ds_write_b64 v12, v[88:89] offset:3968
    v_accvgpr_read_b32 v36, a144
    v_accvgpr_read_b32 v37, a145
    v_accvgpr_read_b32 v38, a146
    v_accvgpr_read_b32 v39, a147
    v_mul_f32 v36, s40, v36
    v_mul_f32 v37, s40, v37
    v_mul_f32 v38, s40, v38
    v_mul_f32 v39, s40, v39
    v_cvt_pk_bf16_f32 v40, v36, v37
    v_cvt_pk_bf16_f32 v41, v38, v39
    ds_write_b64 v12, v[40:41] offset:4000
    v_accvgpr_read_b32 v52, a172
    v_accvgpr_read_b32 v53, a173
    v_accvgpr_read_b32 v54, a174
    v_accvgpr_read_b32 v55, a175
    v_mul_f32 v52, s40, v52
    v_mul_f32 v53, s40, v53
    v_mul_f32 v54, s40, v54
    v_mul_f32 v55, s40, v55
    v_cvt_pk_bf16_f32 v56, v52, v53
    v_cvt_pk_bf16_f32 v57, v54, v55
    ds_write_b64 v12, v[56:57] offset:4032
    v_accvgpr_read_b32 v68, a8
    v_accvgpr_read_b32 v69, a9
    v_accvgpr_read_b32 v70, a10
    v_accvgpr_read_b32 v71, a11
    v_mul_f32 v68, s40, v68
    v_mul_f32 v69, s40, v69
    v_mul_f32 v70, s40, v70
    v_mul_f32 v71, s40, v71
    v_cvt_pk_bf16_f32 v72, v68, v69
    v_cvt_pk_bf16_f32 v73, v70, v71
    ds_write_b64 v12, v[72:73] offset:7680
    v_accvgpr_read_b32 v84, a36
    v_accvgpr_read_b32 v85, a37
    v_accvgpr_read_b32 v86, a38
    v_accvgpr_read_b32 v87, a39
    v_mul_f32 v84, s40, v84
    v_mul_f32 v85, s40, v85
    v_mul_f32 v86, s40, v86
    v_mul_f32 v87, s40, v87
    v_cvt_pk_bf16_f32 v88, v84, v85
    v_cvt_pk_bf16_f32 v89, v86, v87
    ds_write_b64 v12, v[88:89] offset:7712
    v_accvgpr_read_b32 v36, a64
    v_accvgpr_read_b32 v37, a65
    v_accvgpr_read_b32 v38, a66
    v_accvgpr_read_b32 v39, a67
    v_mul_f32 v36, s40, v36
    v_mul_f32 v37, s40, v37
    v_mul_f32 v38, s40, v38
    v_mul_f32 v39, s40, v39
    v_cvt_pk_bf16_f32 v40, v36, v37
    v_cvt_pk_bf16_f32 v41, v38, v39
    ds_write_b64 v12, v[40:41] offset:7744
    v_accvgpr_read_b32 v52, a92
    v_accvgpr_read_b32 v53, a93
    v_accvgpr_read_b32 v54, a94
    v_accvgpr_read_b32 v55, a95
    v_mul_f32 v52, s40, v52
    v_mul_f32 v53, s40, v53
    v_mul_f32 v54, s40, v54
    v_mul_f32 v55, s40, v55
    v_cvt_pk_bf16_f32 v56, v52, v53
    v_cvt_pk_bf16_f32 v57, v54, v55
    ds_write_b64 v12, v[56:57] offset:7776
    v_accvgpr_read_b32 v68, a120
    v_accvgpr_read_b32 v69, a121
    v_accvgpr_read_b32 v70, a122
    v_accvgpr_read_b32 v71, a123
    v_mul_f32 v68, s40, v68
    v_mul_f32 v69, s40, v69
    v_mul_f32 v70, s40, v70
    v_mul_f32 v71, s40, v71
    v_cvt_pk_bf16_f32 v72, v68, v69
    v_cvt_pk_bf16_f32 v73, v70, v71
    ds_write_b64 v12, v[72:73] offset:7808
    v_accvgpr_read_b32 v84, a148
    v_accvgpr_read_b32 v85, a149
    v_accvgpr_read_b32 v86, a150
    v_accvgpr_read_b32 v87, a151
    v_mul_f32 v84, s40, v84
    v_mul_f32 v85, s40, v85
    v_mul_f32 v86, s40, v86
    v_mul_f32 v87, s40, v87
    v_cvt_pk_bf16_f32 v88, v84, v85
    v_cvt_pk_bf16_f32 v89, v86, v87
    ds_write_b64 v12, v[88:89] offset:7840
    v_accvgpr_read_b32 v36, a176
    v_accvgpr_read_b32 v37, a177
    v_accvgpr_read_b32 v38, a178
    v_accvgpr_read_b32 v39, a179
    v_mul_f32 v36, s40, v36
    v_mul_f32 v37, s40, v37
    v_mul_f32 v38, s40, v38
    v_mul_f32 v39, s40, v39
    v_cvt_pk_bf16_f32 v40, v36, v37
    v_cvt_pk_bf16_f32 v41, v38, v39
    ds_write_b64 v12, v[40:41] offset:7872
    v_accvgpr_read_b32 v52, a12
    v_accvgpr_read_b32 v53, a13
    v_accvgpr_read_b32 v54, a14
    v_accvgpr_read_b32 v55, a15
    v_mul_f32 v52, s40, v52
    v_mul_f32 v53, s40, v53
    v_mul_f32 v54, s40, v54
    v_mul_f32 v55, s40, v55
    v_cvt_pk_bf16_f32 v56, v52, v53
    v_cvt_pk_bf16_f32 v57, v54, v55
    ds_write_b64 v12, v[56:57] offset:11520
    v_accvgpr_read_b32 v68, a40
    v_accvgpr_read_b32 v69, a41
    v_accvgpr_read_b32 v70, a42
    v_accvgpr_read_b32 v71, a43
    v_mul_f32 v68, s40, v68
    v_mul_f32 v69, s40, v69
    v_mul_f32 v70, s40, v70
    v_mul_f32 v71, s40, v71
    v_cvt_pk_bf16_f32 v72, v68, v69
    v_cvt_pk_bf16_f32 v73, v70, v71
    ds_write_b64 v12, v[72:73] offset:11552
    v_accvgpr_read_b32 v84, a68
    v_accvgpr_read_b32 v85, a69
    v_accvgpr_read_b32 v86, a70
    v_accvgpr_read_b32 v87, a71
    v_mul_f32 v84, s40, v84
    v_mul_f32 v85, s40, v85
    v_mul_f32 v86, s40, v86
    v_mul_f32 v87, s40, v87
    v_cvt_pk_bf16_f32 v88, v84, v85
    v_cvt_pk_bf16_f32 v89, v86, v87
    ds_write_b64 v12, v[88:89] offset:11584
    v_accvgpr_read_b32 v36, a96
    v_accvgpr_read_b32 v37, a97
    v_accvgpr_read_b32 v38, a98
    v_accvgpr_read_b32 v39, a99
    v_mul_f32 v36, s40, v36
    v_mul_f32 v37, s40, v37
    v_mul_f32 v38, s40, v38
    v_mul_f32 v39, s40, v39
    v_cvt_pk_bf16_f32 v40, v36, v37
    v_cvt_pk_bf16_f32 v41, v38, v39
    ds_write_b64 v12, v[40:41] offset:11616
    v_accvgpr_read_b32 v52, a124
    v_accvgpr_read_b32 v53, a125
    v_accvgpr_read_b32 v54, a126
    v_accvgpr_read_b32 v55, a127
    v_mul_f32 v52, s40, v52
    v_mul_f32 v53, s40, v53
    v_mul_f32 v54, s40, v54
    v_mul_f32 v55, s40, v55
    v_cvt_pk_bf16_f32 v56, v52, v53
    v_cvt_pk_bf16_f32 v57, v54, v55
    ds_write_b64 v12, v[56:57] offset:11648
    v_accvgpr_read_b32 v68, a152
    v_accvgpr_read_b32 v69, a153
    v_accvgpr_read_b32 v70, a154
    v_accvgpr_read_b32 v71, a155
    v_mul_f32 v68, s40, v68
    v_mul_f32 v69, s40, v69
    v_mul_f32 v70, s40, v70
    v_mul_f32 v71, s40, v71
    v_cvt_pk_bf16_f32 v72, v68, v69
    v_cvt_pk_bf16_f32 v73, v70, v71
    ds_write_b64 v12, v[72:73] offset:11680
    v_accvgpr_read_b32 v84, a180
    v_accvgpr_read_b32 v85, a181
    v_accvgpr_read_b32 v86, a182
    v_accvgpr_read_b32 v87, a183
    v_mul_f32 v84, s40, v84
    v_mul_f32 v85, s40, v85
    v_mul_f32 v86, s40, v86
    v_mul_f32 v87, s40, v87
    v_cvt_pk_bf16_f32 v88, v84, v85
    v_cvt_pk_bf16_f32 v89, v86, v87
    ds_write_b64 v12, v[88:89] offset:11712
    v_accvgpr_read_b32 v36, a16
    v_accvgpr_read_b32 v37, a17
    v_accvgpr_read_b32 v38, a18
    v_accvgpr_read_b32 v39, a19
    v_mul_f32 v36, s40, v36
    v_mul_f32 v37, s40, v37
    v_mul_f32 v38, s40, v38
    v_mul_f32 v39, s40, v39
    v_cvt_pk_bf16_f32 v40, v36, v37
    v_cvt_pk_bf16_f32 v41, v38, v39
    ds_write_b64 v12, v[40:41] offset:15360
    v_accvgpr_read_b32 v52, a44
    v_accvgpr_read_b32 v53, a45
    v_accvgpr_read_b32 v54, a46
    v_accvgpr_read_b32 v55, a47
    v_mul_f32 v52, s40, v52
    v_mul_f32 v53, s40, v53
    v_mul_f32 v54, s40, v54
    v_mul_f32 v55, s40, v55
    v_cvt_pk_bf16_f32 v56, v52, v53
    v_cvt_pk_bf16_f32 v57, v54, v55
    ds_write_b64 v12, v[56:57] offset:15392
    v_accvgpr_read_b32 v68, a72
    v_accvgpr_read_b32 v69, a73
    v_accvgpr_read_b32 v70, a74
    v_accvgpr_read_b32 v71, a75
    v_mul_f32 v68, s40, v68
    v_mul_f32 v69, s40, v69
    v_mul_f32 v70, s40, v70
    v_mul_f32 v71, s40, v71
    v_cvt_pk_bf16_f32 v72, v68, v69
    v_cvt_pk_bf16_f32 v73, v70, v71
    ds_write_b64 v12, v[72:73] offset:15424
    v_accvgpr_read_b32 v84, a100
    v_accvgpr_read_b32 v85, a101
    v_accvgpr_read_b32 v86, a102
    v_accvgpr_read_b32 v87, a103
    v_mul_f32 v84, s40, v84
    v_mul_f32 v85, s40, v85
    v_mul_f32 v86, s40, v86
    v_mul_f32 v87, s40, v87
    v_cvt_pk_bf16_f32 v88, v84, v85
    v_cvt_pk_bf16_f32 v89, v86, v87
    ds_write_b64 v12, v[88:89] offset:15456
    v_accvgpr_read_b32 v36, a128
    v_accvgpr_read_b32 v37, a129
    v_accvgpr_read_b32 v38, a130
    v_accvgpr_read_b32 v39, a131
    v_mul_f32 v36, s40, v36
    v_mul_f32 v37, s40, v37
    v_mul_f32 v38, s40, v38
    v_mul_f32 v39, s40, v39
    v_cvt_pk_bf16_f32 v40, v36, v37
    v_cvt_pk_bf16_f32 v41, v38, v39
    ds_write_b64 v12, v[40:41] offset:15488
    v_accvgpr_read_b32 v52, a156
    v_accvgpr_read_b32 v53, a157
    v_accvgpr_read_b32 v54, a158
    v_accvgpr_read_b32 v55, a159
    v_mul_f32 v52, s40, v52
    v_mul_f32 v53, s40, v53
    v_mul_f32 v54, s40, v54
    v_mul_f32 v55, s40, v55
    v_cvt_pk_bf16_f32 v56, v52, v53
    v_cvt_pk_bf16_f32 v57, v54, v55
    ds_write_b64 v12, v[56:57] offset:15520
    v_accvgpr_read_b32 v68, a184
    v_accvgpr_read_b32 v69, a185
    v_accvgpr_read_b32 v70, a186
    v_accvgpr_read_b32 v71, a187
    v_mul_f32 v68, s40, v68
    v_mul_f32 v69, s40, v69
    v_mul_f32 v70, s40, v70
    v_mul_f32 v71, s40, v71
    v_cvt_pk_bf16_f32 v72, v68, v69
    v_cvt_pk_bf16_f32 v73, v70, v71
    ds_write_b64 v12, v[72:73] offset:15552
    v_accvgpr_read_b32 v84, a20
    v_accvgpr_read_b32 v85, a21
    v_accvgpr_read_b32 v86, a22
    v_accvgpr_read_b32 v87, a23
    v_mul_f32 v84, s40, v84
    v_mul_f32 v85, s40, v85
    v_mul_f32 v86, s40, v86
    v_mul_f32 v87, s40, v87
    v_cvt_pk_bf16_f32 v88, v84, v85
    v_cvt_pk_bf16_f32 v89, v86, v87
    ds_write_b64 v12, v[88:89] offset:19200
    v_accvgpr_read_b32 v36, a48
    v_accvgpr_read_b32 v37, a49
    v_accvgpr_read_b32 v38, a50
    v_accvgpr_read_b32 v39, a51
    v_mul_f32 v36, s40, v36
    v_mul_f32 v37, s40, v37
    v_mul_f32 v38, s40, v38
    v_mul_f32 v39, s40, v39
    v_cvt_pk_bf16_f32 v40, v36, v37
    v_cvt_pk_bf16_f32 v41, v38, v39
    ds_write_b64 v12, v[40:41] offset:19232
    v_accvgpr_read_b32 v52, a76
    v_accvgpr_read_b32 v53, a77
    v_accvgpr_read_b32 v54, a78
    v_accvgpr_read_b32 v55, a79
    v_mul_f32 v52, s40, v52
    v_mul_f32 v53, s40, v53
    v_mul_f32 v54, s40, v54
    v_mul_f32 v55, s40, v55
    v_cvt_pk_bf16_f32 v56, v52, v53
    v_cvt_pk_bf16_f32 v57, v54, v55
    ds_write_b64 v12, v[56:57] offset:19264
    v_accvgpr_read_b32 v68, a104
    v_accvgpr_read_b32 v69, a105
    v_accvgpr_read_b32 v70, a106
    v_accvgpr_read_b32 v71, a107
    v_mul_f32 v68, s40, v68
    v_mul_f32 v69, s40, v69
    v_mul_f32 v70, s40, v70
    v_mul_f32 v71, s40, v71
    v_cvt_pk_bf16_f32 v72, v68, v69
    v_cvt_pk_bf16_f32 v73, v70, v71
    ds_write_b64 v12, v[72:73] offset:19296
    v_accvgpr_read_b32 v84, a132
    v_accvgpr_read_b32 v85, a133
    v_accvgpr_read_b32 v86, a134
    v_accvgpr_read_b32 v87, a135
    v_mul_f32 v84, s40, v84
    v_mul_f32 v85, s40, v85
    v_mul_f32 v86, s40, v86
    v_mul_f32 v87, s40, v87
    v_cvt_pk_bf16_f32 v88, v84, v85
    v_cvt_pk_bf16_f32 v89, v86, v87
    ds_write_b64 v12, v[88:89] offset:19328
    v_accvgpr_read_b32 v36, a160
    v_accvgpr_read_b32 v37, a161
    v_accvgpr_read_b32 v38, a162
    v_accvgpr_read_b32 v39, a163
    v_mul_f32 v36, s40, v36
    v_mul_f32 v37, s40, v37
    v_mul_f32 v38, s40, v38
    v_mul_f32 v39, s40, v39
    v_cvt_pk_bf16_f32 v40, v36, v37
    v_cvt_pk_bf16_f32 v41, v38, v39
    ds_write_b64 v12, v[40:41] offset:19360
    v_accvgpr_read_b32 v52, a188
    v_accvgpr_read_b32 v53, a189
    v_accvgpr_read_b32 v54, a190
    v_accvgpr_read_b32 v55, a191
    v_mul_f32 v52, s40, v52
    v_mul_f32 v53, s40, v53
    v_mul_f32 v54, s40, v54
    v_mul_f32 v55, s40, v55
    v_cvt_pk_bf16_f32 v56, v52, v53
    v_cvt_pk_bf16_f32 v57, v54, v55
    ds_write_b64 v12, v[56:57] offset:19392
    v_accvgpr_read_b32 v68, a24
    v_accvgpr_read_b32 v69, a25
    v_accvgpr_read_b32 v70, a26
    v_accvgpr_read_b32 v71, a27
    v_mul_f32 v68, s40, v68
    v_mul_f32 v69, s40, v69
    v_mul_f32 v70, s40, v70
    v_mul_f32 v71, s40, v71
    v_cvt_pk_bf16_f32 v72, v68, v69
    v_cvt_pk_bf16_f32 v73, v70, v71
    ds_write_b64 v12, v[72:73] offset:23040
    v_accvgpr_read_b32 v84, a52
    v_accvgpr_read_b32 v85, a53
    v_accvgpr_read_b32 v86, a54
    v_accvgpr_read_b32 v87, a55
    v_mul_f32 v84, s40, v84
    v_mul_f32 v85, s40, v85
    v_mul_f32 v86, s40, v86
    v_mul_f32 v87, s40, v87
    v_cvt_pk_bf16_f32 v88, v84, v85
    v_cvt_pk_bf16_f32 v89, v86, v87
    ds_write_b64 v12, v[88:89] offset:23072
    v_accvgpr_read_b32 v36, a80
    v_accvgpr_read_b32 v37, a81
    v_accvgpr_read_b32 v38, a82
    v_accvgpr_read_b32 v39, a83
    v_mul_f32 v36, s40, v36
    v_mul_f32 v37, s40, v37
    v_mul_f32 v38, s40, v38
    v_mul_f32 v39, s40, v39
    v_cvt_pk_bf16_f32 v40, v36, v37
    v_cvt_pk_bf16_f32 v41, v38, v39
    ds_write_b64 v12, v[40:41] offset:23104
    v_accvgpr_read_b32 v52, a108
    v_accvgpr_read_b32 v53, a109
    v_accvgpr_read_b32 v54, a110
    v_accvgpr_read_b32 v55, a111
    v_mul_f32 v52, s40, v52
    v_mul_f32 v53, s40, v53
    v_mul_f32 v54, s40, v54
    v_mul_f32 v55, s40, v55
    v_cvt_pk_bf16_f32 v56, v52, v53
    v_cvt_pk_bf16_f32 v57, v54, v55
    ds_write_b64 v12, v[56:57] offset:23136
    v_accvgpr_read_b32 v68, a136
    v_accvgpr_read_b32 v69, a137
    v_accvgpr_read_b32 v70, a138
    v_accvgpr_read_b32 v71, a139
    v_mul_f32 v68, s40, v68
    v_mul_f32 v69, s40, v69
    v_mul_f32 v70, s40, v70
    v_mul_f32 v71, s40, v71
    v_cvt_pk_bf16_f32 v72, v68, v69
    v_cvt_pk_bf16_f32 v73, v70, v71
    ds_write_b64 v12, v[72:73] offset:23168
    v_accvgpr_read_b32 v84, a164
    v_accvgpr_read_b32 v85, a165
    v_accvgpr_read_b32 v86, a166
    v_accvgpr_read_b32 v87, a167
    v_mul_f32 v84, s40, v84
    v_mul_f32 v85, s40, v85
    v_mul_f32 v86, s40, v86
    v_mul_f32 v87, s40, v87
    v_cvt_pk_bf16_f32 v88, v84, v85
    v_cvt_pk_bf16_f32 v89, v86, v87
    ds_write_b64 v12, v[88:89] offset:23200
    v_accvgpr_read_b32 v36, a192
    v_accvgpr_read_b32 v37, a193
    v_accvgpr_read_b32 v38, a194
    v_accvgpr_read_b32 v39, a195
    v_mul_f32 v36, s40, v36
    v_mul_f32 v37, s40, v37
    v_mul_f32 v38, s40, v38
    v_mul_f32 v39, s40, v39
    v_cvt_pk_bf16_f32 v40, v36, v37
    v_cvt_pk_bf16_f32 v41, v38, v39
    ds_write_b64 v12, v[40:41] offset:23232
    s_mul_i32 s41, s21, 448
    s_mul_i32 s42, s23, 224
    s_add_u32 s41, s41, s42
    v_mul_u32_u24 v10, 112, v9
    v_add_u32 v10, s41, v10
    v_mul_u32_u24 v10, 896, v10
    s_mul_i32 s42, s22, 448
    v_mul_u32_u24 v11, 224, v8
    v_add3_u32 v10, v10, v11, s42
    s_mov_b32 s43, 12582912
    v_mul_u32_u24 v5, 4682, v1
    v_lshrrev_b32 v5, 16, v5
    v_mul_u32_u24 v6, 14, v5
    v_sub_u32 v6, v1, v6
    v_mul_u32_u24 v7, 240, v5
    v_lshl_add_u32 v7, v6, 4, v7
    v_mul_u32_u24 v13, 26880, v2
    v_add_u32 v7, v7, v13
    v_mul_u32_u24 v5, 896, v5
    v_lshl_add_u32 v5, v6, 4, v5
    v_add_u32 v5, v5, v10
    v_cmp_gt_u32 vcc, 56, v1
    s_waitcnt lgkmcnt(0)
    s_and_saveexec_b64 s[44:45], vcc
    ds_read_b128 v[36:39], v7 offset:0
    ds_read_b128 v[40:43], v7 offset:960
    ds_read_b128 v[44:47], v7 offset:1920
    ds_read_b128 v[48:51], v7 offset:2880
    ds_read_b128 v[52:55], v7 offset:3840
    ds_read_b128 v[56:59], v7 offset:4800
    ds_read_b128 v[60:63], v7 offset:5760
    ds_read_b128 v[64:67], v7 offset:6720
    s_waitcnt lgkmcnt(7)
    s_add_u32 s46, s43, 0
    buffer_store_dwordx4 v[36:39], v5, s[4:7], s46 offen
    s_waitcnt lgkmcnt(6)
    s_add_u32 s46, s43, 3584
    buffer_store_dwordx4 v[40:43], v5, s[4:7], s46 offen
    s_waitcnt lgkmcnt(5)
    s_add_u32 s46, s43, 7168
    buffer_store_dwordx4 v[44:47], v5, s[4:7], s46 offen
    s_waitcnt lgkmcnt(4)
    s_add_u32 s46, s43, 10752
    buffer_store_dwordx4 v[48:51], v5, s[4:7], s46 offen
    s_waitcnt lgkmcnt(3)
    s_add_u32 s46, s43, 14336
    buffer_store_dwordx4 v[52:55], v5, s[4:7], s46 offen
    s_waitcnt lgkmcnt(2)
    s_add_u32 s46, s43, 17920
    buffer_store_dwordx4 v[56:59], v5, s[4:7], s46 offen
    s_waitcnt lgkmcnt(1)
    s_add_u32 s46, s43, 21504
    buffer_store_dwordx4 v[60:63], v5, s[4:7], s46 offen
    s_waitcnt lgkmcnt(0)
    s_add_u32 s46, s43, 25088
    buffer_store_dwordx4 v[64:67], v5, s[4:7], s46 offen
    ds_read_b128 v[36:39], v7 offset:7680
    ds_read_b128 v[40:43], v7 offset:8640
    ds_read_b128 v[44:47], v7 offset:9600
    ds_read_b128 v[48:51], v7 offset:10560
    ds_read_b128 v[52:55], v7 offset:11520
    ds_read_b128 v[56:59], v7 offset:12480
    ds_read_b128 v[60:63], v7 offset:13440
    ds_read_b128 v[64:67], v7 offset:14400
    s_waitcnt lgkmcnt(7)
    s_add_u32 s46, s43, 28672
    buffer_store_dwordx4 v[36:39], v5, s[4:7], s46 offen
    s_waitcnt lgkmcnt(6)
    s_add_u32 s46, s43, 32256
    buffer_store_dwordx4 v[40:43], v5, s[4:7], s46 offen
    s_waitcnt lgkmcnt(5)
    s_add_u32 s46, s43, 35840
    buffer_store_dwordx4 v[44:47], v5, s[4:7], s46 offen
    s_waitcnt lgkmcnt(4)
    s_add_u32 s46, s43, 39424
    buffer_store_dwordx4 v[48:51], v5, s[4:7], s46 offen
    s_waitcnt lgkmcnt(3)
    s_add_u32 s46, s43, 43008
    buffer_store_dwordx4 v[52:55], v5, s[4:7], s46 offen
    s_waitcnt lgkmcnt(2)
    s_add_u32 s46, s43, 46592
    buffer_store_dwordx4 v[56:59], v5, s[4:7], s46 offen
    s_waitcnt lgkmcnt(1)
    s_add_u32 s46, s43, 50176
    buffer_store_dwordx4 v[60:63], v5, s[4:7], s46 offen
    s_waitcnt lgkmcnt(0)
    s_add_u32 s46, s43, 53760
    buffer_store_dwordx4 v[64:67], v5, s[4:7], s46 offen
    ds_read_b128 v[36:39], v7 offset:15360
    ds_read_b128 v[40:43], v7 offset:16320
    ds_read_b128 v[44:47], v7 offset:17280
    ds_read_b128 v[48:51], v7 offset:18240
    ds_read_b128 v[52:55], v7 offset:19200
    ds_read_b128 v[56:59], v7 offset:20160
    ds_read_b128 v[60:63], v7 offset:21120
    ds_read_b128 v[64:67], v7 offset:22080
    s_waitcnt lgkmcnt(7)
    s_add_u32 s46, s43, 57344
    buffer_store_dwordx4 v[36:39], v5, s[4:7], s46 offen
    s_waitcnt lgkmcnt(6)
    s_add_u32 s46, s43, 60928
    buffer_store_dwordx4 v[40:43], v5, s[4:7], s46 offen
    s_waitcnt lgkmcnt(5)
    s_add_u32 s46, s43, 64512
    buffer_store_dwordx4 v[44:47], v5, s[4:7], s46 offen
    s_waitcnt lgkmcnt(4)
    s_add_u32 s46, s43, 68096
    buffer_store_dwordx4 v[48:51], v5, s[4:7], s46 offen
    s_waitcnt lgkmcnt(3)
    s_add_u32 s46, s43, 71680
    buffer_store_dwordx4 v[52:55], v5, s[4:7], s46 offen
    s_waitcnt lgkmcnt(2)
    s_add_u32 s46, s43, 75264
    buffer_store_dwordx4 v[56:59], v5, s[4:7], s46 offen
    s_waitcnt lgkmcnt(1)
    s_add_u32 s46, s43, 78848
    buffer_store_dwordx4 v[60:63], v5, s[4:7], s46 offen
    s_waitcnt lgkmcnt(0)
    s_add_u32 s46, s43, 82432
    buffer_store_dwordx4 v[64:67], v5, s[4:7], s46 offen
    ds_read_b128 v[36:39], v7 offset:23040
    ds_read_b128 v[40:43], v7 offset:24000
    ds_read_b128 v[44:47], v7 offset:24960
    ds_read_b128 v[48:51], v7 offset:25920
    s_waitcnt lgkmcnt(3)
    s_add_u32 s46, s43, 86016
    buffer_store_dwordx4 v[36:39], v5, s[4:7], s46 offen
    s_waitcnt lgkmcnt(2)
    s_add_u32 s46, s43, 89600
    buffer_store_dwordx4 v[40:43], v5, s[4:7], s46 offen
    s_waitcnt lgkmcnt(1)
    s_add_u32 s46, s43, 93184
    buffer_store_dwordx4 v[44:47], v5, s[4:7], s46 offen
    s_waitcnt lgkmcnt(0)
    s_add_u32 s46, s43, 96768
    buffer_store_dwordx4 v[48:51], v5, s[4:7], s46 offen
    s_mov_b64 exec, s[44:45]
prep2_kernel_gdone:
prep2_kernel_end:
    s_endpgm
.globl chain_kernel
.p2align 8
.type chain_kernel,@function
chain_kernel:
    s_cmp_ge_u32 s2, 256
    s_cbranch_scc1 chain_kernel_end
    s_load_dwordx2 s[4:5], s[0:1], 104
    s_mov_b32 s6, 268435456
    s_mov_b32 s7, 0x00020000
    s_load_dwordx2 s[8:9], s[0:1], 96
    s_mov_b32 s10, 256
    s_mov_b32 s11, 0x00020000
    s_load_dwordx2 s[84:85], s[0:1], 0
    s_mov_b32 s86, 1835008
    s_mov_b32 s87, 0x00020000
    s_load_dwordx2 s[88:89], s[0:1], 88
    s_mov_b32 s90, 1835008
    s_mov_b32 s91, 0x00020000
    s_load_dwordx2 s[78:79], s[0:1], 64
    s_load_dwordx2 s[80:81], s[0:1], 72
    s_load_dwordx2 s[82:83], s[0:1], 80
    v_and_b32 v1, 63, v0
    v_lshrrev_b32 v2, 6, v0
    v_and_b32 v3, 15, v1
    v_lshrrev_b32 v4, 4, v1
    s_nop 0
    v_readfirstlane_b32 s14, v2
    s_waitcnt lgkmcnt(0)
    s_cmp_lg_u32 s14, 0
    s_cbranch_scc1 chain_kernel_wait
    s_getreg_b32 s15, hwreg(HW_REG_XCC_ID)
    s_and_b32 s15, s15, 7
    s_mov_b64 exec, 1
    s_lshl_b32 s16, s15, 2
    v_mov_b32 v6, s16
    v_mov_b32 v5, 1
    buffer_atomic_add v5, v6, s[8:11], 0 offen sc0 sc1
    s_waitcnt vmcnt(0)
    v_readfirstlane_b32 s16, v5
    v_mov_b32 v7, 32
    v_mov_b32 v10, 36
    s_cmp_lg_u32 s16, 31
    s_cbranch_scc1 chain_kernel_nocas
    s_add_u32 s17, s15, 1
    v_mov_b32 v8, s17
    v_mov_b32 v9, 0
    buffer_atomic_cmpswap v[8:9], v7, s[8:11], 0 offen sc0 sc1
    s_waitcnt vmcnt(0)
chain_kernel_nocas:
    v_mov_b32 v5, 1
    buffer_atomic_add v5, v10, s[8:11], 0 offen sc0 sc1
    s_waitcnt vmcnt(0)
    v_readfirstlane_b32 s17, v5
    s_mov_b32 s12, -1
    s_mov_b32 s13, 0
    s_mov_b32 s48, 0
    s_min_u32 s18, s16, s17
    s_cmp_ge_u32 s18, 32
    s_cbranch_scc1 chain_kernel_rdone
chain_kernel_rpoll:
    s_add_u32 s48, s48, 1
    s_cmp_gt_u32 s48, 0x100000
    s_cbranch_scc1 chain_kernel_rdone
    v_mov_b32 v5, 0
    buffer_atomic_add v5, v10, s[8:11], 0 offen sc0 sc1
    s_waitcnt vmcnt(0)
    v_readfirstlane_b32 s19, v5
    v_mov_b32 v5, 0
    buffer_atomic_add v5, v7, s[8:11], 0 offen sc0 sc1
    s_waitcnt vmcnt(0)
    v_readfirstlane_b32 s18, v5
    s_cmp_eq_u32 s18, 0
    s_cbranch_scc1 chain_kernel_nowin
    s_sub_u32 s18, s18, 1
    s_cmp_lg_u32 s18, s15
    s_cbranch_scc1 chain_kernel_rdone
    s_cmp_ge_u32 s16, 32
    s_cbranch_scc1 chain_kernel_rdone
    s_mov_b32 s12, s16
    s_branch chain_kernel_rdone
chain_kernel_nowin:
    s_cmp_lt_u32 s19, 256
    s_cbranch_scc1 chain_kernel_rpoll
    s_cmp_ge_u32 s17, 32
    s_cbranch_scc1 chain_kernel_rdone
    s_mov_b32 s12, s17
    s_mov_b32 s13, 1
chain_kernel_rdone:
    s_cmp_lt_i32 s12, 0
    s_cbranch_scc0 chain_kernel_rdone2
    v_mov_b32 v5, 1
    v_mov_b32 v6, 40
    buffer_atomic_add v5, v6, s[8:11], 0 offen sc0 sc1
    s_waitcnt vmcnt(0)
    v_readfirstlane_b32 s13, v5
chain_kernel_rdone2:
    v_mov_b32 v6, s12
    v_mov_b32 v7, s13
    v_mov_b32 v5, 0
    ds_write_b64 v5, v[6:7]
    s_waitcnt lgkmcnt(0)
    s_mov_b64 exec, -1
chain_kernel_wait:
    s_barrier
    v_mov_b32 v5, 0
    ds_read_b64 v[6:7], v5
    s_waitcnt lgkmcnt(0)
    v_readfirstlane_b32 s12, v6
    v_readfirstlane_b32 s13, v7
    s_cmp_lt_i32 s12, 0
    s_cbranch_scc1 chain_kernel_worker
    s_mov_b32 s48, 0
    v_lshlrev_b32 v10, 4, v0
    v_add_u32 v11, 4096, v10
    v_cmp_gt_u32 vcc, 192, v0
    s_nop 1
    v_cndmask_b32 v11, v10, v11, vcc
    v_lshrrev_b32 v5, 4, v10
    v_mul_u32_u24 v6, 1171, v5
    v_lshrrev_b32 v6, 16, v6
    v_mul_u32_u24 v7, 56, v6
    v_sub_u32 v7, v5, v7
    v_mul_u32_u24 v6, 928, v6
    v_lshl_add_u32 v6, v7, 4, v6
    v_add_u32 v12, 64, v6
    v_lshrrev_b32 v5, 4, v11
    v_mul_u32_u24 v6, 1171, v5
    v_lshrrev_b32 v6, 16, v6
    v_mul_u32_u24 v7, 56, v6
    v_sub_u32 v7, v5, v7
    v_mul_u32_u24 v6, 928, v6
    v_lshl_add_u32 v6, v7, 4, v6
    v_add_u32 v13, 64, v6
    v_and_b32 v5, 7, v3
    v_mul_u32_u24 v14, 928, v5
    v_lshl_add_u32 v14, v4, 4, v14
    v_add_u32 v14, 64, v14
    s_cmp_lt_u32 s12, 16
    s_cbranch_scc0 chain_kernel_brole
    s_cmp_eq_u32 s13, 0
    s_cbranch_scc0 chain_kernel_a_safe
    s_mul_i32 s20, s12, 448
    v_mul_u32_u24 v5, 112, v2
    v_add_u32 v5, s20, v5
    v_lshrrev_b32 v6, 2, v3
    v_lshlrev_b32 v6, 3, v6
    v_and_b32 v7, 3, v3
    v_add_u32 v6, v6, v7
    v_add_u32 v7, 0, v6
    v_add_u32 v7, v7, v5
    v_mul_u32_u24 v7, 896, v7
    v_lshl_add_u32 v40, v4, 4, v7
    v_add_u32 v7, 4, v6
    v_add_u32 v7, v7, v5
    v_mul_u32_u24 v7, 896, v7
    v_lshl_add_u32 v41, v4, 4, v7
    v_add_u32 v7, 32, v6
    v_add_u32 v7, v7, v5
    v_mul_u32_u24 v7, 896, v7
    v_lshl_add_u32 v42, v4, 4, v7
    v_add_u32 v7, 36, v6
    v_add_u32 v7, v7, v5
    v_mul_u32_u24 v7, 896, v7
    v_lshl_add_u32 v43, v4, 4, v7
    v_add_u32 v7, 64, v6
    v_add_u32 v7, v7, v5
    v_mul_u32_u24 v7, 896, v7
    v_lshl_add_u32 v44, v4, 4, v7
    v_add_u32 v7, 68, v6
    v_add_u32 v7, v7, v5
    v_mul_u32_u24 v7, 896, v7
    v_lshl_add_u32 v45, v4, 4, v7
    v_add_u32 v7, 96, v3
    v_add_u32 v7, v7, v5
    v_mul_u32_u24 v7, 896, v7
    v_lshl_add_u32 v46, v4, 4, v7
    s_mov_b32 s30, 12582912
    buffer_load_dwordx4 a[0:3], v40, s[4:7], s30 offen offset:0
    buffer_load_dwordx4 a[4:7], v41, s[4:7], s30 offen offset:0
    buffer_load_dwordx4 a[8:11], v42, s[4:7], s30 offen offset:0
    buffer_load_dwordx4 a[12:15], v43, s[4:7], s30 offen offset:0
    buffer_load_dwordx4 a[16:19], v44, s[4:7], s30 offen offset:0
    buffer_load_dwordx4 a[20:23], v45, s[4:7], s30 offen offset:0
    buffer_load_dwordx4 a[24:27], v46, s[4:7], s30 offen offset:0
    buffer_load_dwordx4 a[28:31], v40, s[4:7], s30 offen offset:64
    buffer_load_dwordx4 a[32:35], v41, s[4:7], s30 offen offset:64
    buffer_load_dwordx4 a[36:39], v42, s[4:7], s30 offen offset:64
    buffer_load_dwordx4 a[40:43], v43, s[4:7], s30 offen offset:64
    buffer_load_dwordx4 a[44:47], v44, s[4:7], s30 offen offset:64
    buffer_load_dwordx4 a[48:51], v45, s[4:7], s30 offen offset:64
    buffer_load_dwordx4 a[52:55], v46, s[4:7], s30 offen offset:64
    buffer_load_dwordx4 a[56:59], v40, s[4:7], s30 offen offset:128
    buffer_load_dwordx4 a[60:63], v41, s[4:7], s30 offen offset:128
    buffer_load_dwordx4 a[64:67], v42, s[4:7], s30 offen offset:128
    buffer_load_dwordx4 a[68:71], v43, s[4:7], s30 offen offset:128
    buffer_load_dwordx4 a[72:75], v44, s[4:7], s30 offen offset:128
    buffer_load_dwordx4 a[76:79], v45, s[4:7], s30 offen offset:128
    buffer_load_dwordx4 a[80:83], v46, s[4:7], s30 offen offset:128
    buffer_load_dwordx4 a[84:87], v40, s[4:7], s30 offen offset:192
    buffer_load_dwordx4 a[88:91], v41, s[4:7], s30 offen offset:192
    buffer_load_dwordx4 a[92:95], v42, s[4:7], s30 offen offset:192
    buffer_load_dwordx4 a[96:99], v43, s[4:7], s30 offen offset:192
    buffer_load_dwordx4 a[100:103], v44, s[4:7], s30 offen offset:192
    buffer_load_dwordx4 a[104:107], v45, s[4:7], s30 offen offset:192
    buffer_load_dwordx4 a[108:111], v46, s[4:7], s30 offen offset:192
    buffer_load_dwordx4 a[112:115], v40, s[4:7], s30 offen offset:256
    buffer_load_dwordx4 a[116:119], v41, s[4:7], s30 offen offset:256
    buffer_load_dwordx4 a[120:123], v42, s[4:7], s30 offen offset:256
    buffer_load_dwordx4 a[124:127], v43, s[4:7], s30 offen offset:256
    buffer_load_dwordx4 a[128:131], v44, s[4:7], s30 offen offset:256
    buffer_load_dwordx4 a[132:135], v45, s[4:7], s30 offen offset:256
    buffer_load_dwordx4 a[136:139], v46, s[4:7], s30 offen offset:256
    buffer_load_dwordx4 a[140:143], v40, s[4:7], s30 offen offset:320
    buffer_load_dwordx4 a[144:147], v41, s[4:7], s30 offen offset:320
    buffer_load_dwordx4 a[148:151], v42, s[4:7], s30 offen offset:320
    buffer_load_dwordx4 a[152:155], v43, s[4:7], s30 offen offset:320
    buffer_load_dwordx4 a[156:159], v44, s[4:7], s30 offen offset:320
    buffer_load_dwordx4 a[160:163], v45, s[4:7], s30 offen offset:320
    buffer_load_dwordx4 a[164:167], v46, s[4:7], s30 offen offset:320
    buffer_load_dwordx4 a[168:171], v40, s[4:7], s30 offen offset:384
    buffer_load_dwordx4 a[172:175], v41, s[4:7], s30 offen offset:384
    buffer_load_dwordx4 a[176:179], v42, s[4:7], s30 offen offset:384
    buffer_load_dwordx4 a[180:183], v43, s[4:7], s30 offen offset:384
    buffer_load_dwordx4 a[184:187], v44, s[4:7], s30 offen offset:384
    buffer_load_dwordx4 a[188:191], v45, s[4:7], s30 offen offset:384
    buffer_load_dwordx4 a[192:195], v46, s[4:7], s30 offen offset:384
    buffer_load_dwordx4 a[196:199], v40, s[4:7], s30 offen offset:448
    buffer_load_dwordx4 a[200:203], v41, s[4:7], s30 offen offset:448
    buffer_load_dwordx4 a[204:207], v42, s[4:7], s30 offen offset:448
    buffer_load_dwordx4 a[208:211], v43, s[4:7], s30 offen offset:448
    buffer_load_dwordx4 a[212:215], v44, s[4:7], s30 offen offset:448
    buffer_load_dwordx4 a[216:219], v45, s[4:7], s30 offen offset:448
    buffer_load_dwordx4 a[220:223], v46, s[4:7], s30 offen offset:448
    buffer_load_dwordx4 a[224:227], v40, s[4:7], s30 offen offset:512
    buffer_load_dwordx4 a[228:231], v41, s[4:7], s30 offen offset:512
    buffer_load_dwordx4 a[232:235], v42, s[4:7], s30 offen offset:512
    buffer_load_dwordx4 a[236:239], v43, s[4:7], s30 offen offset:512
    buffer_load_dwordx4 a[240:243], v44, s[4:7], s30 offen offset:512
    buffer_load_dwordx4 a[244:247], v45, s[4:7], s30 offen offset:512
    buffer_load_dwordx4 a[248:251], v46, s[4:7], s30 offen offset:512
    buffer_load_dwordx4 a[252:255], v40, s[4:7], s30 offen offset:576
    buffer_load_dwordx4 v[120:123], v41, s[4:7], s30 offen offset:576
    buffer_load_dwordx4 v[124:127], v42, s[4:7], s30 offen offset:576
    buffer_load_dwordx4 v[128:131], v43, s[4:7], s30 offen offset:576
    buffer_load_dwordx4 v[132:135], v44, s[4:7], s30 offen offset:576
    buffer_load_dwordx4 v[136:139], v45, s[4:7], s30 offen offset:576
    buffer_load_dwordx4 v[140:143], v46, s[4:7], s30 offen offset:576
    buffer_load_dwordx4 v[144:147], v40, s[4:7], s30 offen offset:640
    buffer_load_dwordx4 v[148:151], v41, s[4:7], s30 offen offset:640
    buffer_load_dwordx4 v[152:155], v42, s[4:7], s30 offen offset:640
    buffer_load_dwordx4 v[156:159], v43, s[4:7], s30 offen offset:640
    buffer_load_dwordx4 v[160:163], v44, s[4:7], s30 offen offset:640
    buffer_load_dwordx4 v[164:167], v45, s[4:7], s30 offen offset:640
    buffer_load_dwordx4 v[168:171], v46, s[4:7], s30 offen offset:640
    buffer_load_dwordx4 v[172:175], v40, s[4:7], s30 offen offset:704
    buffer_load_dwordx4 v[176:179], v41, s[4:7], s30 offen offset:704
    buffer_load_dwordx4 v[180:183], v42, s[4:7], s30 offen offset:704
    buffer_load_dwordx4 v[184:187], v43, s[4:7], s30 offen offset:704
    buffer_load_dwordx4 v[188:191], v44, s[4:7], s30 offen offset:704
    buffer_load_dwordx4 v[192:195], v45, s[4:7], s30 offen offset:704
    buffer_load_dwordx4 v[196:199], v46, s[4:7], s30 offen offset:704
    buffer_load_dwordx4 v[200:203], v40, s[4:7], s30 offen offset:768
    buffer_load_dwordx4 v[204:207], v41, s[4:7], s30 offen offset:768
    buffer_load_dwordx4 v[208:211], v42, s[4:7], s30 offen offset:768
    buffer_load_dwordx4 v[212:215], v43, s[4:7], s30 offen offset:768
    buffer_load_dwordx4 v[216:219], v44, s[4:7], s30 offen offset:768
    buffer_load_dwordx4 v[220:223], v45, s[4:7], s30 offen offset:768
    buffer_load_dwordx4 v[224:227], v46, s[4:7], s30 offen offset:768
    buffer_load_dwordx4 v[228:231], v40, s[4:7], s30 offen offset:832
    buffer_load_dwordx4 v[232:235], v41, s[4:7], s30 offen offset:832
    buffer_load_dwordx4 v[236:239], v42, s[4:7], s30 offen offset:832
    buffer_load_dwordx4 v[240:243], v43, s[4:7], s30 offen offset:832
    buffer_load_dwordx4 v[244:247], v44, s[4:7], s30 offen offset:832
    buffer_load_dwordx4 v[248:251], v45, s[4:7], s30 offen offset:832
    buffer_load_dwordx4 v[252:255], v46, s[4:7], s30 offen offset:832
    v_mul_u32_u24 v5, 928, v3
    v_mul_u32_u24 v6, 224, v2
    v_add_u32 v5, v5, v6
    v_lshl_add_u32 v15, v4, 4, v5
    v_add_u32 v15, 8192, v15
    v_lshl_add_u32 v16, v4, 3, v5
    v_add_u32 v16, 8384, v16
    v_add_u32 v17, v14, v6
    v_and_b32 v5, 7, v3
    v_mul_u32_u24 v5, 928, v5
    v_add_u32 v5, v5, v6
    v_lshl_add_u32 v18, v4, 3, v5
    v_add_u32 v18, 256, v18
    v_lshl_add_u32 v5, v4, 3, v3
    v_lshlrev_b32 v5, 4, v5
    v_mul_u32_u24 v6, 1536, v2
    v_add_u32 v5, v5, v6
    v_add_u32 v19, 67584, v5
    v_lshrrev_b32 v5, 3, v1
    v_and_b32 v6, 7, v1
    v_min_u32 v7, 4, v6
    v_mul_u32_u24 v8, 40, v5
    v_lshl_add_u32 v8, v7, 3, v8
    v_lshlrev_b32 v118, 8, v7
    v_add_u32 v118, 256, v118
    v_cmp_eq_u32 vcc, 0, v7
    s_nop 1
    v_cndmask_b32 v118, v118, 0, vcc
    v_lshl_add_u32 v118, v5, 4, v118
    v_add_u32 v118, 67584, v118
    v_lshlrev_b32 v119, 1, v8
    v_cmp_gt_u32 s[40:41], 8, v3
    v_cmp_gt_u32 s[42:43], 2, v4
    s_and_b64 s[42:43], s[42:43], s[40:41]
    v_cmp_gt_u32 s[44:45], 5, v6
    v_cmp_gt_u32 s[46:47], 56, v1
    v_lshlrev_b32 v9, 4, v1
    s_mov_b32 s20, 26214400
    s_mul_i32 s21, s12, 640
    s_add_u32 s21, s21, 27262976
    s_lshl_b32 s22, s14, 3
    s_mul_i32 s23, s22, 896
    s_add_u32 s23, s23, 0
    s_mul_i32 s24, s22, 928
    s_add_u32 s24, s24, 8192
    s_mov_b32 s25, 0
    s_lshl_b32 s50, s12, 2
    s_add_u32 s50, s50, 6144
    s_mov_b32 s26, 0
    s_mov_b64 exec, s[46:47]
    s_add_u32 s27, s24, s26
    s_add_u32 m0, s27, 0
    s_add_u32 s28, s23, 0
    buffer_load_dwordx4 v9, s[4:7], s28 offen lds
    s_add_u32 s27, s24, s26
    s_add_u32 m0, s27, 928
    s_add_u32 s28, s23, 896
    buffer_load_dwordx4 v9, s[4:7], s28 offen lds
    s_add_u32 s27, s24, s26
    s_add_u32 m0, s27, 1856
    s_add_u32 s28, s23, 1792
    buffer_load_dwordx4 v9, s[4:7], s28 offen lds
    s_add_u32 s27, s24, s26
    s_add_u32 m0, s27, 2784
    s_add_u32 s28, s23, 2688
    buffer_load_dwordx4 v9, s[4:7], s28 offen lds
    s_add_u32 s27, s24, s26
    s_add_u32 m0, s27, 3712
    s_add_u32 s28, s23, 3584
    buffer_load_dwordx4 v9, s[4:7], s28 offen lds
    s_add_u32 s27, s24, s26
    s_add_u32 m0, s27, 4640
    s_add_u32 s28, s23, 4480
    buffer_load_dwordx4 v9, s[4:7], s28 offen lds
    s_add_u32 s27, s24, s26
    s_add_u32 m0, s27, 5568
    s_add_u32 s28, s23, 5376
    buffer_load_dwordx4 v9, s[4:7], s28 offen lds
    s_add_u32 s27, s24, s26
    s_add_u32 m0, s27, 6496
    s_add_u32 s28, s23, 6272
    buffer_load_dwordx4 v9, s[4:7], s28 offen lds
    s_mov_b64 exec, -1
    s_sub_u32 s22, s14, 1
    s_mul_i32 s22, s22, 11
    s_min_u32 s22, s22, 21
    s_mul_i32 s23, s22, 896
    s_add_u32 s23, s23, 28672
    s_mul_i32 s24, s22, 928
    s_add_u32 s24, s24, 8192
chain_kernel_af_loop:
    buffer_load_dwordx4 v[20:23], v10, s[4:7], s20 offen sc1
    buffer_load_dwordx4 v[24:27], v11, s[4:7], s20 offen sc1
chain_kernel_af_pm:
    buffer_load_dwordx4 v[40:43], v10, s[4:7], s20 offen sc1
    buffer_load_dwordx4 v[44:47], v11, s[4:7], s20 offen sc1
    s_waitcnt vmcnt(2)
    v_max3_u32 v5, v20, v21, v22
    v_max3_u32 v6, v23, v24, v25
    v_max3_u32 v5, v5, v26, v27
    v_max_u32 v5, v5, v6
    v_cmp_eq_u32 vcc, -1, v5
    s_cbranch_vccz chain_kernel_af_pm_ok0
    buffer_load_dwordx4 v[20:23], v10, s[4:7], s20 offen sc1
    buffer_load_dwordx4 v[24:27], v11, s[4:7], s20 offen sc1
    s_waitcnt vmcnt(2)
    v_max3_u32 v5, v40, v41, v42
    v_max3_u32 v6, v43, v44, v45
    v_max3_u32 v5, v5, v46, v47
    v_max_u32 v5, v5, v6
    v_cmp_eq_u32 vcc, -1, v5
    s_cbranch_vccz chain_kernel_af_pm_ok1
    s_add_u32 s48, s48, 1
    s_cmp_gt_u32 s48, 0x200000
    s_cbranch_scc0 chain_kernel_af_pm
    s_branch chain_kernel_end
chain_kernel_af_pm_ok0:
    ds_write_b128 v12, v[20:23]
    ds_write_b128 v13, v[24:27]
    s_branch chain_kernel_af_pm_done
chain_kernel_af_pm_ok1:
    ds_write_b128 v12, v[40:43]
    ds_write_b128 v13, v[44:47]
chain_kernel_af_pm_done:
    s_waitcnt lgkmcnt(0)
    s_barrier
    v_add_u32 v5, s26, v15
    v_add_u32 v6, s26, v16
    ds_read_b128 v[28:31], v14 offset:0
    ds_read_b128 v[32:35], v14 offset:64
    ds_read_b128 v[36:39], v14 offset:128
    s_waitcnt lgkmcnt(2)
    v_mfma_f32_16x16x32_bf16 v[48:51], a[0:3], v[28:31], 0
    v_mfma_f32_16x16x32_bf16 v[52:55], a[4:7], v[28:31], 0
    v_mfma_f32_16x16x32_bf16 v[56:59], a[8:11], v[28:31], 0
    v_mfma_f32_16x16x32_bf16 v[60:63], a[12:15], v[28:31], 0
    ds_read_b128 v[28:31], v14 offset:192
    s_waitcnt lgkmcnt(2)
    v_mfma_f32_16x16x32_bf16 v[48:51], a[28:31], v[32:35], v[48:51]
    v_mfma_f32_16x16x32_bf16 v[52:55], a[32:35], v[32:35], v[52:55]
    v_mfma_f32_16x16x32_bf16 v[56:59], a[36:39], v[32:35], v[56:59]
    v_mfma_f32_16x16x32_bf16 v[60:63], a[40:43], v[32:35], v[60:63]
    ds_read_b128 v[76:79], v5 offset:0
    ds_read_b128 v[32:35], v14 offset:256
    s_waitcnt lgkmcnt(3)
    v_mfma_f32_16x16x32_bf16 v[48:51], a[56:59], v[36:39], v[48:51]
    v_mfma_f32_16x16x32_bf16 v[52:55], a[60:63], v[36:39], v[52:55]
    v_mfma_f32_16x16x32_bf16 v[56:59], a[64:67], v[36:39], v[56:59]
    v_mfma_f32_16x16x32_bf16 v[60:63], a[68:71], v[36:39], v[60:63]
    ds_read_b128 v[80:83], v5 offset:14848
    ds_read_b128 v[36:39], v14 offset:320
    s_waitcnt lgkmcnt(4)
    v_mfma_f32_16x16x32_bf16 v[48:51], a[84:87], v[28:31], v[48:51]
    v_mfma_f32_16x16x32_bf16 v[52:55], a[88:91], v[28:31], v[52:55]
    v_mfma_f32_16x16x32_bf16 v[56:59], a[92:95], v[28:31], v[56:59]
    v_mfma_f32_16x16x32_bf16 v[60:63], a[96:99], v[28:31], v[60:63]
    ds_read_b128 v[84:87], v17 offset:0
    ds_read_b128 v[28:31], v14 offset:384
    s_waitcnt lgkmcnt(4)
    v_mfma_f32_16x16x32_bf16 v[48:51], a[112:115], v[32:35], v[48:51]
    v_mfma_f32_16x16x32_bf16 v[52:55], a[116:119], v[32:35], v[52:55]
    v_mfma_f32_16x16x32_bf16 v[56:59], a[120:123], v[32:35], v[56:59]
    v_mfma_f32_16x16x32_bf16 v[60:63], a[124:127], v[32:35], v[60:63]
    ds_read_b128 v[88:91], v5 offset:64
    ds_read_b128 v[32:35], v14 offset:448
    s_waitcnt lgkmcnt(4)
    v_mfma_f32_16x16x32_bf16 v[48:51], a[140:143], v[36:39], v[48:51]
    v_mfma_f32_16x16x32_bf16 v[52:55], a[144:147], v[36:39], v[52:55]
    v_mfma_f32_16x16x32_bf16 v[56:59], a[148:151], v[36:39], v[56:59]
    v_mfma_f32_16x16x32_bf16 v[60:63], a[152:155], v[36:39], v[60:63]
    ds_read_b128 v[92:95], v5 offset:14912
    ds_read_b128 v[36:39], v14 offset:512
    s_waitcnt lgkmcnt(4)
    v_mfma_f32_16x16x32_bf16 v[48:51], a[168:171], v[28:31], v[48:51]
    v_mfma_f32_16x16x32_bf16 v[52:55], a[172:175], v[28:31], v[52:55]
    v_mfma_f32_16x16x32_bf16 v[56:59], a[176:179], v[28:31], v[56:59]
    v_mfma_f32_16x16x32_bf16 v[60:63], a[180:183], v[28:31], v[60:63]
    ds_read_b128 v[96:99], v17 offset:64
    ds_read_b128 v[28:31], v14 offset:576
    s_waitcnt lgkmcnt(4)
    v_mfma_f32_16x16x32_bf16 v[48:51], a[196:199], v[32:35], v[48:51]
    v_mfma_f32_16x16x32_bf16 v[52:55], a[200:203], v[32:35], v[52:55]
    v_mfma_f32_16x16x32_bf16 v[56:59], a[204:207], v[32:35], v[56:59]
    v_mfma_f32_16x16x32_bf16 v[60:63], a[208:211], v[32:35], v[60:63]
    ds_read_b128 v[100:103], v5 offset:128
    ds_read_b128 v[32:35], v14 offset:640
    s_waitcnt lgkmcnt(4)
    v_mfma_f32_16x16x32_bf16 v[48:51], a[224:227], v[36:39], v[48:51]
    v_mfma_f32_16x16x32_bf16 v[52:55], a[228:231], v[36:39], v[52:55]
    v_mfma_f32_16x16x32_bf16 v[56:59], a[232:235], v[36:39], v[56:59]
    v_mfma_f32_16x16x32_bf16 v[60:63], a[236:239], v[36:39], v[60:63]
    ds_read_b128 v[104:107], v5 offset:14976
    ds_read_b128 v[36:39], v14 offset:704
    s_waitcnt lgkmcnt(4)
    v_mfma_f32_16x16x32_bf16 v[48:51], a[252:255], v[28:31], v[48:51]
    v_mfma_f32_16x16x32_bf16 v[52:55], v[120:123], v[28:31], v[52:55]
    v_mfma_f32_16x16x32_bf16 v[56:59], v[124:127], v[28:31], v[56:59]
    v_mfma_f32_16x16x32_bf16 v[60:63], v[128:131], v[28:31], v[60:63]
    ds_read_b128 v[108:111], v17 offset:128
    ds_read_b128 v[28:31], v14 offset:768
    s_waitcnt lgkmcnt(4)
    v_mfma_f32_16x16x32_bf16 v[48:51], v[144:147], v[32:35], v[48:51]
    v_mfma_f32_16x16x32_bf16 v[52:55], v[148:151], v[32:35], v[52:55]
    v_mfma_f32_16x16x32_bf16 v[56:59], v[152:155], v[32:35], v[56:59]
    v_mfma_f32_16x16x32_bf16 v[60:63], v[156:159], v[32:35], v[60:63]
    ds_read_b64 v[112:113], v6
    ds_read_b128 v[32:35], v14 offset:832
    s_waitcnt lgkmcnt(4)
    v_mfma_f32_16x16x32_bf16 v[48:51], v[172:175], v[36:39], v[48:51]
    v_mfma_f32_16x16x32_bf16 v[52:55], v[176:179], v[36:39], v[52:55]
    v_mfma_f32_16x16x32_bf16 v[56:59], v[180:183], v[36:39], v[56:59]
    v_mfma_f32_16x16x32_bf16 v[60:63], v[184:187], v[36:39], v[60:63]
    ds_read_b64 v[114:115], v6 offset:14848
    ds_read_b128 v[36:39], v14 offset:0
    s_waitcnt lgkmcnt(4)
    v_mfma_f32_16x16x32_bf16 v[48:51], v[200:203], v[28:31], v[48:51]
    v_mfma_f32_16x16x32_bf16 v[52:55], v[204:207], v[28:31], v[52:55]
    v_mfma_f32_16x16x32_bf16 v[56:59], v[208:211], v[28:31], v[56:59]
    v_mfma_f32_16x16x32_bf16 v[60:63], v[212:215], v[28:31], v[60:63]
    ds_read_b64 v[116:117], v18
    ds_read_b128 v[28:31], v14 offset:64
    s_waitcnt lgkmcnt(4)
    v_mfma_f32_16x16x32_bf16 v[48:51], v[228:231], v[32:35], v[48:51]
    v_mfma_f32_16x16x32_bf16 v[52:55], v[232:235], v[32:35], v[52:55]
    v_mfma_f32_16x16x32_bf16 v[56:59], v[236:239], v[32:35], v[56:59]
    v_mfma_f32_16x16x32_bf16 v[60:63], v[240:243], v[32:35], v[60:63]
    ds_read_b128 v[32:35], v14 offset:128
    s_waitcnt lgkmcnt(3)
    v_mfma_f32_16x16x32_bf16 v[64:67], a[16:19], v[36:39], 0
    v_mfma_f32_16x16x32_bf16 v[68:71], a[20:23], v[36:39], 0
    v_mfma_f32_16x16x32_bf16 v[72:75], a[24:27], v[36:39], 0
    ds_read_b128 v[36:39], v14 offset:192
    s_waitcnt lgkmcnt(2)
    v_mfma_f32_16x16x32_bf16 v[64:67], a[44:47], v[28:31], v[64:67]
    v_mfma_f32_16x16x32_bf16 v[68:71], a[48:51], v[28:31], v[68:71]
    v_mfma_f32_16x16x32_bf16 v[72:75], a[52:55], v[28:31], v[72:75]
    s_waitcnt vmcnt(0)
    ds_read_b128 v[28:31], v14 offset:256
    s_waitcnt lgkmcnt(2)
    v_mfma_f32_16x16x32_bf16 v[64:67], a[72:75], v[32:35], v[64:67]
    v_mfma_f32_16x16x32_bf16 v[68:71], a[76:79], v[32:35], v[68:71]
    v_mfma_f32_16x16x32_bf16 v[72:75], a[80:83], v[32:35], v[72:75]
    v_cvt_pk_bf16_f32 v20, v48, v49
    v_cvt_pk_bf16_f32 v21, v50, v51
    v_cvt_pk_bf16_f32 v22, v52, v53
    v_cvt_pk_bf16_f32 v23, v54, v55
    v_cvt_pk_bf16_f32 v24, v56, v57
    v_cvt_pk_bf16_f32 v25, v58, v59
    v_cvt_pk_bf16_f32 v26, v60, v61
    v_cvt_pk_bf16_f32 v27, v62, v63
    ds_read_b128 v[32:35], v14 offset:320
    s_waitcnt lgkmcnt(2)
    v_mfma_f32_16x16x32_bf16 v[64:67], a[100:103], v[36:39], v[64:67]
    v_mfma_f32_16x16x32_bf16 v[68:71], a[104:107], v[36:39], v[68:71]
    v_mfma_f32_16x16x32_bf16 v[72:75], a[108:111], v[36:39], v[72:75]
    ds_read_b128 v[36:39], v14 offset:384
    s_waitcnt lgkmcnt(2)
    v_mfma_f32_16x16x32_bf16 v[64:67], a[128:131], v[28:31], v[64:67]
    v_mfma_f32_16x16x32_bf16 v[68:71], a[132:135], v[28:31], v[68:71]
    v_mfma_f32_16x16x32_bf16 v[72:75], a[136:139], v[28:31], v[72:75]
    v_mfma_f32_16x16x32_bf16 v[48:51], v[76:79], v[20:23], 0
    v_mfma_f32_16x16x32_bf16 v[52:55], v[80:83], v[20:23], 0
    v_mfma_f32_16x16x32_bf16 v[56:59], v[84:87], v[20:23], 0
    ds_read_b128 v[28:31], v14 offset:448
    s_waitcnt lgkmcnt(2)
    v_mfma_f32_16x16x32_bf16 v[64:67], a[156:159], v[32:35], v[64:67]
    v_mfma_f32_16x16x32_bf16 v[68:71], a[160:163], v[32:35], v[68:71]
    v_mfma_f32_16x16x32_bf16 v[72:75], a[164:167], v[32:35], v[72:75]
    ds_read_b128 v[32:35], v14 offset:512
    s_waitcnt lgkmcnt(2)
    v_mfma_f32_16x16x32_bf16 v[64:67], a[184:187], v[36:39], v[64:67]
    v_mfma_f32_16x16x32_bf16 v[68:71], a[188:191], v[36:39], v[68:71]
    v_mfma_f32_16x16x32_bf16 v[72:75], a[192:195], v[36:39], v[72:75]
    v_mfma_f32_16x16x32_bf16 v[48:51], v[88:91], v[24:27], v[48:51]
    v_mfma_f32_16x16x32_bf16 v[52:55], v[92:95], v[24:27], v[52:55]
    v_mfma_f32_16x16x32_bf16 v[56:59], v[96:99], v[24:27], v[56:59]
    ds_read_b128 v[36:39], v14 offset:576
    s_waitcnt lgkmcnt(2)
    v_mfma_f32_16x16x32_bf16 v[64:67], a[212:215], v[28:31], v[64:67]
    v_mfma_f32_16x16x32_bf16 v[68:71], a[216:219], v[28:31], v[68:71]
    v_mfma_f32_16x16x32_bf16 v[72:75], a[220:223], v[28:31], v[72:75]
    ds_read_b128 v[28:31], v14 offset:640
    s_waitcnt lgkmcnt(2)
    v_mfma_f32_16x16x32_bf16 v[64:67], a[240:243], v[32:35], v[64:67]
    v_mfma_f32_16x16x32_bf16 v[68:71], a[244:247], v[32:35], v[68:71]
    v_mfma_f32_16x16x32_bf16 v[72:75], a[248:251], v[32:35], v[72:75]
    ds_read_b128 v[32:35], v14 offset:704
    s_waitcnt lgkmcnt(2)
    v_mfma_f32_16x16x32_bf16 v[64:67], v[132:135], v[36:39], v[64:67]
    v_mfma_f32_16x16x32_bf16 v[68:71], v[136:139], v[36:39], v[68:71]
    v_mfma_f32_16x16x32_bf16 v[72:75], v[140:143], v[36:39], v[72:75]
    ds_read_b128 v[36:39], v14 offset:768
    s_waitcnt lgkmcnt(2)
    v_mfma_f32_16x16x32_bf16 v[64:67], v[160:163], v[28:31], v[64:67]
    v_mfma_f32_16x16x32_bf16 v[68:71], v[164:167], v[28:31], v[68:71]
    v_mfma_f32_16x16x32_bf16 v[72:75], v[168:171], v[28:31], v[72:75]
    ds_read_b128 v[28:31], v14 offset:832
    s_waitcnt lgkmcnt(2)
    v_mfma_f32_16x16x32_bf16 v[64:67], v[188:191], v[32:35], v[64:67]
    v_mfma_f32_16x16x32_bf16 v[68:71], v[192:195], v[32:35], v[68:71]
    v_mfma_f32_16x16x32_bf16 v[72:75], v[196:199], v[32:35], v[72:75]
    s_waitcnt lgkmcnt(1)
    v_mfma_f32_16x16x32_bf16 v[64:67], v[216:219], v[36:39], v[64:67]
    v_mfma_f32_16x16x32_bf16 v[68:71], v[220:223], v[36:39], v[68:71]
    v_mfma_f32_16x16x32_bf16 v[72:75], v[224:227], v[36:39], v[72:75]
    s_waitcnt lgkmcnt(0)
    v_mfma_f32_16x16x32_bf16 v[64:67], v[244:247], v[28:31], v[64:67]
    v_mfma_f32_16x16x32_bf16 v[68:71], v[248:251], v[28:31], v[68:71]
    v_mfma_f32_16x16x32_bf16 v[72:75], v[252:255], v[28:31], v[72:75]
    s_nop 7
    v_cvt_pk_bf16_f32 v40, v64, v65
    v_cvt_pk_bf16_f32 v41, v66, v67
    v_cvt_pk_bf16_f32 v42, v68, v69
    v_cvt_pk_bf16_f32 v43, v70, v71
    v_cvt_pk_bf16_f32 v44, v72, v73
    v_cvt_pk_bf16_f32 v45, v74, v75
    s_nop 1
    v_mfma_f32_16x16x32_bf16 v[48:51], v[100:103], v[40:43], v[48:51]
    v_mfma_f32_16x16x32_bf16 v[52:55], v[104:107], v[40:43], v[52:55]
    v_mfma_f32_16x16x32_bf16 v[56:59], v[108:111], v[40:43], v[56:59]
    v_mfma_f32_16x16x16_bf16 v[48:51], v[112:113], v[44:45], v[48:51]
    v_mfma_f32_16x16x16_bf16 v[52:55], v[114:115], v[44:45], v[52:55]
    v_mfma_f32_16x16x16_bf16 v[56:59], v[116:117], v[44:45], v[56:59]
    s_mov_b64 exec, s[40:41]
    s_nop 7
    ds_write_b128 v19, v[48:51] offset:512
    ds_write_b128 v19, v[52:55] offset:1024
    ds_write_b128 v19, v[56:59]
    s_mov_b64 exec, -1
    s_waitcnt lgkmcnt(0)
    s_barrier
    s_cmp_lg_u32 s14, 0
    s_cbranch_scc1 chain_kernel_af_dma
    ds_read_b128 v[48:51], v118 offset:0
    ds_read_b128 v[52:55], v118 offset:128
    ds_read_b128 v[56:59], v118 offset:1536
    ds_read_b128 v[60:63], v118 offset:1664
    ds_read_b128 v[64:67], v118 offset:3072
    ds_read_b128 v[68:71], v118 offset:3200
    ds_read_b128 v[72:75], v118 offset:4608
    ds_read_b128 v[76:79], v118 offset:4736
    s_waitcnt lgkmcnt(4)
    v_pk_add_f32 v[48:49], v[48:49], v[56:57]
    v_pk_add_f32 v[50:51], v[50:51], v[58:59]
    v_pk_add_f32 v[52:53], v[52:53], v[60:61]
    v_pk_add_f32 v[54:55], v[54:55], v[62:63]
    s_waitcnt lgkmcnt(0)
    v_pk_add_f32 v[64:65], v[64:65], v[72:73]
    v_pk_add_f32 v[66:67], v[66:67], v[74:75]
    v_pk_add_f32 v[68:69], v[68:69], v[76:77]
    v_pk_add_f32 v[70:71], v[70:71], v[78:79]
    v_pk_add_f32 v[80:81], v[48:49], v[64:65]
    v_pk_add_f32 v[82:83], v[50:51], v[66:67]
    v_pk_add_f32 v[84:85], v[52:53], v[68:69]
    v_pk_add_f32 v[86:87], v[54:55], v[70:71]
    v_max3_f32 v5, v80, v81, v82
    v_max3_f32 v6, v83, v84, v85
    v_max3_f32 v5, v5, v86, v87
    v_max_f32 v5, v5, v6
    s_nop 1
    v_max_f32_dpp v5, v5, v5 quad_perm:[1,0,3,2] row_mask:0xf bank_mask:0xf
    s_nop 1
    v_max_f32_dpp v5, v5, v5 quad_perm:[2,3,0,1] row_mask:0xf bank_mask:0xf
    s_nop 1
    v_max_f32_dpp v5, v5, v5 row_half_mirror row_mask:0xf bank_mask:0xf
    v_mul_f32 v5, 0xbfb8aa3b, v5
    v_fmamk_f32 v80, v80, 0x3fb8aa3b, v5
    v_fmamk_f32 v81, v81, 0x3fb8aa3b, v5
    v_fmamk_f32 v82, v82, 0x3fb8aa3b, v5
    v_fmamk_f32 v83, v83, 0x3fb8aa3b, v5
    v_fmamk_f32 v84, v84, 0x3fb8aa3b, v5
    v_fmamk_f32 v85, v85, 0x3fb8aa3b, v5
    v_fmamk_f32 v86, v86, 0x3fb8aa3b, v5
    v_fmamk_f32 v87, v87, 0x3fb8aa3b, v5
    v_exp_f32 v80, v80
    v_exp_f32 v81, v81
    v_exp_f32 v82, v82
    v_exp_f32 v83, v83
    v_exp_f32 v84, v84
    v_exp_f32 v85, v85
    v_exp_f32 v86, v86
    v_exp_f32 v87, v87
    s_nop 0
    v_add_f32 v5, v80, v81
    v_add_f32 v6, v82, v83
    v_add_f32 v7, v84, v85
    v_add_f32 v8, v86, v87
    v_add_f32 v5, v5, v6
    v_add_f32 v7, v7, v8
    v_add_f32 v5, v5, v7
    v_cndmask_b32 v5, 0, v5, s[44:45]
    s_nop 1
    v_add_f32_dpp v5, v5, v5 quad_perm:[1,0,3,2] row_mask:0xf bank_mask:0xf
    s_nop 1
    v_add_f32_dpp v5, v5, v5 quad_perm:[2,3,0,1] row_mask:0xf bank_mask:0xf
    s_nop 1
    v_add_f32_dpp v5, v5, v5 row_half_mirror row_mask:0xf bank_mask:0xf
    v_rcp_f32 v5, v5
    s_nop 0
    v_mul_f32 v80, v80, v5
    v_mul_f32 v81, v81, v5
    v_mul_f32 v82, v82, v5
    v_mul_f32 v83, v83, v5
    v_mul_f32 v84, v84, v5
    v_mul_f32 v85, v85, v5
    v_mul_f32 v86, v86, v5
    v_mul_f32 v87, v87, v5
    v_cvt_pk_bf16_f32 v88, v80, v81
    v_min_u32 v88, 0xfffffffe, v88
    v_cvt_pk_bf16_f32 v89, v82, v83
    v_min_u32 v89, 0xfffffffe, v89
    v_cvt_pk_bf16_f32 v90, v84, v85
    v_min_u32 v90, 0xfffffffe, v90
    v_cvt_pk_bf16_f32 v91, v86, v87
    v_min_u32 v91, 0xfffffffe, v91
    s_mov_b64 exec, s[44:45]
    buffer_store_dwordx4 v[88:91], v119, s[4:7], s21 offen
    s_mov_b64 exec, -1
    s_barrier
    s_branch chain_kernel_af_skip
chain_kernel_af_dma:
    s_barrier
    s_sub_u32 s29, 29696, s26
    s_mov_b64 exec, s[46:47]
    s_add_u32 s27, s24, s29
    s_add_u32 m0, s27, 0
    s_add_u32 s28, s23, 0
    buffer_load_dwordx4 v9, s[4:7], s28 offen lds
    s_add_u32 s27, s24, s29
    s_add_u32 m0, s27, 928
    s_add_u32 s28, s23, 896
    buffer_load_dwordx4 v9, s[4:7], s28 offen lds
    s_add_u32 s27, s24, s29
    s_add_u32 m0, s27, 1856
    s_add_u32 s28, s23, 1792
    buffer_load_dwordx4 v9, s[4:7], s28 offen lds
    s_add_u32 s27, s24, s29
    s_add_u32 m0, s27, 2784
    s_add_u32 s28, s23, 2688
    buffer_load_dwordx4 v9, s[4:7], s28 offen lds
    s_add_u32 s27, s24, s29
    s_add_u32 m0, s27, 3712
    s_add_u32 s28, s23, 3584
    buffer_load_dwordx4 v9, s[4:7], s28 offen lds
    s_add_u32 s27, s24, s29
    s_add_u32 m0, s27, 4640
    s_add_u32 s28, s23, 4480
    buffer_load_dwordx4 v9, s[4:7], s28 offen lds
    s_add_u32 s27, s24, s29
    s_add_u32 m0, s27, 5568
    s_add_u32 s28, s23, 5376
    buffer_load_dwordx4 v9, s[4:7], s28 offen lds
    s_add_u32 s27, s24, s29
    s_add_u32 m0, s27, 6496
    s_add_u32 s28, s23, 6272
    buffer_load_dwordx4 v9, s[4:7], s28 offen lds
    s_add_u32 s27, s24, s29
    s_add_u32 m0, s27, 7424
    s_add_u32 s28, s23, 7168
    buffer_load_dwordx4 v9, s[4:7], s28 offen lds
    s_add_u32 s27, s24, s29
    s_add_u32 m0, s27, 8352
    s_add_u32 s28, s23, 8064
    buffer_load_dwordx4 v9, s[4:7], s28 offen lds
    s_add_u32 s27, s24, s29
    s_add_u32 m0, s27, 9280
    s_add_u32 s28, s23, 8960
    buffer_load_dwordx4 v9, s[4:7], s28 offen lds
    s_mov_b64 exec, -1
    s_add_u32 s23, s23, 28672
chain_kernel_af_skip:
    s_add_u32 s20, s20, 7168
    s_add_u32 s21, s21, 10240
    s_sub_u32 s26, 29696, s26
    s_add_u32 s25, s25, 1
    s_cmp_lt_u32 s25, 64
    s_cbranch_scc1 chain_kernel_af_loop
    s_endpgm
chain_kernel_a_safe:
    s_mul_i32 s20, s12, 448
    v_mul_u32_u24 v5, 112, v2
    v_add_u32 v5, s20, v5
    v_lshrrev_b32 v6, 2, v3
    v_lshlrev_b32 v6, 3, v6
    v_and_b32 v7, 3, v3
    v_add_u32 v6, v6, v7
    v_add_u32 v7, 0, v6
    v_add_u32 v7, v7, v5
    v_mul_u32_u24 v7, 896, v7
    v_lshl_add_u32 v40, v4, 4, v7
    v_add_u32 v7, 4, v6
    v_add_u32 v7, v7, v5
    v_mul_u32_u24 v7, 896, v7
    v_lshl_add_u32 v41, v4, 4, v7
    v_add_u32 v7, 32, v6
    v_add_u32 v7, v7, v5
    v_mul_u32_u24 v7, 896, v7
    v_lshl_add_u32 v42, v4, 4, v7
    v_add_u32 v7, 36, v6
    v_add_u32 v7, v7, v5
    v_mul_u32_u24 v7, 896, v7
    v_lshl_add_u32 v43, v4, 4, v7
    v_add_u32 v7, 64, v6
    v_add_u32 v7, v7, v5
    v_mul_u32_u24 v7, 896, v7
    v_lshl_add_u32 v44, v4, 4, v7
    v_add_u32 v7, 68, v6
    v_add_u32 v7, v7, v5
    v_mul_u32_u24 v7, 896, v7
    v_lshl_add_u32 v45, v4, 4, v7
    v_add_u32 v7, 96, v3
    v_add_u32 v7, v7, v5
    v_mul_u32_u24 v7, 896, v7
    v_lshl_add_u32 v46, v4, 4, v7
    s_mov_b32 s30, 12582912
    buffer_load_dwordx4 a[0:3], v40, s[4:7], s30 offen offset:0
    buffer_load_dwordx4 a[4:7], v41, s[4:7], s30 offen offset:0
    buffer_load_dwordx4 a[8:11], v42, s[4:7], s30 offen offset:0
    buffer_load_dwordx4 a[12:15], v43, s[4:7], s30 offen offset:0
    buffer_load_dwordx4 a[16:19], v44, s[4:7], s30 offen offset:0
    buffer_load_dwordx4 a[20:23], v45, s[4:7], s30 offen offset:0
    buffer_load_dwordx4 a[24:27], v46, s[4:7], s30 offen offset:0
    buffer_load_dwordx4 a[28:31], v40, s[4:7], s30 offen offset:64
    buffer_load_dwordx4 a[32:35], v41, s[4:7], s30 offen offset:64
    buffer_load_dwordx4 a[36:39], v42, s[4:7], s30 offen offset:64
    buffer_load_dwordx4 a[40:43], v43, s[4:7], s30 offen offset:64
    buffer_load_dwordx4 a[44:47], v44, s[4:7], s30 offen offset:64
    buffer_load_dwordx4 a[48:51], v45, s[4:7], s30 offen offset:64
    buffer_load_dwordx4 a[52:55], v46, s[4:7], s30 offen offset:64
    buffer_load_dwordx4 a[56:59], v40, s[4:7], s30 offen offset:128
    buffer_load_dwordx4 a[60:63], v41, s[4:7], s30 offen offset:128
    buffer_load_dwordx4 a[64:67], v42, s[4:7], s30 offen offset:128
    buffer_load_dwordx4 a[68:71], v43, s[4:7], s30 offen offset:128
    buffer_load_dwordx4 a[72:75], v44, s[4:7], s30 offen offset:128
    buffer_load_dwordx4 a[76:79], v45, s[4:7], s30 offen offset:128
    buffer_load_dwordx4 a[80:83], v46, s[4:7], s30 offen offset:128
    buffer_load_dwordx4 a[84:87], v40, s[4:7], s30 offen offset:192
    buffer_load_dwordx4 a[88:91], v41, s[4:7], s30 offen offset:192
    buffer_load_dwordx4 a[92:95], v42, s[4:7], s30 offen offset:192
    buffer_load_dwordx4 a[96:99], v43, s[4:7], s30 offen offset:192
    buffer_load_dwordx4 a[100:103], v44, s[4:7], s30 offen offset:192
    buffer_load_dwordx4 a[104:107], v45, s[4:7], s30 offen offset:192
    buffer_load_dwordx4 a[108:111], v46, s[4:7], s30 offen offset:192
    buffer_load_dwordx4 a[112:115], v40, s[4:7], s30 offen offset:256
    buffer_load_dwordx4 a[116:119], v41, s[4:7], s30 offen offset:256
    buffer_load_dwordx4 a[120:123], v42, s[4:7], s30 offen offset:256
    buffer_load_dwordx4 a[124:127], v43, s[4:7], s30 offen offset:256
    buffer_load_dwordx4 a[128:131], v44, s[4:7], s30 offen offset:256
    buffer_load_dwordx4 a[132:135], v45, s[4:7], s30 offen offset:256
    buffer_load_dwordx4 a[136:139], v46, s[4:7], s30 offen offset:256
    buffer_load_dwordx4 a[140:143], v40, s[4:7], s30 offen offset:320
    buffer_load_dwordx4 a[144:147], v41, s[4:7], s30 offen offset:320
    buffer_load_dwordx4 a[148:151], v42, s[4:7], s30 offen offset:320
    buffer_load_dwordx4 a[152:155], v43, s[4:7], s30 offen offset:320
    buffer_load_dwordx4 a[156:159], v44, s[4:7], s30 offen offset:320
    buffer_load_dwordx4 a[160:163], v45, s[4:7], s30 offen offset:320
    buffer_load_dwordx4 a[164:167], v46, s[4:7], s30 offen offset:320
    buffer_load_dwordx4 a[168:171], v40, s[4:7], s30 offen offset:384
    buffer_load_dwordx4 a[172:175], v41, s[4:7], s30 offen offset:384
    buffer_load_dwordx4 a[176:179], v42, s[4:7], s30 offen offset:384
    buffer_load_dwordx4 a[180:183], v43, s[4:7], s30 offen offset:384
    buffer_load_dwordx4 a[184:187], v44, s[4:7], s30 offen offset:384
    buffer_load_dwordx4 a[188:191], v45, s[4:7], s30 offen offset:384
    buffer_load_dwordx4 a[192:195], v46, s[4:7], s30 offen offset:384
    buffer_load_dwordx4 a[196:199], v40, s[4:7], s30 offen offset:448
    buffer_load_dwordx4 a[200:203], v41, s[4:7], s30 offen offset:448
    buffer_load_dwordx4 a[204:207], v42, s[4:7], s30 offen offset:448
    buffer_load_dwordx4 a[208:211], v43, s[4:7], s30 offen offset:448
    buffer_load_dwordx4 a[212:215], v44, s[4:7], s30 offen offset:448
    buffer_load_dwordx4 a[216:219], v45, s[4:7], s30 offen offset:448
    buffer_load_dwordx4 a[220:223], v46, s[4:7], s30 offen offset:448
    buffer_load_dwordx4 a[224:227], v40, s[4:7], s30 offen offset:512
    buffer_load_dwordx4 a[228:231], v41, s[4:7], s30 offen offset:512
    buffer_load_dwordx4 a[232:235], v42, s[4:7], s30 offen offset:512
    buffer_load_dwordx4 a[236:239], v43, s[4:7], s30 offen offset:512
    buffer_load_dwordx4 a[240:243], v44, s[4:7], s30 offen offset:512
    buffer_load_dwordx4 a[244:247], v45, s[4:7], s30 offen offset:512
    buffer_load_dwordx4 a[248:251], v46, s[4:7], s30 offen offset:512
    buffer_load_dwordx4 a[252:255], v40, s[4:7], s30 offen offset:576
    buffer_load_dwordx4 v[120:123], v41, s[4:7], s30 offen offset:576
    buffer_load_dwordx4 v[124:127], v42, s[4:7], s30 offen offset:576
    buffer_load_dwordx4 v[128:131], v43, s[4:7], s30 offen offset:576
    buffer_load_dwordx4 v[132:135], v44, s[4:7], s30 offen offset:576
    buffer_load_dwordx4 v[136:139], v45, s[4:7], s30 offen offset:576
    buffer_load_dwordx4 v[140:143], v46, s[4:7], s30 offen offset:576
    buffer_load_dwordx4 v[144:147], v40, s[4:7], s30 offen offset:640
    buffer_load_dwordx4 v[148:151], v41, s[4:7], s30 offen offset:640
    buffer_load_dwordx4 v[152:155], v42, s[4:7], s30 offen offset:640
    buffer_load_dwordx4 v[156:159], v43, s[4:7], s30 offen offset:640
    buffer_load_dwordx4 v[160:163], v44, s[4:7], s30 offen offset:640
    buffer_load_dwordx4 v[164:167], v45, s[4:7], s30 offen offset:640
    buffer_load_dwordx4 v[168:171], v46, s[4:7], s30 offen offset:640
    buffer_load_dwordx4 v[172:175], v40, s[4:7], s30 offen offset:704
    buffer_load_dwordx4 v[176:179], v41, s[4:7], s30 offen offset:704
    buffer_load_dwordx4 v[180:183], v42, s[4:7], s30 offen offset:704
    buffer_load_dwordx4 v[184:187], v43, s[4:7], s30 offen offset:704
    buffer_load_dwordx4 v[188:191], v44, s[4:7], s30 offen offset:704
    buffer_load_dwordx4 v[192:195], v45, s[4:7], s30 offen offset:704
    buffer_load_dwordx4 v[196:199], v46, s[4:7], s30 offen offset:704
    buffer_load_dwordx4 v[200:203], v40, s[4:7], s30 offen offset:768
    buffer_load_dwordx4 v[204:207], v41, s[4:7], s30 offen offset:768
    buffer_load_dwordx4 v[208:211], v42, s[4:7], s30 offen offset:768
    buffer_load_dwordx4 v[212:215], v43, s[4:7], s30 offen offset:768
    buffer_load_dwordx4 v[216:219], v44, s[4:7], s30 offen offset:768
    buffer_load_dwordx4 v[220:223], v45, s[4:7], s30 offen offset:768
    buffer_load_dwordx4 v[224:227], v46, s[4:7], s30 offen offset:768
    buffer_load_dwordx4 v[228:231], v40, s[4:7], s30 offen offset:832
    buffer_load_dwordx4 v[232:235], v41, s[4:7], s30 offen offset:832
    buffer_load_dwordx4 v[236:239], v42, s[4:7], s30 offen offset:832
    buffer_load_dwordx4 v[240:243], v43, s[4:7], s30 offen offset:832
    buffer_load_dwordx4 v[244:247], v44, s[4:7], s30 offen offset:832
    buffer_load_dwordx4 v[248:251], v45, s[4:7], s30 offen offset:832
    buffer_load_dwordx4 v[252:255], v46, s[4:7], s30 offen offset:832
    v_mul_u32_u24 v5, 928, v3
    v_mul_u32_u24 v6, 224, v2
    v_add_u32 v5, v5, v6
    v_lshl_add_u32 v15, v4, 4, v5
    v_add_u32 v15, 8192, v15
    v_lshl_add_u32 v16, v4, 3, v5
    v_add_u32 v16, 8384, v16
    v_add_u32 v17, v14, v6
    v_and_b32 v5, 7, v3
    v_mul_u32_u24 v5, 928, v5
    v_add_u32 v5, v5, v6
    v_lshl_add_u32 v18, v4, 3, v5
    v_add_u32 v18, 256, v18
    v_lshl_add_u32 v5, v4, 3, v3
    v_lshlrev_b32 v5, 4, v5
    v_mul_u32_u24 v6, 1536, v2
    v_add_u32 v5, v5, v6
    v_add_u32 v19, 67584, v5
    v_lshrrev_b32 v5, 3, v1
    v_and_b32 v6, 7, v1
    v_min_u32 v7, 4, v6
    v_mul_u32_u24 v8, 40, v5
    v_lshl_add_u32 v8, v7, 3, v8
    v_lshlrev_b32 v118, 8, v7
    v_add_u32 v118, 256, v118
    v_cmp_eq_u32 vcc, 0, v7
    s_nop 1
    v_cndmask_b32 v118, v118, 0, vcc
    v_lshl_add_u32 v118, v5, 4, v118
    v_add_u32 v118, 67584, v118
    v_lshlrev_b32 v119, 1, v8
    v_cmp_gt_u32 s[40:41], 8, v3
    v_cmp_gt_u32 s[42:43], 2, v4
    s_and_b64 s[42:43], s[42:43], s[40:41]
    v_cmp_gt_u32 s[44:45], 5, v6
    v_cmp_gt_u32 s[46:47], 56, v1
    v_lshlrev_b32 v9, 4, v1
    s_mov_b32 s20, 26214400
    s_mul_i32 s21, s12, 640
    s_add_u32 s21, s21, 27262976
    s_lshl_b32 s22, s14, 3
    s_mul_i32 s23, s22, 896
    s_add_u32 s23, s23, 0
    s_mul_i32 s24, s22, 928
    s_add_u32 s24, s24, 8192
    s_mov_b32 s25, 0
    s_lshl_b32 s50, s12, 2
    s_add_u32 s50, s50, 6144
    s_mov_b32 s26, 0
    s_mov_b64 exec, s[46:47]
    s_add_u32 s27, s24, s26
    s_add_u32 m0, s27, 0
    s_add_u32 s28, s23, 0
    buffer_load_dwordx4 v9, s[4:7], s28 offen lds
    s_add_u32 s27, s24, s26
    s_add_u32 m0, s27, 928
    s_add_u32 s28, s23, 896
    buffer_load_dwordx4 v9, s[4:7], s28 offen lds
    s_add_u32 s27, s24, s26
    s_add_u32 m0, s27, 1856
    s_add_u32 s28, s23, 1792
    buffer_load_dwordx4 v9, s[4:7], s28 offen lds
    s_add_u32 s27, s24, s26
    s_add_u32 m0, s27, 2784
    s_add_u32 s28, s23, 2688
    buffer_load_dwordx4 v9, s[4:7], s28 offen lds
    s_add_u32 s27, s24, s26
    s_add_u32 m0, s27, 3712
    s_add_u32 s28, s23, 3584
    buffer_load_dwordx4 v9, s[4:7], s28 offen lds
    s_add_u32 s27, s24, s26
    s_add_u32 m0, s27, 4640
    s_add_u32 s28, s23, 4480
    buffer_load_dwordx4 v9, s[4:7], s28 offen lds
    s_add_u32 s27, s24, s26
    s_add_u32 m0, s27, 5568
    s_add_u32 s28, s23, 5376
    buffer_load_dwordx4 v9, s[4:7], s28 offen lds
    s_add_u32 s27, s24, s26
    s_add_u32 m0, s27, 6496
    s_add_u32 s28, s23, 6272
    buffer_load_dwordx4 v9, s[4:7], s28 offen lds
    s_mov_b64 exec, -1
    s_sub_u32 s22, s14, 1
    s_mul_i32 s22, s22, 11
    s_min_u32 s22, s22, 21
    s_mul_i32 s23, s22, 896
    s_add_u32 s23, s23, 28672
    s_mul_i32 s24, s22, 928
    s_add_u32 s24, s24, 8192
chain_kernel_as_loop:
    buffer_load_dwordx4 v[20:23], v10, s[4:7], s20 offen sc0 sc1
    buffer_load_dwordx4 v[24:27], v11, s[4:7], s20 offen sc0 sc1
chain_kernel_as_pm:
    buffer_load_dwordx4 v[40:43], v10, s[4:7], s20 offen sc0 sc1
    buffer_load_dwordx4 v[44:47], v11, s[4:7], s20 offen sc0 sc1
    s_waitcnt vmcnt(2)
    v_max3_u32 v5, v20, v21, v22
    v_max3_u32 v6, v23, v24, v25
    v_max3_u32 v5, v5, v26, v27
    v_max_u32 v5, v5, v6
    v_cmp_eq_u32 vcc, -1, v5
    s_cbranch_vccz chain_kernel_as_pm_ok0
    buffer_load_dwordx4 v[20:23], v10, s[4:7], s20 offen sc0 sc1
    buffer_load_dwordx4 v[24:27], v11, s[4:7], s20 offen sc0 sc1
    s_waitcnt vmcnt(2)
    v_max3_u32 v5, v40, v41, v42
    v_max3_u32 v6, v43, v44, v45
    v_max3_u32 v5, v5, v46, v47
    v_max_u32 v5, v5, v6
    v_cmp_eq_u32 vcc, -1, v5
    s_cbranch_vccz chain_kernel_as_pm_ok1
    s_add_u32 s48, s48, 1
    s_cmp_gt_u32 s48, 0x200000
    s_cbranch_scc0 chain_kernel_as_pm
    s_branch chain_kernel_end
chain_kernel_as_pm_ok0:
    ds_write_b128 v12, v[20:23]
    ds_write_b128 v13, v[24:27]
    s_branch chain_kernel_as_pm_done
chain_kernel_as_pm_ok1:
    ds_write_b128 v12, v[40:43]
    ds_write_b128 v13, v[44:47]
chain_kernel_as_pm_done:
    s_waitcnt lgkmcnt(0)
    s_barrier
    v_add_u32 v5, s26, v15
    v_add_u32 v6, s26, v16
    ds_read_b128 v[28:31], v14 offset:0
    ds_read_b128 v[32:35], v14 offset:64
    ds_read_b128 v[36:39], v14 offset:128
    s_waitcnt lgkmcnt(2)
    v_mfma_f32_16x16x32_bf16 v[48:51], a[0:3], v[28:31], 0
    v_mfma_f32_16x16x32_bf16 v[52:55], a[4:7], v[28:31], 0
    v_mfma_f32_16x16x32_bf16 v[56:59], a[8:11], v[28:31], 0
    v_mfma_f32_16x16x32_bf16 v[60:63], a[12:15], v[28:31], 0
    ds_read_b128 v[28:31], v14 offset:192
    s_waitcnt lgkmcnt(2)
    v_mfma_f32_16x16x32_bf16 v[48:51], a[28:31], v[32:35], v[48:51]
    v_mfma_f32_16x16x32_bf16 v[52:55], a[32:35], v[32:35], v[52:55]
    v_mfma_f32_16x16x32_bf16 v[56:59], a[36:39], v[32:35], v[56:59]
    v_mfma_f32_16x16x32_bf16 v[60:63], a[40:43], v[32:35], v[60:63]
    ds_read_b128 v[76:79], v5 offset:0
    ds_read_b128 v[32:35], v14 offset:256
    s_waitcnt lgkmcnt(3)
    v_mfma_f32_16x16x32_bf16 v[48:51], a[56:59], v[36:39], v[48:51]
    v_mfma_f32_16x16x32_bf16 v[52:55], a[60:63], v[36:39], v[52:55]
    v_mfma_f32_16x16x32_bf16 v[56:59], a[64:67], v[36:39], v[56:59]
    v_mfma_f32_16x16x32_bf16 v[60:63], a[68:71], v[36:39], v[60:63]
    ds_read_b128 v[80:83], v5 offset:14848
    ds_read_b128 v[36:39], v14 offset:320
    s_waitcnt lgkmcnt(4)
    v_mfma_f32_16x16x32_bf16 v[48:51], a[84:87], v[28:31], v[48:51]
    v_mfma_f32_16x16x32_bf16 v[52:55], a[88:91], v[28:31], v[52:55]
    v_mfma_f32_16x16x32_bf16 v[56:59], a[92:95], v[28:31], v[56:59]
    v_mfma_f32_16x16x32_bf16 v[60:63], a[96:99], v[28:31], v[60:63]
    ds_read_b128 v[84:87], v17 offset:0
    ds_read_b128 v[28:31], v14 offset:384
    s_waitcnt lgkmcnt(4)
    v_mfma_f32_16x16x32_bf16 v[48:51], a[112:115], v[32:35], v[48:51]
    v_mfma_f32_16x16x32_bf16 v[52:55], a[116:119], v[32:35], v[52:55]
    v_mfma_f32_16x16x32_bf16 v[56:59], a[120:123], v[32:35], v[56:59]
    v_mfma_f32_16x16x32_bf16 v[60:63], a[124:127], v[32:35], v[60:63]
    ds_read_b128 v[88:91], v5 offset:64
    ds_read_b128 v[32:35], v14 offset:448
    s_waitcnt lgkmcnt(4)
    v_mfma_f32_16x16x32_bf16 v[48:51], a[140:143], v[36:39], v[48:51]
    v_mfma_f32_16x16x32_bf16 v[52:55], a[144:147], v[36:39], v[52:55]
    v_mfma_f32_16x16x32_bf16 v[56:59], a[148:151], v[36:39], v[56:59]
    v_mfma_f32_16x16x32_bf16 v[60:63], a[152:155], v[36:39], v[60:63]
    ds_read_b128 v[92:95], v5 offset:14912
    ds_read_b128 v[36:39], v14 offset:512
    s_waitcnt lgkmcnt(4)
    v_mfma_f32_16x16x32_bf16 v[48:51], a[168:171], v[28:31], v[48:51]
    v_mfma_f32_16x16x32_bf16 v[52:55], a[172:175], v[28:31], v[52:55]
    v_mfma_f32_16x16x32_bf16 v[56:59], a[176:179], v[28:31], v[56:59]
    v_mfma_f32_16x16x32_bf16 v[60:63], a[180:183], v[28:31], v[60:63]
    ds_read_b128 v[96:99], v17 offset:64
    ds_read_b128 v[28:31], v14 offset:576
    s_waitcnt lgkmcnt(4)
    v_mfma_f32_16x16x32_bf16 v[48:51], a[196:199], v[32:35], v[48:51]
    v_mfma_f32_16x16x32_bf16 v[52:55], a[200:203], v[32:35], v[52:55]
    v_mfma_f32_16x16x32_bf16 v[56:59], a[204:207], v[32:35], v[56:59]
    v_mfma_f32_16x16x32_bf16 v[60:63], a[208:211], v[32:35], v[60:63]
    ds_read_b128 v[100:103], v5 offset:128
    ds_read_b128 v[32:35], v14 offset:640
    s_waitcnt lgkmcnt(4)
    v_mfma_f32_16x16x32_bf16 v[48:51], a[224:227], v[36:39], v[48:51]
    v_mfma_f32_16x16x32_bf16 v[52:55], a[228:231], v[36:39], v[52:55]
    v_mfma_f32_16x16x32_bf16 v[56:59], a[232:235], v[36:39], v[56:59]
    v_mfma_f32_16x16x32_bf16 v[60:63], a[236:239], v[36:39], v[60:63]
    ds_read_b128 v[104:107], v5 offset:14976
    ds_read_b128 v[36:39], v14 offset:704
    s_waitcnt lgkmcnt(4)
    v_mfma_f32_16x16x32_bf16 v[48:51], a[252:255], v[28:31], v[48:51]
    v_mfma_f32_16x16x32_bf16 v[52:55], v[120:123], v[28:31], v[52:55]
    v_mfma_f32_16x16x32_bf16 v[56:59], v[124:127], v[28:31], v[56:59]
    v_mfma_f32_16x16x32_bf16 v[60:63], v[128:131], v[28:31], v[60:63]
    ds_read_b128 v[108:111], v17 offset:128
    ds_read_b128 v[28:31], v14 offset:768
    s_waitcnt lgkmcnt(4)
    v_mfma_f32_16x16x32_bf16 v[48:51], v[144:147], v[32:35], v[48:51]
    v_mfma_f32_16x16x32_bf16 v[52:55], v[148:151], v[32:35], v[52:55]
    v_mfma_f32_16x16x32_bf16 v[56:59], v[152:155], v[32:35], v[56:59]
    v_mfma_f32_16x16x32_bf16 v[60:63], v[156:159], v[32:35], v[60:63]
    ds_read_b64 v[112:113], v6
    ds_read_b128 v[32:35], v14 offset:832
    s_waitcnt lgkmcnt(4)
    v_mfma_f32_16x16x32_bf16 v[48:51], v[172:175], v[36:39], v[48:51]
    v_mfma_f32_16x16x32_bf16 v[52:55], v[176:179], v[36:39], v[52:55]
    v_mfma_f32_16x16x32_bf16 v[56:59], v[180:183], v[36:39], v[56:59]
    v_mfma_f32_16x16x32_bf16 v[60:63], v[184:187], v[36:39], v[60:63]
    ds_read_b64 v[114:115], v6 offset:14848
    ds_read_b128 v[36:39], v14 offset:0
    s_waitcnt lgkmcnt(4)
    v_mfma_f32_16x16x32_bf16 v[48:51], v[200:203], v[28:31], v[48:51]
    v_mfma_f32_16x16x32_bf16 v[52:55], v[204:207], v[28:31], v[52:55]
    v_mfma_f32_16x16x32_bf16 v[56:59], v[208:211], v[28:31], v[56:59]
    v_mfma_f32_16x16x32_bf16 v[60:63], v[212:215], v[28:31], v[60:63]
    ds_read_b64 v[116:117], v18
    ds_read_b128 v[28:31], v14 offset:64
    s_waitcnt lgkmcnt(4)
    v_mfma_f32_16x16x32_bf16 v[48:51], v[228:231], v[32:35], v[48:51]
    v_mfma_f32_16x16x32_bf16 v[52:55], v[232:235], v[32:35], v[52:55]
    v_mfma_f32_16x16x32_bf16 v[56:59], v[236:239], v[32:35], v[56:59]
    v_mfma_f32_16x16x32_bf16 v[60:63], v[240:243], v[32:35], v[60:63]
    ds_read_b128 v[32:35], v14 offset:128
    s_waitcnt lgkmcnt(3)
    v_mfma_f32_16x16x32_bf16 v[64:67], a[16:19], v[36:39], 0
    v_mfma_f32_16x16x32_bf16 v[68:71], a[20:23], v[36:39], 0
    v_mfma_f32_16x16x32_bf16 v[72:75], a[24:27], v[36:39], 0
    ds_read_b128 v[36:39], v14 offset:192
    s_waitcnt lgkmcnt(2)
    v_mfma_f32_16x16x32_bf16 v[64:67], a[44:47], v[28:31], v[64:67]
    v_mfma_f32_16x16x32_bf16 v[68:71], a[48:51], v[28:31], v[68:71]
    v_mfma_f32_16x16x32_bf16 v[72:75], a[52:55], v[28:31], v[72:75]
    s_waitcnt vmcnt(0)
    ds_read_b128 v[28:31], v14 offset:256
    s_waitcnt lgkmcnt(2)
    v_mfma_f32_16x16x32_bf16 v[64:67], a[72:75], v[32:35], v[64:67]
    v_mfma_f32_16x16x32_bf16 v[68:71], a[76:79], v[32:35], v[68:71]
    v_mfma_f32_16x16x32_bf16 v[72:75], a[80:83], v[32:35], v[72:75]
    v_cvt_pk_bf16_f32 v20, v48, v49
    v_cvt_pk_bf16_f32 v21, v50, v51
    v_cvt_pk_bf16_f32 v22, v52, v53
    v_cvt_pk_bf16_f32 v23, v54, v55
    v_cvt_pk_bf16_f32 v24, v56, v57
    v_cvt_pk_bf16_f32 v25, v58, v59
    v_cvt_pk_bf16_f32 v26, v60, v61
    v_cvt_pk_bf16_f32 v27, v62, v63
    ds_read_b128 v[32:35], v14 offset:320
    s_waitcnt lgkmcnt(2)
    v_mfma_f32_16x16x32_bf16 v[64:67], a[100:103], v[36:39], v[64:67]
    v_mfma_f32_16x16x32_bf16 v[68:71], a[104:107], v[36:39], v[68:71]
    v_mfma_f32_16x16x32_bf16 v[72:75], a[108:111], v[36:39], v[72:75]
    ds_read_b128 v[36:39], v14 offset:384
    s_waitcnt lgkmcnt(2)
    v_mfma_f32_16x16x32_bf16 v[64:67], a[128:131], v[28:31], v[64:67]
    v_mfma_f32_16x16x32_bf16 v[68:71], a[132:135], v[28:31], v[68:71]
    v_mfma_f32_16x16x32_bf16 v[72:75], a[136:139], v[28:31], v[72:75]
    v_mfma_f32_16x16x32_bf16 v[48:51], v[76:79], v[20:23], 0
    v_mfma_f32_16x16x32_bf16 v[52:55], v[80:83], v[20:23], 0
    v_mfma_f32_16x16x32_bf16 v[56:59], v[84:87], v[20:23], 0
    ds_read_b128 v[28:31], v14 offset:448
    s_waitcnt lgkmcnt(2)
    v_mfma_f32_16x16x32_bf16 v[64:67], a[156:159], v[32:35], v[64:67]
    v_mfma_f32_16x16x32_bf16 v[68:71], a[160:163], v[32:35], v[68:71]
    v_mfma_f32_16x16x32_bf16 v[72:75], a[164:167], v[32:35], v[72:75]
    ds_read_b128 v[32:35], v14 offset:512
    s_waitcnt lgkmcnt(2)
    v_mfma_f32_16x16x32_bf16 v[64:67], a[184:187], v[36:39], v[64:67]
    v_mfma_f32_16x16x32_bf16 v[68:71], a[188:191], v[36:39], v[68:71]
    v_mfma_f32_16x16x32_bf16 v[72:75], a[192:195], v[36:39], v[72:75]
    v_mfma_f32_16x16x32_bf16 v[48:51], v[88:91], v[24:27], v[48:51]
    v_mfma_f32_16x16x32_bf16 v[52:55], v[92:95], v[24:27], v[52:55]
    v_mfma_f32_16x16x32_bf16 v[56:59], v[96:99], v[24:27], v[56:59]
    ds_read_b128 v[36:39], v14 offset:576
    s_waitcnt lgkmcnt(2)
    v_mfma_f32_16x16x32_bf16 v[64:67], a[212:215], v[28:31], v[64:67]
    v_mfma_f32_16x16x32_bf16 v[68:71], a[216:219], v[28:31], v[68:71]
    v_mfma_f32_16x16x32_bf16 v[72:75], a[220:223], v[28:31], v[72:75]
    ds_read_b128 v[28:31], v14 offset:640
    s_waitcnt lgkmcnt(2)
    v_mfma_f32_16x16x32_bf16 v[64:67], a[240:243], v[32:35], v[64:67]
    v_mfma_f32_16x16x32_bf16 v[68:71], a[244:247], v[32:35], v[68:71]
    v_mfma_f32_16x16x32_bf16 v[72:75], a[248:251], v[32:35], v[72:75]
    ds_read_b128 v[32:35], v14 offset:704
    s_waitcnt lgkmcnt(2)
    v_mfma_f32_16x16x32_bf16 v[64:67], v[132:135], v[36:39], v[64:67]
    v_mfma_f32_16x16x32_bf16 v[68:71], v[136:139], v[36:39], v[68:71]
    v_mfma_f32_16x16x32_bf16 v[72:75], v[140:143], v[36:39], v[72:75]
    ds_read_b128 v[36:39], v14 offset:768
    s_waitcnt lgkmcnt(2)
    v_mfma_f32_16x16x32_bf16 v[64:67], v[160:163], v[28:31], v[64:67]
    v_mfma_f32_16x16x32_bf16 v[68:71], v[164:167], v[28:31], v[68:71]
    v_mfma_f32_16x16x32_bf16 v[72:75], v[168:171], v[28:31], v[72:75]
    ds_read_b128 v[28:31], v14 offset:832
    s_waitcnt lgkmcnt(2)
    v_mfma_f32_16x16x32_bf16 v[64:67], v[188:191], v[32:35], v[64:67]
    v_mfma_f32_16x16x32_bf16 v[68:71], v[192:195], v[32:35], v[68:71]
    v_mfma_f32_16x16x32_bf16 v[72:75], v[196:199], v[32:35], v[72:75]
    s_waitcnt lgkmcnt(1)
    v_mfma_f32_16x16x32_bf16 v[64:67], v[216:219], v[36:39], v[64:67]
    v_mfma_f32_16x16x32_bf16 v[68:71], v[220:223], v[36:39], v[68:71]
    v_mfma_f32_16x16x32_bf16 v[72:75], v[224:227], v[36:39], v[72:75]
    s_waitcnt lgkmcnt(0)
    v_mfma_f32_16x16x32_bf16 v[64:67], v[244:247], v[28:31], v[64:67]
    v_mfma_f32_16x16x32_bf16 v[68:71], v[248:251], v[28:31], v[68:71]
    v_mfma_f32_16x16x32_bf16 v[72:75], v[252:255], v[28:31], v[72:75]
    s_nop 7
    v_cvt_pk_bf16_f32 v40, v64, v65
    v_cvt_pk_bf16_f32 v41, v66, v67
    v_cvt_pk_bf16_f32 v42, v68, v69
    v_cvt_pk_bf16_f32 v43, v70, v71
    v_cvt_pk_bf16_f32 v44, v72, v73
    v_cvt_pk_bf16_f32 v45, v74, v75
    s_nop 1
    v_mfma_f32_16x16x32_bf16 v[48:51], v[100:103], v[40:43], v[48:51]
    v_mfma_f32_16x16x32_bf16 v[52:55], v[104:107], v[40:43], v[52:55]
    v_mfma_f32_16x16x32_bf16 v[56:59], v[108:111], v[40:43], v[56:59]
    v_mfma_f32_16x16x16_bf16 v[48:51], v[112:113], v[44:45], v[48:51]
    v_mfma_f32_16x16x16_bf16 v[52:55], v[114:115], v[44:45], v[52:55]
    v_mfma_f32_16x16x16_bf16 v[56:59], v[116:117], v[44:45], v[56:59]
    s_mov_b64 exec, s[40:41]
    s_nop 7
    ds_write_b128 v19, v[48:51] offset:512
    ds_write_b128 v19, v[52:55] offset:1024
    ds_write_b128 v19, v[56:59]
    s_mov_b64 exec, -1
    s_waitcnt lgkmcnt(0)
    s_barrier
    s_cmp_lg_u32 s14, 0
    s_cbranch_scc1 chain_kernel_as_dma
    ds_read_b128 v[48:51], v118 offset:0
    ds_read_b128 v[52:55], v118 offset:128
    ds_read_b128 v[56:59], v118 offset:1536
    ds_read_b128 v[60:63], v118 offset:1664
    ds_read_b128 v[64:67], v118 offset:3072
    ds_read_b128 v[68:71], v118 offset:3200
    ds_read_b128 v[72:75], v118 offset:4608
    ds_read_b128 v[76:79], v118 offset:4736
    s_waitcnt lgkmcnt(4)
    v_pk_add_f32 v[48:49], v[48:49], v[56:57]
    v_pk_add_f32 v[50:51], v[50:51], v[58:59]
    v_pk_add_f32 v[52:53], v[52:53], v[60:61]
    v_pk_add_f32 v[54:55], v[54:55], v[62:63]
    s_waitcnt lgkmcnt(0)
    v_pk_add_f32 v[64:65], v[64:65], v[72:73]
    v_pk_add_f32 v[66:67], v[66:67], v[74:75]
    v_pk_add_f32 v[68:69], v[68:69], v[76:77]
    v_pk_add_f32 v[70:71], v[70:71], v[78:79]
    v_pk_add_f32 v[80:81], v[48:49], v[64:65]
    v_pk_add_f32 v[82:83], v[50:51], v[66:67]
    v_pk_add_f32 v[84:85], v[52:53], v[68:69]
    v_pk_add_f32 v[86:87], v[54:55], v[70:71]
    v_max3_f32 v5, v80, v81, v82
    v_max3_f32 v6, v83, v84, v85
    v_max3_f32 v5, v5, v86, v87
    v_max_f32 v5, v5, v6
    s_nop 1
    v_max_f32_dpp v5, v5, v5 quad_perm:[1,0,3,2] row_mask:0xf bank_mask:0xf
    s_nop 1
    v_max_f32_dpp v5, v5, v5 quad_perm:[2,3,0,1] row_mask:0xf bank_mask:0xf
    s_nop 1
    v_max_f32_dpp v5, v5, v5 row_half_mirror row_mask:0xf bank_mask:0xf
    v_mul_f32 v5, 0xbfb8aa3b, v5
    v_fmamk_f32 v80, v80, 0x3fb8aa3b, v5
    v_fmamk_f32 v81, v81, 0x3fb8aa3b, v5
    v_fmamk_f32 v82, v82, 0x3fb8aa3b, v5
    v_fmamk_f32 v83, v83, 0x3fb8aa3b, v5
    v_fmamk_f32 v84, v84, 0x3fb8aa3b, v5
    v_fmamk_f32 v85, v85, 0x3fb8aa3b, v5
    v_fmamk_f32 v86, v86, 0x3fb8aa3b, v5
    v_fmamk_f32 v87, v87, 0x3fb8aa3b, v5
    v_exp_f32 v80, v80
    v_exp_f32 v81, v81
    v_exp_f32 v82, v82
    v_exp_f32 v83, v83
    v_exp_f32 v84, v84
    v_exp_f32 v85, v85
    v_exp_f32 v86, v86
    v_exp_f32 v87, v87
    s_nop 0
    v_add_f32 v5, v80, v81
    v_add_f32 v6, v82, v83
    v_add_f32 v7, v84, v85
    v_add_f32 v8, v86, v87
    v_add_f32 v5, v5, v6
    v_add_f32 v7, v7, v8
    v_add_f32 v5, v5, v7
    v_cndmask_b32 v5, 0, v5, s[44:45]
    s_nop 1
    v_add_f32_dpp v5, v5, v5 quad_perm:[1,0,3,2] row_mask:0xf bank_mask:0xf
    s_nop 1
    v_add_f32_dpp v5, v5, v5 quad_perm:[2,3,0,1] row_mask:0xf bank_mask:0xf
    s_nop 1
    v_add_f32_dpp v5, v5, v5 row_half_mirror row_mask:0xf bank_mask:0xf
    v_rcp_f32 v5, v5
    s_nop 0
    v_mul_f32 v80, v80, v5
    v_mul_f32 v81, v81, v5
    v_mul_f32 v82, v82, v5
    v_mul_f32 v83, v83, v5
    v_mul_f32 v84, v84, v5
    v_mul_f32 v85, v85, v5
    v_mul_f32 v86, v86, v5
    v_mul_f32 v87, v87, v5
    v_cvt_pk_bf16_f32 v88, v80, v81
    v_min_u32 v88, 0xfffffffe, v88
    v_cvt_pk_bf16_f32 v89, v82, v83
    v_min_u32 v89, 0xfffffffe, v89
    v_cvt_pk_bf16_f32 v90, v84, v85
    v_min_u32 v90, 0xfffffffe, v90
    v_cvt_pk_bf16_f32 v91, v86, v87
    v_min_u32 v91, 0xfffffffe, v91
    s_mov_b64 exec, s[44:45]
    buffer_store_dwordx4 v[88:91], v119, s[4:7], s21 offen sc0 sc1
    s_mov_b64 exec, -1
    s_barrier
    s_branch chain_kernel_as_skip
chain_kernel_as_dma:
    s_barrier
    s_sub_u32 s29, 29696, s26
    s_mov_b64 exec, s[46:47]
    s_add_u32 s27, s24, s29
    s_add_u32 m0, s27, 0
    s_add_u32 s28, s23, 0
    buffer_load_dwordx4 v9, s[4:7], s28 offen lds
    s_add_u32 s27, s24, s29
    s_add_u32 m0, s27, 928
    s_add_u32 s28, s23, 896
    buffer_load_dwordx4 v9, s[4:7], s28 offen lds
    s_add_u32 s27, s24, s29
    s_add_u32 m0, s27, 1856
    s_add_u32 s28, s23, 1792
    buffer_load_dwordx4 v9, s[4:7], s28 offen lds
    s_add_u32 s27, s24, s29
    s_add_u32 m0, s27, 2784
    s_add_u32 s28, s23, 2688
    buffer_load_dwordx4 v9, s[4:7], s28 offen lds
    s_add_u32 s27, s24, s29
    s_add_u32 m0, s27, 3712
    s_add_u32 s28, s23, 3584
    buffer_load_dwordx4 v9, s[4:7], s28 offen lds
    s_add_u32 s27, s24, s29
    s_add_u32 m0, s27, 4640
    s_add_u32 s28, s23, 4480
    buffer_load_dwordx4 v9, s[4:7], s28 offen lds
    s_add_u32 s27, s24, s29
    s_add_u32 m0, s27, 5568
    s_add_u32 s28, s23, 5376
    buffer_load_dwordx4 v9, s[4:7], s28 offen lds
    s_add_u32 s27, s24, s29
    s_add_u32 m0, s27, 6496
    s_add_u32 s28, s23, 6272
    buffer_load_dwordx4 v9, s[4:7], s28 offen lds
    s_add_u32 s27, s24, s29
    s_add_u32 m0, s27, 7424
    s_add_u32 s28, s23, 7168
    buffer_load_dwordx4 v9, s[4:7], s28 offen lds
    s_add_u32 s27, s24, s29
    s_add_u32 m0, s27, 8352
    s_add_u32 s28, s23, 8064
    buffer_load_dwordx4 v9, s[4:7], s28 offen lds
    s_add_u32 s27, s24, s29
    s_add_u32 m0, s27, 9280
    s_add_u32 s28, s23, 8960
    buffer_load_dwordx4 v9, s[4:7], s28 offen lds
    s_mov_b64 exec, -1
    s_add_u32 s23, s23, 28672
chain_kernel_as_skip:
    s_add_u32 s20, s20, 7168
    s_add_u32 s21, s21, 10240
    s_sub_u32 s26, 29696, s26
    s_add_u32 s25, s25, 1
    s_cmp_lt_u32 s25, 64
    s_cbranch_scc1 chain_kernel_as_loop
    s_endpgm
chain_kernel_brole:
    s_cmp_eq_u32 s13, 0
    s_cbranch_scc0 chain_kernel_b_safe
    s_sub_u32 s31, s12, 16
    s_mul_i32 s32, s31, 28
    v_add_u32 v5, 0, v3
    v_mul_u32_u24 v6, 2341, v5
    v_lshrrev_b32 v6, 16, v6
    v_mul_u32_u24 v7, 28, v6
    v_sub_u32 v7, v5, v7
    v_lshl_add_u32 v8, v2, 2, v6
    v_mul_u32_u24 v8, 448, v8
    v_add3_u32 v8, v8, v7, s32
    v_add_u32 v8, 7168, v8
    v_mul_u32_u24 v8, 896, v8
    v_lshl_add_u32 v40, v4, 4, v8
    v_lshl_add_u32 v8, v6, 5, v7
    v_lshlrev_b32 v8, 4, v8
    v_lshl_add_u32 v8, v2, 11, v8
    v_and_b32 v9, 1, v4
    v_lshl_add_u32 v8, v9, 3, v8
    v_add_u32 v108, 73728, v8
    v_add_u32 v5, 16, v3
    v_mul_u32_u24 v6, 2341, v5
    v_lshrrev_b32 v6, 16, v6
    v_mul_u32_u24 v7, 28, v6
    v_sub_u32 v7, v5, v7
    v_lshl_add_u32 v8, v2, 2, v6
    v_mul_u32_u24 v8, 448, v8
    v_add3_u32 v8, v8, v7, s32
    v_add_u32 v8, 7168, v8
    v_mul_u32_u24 v8, 896, v8
    v_lshl_add_u32 v41, v4, 4, v8
    v_lshl_add_u32 v8, v6, 5, v7
    v_lshlrev_b32 v8, 4, v8
    v_lshl_add_u32 v8, v2, 11, v8
    v_and_b32 v9, 1, v4
    v_lshl_add_u32 v8, v9, 3, v8
    v_add_u32 v109, 73728, v8
    v_add_u32 v5, 32, v3
    v_mul_u32_u24 v6, 2341, v5
    v_lshrrev_b32 v6, 16, v6
    v_mul_u32_u24 v7, 28, v6
    v_sub_u32 v7, v5, v7
    v_lshl_add_u32 v8, v2, 2, v6
    v_mul_u32_u24 v8, 448, v8
    v_add3_u32 v8, v8, v7, s32
    v_add_u32 v8, 7168, v8
    v_mul_u32_u24 v8, 896, v8
    v_lshl_add_u32 v42, v4, 4, v8
    v_lshl_add_u32 v8, v6, 5, v7
    v_lshlrev_b32 v8, 4, v8
    v_lshl_add_u32 v8, v2, 11, v8
    v_and_b32 v9, 1, v4
    v_lshl_add_u32 v8, v9, 3, v8
    v_add_u32 v110, 73728, v8
    v_add_u32 v5, 48, v3
    v_mul_u32_u24 v6, 2341, v5
    v_lshrrev_b32 v6, 16, v6
    v_mul_u32_u24 v7, 28, v6
    v_sub_u32 v7, v5, v7
    v_lshl_add_u32 v8, v2, 2, v6
    v_mul_u32_u24 v8, 448, v8
    v_add3_u32 v8, v8, v7, s32
    v_add_u32 v8, 7168, v8
    v_mul_u32_u24 v8, 896, v8
    v_lshl_add_u32 v43, v4, 4, v8
    v_lshl_add_u32 v8, v6, 5, v7
    v_lshlrev_b32 v8, 4, v8
    v_lshl_add_u32 v8, v2, 11, v8
    v_and_b32 v9, 1, v4
    v_lshl_add_u32 v8, v9, 3, v8
    v_add_u32 v111, 73728, v8
    v_add_u32 v5, 64, v3
    v_mul_u32_u24 v6, 2341, v5
    v_lshrrev_b32 v6, 16, v6
    v_mul_u32_u24 v7, 28, v6
    v_sub_u32 v7, v5, v7
    v_lshl_add_u32 v8, v2, 2, v6
    v_mul_u32_u24 v8, 448, v8
    v_add3_u32 v8, v8, v7, s32
    v_add_u32 v8, 7168, v8
    v_mul_u32_u24 v8, 896, v8
    v_lshl_add_u32 v44, v4, 4, v8
    v_lshl_add_u32 v8, v6, 5, v7
    v_lshlrev_b32 v8, 4, v8
    v_lshl_add_u32 v8, v2, 11, v8
    v_and_b32 v9, 1, v4
    v_lshl_add_u32 v8, v9, 3, v8
    v_add_u32 v112, 73728, v8
    v_add_u32 v5, 80, v3
    v_mul_u32_u24 v6, 2341, v5
    v_lshrrev_b32 v6, 16, v6
    v_mul_u32_u24 v7, 28, v6
    v_sub_u32 v7, v5, v7
    v_lshl_add_u32 v8, v2, 2, v6
    v_mul_u32_u24 v8, 448, v8
    v_add3_u32 v8, v8, v7, s32
    v_add_u32 v8, 7168, v8
    v_mul_u32_u24 v8, 896, v8
    v_lshl_add_u32 v45, v4, 4, v8
    v_lshl_add_u32 v8, v6, 5, v7
    v_lshlrev_b32 v8, 4, v8
    v_lshl_add_u32 v8, v2, 11, v8
    v_and_b32 v9, 1, v4
    v_lshl_add_u32 v8, v9, 3, v8
    v_add_u32 v113, 73728, v8
    v_add_u32 v5, 96, v3
    v_mul_u32_u24 v6, 2341, v5
    v_lshrrev_b32 v6, 16, v6
    v_mul_u32_u24 v7, 28, v6
    v_sub_u32 v7, v5, v7
    v_lshl_add_u32 v8, v2, 2, v6
    v_mul_u32_u24 v8, 448, v8
    v_add3_u32 v8, v8, v7, s32
    v_add_u32 v8, 7168, v8
    v_mul_u32_u24 v8, 896, v8
    v_lshl_add_u32 v46, v4, 4, v8
    v_lshl_add_u32 v8, v6, 5, v7
    v_lshlrev_b32 v8, 4, v8
    v_lshl_add_u32 v8, v2, 11, v8
    v_and_b32 v9, 1, v4
    v_lshl_add_u32 v8, v9, 3, v8
    v_add_u32 v114, 73728, v8
    s_mov_b32 s30, 12582912
    buffer_load_dwordx4 a[0:3], v40, s[4:7], s30 offen offset:0
    buffer_load_dwordx4 a[4:7], v41, s[4:7], s30 offen offset:0
    buffer_load_dwordx4 a[8:11], v42, s[4:7], s30 offen offset:0
    buffer_load_dwordx4 a[12:15], v43, s[4:7], s30 offen offset:0
    buffer_load_dwordx4 a[16:19], v44, s[4:7], s30 offen offset:0
    buffer_load_dwordx4 a[20:23], v45, s[4:7], s30 offen offset:0
    buffer_load_dwordx4 a[24:27], v46, s[4:7], s30 offen offset:0
    buffer_load_dwordx4 a[28:31], v40, s[4:7], s30 offen offset:64
    buffer_load_dwordx4 a[32:35], v41, s[4:7], s30 offen offset:64
    buffer_load_dwordx4 a[36:39], v42, s[4:7], s30 offen offset:64
    buffer_load_dwordx4 a[40:43], v43, s[4:7], s30 offen offset:64
    buffer_load_dwordx4 a[44:47], v44, s[4:7], s30 offen offset:64
    buffer_load_dwordx4 a[48:51], v45, s[4:7], s30 offen offset:64
    buffer_load_dwordx4 a[52:55], v46, s[4:7], s30 offen offset:64
    buffer_load_dwordx4 a[56:59], v40, s[4:7], s30 offen offset:128
    buffer_load_dwordx4 a[60:63], v41, s[4:7], s30 offen offset:128
    buffer_load_dwordx4 a[64:67], v42, s[4:7], s30 offen offset:128
    buffer_load_dwordx4 a[68:71], v43, s[4:7], s30 offen offset:128
    buffer_load_dwordx4 a[72:75], v44, s[4:7], s30 offen offset:128
    buffer_load_dwordx4 a[76:79], v45, s[4:7], s30 offen offset:128
    buffer_load_dwordx4 a[80:83], v46, s[4:7], s30 offen offset:128
    buffer_load_dwordx4 a[84:87], v40, s[4:7], s30 offen offset:192
    buffer_load_dwordx4 a[88:91], v41, s[4:7], s30 offen offset:192
    buffer_load_dwordx4 a[92:95], v42, s[4:7], s30 offen offset:192
    buffer_load_dwordx4 a[96:99], v43, s[4:7], s30 offen offset:192
    buffer_load_dwordx4 a[100:103], v44, s[4:7], s30 offen offset:192
    buffer_load_dwordx4 a[104:107], v45, s[4:7], s30 offen offset:192
    buffer_load_dwordx4 a[108:111], v46, s[4:7], s30 offen offset:192
    buffer_load_dwordx4 a[112:115], v40, s[4:7], s30 offen offset:256
    buffer_load_dwordx4 a[116:119], v41, s[4:7], s30 offen offset:256
    buffer_load_dwordx4 a[120:123], v42, s[4:7], s30 offen offset:256
    buffer_load_dwordx4 a[124:127], v43, s[4:7], s30 offen offset:256
    buffer_load_dwordx4 a[128:131], v44, s[4:7], s30 offen offset:256
    buffer_load_dwordx4 a[132:135], v45, s[4:7], s30 offen offset:256
    buffer_load_dwordx4 a[136:139], v46, s[4:7], s30 offen offset:256
    buffer_load_dwordx4 a[140:143], v40, s[4:7], s30 offen offset:320
    buffer_load_dwordx4 a[144:147], v41, s[4:7], s30 offen offset:320
    buffer_load_dwordx4 a[148:151], v42, s[4:7], s30 offen offset:320
    buffer_load_dwordx4 a[152:155], v43, s[4:7], s30 offen offset:320
    buffer_load_dwordx4 a[156:159], v44, s[4:7], s30 offen offset:320
    buffer_load_dwordx4 a[160:163], v45, s[4:7], s30 offen offset:320
    buffer_load_dwordx4 a[164:167], v46, s[4:7], s30 offen offset:320
    buffer_load_dwordx4 a[168:171], v40, s[4:7], s30 offen offset:384
    buffer_load_dwordx4 a[172:175], v41, s[4:7], s30 offen offset:384
    buffer_load_dwordx4 a[176:179], v42, s[4:7], s30 offen offset:384
    buffer_load_dwordx4 a[180:183], v43, s[4:7], s30 offen offset:384
    buffer_load_dwordx4 a[184:187], v44, s[4:7], s30 offen offset:384
    buffer_load_dwordx4 a[188:191], v45, s[4:7], s30 offen offset:384
    buffer_load_dwordx4 a[192:195], v46, s[4:7], s30 offen offset:384
    buffer_load_dwordx4 a[196:199], v40, s[4:7], s30 offen offset:448
    buffer_load_dwordx4 a[200:203], v41, s[4:7], s30 offen offset:448
    buffer_load_dwordx4 a[204:207], v42, s[4:7], s30 offen offset:448
    buffer_load_dwordx4 a[208:211], v43, s[4:7], s30 offen offset:448
    buffer_load_dwordx4 a[212:215], v44, s[4:7], s30 offen offset:448
    buffer_load_dwordx4 a[216:219], v45, s[4:7], s30 offen offset:448
    buffer_load_dwordx4 a[220:223], v46, s[4:7], s30 offen offset:448
    buffer_load_dwordx4 a[224:227], v40, s[4:7], s30 offen offset:512
    buffer_load_dwordx4 a[228:231], v41, s[4:7], s30 offen offset:512
    buffer_load_dwordx4 a[232:235], v42, s[4:7], s30 offen offset:512
    buffer_load_dwordx4 a[236:239], v43, s[4:7], s30 offen offset:512
    buffer_load_dwordx4 a[240:243], v44, s[4:7], s30 offen offset:512
    buffer_load_dwordx4 a[244:247], v45, s[4:7], s30 offen offset:512
    buffer_load_dwordx4 a[248:251], v46, s[4:7], s30 offen offset:512
    buffer_load_dwordx4 a[252:255], v40, s[4:7], s30 offen offset:576
    buffer_load_dwordx4 v[120:123], v41, s[4:7], s30 offen offset:576
    buffer_load_dwordx4 v[124:127], v42, s[4:7], s30 offen offset:576
    buffer_load_dwordx4 v[128:131], v43, s[4:7], s30 offen offset:576
    buffer_load_dwordx4 v[132:135], v44, s[4:7], s30 offen offset:576
    buffer_load_dwordx4 v[136:139], v45, s[4:7], s30 offen offset:576
    buffer_load_dwordx4 v[140:143], v46, s[4:7], s30 offen offset:576
    buffer_load_dwordx4 v[144:147], v40, s[4:7], s30 offen offset:640
    buffer_load_dwordx4 v[148:151], v41, s[4:7], s30 offen offset:640
    buffer_load_dwordx4 v[152:155], v42, s[4:7], s30 offen offset:640
    buffer_load_dwordx4 v[156:159], v43, s[4:7], s30 offen offset:640
    buffer_load_dwordx4 v[160:163], v44, s[4:7], s30 offen offset:640
    buffer_load_dwordx4 v[164:167], v45, s[4:7], s30 offen offset:640
    buffer_load_dwordx4 v[168:171], v46, s[4:7], s30 offen offset:640
    buffer_load_dwordx4 v[172:175], v40, s[4:7], s30 offen offset:704
    buffer_load_dwordx4 v[176:179], v41, s[4:7], s30 offen offset:704
    buffer_load_dwordx4 v[180:183], v42, s[4:7], s30 offen offset:704
    buffer_load_dwordx4 v[184:187], v43, s[4:7], s30 offen offset:704
    buffer_load_dwordx4 v[188:191], v44, s[4:7], s30 offen offset:704
    buffer_load_dwordx4 v[192:195], v45, s[4:7], s30 offen offset:704
    buffer_load_dwordx4 v[196:199], v46, s[4:7], s30 offen offset:704
    buffer_load_dwordx4 v[200:203], v40, s[4:7], s30 offen offset:768
    buffer_load_dwordx4 v[204:207], v41, s[4:7], s30 offen offset:768
    buffer_load_dwordx4 v[208:211], v42, s[4:7], s30 offen offset:768
    buffer_load_dwordx4 v[212:215], v43, s[4:7], s30 offen offset:768
    buffer_load_dwordx4 v[216:219], v44, s[4:7], s30 offen offset:768
    buffer_load_dwordx4 v[220:223], v45, s[4:7], s30 offen offset:768
    buffer_load_dwordx4 v[224:227], v46, s[4:7], s30 offen offset:768
    buffer_load_dwordx4 v[228:231], v40, s[4:7], s30 offen offset:832
    buffer_load_dwordx4 v[232:235], v41, s[4:7], s30 offen offset:832
    buffer_load_dwordx4 v[236:239], v42, s[4:7], s30 offen offset:832
    buffer_load_dwordx4 v[240:243], v43, s[4:7], s30 offen offset:832
    buffer_load_dwordx4 v[244:247], v44, s[4:7], s30 offen offset:832
    buffer_load_dwordx4 v[248:251], v45, s[4:7], s30 offen offset:832
    buffer_load_dwordx4 v[252:255], v46, s[4:7], s30 offen offset:832
    v_lshl_add_u32 v5, v4, 5, v3
    v_lshlrev_b32 v5, 4, v5
    v_lshl_add_u32 v5, v2, 11, v5
    v_add_u32 v15, 73728, v5
    v_mul_u32_u24 v5, 1792, v2
    v_add3_u32 v5, v5, v3, s32
    v_lshlrev_b32 v5, 6, v5
    v_lshl_add_u32 v16, v4, 4, v5
    v_lshl_add_u32 v5, v2, 2, v4
    v_mul_u32_u24 v5, 448, v5
    v_add3_u32 v5, v5, v3, s32
    v_lshlrev_b32 v17, 4, v5
    v_and_b32 v5, 7, v3
    v_mul_u32_u24 v5, 80, v5
    v_mul_u32_u24 v6, 2560, v2
    v_add_u32 v5, v5, v6
    v_lshl_add_u32 v18, v4, 4, v5
    v_add_u32 v18, 16, v18
    v_mul_u32_u24 v6, 640, v4
    v_add_u32 v19, v5, v6
    v_lshlrev_b32 v5, 4, v1
    v_lshl_add_u32 v118, v2, 11, v5
    v_add_u32 v118, 81920, v118
    v_and_b32 v6, 1, v2
    v_lshl_add_u32 v119, v6, 10, v5
    v_add_u32 v119, 81920, v119
    v_mul_u32_u24 v7, 896, v3
    v_lshl_add_u32 v7, v4, 3, v7
    v_lshl_add_u32 v7, v6, 5, v7
    s_lshl_b32 s33, s32, 1
    v_add_u32 v9, s33, v7
    v_lshl_add_u32 v7, v6, 2, v4
    v_cmp_gt_u32 s[46:47], 7, v7
    v_cmp_gt_u32 s[44:45], 8, v3
    s_and_b64 s[46:47], s[46:47], s[44:45]
    v_cmp_gt_u32 s[40:41], 32, v1
    v_cmp_gt_u32 s[42:43], 12, v3
    s_mov_b32 s20, 26214400
    s_mov_b32 s21, 27262976
    s_mov_b32 s22, 28311552
    s_mov_b32 s34, 67108864
    s_mov_b32 s35, 67137536
    s_mov_b32 s36, 67166208
    s_mov_b32 s37, 67194880
    s_mov_b32 s25, 0
    s_lshl_b32 s50, s31, 2
chain_kernel_bf_loop:
chain_kernel_bf_pm:
    buffer_load_dwordx4 v[20:23], v10, s[4:7], s20 offen sc1
    buffer_load_dwordx4 v[24:27], v11, s[4:7], s20 offen sc1
    s_waitcnt vmcnt(0)
    v_max3_u32 v5, v20, v21, v22
    v_max3_u32 v6, v23, v24, v25
    v_max3_u32 v5, v5, v26, v27
    v_max_u32 v5, v5, v6
    v_cmp_eq_u32 vcc, -1, v5
    s_cbranch_vccz chain_kernel_bf_pm_ok0
    s_add_u32 s48, s48, 1
    s_cmp_gt_u32 s48, 0x200000
    s_cbranch_scc0 chain_kernel_bf_pm
    s_branch chain_kernel_end
chain_kernel_bf_pm_ok0:
    ds_write_b128 v12, v[20:23]
    ds_write_b128 v13, v[24:27]
chain_kernel_bf_pm_done:
    s_waitcnt lgkmcnt(0)
    s_barrier
    s_cmp_eq_u32 s25, 0
    s_cbranch_scc1 chain_kernel_bf_s0
    s_sub_u32 s54, s22, 114688
    buffer_store_dwordx4 v[36:39], v17, s[4:7], s54 offen sc0 sc1
    s_mov_b64 exec, s[42:43]
    buffer_store_dwordx4 v[40:43], v17, s[4:7], s54 offen offset:256 sc0 sc1
    s_mov_b64 exec, -1
    s_cmp_ge_u32 s14, 2
    s_cbranch_scc1 chain_kernel_wt1
    s_mov_b64 exec, s[46:47]
    s_add_u32 s54, s20, 9961472
    buffer_store_dwordx2 v[80:81], v9, s[4:7], s54 offen sc0 sc1
    s_mov_b64 exec, -1
chain_kernel_wt1:
    s_and_b32 s53, s25, 7
    s_cmp_lg_u32 s53, 1
    s_cbranch_scc1 chain_kernel_bf_s0
    s_cmp_eq_u32 s25, 1
    s_cbranch_scc1 chain_kernel_bf_s0
    s_cmp_lg_u32 s14, 0
    s_cbranch_scc1 chain_kernel_bf_s0
    s_lshr_b32 s53, s25, 3
    s_lshl_b32 s53, s53, 2
    s_mov_b64 exec, 1
    s_add_u32 s55, s53, 124
    v_mov_b32 v6, s55
    v_mov_b32 v5, 1
    buffer_atomic_add v5, v6, s[8:11], 0 offen sc1
    s_mov_b64 exec, -1
chain_kernel_bf_s0:
    s_and_b32 s53, s25, 7
    s_cmp_lg_u32 s53, 0
    s_cbranch_scc1 chain_kernel_bf_uw_ok
    s_lshr_b32 s53, s25, 3
    s_lshl_b32 s53, s53, 2
    s_cmp_eq_u32 s25, 0
    s_cselect_b32 s56, 128, 32
    s_add_u32 s53, s53, 64
chain_kernel_bf_uw_go:
    v_mov_b32 v6, s53
chain_kernel_bf_uw:
    buffer_load_dword v5, v6, s[8:11], 0 offen sc0 sc1
    s_add_u32 s48, s48, 1
    s_cmp_gt_u32 s48, 0x200000
    s_cbranch_scc1 chain_kernel_end
    s_waitcnt vmcnt(0)
    v_cmp_ne_u32 vcc, s56, v5
    s_cbranch_vccnz chain_kernel_bf_uw
chain_kernel_bf_uw_ok:
    buffer_load_dwordx4 v[76:79], v16, s[4:7], s34 offen offset:0 sc0 sc1
    buffer_load_dwordx4 v[80:83], v16, s[4:7], s34 offen offset:1024 sc0 sc1
    buffer_load_dwordx4 v[84:87], v16, s[4:7], s35 offen offset:0 sc0 sc1
    buffer_load_dwordx4 v[88:91], v16, s[4:7], s35 offen offset:1024 sc0 sc1
    buffer_load_dwordx4 v[92:95], v16, s[4:7], s36 offen offset:0 sc0 sc1
    buffer_load_dwordx4 v[96:99], v16, s[4:7], s36 offen offset:1024 sc0 sc1
    buffer_load_dwordx4 v[100:103], v16, s[4:7], s37 offen offset:0 sc0 sc1
    buffer_load_dwordx4 v[104:107], v16, s[4:7], s37 offen offset:1024 sc0 sc1
    s_add_u32 s34, s34, 458752
    s_add_u32 s35, s35, 458752
    s_add_u32 s36, s36, 458752
    s_add_u32 s37, s37, 458752
    ds_read_b128 v[32:35], v14
    ds_read_b128 v[36:39], v14 offset:64
    s_waitcnt lgkmcnt(1)
    v_mfma_f32_16x16x32_bf16 v[48:51], v[32:35], a[0:3], 0
    v_mfma_f32_16x16x32_bf16 v[52:55], v[32:35], a[4:7], 0
    v_mfma_f32_16x16x32_bf16 v[56:59], v[32:35], a[8:11], 0
    v_mfma_f32_16x16x32_bf16 v[60:63], v[32:35], a[12:15], 0
    v_mfma_f32_16x16x32_bf16 v[64:67], v[32:35], a[16:19], 0
    v_mfma_f32_16x16x32_bf16 v[68:71], v[32:35], a[20:23], 0
    v_mfma_f32_16x16x32_bf16 v[72:75], v[32:35], a[24:27], 0
    ds_read_b128 v[32:35], v14 offset:128
    s_waitcnt lgkmcnt(1)
    v_mfma_f32_16x16x32_bf16 v[48:51], v[36:39], a[28:31], v[48:51]
    v_mfma_f32_16x16x32_bf16 v[52:55], v[36:39], a[32:35], v[52:55]
    v_mfma_f32_16x16x32_bf16 v[56:59], v[36:39], a[36:39], v[56:59]
    v_mfma_f32_16x16x32_bf16 v[60:63], v[36:39], a[40:43], v[60:63]
    v_mfma_f32_16x16x32_bf16 v[64:67], v[36:39], a[44:47], v[64:67]
    v_mfma_f32_16x16x32_bf16 v[68:71], v[36:39], a[48:51], v[68:71]
    v_mfma_f32_16x16x32_bf16 v[72:75], v[36:39], a[52:55], v[72:75]
    ds_read_b128 v[36:39], v14 offset:192
    s_waitcnt lgkmcnt(1)
    v_mfma_f32_16x16x32_bf16 v[48:51], v[32:35], a[56:59], v[48:51]
    v_mfma_f32_16x16x32_bf16 v[52:55], v[32:35], a[60:63], v[52:55]
    v_mfma_f32_16x16x32_bf16 v[56:59], v[32:35], a[64:67], v[56:59]
    v_mfma_f32_16x16x32_bf16 v[60:63], v[32:35], a[68:71], v[60:63]
    v_mfma_f32_16x16x32_bf16 v[64:67], v[32:35], a[72:75], v[64:67]
    v_mfma_f32_16x16x32_bf16 v[68:71], v[32:35], a[76:79], v[68:71]
    v_mfma_f32_16x16x32_bf16 v[72:75], v[32:35], a[80:83], v[72:75]
    ds_read_b128 v[32:35], v14 offset:256
    s_waitcnt lgkmcnt(1)
    v_mfma_f32_16x16x32_bf16 v[48:51], v[36:39], a[84:87], v[48:51]
    v_mfma_f32_16x16x32_bf16 v[52:55], v[36:39], a[88:91], v[52:55]
    v_mfma_f32_16x16x32_bf16 v[56:59], v[36:39], a[92:95], v[56:59]
    v_mfma_f32_16x16x32_bf16 v[60:63], v[36:39], a[96:99], v[60:63]
    v_mfma_f32_16x16x32_bf16 v[64:67], v[36:39], a[100:103], v[64:67]
    v_mfma_f32_16x16x32_bf16 v[68:71], v[36:39], a[104:107], v[68:71]
    v_mfma_f32_16x16x32_bf16 v[72:75], v[36:39], a[108:111], v[72:75]
    ds_read_b128 v[36:39], v14 offset:320
    s_waitcnt lgkmcnt(1)
    v_mfma_f32_16x16x32_bf16 v[48:51], v[32:35], a[112:115], v[48:51]
    v_mfma_f32_16x16x32_bf16 v[52:55], v[32:35], a[116:119], v[52:55]
    v_mfma_f32_16x16x32_bf16 v[56:59], v[32:35], a[120:123], v[56:59]
    v_mfma_f32_16x16x32_bf16 v[60:63], v[32:35], a[124:127], v[60:63]
    v_mfma_f32_16x16x32_bf16 v[64:67], v[32:35], a[128:131], v[64:67]
    v_mfma_f32_16x16x32_bf16 v[68:71], v[32:35], a[132:135], v[68:71]
    v_mfma_f32_16x16x32_bf16 v[72:75], v[32:35], a[136:139], v[72:75]
    ds_read_b128 v[32:35], v14 offset:384
    s_waitcnt lgkmcnt(1)
    v_mfma_f32_16x16x32_bf16 v[48:51], v[36:39], a[140:143], v[48:51]
    v_mfma_f32_16x16x32_bf16 v[52:55], v[36:39], a[144:147], v[52:55]
    v_mfma_f32_16x16x32_bf16 v[56:59], v[36:39], a[148:151], v[56:59]
    v_mfma_f32_16x16x32_bf16 v[60:63], v[36:39], a[152:155], v[60:63]
    v_mfma_f32_16x16x32_bf16 v[64:67], v[36:39], a[156:159], v[64:67]
    v_mfma_f32_16x16x32_bf16 v[68:71], v[36:39], a[160:163], v[68:71]
    v_mfma_f32_16x16x32_bf16 v[72:75], v[36:39], a[164:167], v[72:75]
    ds_read_b128 v[36:39], v14 offset:448
    s_waitcnt lgkmcnt(1)
    v_mfma_f32_16x16x32_bf16 v[48:51], v[32:35], a[168:171], v[48:51]
    v_mfma_f32_16x16x32_bf16 v[52:55], v[32:35], a[172:175], v[52:55]
    v_mfma_f32_16x16x32_bf16 v[56:59], v[32:35], a[176:179], v[56:59]
    v_mfma_f32_16x16x32_bf16 v[60:63], v[32:35], a[180:183], v[60:63]
    v_mfma_f32_16x16x32_bf16 v[64:67], v[32:35], a[184:187], v[64:67]
    v_mfma_f32_16x16x32_bf16 v[68:71], v[32:35], a[188:191], v[68:71]
    v_mfma_f32_16x16x32_bf16 v[72:75], v[32:35], a[192:195], v[72:75]
    ds_read_b128 v[32:35], v14 offset:512
    s_waitcnt lgkmcnt(1)
    v_mfma_f32_16x16x32_bf16 v[48:51], v[36:39], a[196:199], v[48:51]
    v_mfma_f32_16x16x32_bf16 v[52:55], v[36:39], a[200:203], v[52:55]
    v_mfma_f32_16x16x32_bf16 v[56:59], v[36:39], a[204:207], v[56:59]
    v_mfma_f32_16x16x32_bf16 v[60:63], v[36:39], a[208:211], v[60:63]
    v_mfma_f32_16x16x32_bf16 v[64:67], v[36:39], a[212:215], v[64:67]
    v_mfma_f32_16x16x32_bf16 v[68:71], v[36:39], a[216:219], v[68:71]
    v_mfma_f32_16x16x32_bf16 v[72:75], v[36:39], a[220:223], v[72:75]
    ds_read_b128 v[36:39], v14 offset:576
    s_waitcnt lgkmcnt(1)
    v_mfma_f32_16x16x32_bf16 v[48:51], v[32:35], a[224:227], v[48:51]
    v_mfma_f32_16x16x32_bf16 v[52:55], v[32:35], a[228:231], v[52:55]
    v_mfma_f32_16x16x32_bf16 v[56:59], v[32:35], a[232:235], v[56:59]
    v_mfma_f32_16x16x32_bf16 v[60:63], v[32:35], a[236:239], v[60:63]
    v_mfma_f32_16x16x32_bf16 v[64:67], v[32:35], a[240:243], v[64:67]
    v_mfma_f32_16x16x32_bf16 v[68:71], v[32:35], a[244:247], v[68:71]
    v_mfma_f32_16x16x32_bf16 v[72:75], v[32:35], a[248:251], v[72:75]
    ds_read_b128 v[32:35], v14 offset:640
    s_waitcnt lgkmcnt(1)
    v_mfma_f32_16x16x32_bf16 v[48:51], v[36:39], a[252:255], v[48:51]
    v_mfma_f32_16x16x32_bf16 v[52:55], v[36:39], v[120:123], v[52:55]
    v_mfma_f32_16x16x32_bf16 v[56:59], v[36:39], v[124:127], v[56:59]
    v_mfma_f32_16x16x32_bf16 v[60:63], v[36:39], v[128:131], v[60:63]
    v_mfma_f32_16x16x32_bf16 v[64:67], v[36:39], v[132:135], v[64:67]
    v_mfma_f32_16x16x32_bf16 v[68:71], v[36:39], v[136:139], v[68:71]
    v_mfma_f32_16x16x32_bf16 v[72:75], v[36:39], v[140:143], v[72:75]
    ds_read_b128 v[36:39], v14 offset:704
    s_waitcnt lgkmcnt(1)
    v_mfma_f32_16x16x32_bf16 v[48:51], v[32:35], v[144:147], v[48:51]
    v_mfma_f32_16x16x32_bf16 v[52:55], v[32:35], v[148:151], v[52:55]
    v_mfma_f32_16x16x32_bf16 v[56:59], v[32:35], v[152:155], v[56:59]
    v_mfma_f32_16x16x32_bf16 v[60:63], v[32:35], v[156:159], v[60:63]
    v_mfma_f32_16x16x32_bf16 v[64:67], v[32:35], v[160:163], v[64:67]
    v_mfma_f32_16x16x32_bf16 v[68:71], v[32:35], v[164:167], v[68:71]
    v_mfma_f32_16x16x32_bf16 v[72:75], v[32:35], v[168:171], v[72:75]
    ds_read_b128 v[32:35], v14 offset:768
    s_waitcnt lgkmcnt(1)
    v_mfma_f32_16x16x32_bf16 v[48:51], v[36:39], v[172:175], v[48:51]
    v_mfma_f32_16x16x32_bf16 v[52:55], v[36:39], v[176:179], v[52:55]
    v_mfma_f32_16x16x32_bf16 v[56:59], v[36:39], v[180:183], v[56:59]
    v_mfma_f32_16x16x32_bf16 v[60:63], v[36:39], v[184:187], v[60:63]
    v_mfma_f32_16x16x32_bf16 v[64:67], v[36:39], v[188:191], v[64:67]
    v_mfma_f32_16x16x32_bf16 v[68:71], v[36:39], v[192:195], v[68:71]
    v_mfma_f32_16x16x32_bf16 v[72:75], v[36:39], v[196:199], v[72:75]
    ds_read_b128 v[36:39], v14 offset:832
    s_waitcnt lgkmcnt(1)
    v_mfma_f32_16x16x32_bf16 v[48:51], v[32:35], v[200:203], v[48:51]
    v_mfma_f32_16x16x32_bf16 v[52:55], v[32:35], v[204:207], v[52:55]
    v_mfma_f32_16x16x32_bf16 v[56:59], v[32:35], v[208:211], v[56:59]
    v_mfma_f32_16x16x32_bf16 v[60:63], v[32:35], v[212:215], v[60:63]
    v_mfma_f32_16x16x32_bf16 v[64:67], v[32:35], v[216:219], v[64:67]
    v_mfma_f32_16x16x32_bf16 v[68:71], v[32:35], v[220:223], v[68:71]
    v_mfma_f32_16x16x32_bf16 v[72:75], v[32:35], v[224:227], v[72:75]
    s_waitcnt lgkmcnt(0)
    v_mfma_f32_16x16x32_bf16 v[48:51], v[36:39], v[228:231], v[48:51]
    v_mfma_f32_16x16x32_bf16 v[52:55], v[36:39], v[232:235], v[52:55]
    v_mfma_f32_16x16x32_bf16 v[56:59], v[36:39], v[236:239], v[56:59]
    v_mfma_f32_16x16x32_bf16 v[60:63], v[36:39], v[240:243], v[60:63]
    v_mfma_f32_16x16x32_bf16 v[64:67], v[36:39], v[244:247], v[64:67]
    v_mfma_f32_16x16x32_bf16 v[68:71], v[36:39], v[248:251], v[68:71]
    v_mfma_f32_16x16x32_bf16 v[72:75], v[36:39], v[252:255], v[72:75]
    s_nop 7
    s_mov_b64 exec, s[40:41]
    v_cvt_pk_bf16_f32 v20, v48, v49
    v_cvt_pk_bf16_f32 v21, v50, v51
    ds_write_b64 v108, v[20:21]
    v_cvt_pk_bf16_f32 v22, v52, v53
    v_cvt_pk_bf16_f32 v23, v54, v55
    ds_write_b64 v109, v[22:23]
    v_cvt_pk_bf16_f32 v24, v56, v57
    v_cvt_pk_bf16_f32 v25, v58, v59
    ds_write_b64 v110, v[24:25]
    v_cvt_pk_bf16_f32 v26, v60, v61
    v_cvt_pk_bf16_f32 v27, v62, v63
    ds_write_b64 v111, v[26:27]
    v_cvt_pk_bf16_f32 v28, v64, v65
    v_cvt_pk_bf16_f32 v29, v66, v67
    ds_write_b64 v112, v[28:29]
    v_cvt_pk_bf16_f32 v30, v68, v69
    v_cvt_pk_bf16_f32 v31, v70, v71
    ds_write_b64 v113, v[30:31]
    v_cvt_pk_bf16_f32 v32, v72, v73
    v_cvt_pk_bf16_f32 v33, v74, v75
    ds_write_b64 v114, v[32:33]
    s_mov_b64 exec, -1
    s_waitcnt lgkmcnt(0)
    ds_read_b128 v[36:39], v15
    ds_read_b128 v[40:43], v15 offset:256
    s_mov_b64 exec, s[44:45]
chain_kernel_bf_pp:
    buffer_load_dwordx4 v[48:51], v18, s[4:7], s21 offen offset:0 sc1
    buffer_load_dwordx4 v[52:55], v18, s[4:7], s21 offen offset:640 sc1
    buffer_load_dwordx4 v[56:59], v18, s[4:7], s21 offen offset:1280 sc1
    buffer_load_dwordx4 v[60:63], v18, s[4:7], s21 offen offset:1920 sc1
    buffer_load_dwordx4 v[64:67], v19, s[4:7], s21 offen sc1
    s_add_u32 s48, s48, 1
    s_cmp_gt_u32 s48, 0x200000
    s_cbranch_scc1 chain_kernel_end
    s_waitcnt vmcnt(0)
    v_max3_u32 v5, v48, v49, v50
    v_max3_u32 v6, v51, v52, v53
    v_max3_u32 v5, v5, v54, v55
    v_max3_u32 v6, v6, v56, v57
    v_max3_u32 v5, v5, v58, v59
    v_max3_u32 v6, v6, v60, v61
    v_max3_u32 v5, v5, v62, v63
    v_max3_u32 v6, v6, v64, v65
    v_max3_u32 v5, v5, v66, v67
    v_max_u32 v5, v5, v6
    v_cmp_eq_u32 vcc, -1, v5
    s_cbranch_vccnz chain_kernel_bf_pp
    s_mov_b64 exec, -1
    s_waitcnt lgkmcnt(0)
    s_nop 3
    v_mfma_f32_16x16x32_bf16 v[68:71], v[36:39], v[64:67], 0
    v_mfma_f32_16x16x32_bf16 v[72:75], v[40:43], v[64:67], 0
    v_mfma_f32_16x16x32_bf16 v[68:71], v[76:79], v[48:51], v[68:71]
    v_mfma_f32_16x16x32_bf16 v[72:75], v[80:83], v[48:51], v[72:75]
    v_mfma_f32_16x16x32_bf16 v[68:71], v[84:87], v[52:55], v[68:71]
    v_mfma_f32_16x16x32_bf16 v[72:75], v[88:91], v[52:55], v[72:75]
    v_mfma_f32_16x16x32_bf16 v[68:71], v[92:95], v[56:59], v[68:71]
    v_mfma_f32_16x16x32_bf16 v[72:75], v[96:99], v[56:59], v[72:75]
    v_mfma_f32_16x16x32_bf16 v[68:71], v[100:103], v[60:63], v[68:71]
    v_mfma_f32_16x16x32_bf16 v[72:75], v[104:107], v[60:63], v[72:75]
    s_nop 7
    ds_write_b128 v118, v[68:71]
    ds_write_b128 v118, v[72:75] offset:1024
    s_waitcnt lgkmcnt(0)
    s_barrier
    s_add_u32 s20, s20, 7168
    s_cmp_ge_u32 s14, 2
    s_cbranch_scc1 chain_kernel_bf_skip
    ds_read_b128 v[76:79], v119 offset:0
    ds_read_b128 v[80:83], v119 offset:2048
    ds_read_b128 v[84:87], v119 offset:4096
    ds_read_b128 v[88:91], v119 offset:6144
    s_waitcnt lgkmcnt(2)
    v_pk_add_f32 v[76:77], v[76:77], v[80:81]
    v_pk_add_f32 v[78:79], v[78:79], v[82:83]
    s_waitcnt lgkmcnt(0)
    v_pk_add_f32 v[84:85], v[84:85], v[88:89]
    v_pk_add_f32 v[86:87], v[86:87], v[90:91]
    v_pk_add_f32 v[76:77], v[76:77], v[84:85]
    v_pk_add_f32 v[78:79], v[78:79], v[86:87]
    v_cvt_pk_bf16_f32 v80, v76, v77
    v_cvt_pk_bf16_f32 v81, v78, v79
    v_min_u32 v80, 0xfffffffe, v80
    v_min_u32 v81, 0xfffffffe, v81
    s_mov_b64 exec, s[46:47]
    buffer_store_dwordx2 v[80:81], v9, s[4:7], s20 offen
    s_mov_b64 exec, -1
chain_kernel_bf_skip:
    s_barrier
    s_add_u32 s21, s21, 10240
    s_add_u32 s22, s22, 114688
    s_add_u32 s25, s25, 1
    s_cmp_lt_u32 s25, 64
    s_cbranch_scc1 chain_kernel_bf_loop
    s_sub_u32 s54, s22, 114688
    buffer_store_dwordx4 v[36:39], v17, s[4:7], s54 offen sc0 sc1
    s_mov_b64 exec, s[42:43]
    buffer_store_dwordx4 v[40:43], v17, s[4:7], s54 offen offset:256 sc0 sc1
    s_mov_b64 exec, -1
    s_cmp_ge_u32 s14, 2
    s_cbranch_scc1 chain_kernel_wt2
    s_mov_b64 exec, s[46:47]
    s_add_u32 s54, s20, 9961472
    buffer_store_dwordx2 v[80:81], v9, s[4:7], s54 offen sc0 sc1
    s_mov_b64 exec, -1
chain_kernel_wt2:
    s_waitcnt vmcnt(0)
    s_barrier
    s_cmp_lg_u32 s14, 0
    s_cbranch_scc1 chain_kernel_end
    s_mov_b64 exec, 1
    v_mov_b32 v6, 156
    v_mov_b32 v5, 1
    buffer_atomic_add v5, v6, s[8:11], 0 offen sc1
    s_endpgm
chain_kernel_b_safe:
    s_sub_u32 s31, s12, 16
    s_mul_i32 s32, s31, 28
    v_add_u32 v5, 0, v3
    v_mul_u32_u24 v6, 2341, v5
    v_lshrrev_b32 v6, 16, v6
    v_mul_u32_u24 v7, 28, v6
    v_sub_u32 v7, v5, v7
    v_lshl_add_u32 v8, v2, 2, v6
    v_mul_u32_u24 v8, 448, v8
    v_add3_u32 v8, v8, v7, s32
    v_add_u32 v8, 7168, v8
    v_mul_u32_u24 v8, 896, v8
    v_lshl_add_u32 v40, v4, 4, v8
    v_lshl_add_u32 v8, v6, 5, v7
    v_lshlrev_b32 v8, 4, v8
    v_lshl_add_u32 v8, v2, 11, v8
    v_and_b32 v9, 1, v4
    v_lshl_add_u32 v8, v9, 3, v8
    v_add_u32 v108, 73728, v8
    v_add_u32 v5, 16, v3
    v_mul_u32_u24 v6, 2341, v5
    v_lshrrev_b32 v6, 16, v6
    v_mul_u32_u24 v7, 28, v6
    v_sub_u32 v7, v5, v7
    v_lshl_add_u32 v8, v2, 2, v6
    v_mul_u32_u24 v8, 448, v8
    v_add3_u32 v8, v8, v7, s32
    v_add_u32 v8, 7168, v8
    v_mul_u32_u24 v8, 896, v8
    v_lshl_add_u32 v41, v4, 4, v8
    v_lshl_add_u32 v8, v6, 5, v7
    v_lshlrev_b32 v8, 4, v8
    v_lshl_add_u32 v8, v2, 11, v8
    v_and_b32 v9, 1, v4
    v_lshl_add_u32 v8, v9, 3, v8
    v_add_u32 v109, 73728, v8
    v_add_u32 v5, 32, v3
    v_mul_u32_u24 v6, 2341, v5
    v_lshrrev_b32 v6, 16, v6
    v_mul_u32_u24 v7, 28, v6
    v_sub_u32 v7, v5, v7
    v_lshl_add_u32 v8, v2, 2, v6
    v_mul_u32_u24 v8, 448, v8
    v_add3_u32 v8, v8, v7, s32
    v_add_u32 v8, 7168, v8
    v_mul_u32_u24 v8, 896, v8
    v_lshl_add_u32 v42, v4, 4, v8
    v_lshl_add_u32 v8, v6, 5, v7
    v_lshlrev_b32 v8, 4, v8
    v_lshl_add_u32 v8, v2, 11, v8
    v_and_b32 v9, 1, v4
    v_lshl_add_u32 v8, v9, 3, v8
    v_add_u32 v110, 73728, v8
    v_add_u32 v5, 48, v3
    v_mul_u32_u24 v6, 2341, v5
    v_lshrrev_b32 v6, 16, v6
    v_mul_u32_u24 v7, 28, v6
    v_sub_u32 v7, v5, v7
    v_lshl_add_u32 v8, v2, 2, v6
    v_mul_u32_u24 v8, 448, v8
    v_add3_u32 v8, v8, v7, s32
    v_add_u32 v8, 7168, v8
    v_mul_u32_u24 v8, 896, v8
    v_lshl_add_u32 v43, v4, 4, v8
    v_lshl_add_u32 v8, v6, 5, v7
    v_lshlrev_b32 v8, 4, v8
    v_lshl_add_u32 v8, v2, 11, v8
    v_and_b32 v9, 1, v4
    v_lshl_add_u32 v8, v9, 3, v8
    v_add_u32 v111, 73728, v8
    v_add_u32 v5, 64, v3
    v_mul_u32_u24 v6, 2341, v5
    v_lshrrev_b32 v6, 16, v6
    v_mul_u32_u24 v7, 28, v6
    v_sub_u32 v7, v5, v7
    v_lshl_add_u32 v8, v2, 2, v6
    v_mul_u32_u24 v8, 448, v8
    v_add3_u32 v8, v8, v7, s32
    v_add_u32 v8, 7168, v8
    v_mul_u32_u24 v8, 896, v8
    v_lshl_add_u32 v44, v4, 4, v8
    v_lshl_add_u32 v8, v6, 5, v7
    v_lshlrev_b32 v8, 4, v8
    v_lshl_add_u32 v8, v2, 11, v8
    v_and_b32 v9, 1, v4
    v_lshl_add_u32 v8, v9, 3, v8
    v_add_u32 v112, 73728, v8
    v_add_u32 v5, 80, v3
    v_mul_u32_u24 v6, 2341, v5
    v_lshrrev_b32 v6, 16, v6
    v_mul_u32_u24 v7, 28, v6
    v_sub_u32 v7, v5, v7
    v_lshl_add_u32 v8, v2, 2, v6
    v_mul_u32_u24 v8, 448, v8
    v_add3_u32 v8, v8, v7, s32
    v_add_u32 v8, 7168, v8
    v_mul_u32_u24 v8, 896, v8
    v_lshl_add_u32 v45, v4, 4, v8
    v_lshl_add_u32 v8, v6, 5, v7
    v_lshlrev_b32 v8, 4, v8
    v_lshl_add_u32 v8, v2, 11, v8
    v_and_b32 v9, 1, v4
    v_lshl_add_u32 v8, v9, 3, v8
    v_add_u32 v113, 73728, v8
    v_add_u32 v5, 96, v3
    v_mul_u32_u24 v6, 2341, v5
    v_lshrrev_b32 v6, 16, v6
    v_mul_u32_u24 v7, 28, v6
    v_sub_u32 v7, v5, v7
    v_lshl_add_u32 v8, v2, 2, v6
    v_mul_u32_u24 v8, 448, v8
    v_add3_u32 v8, v8, v7, s32
    v_add_u32 v8, 7168, v8
    v_mul_u32_u24 v8, 896, v8
    v_lshl_add_u32 v46, v4, 4, v8
    v_lshl_add_u32 v8, v6, 5, v7
    v_lshlrev_b32 v8, 4, v8
    v_lshl_add_u32 v8, v2, 11, v8
    v_and_b32 v9, 1, v4
    v_lshl_add_u32 v8, v9, 3, v8
    v_add_u32 v114, 73728, v8
    s_mov_b32 s30, 12582912
    buffer_load_dwordx4 a[0:3], v40, s[4:7], s30 offen offset:0
    buffer_load_dwordx4 a[4:7], v41, s[4:7], s30 offen offset:0
    buffer_load_dwordx4 a[8:11], v42, s[4:7], s30 offen offset:0
    buffer_load_dwordx4 a[12:15], v43, s[4:7], s30 offen offset:0
    buffer_load_dwordx4 a[16:19], v44, s[4:7], s30 offen offset:0
    buffer_load_dwordx4 a[20:23], v45, s[4:7], s30 offen offset:0
    buffer_load_dwordx4 a[24:27], v46, s[4:7], s30 offen offset:0
    buffer_load_dwordx4 a[28:31], v40, s[4:7], s30 offen offset:64
    buffer_load_dwordx4 a[32:35], v41, s[4:7], s30 offen offset:64
    buffer_load_dwordx4 a[36:39], v42, s[4:7], s30 offen offset:64
    buffer_load_dwordx4 a[40:43], v43, s[4:7], s30 offen offset:64
    buffer_load_dwordx4 a[44:47], v44, s[4:7], s30 offen offset:64
    buffer_load_dwordx4 a[48:51], v45, s[4:7], s30 offen offset:64
    buffer_load_dwordx4 a[52:55], v46, s[4:7], s30 offen offset:64
    buffer_load_dwordx4 a[56:59], v40, s[4:7], s30 offen offset:128
    buffer_load_dwordx4 a[60:63], v41, s[4:7], s30 offen offset:128
    buffer_load_dwordx4 a[64:67], v42, s[4:7], s30 offen offset:128
    buffer_load_dwordx4 a[68:71], v43, s[4:7], s30 offen offset:128
    buffer_load_dwordx4 a[72:75], v44, s[4:7], s30 offen offset:128
    buffer_load_dwordx4 a[76:79], v45, s[4:7], s30 offen offset:128
    buffer_load_dwordx4 a[80:83], v46, s[4:7], s30 offen offset:128
    buffer_load_dwordx4 a[84:87], v40, s[4:7], s30 offen offset:192
    buffer_load_dwordx4 a[88:91], v41, s[4:7], s30 offen offset:192
    buffer_load_dwordx4 a[92:95], v42, s[4:7], s30 offen offset:192
    buffer_load_dwordx4 a[96:99], v43, s[4:7], s30 offen offset:192
    buffer_load_dwordx4 a[100:103], v44, s[4:7], s30 offen offset:192
    buffer_load_dwordx4 a[104:107], v45, s[4:7], s30 offen offset:192
    buffer_load_dwordx4 a[108:111], v46, s[4:7], s30 offen offset:192
    buffer_load_dwordx4 a[112:115], v40, s[4:7], s30 offen offset:256
    buffer_load_dwordx4 a[116:119], v41, s[4:7], s30 offen offset:256
    buffer_load_dwordx4 a[120:123], v42, s[4:7], s30 offen offset:256
    buffer_load_dwordx4 a[124:127], v43, s[4:7], s30 offen offset:256
    buffer_load_dwordx4 a[128:131], v44, s[4:7], s30 offen offset:256
    buffer_load_dwordx4 a[132:135], v45, s[4:7], s30 offen offset:256
    buffer_load_dwordx4 a[136:139], v46, s[4:7], s30 offen offset:256
    buffer_load_dwordx4 a[140:143], v40, s[4:7], s30 offen offset:320
    buffer_load_dwordx4 a[144:147], v41, s[4:7], s30 offen offset:320
    buffer_load_dwordx4 a[148:151], v42, s[4:7], s30 offen offset:320
    buffer_load_dwordx4 a[152:155], v43, s[4:7], s30 offen offset:320
    buffer_load_dwordx4 a[156:159], v44, s[4:7], s30 offen offset:320
    buffer_load_dwordx4 a[160:163], v45, s[4:7], s30 offen offset:320
    buffer_load_dwordx4 a[164:167], v46, s[4:7], s30 offen offset:320
    buffer_load_dwordx4 a[168:171], v40, s[4:7], s30 offen offset:384
    buffer_load_dwordx4 a[172:175], v41, s[4:7], s30 offen offset:384
    buffer_load_dwordx4 a[176:179], v42, s[4:7], s30 offen offset:384
    buffer_load_dwordx4 a[180:183], v43, s[4:7], s30 offen offset:384
    buffer_load_dwordx4 a[184:187], v44, s[4:7], s30 offen offset:384
    buffer_load_dwordx4 a[188:191], v45, s[4:7], s30 offen offset:384
    buffer_load_dwordx4 a[192:195], v46, s[4:7], s30 offen offset:384
    buffer_load_dwordx4 a[196:199], v40, s[4:7], s30 offen offset:448
    buffer_load_dwordx4 a[200:203], v41, s[4:7], s30 offen offset:448
    buffer_load_dwordx4 a[204:207], v42, s[4:7], s30 offen offset:448
    buffer_load_dwordx4 a[208:211], v43, s[4:7], s30 offen offset:448
    buffer_load_dwordx4 a[212:215], v44, s[4:7], s30 offen offset:448
    buffer_load_dwordx4 a[216:219], v45, s[4:7], s30 offen offset:448
    buffer_load_dwordx4 a[220:223], v46, s[4:7], s30 offen offset:448
    buffer_load_dwordx4 a[224:227], v40, s[4:7], s30 offen offset:512
    buffer_load_dwordx4 a[228:231], v41, s[4:7], s30 offen offset:512
    buffer_load_dwordx4 a[232:235], v42, s[4:7], s30 offen offset:512
    buffer_load_dwordx4 a[236:239], v43, s[4:7], s30 offen offset:512
    buffer_load_dwordx4 a[240:243], v44, s[4:7], s30 offen offset:512
    buffer_load_dwordx4 a[244:247], v45, s[4:7], s30 offen offset:512
    buffer_load_dwordx4 a[248:251], v46, s[4:7], s30 offen offset:512
    buffer_load_dwordx4 a[252:255], v40, s[4:7], s30 offen offset:576
    buffer_load_dwordx4 v[120:123], v41, s[4:7], s30 offen offset:576
    buffer_load_dwordx4 v[124:127], v42, s[4:7], s30 offen offset:576
    buffer_load_dwordx4 v[128:131], v43, s[4:7], s30 offen offset:576
    buffer_load_dwordx4 v[132:135], v44, s[4:7], s30 offen offset:576
    buffer_load_dwordx4 v[136:139], v45, s[4:7], s30 offen offset:576
    buffer_load_dwordx4 v[140:143], v46, s[4:7], s30 offen offset:576
    buffer_load_dwordx4 v[144:147], v40, s[4:7], s30 offen offset:640
    buffer_load_dwordx4 v[148:151], v41, s[4:7], s30 offen offset:640
    buffer_load_dwordx4 v[152:155], v42, s[4:7], s30 offen offset:640
    buffer_load_dwordx4 v[156:159], v43, s[4:7], s30 offen offset:640
    buffer_load_dwordx4 v[160:163], v44, s[4:7], s30 offen offset:640
    buffer_load_dwordx4 v[164:167], v45, s[4:7], s30 offen offset:640
    buffer_load_dwordx4 v[168:171], v46, s[4:7], s30 offen offset:640
    buffer_load_dwordx4 v[172:175], v40, s[4:7], s30 offen offset:704
    buffer_load_dwordx4 v[176:179], v41, s[4:7], s30 offen offset:704
    buffer_load_dwordx4 v[180:183], v42, s[4:7], s30 offen offset:704
    buffer_load_dwordx4 v[184:187], v43, s[4:7], s30 offen offset:704
    buffer_load_dwordx4 v[188:191], v44, s[4:7], s30 offen offset:704
    buffer_load_dwordx4 v[192:195], v45, s[4:7], s30 offen offset:704
    buffer_load_dwordx4 v[196:199], v46, s[4:7], s30 offen offset:704
    buffer_load_dwordx4 v[200:203], v40, s[4:7], s30 offen offset:768
    buffer_load_dwordx4 v[204:207], v41, s[4:7], s30 offen offset:768
    buffer_load_dwordx4 v[208:211], v42, s[4:7], s30 offen offset:768
    buffer_load_dwordx4 v[212:215], v43, s[4:7], s30 offen offset:768
    buffer_load_dwordx4 v[216:219], v44, s[4:7], s30 offen offset:768
    buffer_load_dwordx4 v[220:223], v45, s[4:7], s30 offen offset:768
    buffer_load_dwordx4 v[224:227], v46, s[4:7], s30 offen offset:768
    buffer_load_dwordx4 v[228:231], v40, s[4:7], s30 offen offset:832
    buffer_load_dwordx4 v[232:235], v41, s[4:7], s30 offen offset:832
    buffer_load_dwordx4 v[236:239], v42, s[4:7], s30 offen offset:832
    buffer_load_dwordx4 v[240:243], v43, s[4:7], s30 offen offset:832
    buffer_load_dwordx4 v[244:247], v44, s[4:7], s30 offen offset:832
    buffer_load_dwordx4 v[248:251], v45, s[4:7], s30 offen offset:832
    buffer_load_dwordx4 v[252:255], v46, s[4:7], s30 offen offset:832
    v_lshl_add_u32 v5, v4, 5, v3
    v_lshlrev_b32 v5, 4, v5
    v_lshl_add_u32 v5, v2, 11, v5
    v_add_u32 v15, 73728, v5
    v_mul_u32_u24 v5, 1792, v2
    v_add3_u32 v5, v5, v3, s32
    v_lshlrev_b32 v5, 6, v5
    v_lshl_add_u32 v16, v4, 4, v5
    v_lshl_add_u32 v5, v2, 2, v4
    v_mul_u32_u24 v5, 448, v5
    v_add3_u32 v5, v5, v3, s32
    v_lshlrev_b32 v17, 4, v5
    v_and_b32 v5, 7, v3
    v_mul_u32_u24 v5, 80, v5
    v_mul_u32_u24 v6, 2560, v2
    v_add_u32 v5, v5, v6
    v_lshl_add_u32 v18, v4, 4, v5
    v_add_u32 v18, 16, v18
    v_mul_u32_u24 v6, 640, v4
    v_add_u32 v19, v5, v6
    v_lshlrev_b32 v5, 4, v1
    v_lshl_add_u32 v118, v2, 11, v5
    v_add_u32 v118, 81920, v118
    v_and_b32 v6, 1, v2
    v_lshl_add_u32 v119, v6, 10, v5
    v_add_u32 v119, 81920, v119
    v_mul_u32_u24 v7, 896, v3
    v_lshl_add_u32 v7, v4, 3, v7
    v_lshl_add_u32 v7, v6, 5, v7
    s_lshl_b32 s33, s32, 1
    v_add_u32 v9, s33, v7
    v_lshl_add_u32 v7, v6, 2, v4
    v_cmp_gt_u32 s[46:47], 7, v7
    v_cmp_gt_u32 s[44:45], 8, v3
    s_and_b64 s[46:47], s[46:47], s[44:45]
    v_cmp_gt_u32 s[40:41], 32, v1
    v_cmp_gt_u32 s[42:43], 12, v3
    s_mov_b32 s20, 26214400
    s_mov_b32 s21, 27262976
    s_mov_b32 s22, 28311552
    s_mov_b32 s34, 67108864
    s_mov_b32 s35, 67137536
    s_mov_b32 s36, 67166208
    s_mov_b32 s37, 67194880
    s_mov_b32 s25, 0
    s_lshl_b32 s50, s31, 2
chain_kernel_bs_loop:
chain_kernel_bs_pm:
    buffer_load_dwordx4 v[20:23], v10, s[4:7], s20 offen sc0 sc1
    buffer_load_dwordx4 v[24:27], v11, s[4:7], s20 offen sc0 sc1
    s_waitcnt vmcnt(0)
    v_max3_u32 v5, v20, v21, v22
    v_max3_u32 v6, v23, v24, v25
    v_max3_u32 v5, v5, v26, v27
    v_max_u32 v5, v5, v6
    v_cmp_eq_u32 vcc, -1, v5
    s_cbranch_vccz chain_kernel_bs_pm_ok0
    s_add_u32 s48, s48, 1
    s_cmp_gt_u32 s48, 0x200000
    s_cbranch_scc0 chain_kernel_bs_pm
    s_branch chain_kernel_end
chain_kernel_bs_pm_ok0:
    ds_write_b128 v12, v[20:23]
    ds_write_b128 v13, v[24:27]
chain_kernel_bs_pm_done:
    s_waitcnt lgkmcnt(0)
    s_barrier
    s_cmp_eq_u32 s25, 0
    s_cbranch_scc1 chain_kernel_bs_s0
    s_sub_u32 s54, s22, 114688
    buffer_store_dwordx4 v[36:39], v17, s[4:7], s54 offen sc0 sc1
    s_mov_b64 exec, s[42:43]
    buffer_store_dwordx4 v[40:43], v17, s[4:7], s54 offen offset:256 sc0 sc1
    s_mov_b64 exec, -1
    s_cmp_ge_u32 s14, 2
    s_cbranch_scc1 chain_kernel_wt3
    s_mov_b64 exec, s[46:47]
    s_add_u32 s54, s20, 9961472
    buffer_store_dwordx2 v[80:81], v9, s[4:7], s54 offen sc0 sc1
    s_mov_b64 exec, -1
chain_kernel_wt3:
    s_and_b32 s53, s25, 7
    s_cmp_lg_u32 s53, 1
    s_cbranch_scc1 chain_kernel_bs_s0
    s_cmp_eq_u32 s25, 1
    s_cbranch_scc1 chain_kernel_bs_s0
    s_cmp_lg_u32 s14, 0
    s_cbranch_scc1 chain_kernel_bs_s0
    s_lshr_b32 s53, s25, 3
    s_lshl_b32 s53, s53, 2
    s_mov_b64 exec, 1
    s_add_u32 s55, s53, 124
    v_mov_b32 v6, s55
    v_mov_b32 v5, 1
    buffer_atomic_add v5, v6, s[8:11], 0 offen sc1
    s_mov_b64 exec, -1
chain_kernel_bs_s0:
    s_and_b32 s53, s25, 7
    s_cmp_lg_u32 s53, 0
    s_cbranch_scc1 chain_kernel_bs_uw_ok
    s_lshr_b32 s53, s25, 3
    s_lshl_b32 s53, s53, 2
    s_cmp_eq_u32 s25, 0
    s_cselect_b32 s56, 128, 32
    s_add_u32 s53, s53, 64
chain_kernel_bs_uw_go:
    v_mov_b32 v6, s53
chain_kernel_bs_uw:
    buffer_load_dword v5, v6, s[8:11], 0 offen sc0 sc1
    s_add_u32 s48, s48, 1
    s_cmp_gt_u32 s48, 0x200000
    s_cbranch_scc1 chain_kernel_end
    s_waitcnt vmcnt(0)
    v_cmp_ne_u32 vcc, s56, v5
    s_cbranch_vccnz chain_kernel_bs_uw
chain_kernel_bs_uw_ok:
    buffer_load_dwordx4 v[76:79], v16, s[4:7], s34 offen offset:0 sc0 sc1
    buffer_load_dwordx4 v[80:83], v16, s[4:7], s34 offen offset:1024 sc0 sc1
    buffer_load_dwordx4 v[84:87], v16, s[4:7], s35 offen offset:0 sc0 sc1
    buffer_load_dwordx4 v[88:91], v16, s[4:7], s35 offen offset:1024 sc0 sc1
    buffer_load_dwordx4 v[92:95], v16, s[4:7], s36 offen offset:0 sc0 sc1
    buffer_load_dwordx4 v[96:99], v16, s[4:7], s36 offen offset:1024 sc0 sc1
    buffer_load_dwordx4 v[100:103], v16, s[4:7], s37 offen offset:0 sc0 sc1
    buffer_load_dwordx4 v[104:107], v16, s[4:7], s37 offen offset:1024 sc0 sc1
    s_add_u32 s34, s34, 458752
    s_add_u32 s35, s35, 458752
    s_add_u32 s36, s36, 458752
    s_add_u32 s37, s37, 458752
    ds_read_b128 v[32:35], v14
    ds_read_b128 v[36:39], v14 offset:64
    s_waitcnt lgkmcnt(1)
    v_mfma_f32_16x16x32_bf16 v[48:51], v[32:35], a[0:3], 0
    v_mfma_f32_16x16x32_bf16 v[52:55], v[32:35], a[4:7], 0
    v_mfma_f32_16x16x32_bf16 v[56:59], v[32:35], a[8:11], 0
    v_mfma_f32_16x16x32_bf16 v[60:63], v[32:35], a[12:15], 0
    v_mfma_f32_16x16x32_bf16 v[64:67], v[32:35], a[16:19], 0
    v_mfma_f32_16x16x32_bf16 v[68:71], v[32:35], a[20:23], 0
    v_mfma_f32_16x16x32_bf16 v[72:75], v[32:35], a[24:27], 0
    ds_read_b128 v[32:35], v14 offset:128
    s_waitcnt lgkmcnt(1)
    v_mfma_f32_16x16x32_bf16 v[48:51], v[36:39], a[28:31], v[48:51]
    v_mfma_f32_16x16x32_bf16 v[52:55], v[36:39], a[32:35], v[52:55]
    v_mfma_f32_16x16x32_bf16 v[56:59], v[36:39], a[36:39], v[56:59]
    v_mfma_f32_16x16x32_bf16 v[60:63], v[36:39], a[40:43], v[60:63]
    v_mfma_f32_16x16x32_bf16 v[64:67], v[36:39], a[44:47], v[64:67]
    v_mfma_f32_16x16x32_bf16 v[68:71], v[36:39], a[48:51], v[68:71]
    v_mfma_f32_16x16x32_bf16 v[72:75], v[36:39], a[52:55], v[72:75]
    ds_read_b128 v[36:39], v14 offset:192
    s_waitcnt lgkmcnt(1)
    v_mfma_f32_16x16x32_bf16 v[48:51], v[32:35], a[56:59], v[48:51]
    v_mfma_f32_16x16x32_bf16 v[52:55], v[32:35], a[60:63], v[52:55]
    v_mfma_f32_16x16x32_bf16 v[56:59], v[32:35], a[64:67], v[56:59]
    v_mfma_f32_16x16x32_bf16 v[60:63], v[32:35], a[68:71], v[60:63]
    v_mfma_f32_16x16x32_bf16 v[64:67], v[32:35], a[72:75], v[64:67]
    v_mfma_f32_16x16x32_bf16 v[68:71], v[32:35], a[76:79], v[68:71]
    v_mfma_f32_16x16x32_bf16 v[72:75], v[32:35], a[80:83], v[72:75]
    ds_read_b128 v[32:35], v14 offset:256
    s_waitcnt lgkmcnt(1)
    v_mfma_f32_16x16x32_bf16 v[48:51], v[36:39], a[84:87], v[48:51]
    v_mfma_f32_16x16x32_bf16 v[52:55], v[36:39], a[88:91], v[52:55]
    v_mfma_f32_16x16x32_bf16 v[56:59], v[36:39], a[92:95], v[56:59]
    v_mfma_f32_16x16x32_bf16 v[60:63], v[36:39], a[96:99], v[60:63]
    v_mfma_f32_16x16x32_bf16 v[64:67], v[36:39], a[100:103], v[64:67]
    v_mfma_f32_16x16x32_bf16 v[68:71], v[36:39], a[104:107], v[68:71]
    v_mfma_f32_16x16x32_bf16 v[72:75], v[36:39], a[108:111], v[72:75]
    ds_read_b128 v[36:39], v14 offset:320
    s_waitcnt lgkmcnt(1)
    v_mfma_f32_16x16x32_bf16 v[48:51], v[32:35], a[112:115], v[48:51]
    v_mfma_f32_16x16x32_bf16 v[52:55], v[32:35], a[116:119], v[52:55]
    v_mfma_f32_16x16x32_bf16 v[56:59], v[32:35], a[120:123], v[56:59]
    v_mfma_f32_16x16x32_bf16 v[60:63], v[32:35], a[124:127], v[60:63]
    v_mfma_f32_16x16x32_bf16 v[64:67], v[32:35], a[128:131], v[64:67]
    v_mfma_f32_16x16x32_bf16 v[68:71], v[32:35], a[132:135], v[68:71]
    v_mfma_f32_16x16x32_bf16 v[72:75], v[32:35], a[136:139], v[72:75]
    ds_read_b128 v[32:35], v14 offset:384
    s_waitcnt lgkmcnt(1)
    v_mfma_f32_16x16x32_bf16 v[48:51], v[36:39], a[140:143], v[48:51]
    v_mfma_f32_16x16x32_bf16 v[52:55], v[36:39], a[144:147], v[52:55]
    v_mfma_f32_16x16x32_bf16 v[56:59], v[36:39], a[148:151], v[56:59]
    v_mfma_f32_16x16x32_bf16 v[60:63], v[36:39], a[152:155], v[60:63]
    v_mfma_f32_16x16x32_bf16 v[64:67], v[36:39], a[156:159], v[64:67]
    v_mfma_f32_16x16x32_bf16 v[68:71], v[36:39], a[160:163], v[68:71]
    v_mfma_f32_16x16x32_bf16 v[72:75], v[36:39], a[164:167], v[72:75]
    ds_read_b128 v[36:39], v14 offset:448
    s_waitcnt lgkmcnt(1)
    v_mfma_f32_16x16x32_bf16 v[48:51], v[32:35], a[168:171], v[48:51]
    v_mfma_f32_16x16x32_bf16 v[52:55], v[32:35], a[172:175], v[52:55]
    v_mfma_f32_16x16x32_bf16 v[56:59], v[32:35], a[176:179], v[56:59]
    v_mfma_f32_16x16x32_bf16 v[60:63], v[32:35], a[180:183], v[60:63]
    v_mfma_f32_16x16x32_bf16 v[64:67], v[32:35], a[184:187], v[64:67]
    v_mfma_f32_16x16x32_bf16 v[68:71], v[32:35], a[188:191], v[68:71]
    v_mfma_f32_16x16x32_bf16 v[72:75], v[32:35], a[192:195], v[72:75]
    ds_read_b128 v[32:35], v14 offset:512
    s_waitcnt lgkmcnt(1)
    v_mfma_f32_16x16x32_bf16 v[48:51], v[36:39], a[196:199], v[48:51]
    v_mfma_f32_16x16x32_bf16 v[52:55], v[36:39], a[200:203], v[52:55]
    v_mfma_f32_16x16x32_bf16 v[56:59], v[36:39], a[204:207], v[56:59]
    v_mfma_f32_16x16x32_bf16 v[60:63], v[36:39], a[208:211], v[60:63]
    v_mfma_f32_16x16x32_bf16 v[64:67], v[36:39], a[212:215], v[64:67]
    v_mfma_f32_16x16x32_bf16 v[68:71], v[36:39], a[216:219], v[68:71]
    v_mfma_f32_16x16x32_bf16 v[72:75], v[36:39], a[220:223], v[72:75]
    ds_read_b128 v[36:39], v14 offset:576
    s_waitcnt lgkmcnt(1)
    v_mfma_f32_16x16x32_bf16 v[48:51], v[32:35], a[224:227], v[48:51]
    v_mfma_f32_16x16x32_bf16 v[52:55], v[32:35], a[228:231], v[52:55]
    v_mfma_f32_16x16x32_bf16 v[56:59], v[32:35], a[232:235], v[56:59]
    v_mfma_f32_16x16x32_bf16 v[60:63], v[32:35], a[236:239], v[60:63]
    v_mfma_f32_16x16x32_bf16 v[64:67], v[32:35], a[240:243], v[64:67]
    v_mfma_f32_16x16x32_bf16 v[68:71], v[32:35], a[244:247], v[68:71]
    v_mfma_f32_16x16x32_bf16 v[72:75], v[32:35], a[248:251], v[72:75]
    ds_read_b128 v[32:35], v14 offset:640
    s_waitcnt lgkmcnt(1)
    v_mfma_f32_16x16x32_bf16 v[48:51], v[36:39], a[252:255], v[48:51]
    v_mfma_f32_16x16x32_bf16 v[52:55], v[36:39], v[120:123], v[52:55]
    v_mfma_f32_16x16x32_bf16 v[56:59], v[36:39], v[124:127], v[56:59]
    v_mfma_f32_16x16x32_bf16 v[60:63], v[36:39], v[128:131], v[60:63]
    v_mfma_f32_16x16x32_bf16 v[64:67], v[36:39], v[132:135], v[64:67]
    v_mfma_f32_16x16x32_bf16 v[68:71], v[36:39], v[136:139], v[68:71]
    v_mfma_f32_16x16x32_bf16 v[72:75], v[36:39], v[140:143], v[72:75]
    ds_read_b128 v[36:39], v14 offset:704
    s_waitcnt lgkmcnt(1)
    v_mfma_f32_16x16x32_bf16 v[48:51], v[32:35], v[144:147], v[48:51]
    v_mfma_f32_16x16x32_bf16 v[52:55], v[32:35], v[148:151], v[52:55]
    v_mfma_f32_16x16x32_bf16 v[56:59], v[32:35], v[152:155], v[56:59]
    v_mfma_f32_16x16x32_bf16 v[60:63], v[32:35], v[156:159], v[60:63]
    v_mfma_f32_16x16x32_bf16 v[64:67], v[32:35], v[160:163], v[64:67]
    v_mfma_f32_16x16x32_bf16 v[68:71], v[32:35], v[164:167], v[68:71]
    v_mfma_f32_16x16x32_bf16 v[72:75], v[32:35], v[168:171], v[72:75]
    ds_read_b128 v[32:35], v14 offset:768
    s_waitcnt lgkmcnt(1)
    v_mfma_f32_16x16x32_bf16 v[48:51], v[36:39], v[172:175], v[48:51]
    v_mfma_f32_16x16x32_bf16 v[52:55], v[36:39], v[176:179], v[52:55]
    v_mfma_f32_16x16x32_bf16 v[56:59], v[36:39], v[180:183], v[56:59]
    v_mfma_f32_16x16x32_bf16 v[60:63], v[36:39], v[184:187], v[60:63]
    v_mfma_f32_16x16x32_bf16 v[64:67], v[36:39], v[188:191], v[64:67]
    v_mfma_f32_16x16x32_bf16 v[68:71], v[36:39], v[192:195], v[68:71]
    v_mfma_f32_16x16x32_bf16 v[72:75], v[36:39], v[196:199], v[72:75]
    ds_read_b128 v[36:39], v14 offset:832
    s_waitcnt lgkmcnt(1)
    v_mfma_f32_16x16x32_bf16 v[48:51], v[32:35], v[200:203], v[48:51]
    v_mfma_f32_16x16x32_bf16 v[52:55], v[32:35], v[204:207], v[52:55]
    v_mfma_f32_16x16x32_bf16 v[56:59], v[32:35], v[208:211], v[56:59]
    v_mfma_f32_16x16x32_bf16 v[60:63], v[32:35], v[212:215], v[60:63]
    v_mfma_f32_16x16x32_bf16 v[64:67], v[32:35], v[216:219], v[64:67]
    v_mfma_f32_16x16x32_bf16 v[68:71], v[32:35], v[220:223], v[68:71]
    v_mfma_f32_16x16x32_bf16 v[72:75], v[32:35], v[224:227], v[72:75]
    s_waitcnt lgkmcnt(0)
    v_mfma_f32_16x16x32_bf16 v[48:51], v[36:39], v[228:231], v[48:51]
    v_mfma_f32_16x16x32_bf16 v[52:55], v[36:39], v[232:235], v[52:55]
    v_mfma_f32_16x16x32_bf16 v[56:59], v[36:39], v[236:239], v[56:59]
    v_mfma_f32_16x16x32_bf16 v[60:63], v[36:39], v[240:243], v[60:63]
    v_mfma_f32_16x16x32_bf16 v[64:67], v[36:39], v[244:247], v[64:67]
    v_mfma_f32_16x16x32_bf16 v[68:71], v[36:39], v[248:251], v[68:71]
    v_mfma_f32_16x16x32_bf16 v[72:75], v[36:39], v[252:255], v[72:75]
    s_nop 7
    s_mov_b64 exec, s[40:41]
    v_cvt_pk_bf16_f32 v20, v48, v49
    v_cvt_pk_bf16_f32 v21, v50, v51
    ds_write_b64 v108, v[20:21]
    v_cvt_pk_bf16_f32 v22, v52, v53
    v_cvt_pk_bf16_f32 v23, v54, v55
    ds_write_b64 v109, v[22:23]
    v_cvt_pk_bf16_f32 v24, v56, v57
    v_cvt_pk_bf16_f32 v25, v58, v59
    ds_write_b64 v110, v[24:25]
    v_cvt_pk_bf16_f32 v26, v60, v61
    v_cvt_pk_bf16_f32 v27, v62, v63
    ds_write_b64 v111, v[26:27]
    v_cvt_pk_bf16_f32 v28, v64, v65
    v_cvt_pk_bf16_f32 v29, v66, v67
    ds_write_b64 v112, v[28:29]
    v_cvt_pk_bf16_f32 v30, v68, v69
    v_cvt_pk_bf16_f32 v31, v70, v71
    ds_write_b64 v113, v[30:31]
    v_cvt_pk_bf16_f32 v32, v72, v73
    v_cvt_pk_bf16_f32 v33, v74, v75
    ds_write_b64 v114, v[32:33]
    s_mov_b64 exec, -1
    s_waitcnt lgkmcnt(0)
    ds_read_b128 v[36:39], v15
    ds_read_b128 v[40:43], v15 offset:256
    s_mov_b64 exec, s[44:45]
chain_kernel_bs_pp:
    buffer_load_dwordx4 v[48:51], v18, s[4:7], s21 offen offset:0 sc0 sc1
    buffer_load_dwordx4 v[52:55], v18, s[4:7], s21 offen offset:640 sc0 sc1
    buffer_load_dwordx4 v[56:59], v18, s[4:7], s21 offen offset:1280 sc0 sc1
    buffer_load_dwordx4 v[60:63], v18, s[4:7], s21 offen offset:1920 sc0 sc1
    buffer_load_dwordx4 v[64:67], v19, s[4:7], s21 offen sc0 sc1
    s_add_u32 s48, s48, 1
    s_cmp_gt_u32 s48, 0x200000
    s_cbranch_scc1 chain_kernel_end
    s_waitcnt vmcnt(0)
    v_max3_u32 v5, v48, v49, v50
    v_max3_u32 v6, v51, v52, v53
    v_max3_u32 v5, v5, v54, v55
    v_max3_u32 v6, v6, v56, v57
    v_max3_u32 v5, v5, v58, v59
    v_max3_u32 v6, v6, v60, v61
    v_max3_u32 v5, v5, v62, v63
    v_max3_u32 v6, v6, v64, v65
    v_max3_u32 v5, v5, v66, v67
    v_max_u32 v5, v5, v6
    v_cmp_eq_u32 vcc, -1, v5
    s_cbranch_vccnz chain_kernel_bs_pp
    s_mov_b64 exec, -1
    s_waitcnt lgkmcnt(0)
    s_nop 3
    v_mfma_f32_16x16x32_bf16 v[68:71], v[36:39], v[64:67], 0
    v_mfma_f32_16x16x32_bf16 v[72:75], v[40:43], v[64:67], 0
    v_mfma_f32_16x16x32_bf16 v[68:71], v[76:79], v[48:51], v[68:71]
    v_mfma_f32_16x16x32_bf16 v[72:75], v[80:83], v[48:51], v[72:75]
    v_mfma_f32_16x16x32_bf16 v[68:71], v[84:87], v[52:55], v[68:71]
    v_mfma_f32_16x16x32_bf16 v[72:75], v[88:91], v[52:55], v[72:75]
    v_mfma_f32_16x16x32_bf16 v[68:71], v[92:95], v[56:59], v[68:71]
    v_mfma_f32_16x16x32_bf16 v[72:75], v[96:99], v[56:59], v[72:75]
    v_mfma_f32_16x16x32_bf16 v[68:71], v[100:103], v[60:63], v[68:71]
    v_mfma_f32_16x16x32_bf16 v[72:75], v[104:107], v[60:63], v[72:75]
    s_nop 7
    ds_write_b128 v118, v[68:71]
    ds_write_b128 v118, v[72:75] offset:1024
    s_waitcnt lgkmcnt(0)
    s_barrier
    s_add_u32 s20, s20, 7168
    s_cmp_ge_u32 s14, 2
    s_cbranch_scc1 chain_kernel_bs_skip
    ds_read_b128 v[76:79], v119 offset:0
    ds_read_b128 v[80:83], v119 offset:2048
    ds_read_b128 v[84:87], v119 offset:4096
    ds_read_b128 v[88:91], v119 offset:6144
    s_waitcnt lgkmcnt(2)
    v_pk_add_f32 v[76:77], v[76:77], v[80:81]
    v_pk_add_f32 v[78:79], v[78:79], v[82:83]
    s_waitcnt lgkmcnt(0)
    v_pk_add_f32 v[84:85], v[84:85], v[88:89]
    v_pk_add_f32 v[86:87], v[86:87], v[90:91]
    v_pk_add_f32 v[76:77], v[76:77], v[84:85]
    v_pk_add_f32 v[78:79], v[78:79], v[86:87]
    v_cvt_pk_bf16_f32 v80, v76, v77
    v_cvt_pk_bf16_f32 v81, v78, v79
    v_min_u32 v80, 0xfffffffe, v80
    v_min_u32 v81, 0xfffffffe, v81
    s_mov_b64 exec, s[46:47]
    buffer_store_dwordx2 v[80:81], v9, s[4:7], s20 offen sc0 sc1
    s_mov_b64 exec, -1
chain_kernel_bs_skip:
    s_barrier
    s_add_u32 s21, s21, 10240
    s_add_u32 s22, s22, 114688
    s_add_u32 s25, s25, 1
    s_cmp_lt_u32 s25, 64
    s_cbranch_scc1 chain_kernel_bs_loop
    s_sub_u32 s54, s22, 114688
    buffer_store_dwordx4 v[36:39], v17, s[4:7], s54 offen sc0 sc1
    s_mov_b64 exec, s[42:43]
    buffer_store_dwordx4 v[40:43], v17, s[4:7], s54 offen offset:256 sc0 sc1
    s_mov_b64 exec, -1
    s_cmp_ge_u32 s14, 2
    s_cbranch_scc1 chain_kernel_wt4
    s_mov_b64 exec, s[46:47]
    s_add_u32 s54, s20, 9961472
    buffer_store_dwordx2 v[80:81], v9, s[4:7], s54 offen sc0 sc1
    s_mov_b64 exec, -1
chain_kernel_wt4:
    s_waitcnt vmcnt(0)
    s_barrier
    s_cmp_lg_u32 s14, 0
    s_cbranch_scc1 chain_kernel_end
    s_mov_b64 exec, 1
    v_mov_b32 v6, 156
    v_mov_b32 v5, 1
    buffer_atomic_add v5, v6, s[8:11], 0 offen sc1
    s_endpgm
chain_kernel_worker:
    s_mov_b32 s48, 0
    s_mov_b32 s19, s13
    s_cmp_ge_u32 s19, 224
    s_cbranch_scc1 chain_kernel_end
    s_barrier
    s_cmp_ge_u32 s19, 128
    s_cbranch_scc1 chain_kernel_wtr0
    s_and_b32 s20, s19, 31
    s_lshr_b32 s21, s19, 5
    s_mul_i32 s24, s21, 57344
    s_add_u32 s24, s24, 0
    s_mul_i32 s25, s20, 200704
    s_add_u32 s25, s25, 19005440
    v_lshrrev_b32 v6, 3, v1
    v_and_b32 v5, 7, v1
    v_xor_b32 v5, v5, v6
    v_lshl_add_u32 v6, v2, 3, v6
    v_mul_u32_u24 v16, 896, v6
    v_lshl_add_u32 v16, v5, 4, v16
    v_mul_u32_u24 v17, 896, v6
    v_lshl_add_u32 v17, v5, 4, v17
    s_add_u32 s60, s24, 0
    s_add_u32 s61, s24, 28672
    s_add_u32 s62, s25, 0
    s_add_u32 s63, s25, 28672
    s_add_u32 s64, s25, 57344
    s_add_u32 s65, s25, 86016
    s_add_u32 s66, s25, 114688
    s_add_u32 s67, s25, 143360
    s_add_u32 s68, s25, 172032
    s_lshl_b32 s69, s14, 10
    v_and_b32 v7, 7, v3
    v_xor_b32 v7, v7, v4
    v_lshlrev_b32 v7, 4, v7
    v_lshl_add_u32 v7, v3, 7, v7
    v_lshrrev_b32 v8, 1, v2
    v_and_b32 v9, 1, v2
    v_mul_u32_u24 v10, 4096, v8
    v_mul_u32_u24 v11, 14336, v9
    v_add_u32 v10, v10, v7
    v_add_u32 v11, v11, v7
    v_add_u32 v11, 8192, v11
    v_mov_b32 v18, v10
    v_xor_b32 v20, 64, v10
    v_add_u32 v19, 36864, v18
    v_add_u32 v21, 36864, v20
    v_mov_b32 v22, v11
    v_xor_b32 v24, 64, v11
    v_add_u32 v23, 36864, v22
    v_add_u32 v25, 36864, v24
    s_add_u32 m0, s69, 0
    s_nop 0
    buffer_load_dwordx4 v16, s[4:7], s60 offen  lds
    s_add_u32 s60, s60, 128
    s_add_u32 m0, s69, 4096
    s_nop 0
    buffer_load_dwordx4 v16, s[4:7], s61 offen  lds
    s_add_u32 s61, s61, 128
    s_add_u32 m0, s69, 8192
    s_nop 0
    buffer_load_dwordx4 v17, s[4:7], s62 offen  lds
    s_add_u32 s62, s62, 128
    s_add_u32 m0, s69, 12288
    s_nop 0
    buffer_load_dwordx4 v17, s[4:7], s63 offen  lds
    s_add_u32 s63, s63, 128
    s_add_u32 m0, s69, 16384
    s_nop 0
    buffer_load_dwordx4 v17, s[4:7], s64 offen  lds
    s_add_u32 s64, s64, 128
    s_add_u32 m0, s69, 20480
    s_nop 0
    buffer_load_dwordx4 v17, s[4:7], s65 offen  lds
    s_add_u32 s65, s65, 128
    s_add_u32 m0, s69, 24576
    s_nop 0
    buffer_load_dwordx4 v17, s[4:7], s66 offen  lds
    s_add_u32 s66, s66, 128
    s_add_u32 m0, s69, 28672
    s_nop 0
    buffer_load_dwordx4 v17, s[4:7], s67 offen  lds
    s_add_u32 s67, s67, 128
    s_add_u32 m0, s69, 32768
    s_nop 0
    buffer_load_dwordx4 v17, s[4:7], s68 offen  lds
    s_add_u32 s68, s68, 128
    s_add_u32 m0, s69, 36864
    s_nop 0
    buffer_load_dwordx4 v16, s[4:7], s60 offen  lds
    s_add_u32 s60, s60, 128
    s_add_u32 m0, s69, 40960
    s_nop 0
    buffer_load_dwordx4 v16, s[4:7], s61 offen  lds
    s_add_u32 s61, s61, 128
    s_add_u32 m0, s69, 45056
    s_nop 0
    buffer_load_dwordx4 v17, s[4:7], s62 offen  lds
    s_add_u32 s62, s62, 128
    s_add_u32 m0, s69, 49152
    s_nop 0
    buffer_load_dwordx4 v17, s[4:7], s63 offen  lds
    s_add_u32 s63, s63, 128
    s_add_u32 m0, s69, 53248
    s_nop 0
    buffer_load_dwordx4 v17, s[4:7], s64 offen  lds
    s_add_u32 s64, s64, 128
    s_add_u32 m0, s69, 57344
    s_nop 0
    buffer_load_dwordx4 v17, s[4:7], s65 offen  lds
    s_add_u32 s65, s65, 128
    s_add_u32 m0, s69, 61440
    s_nop 0
    buffer_load_dwordx4 v17, s[4:7], s66 offen  lds
    s_add_u32 s66, s66, 128
    s_add_u32 m0, s69, 65536
    s_nop 0
    buffer_load_dwordx4 v17, s[4:7], s67 offen  lds
    s_add_u32 s67, s67, 128
    s_add_u32 m0, s69, 69632
    s_nop 0
    buffer_load_dwordx4 v17, s[4:7], s68 offen  lds
    s_add_u32 s68, s68, 128
    s_waitcnt vmcnt(9)
    s_barrier
    ds_read_b128 v[36:39], v22 offset:0
    ds_read_b128 v[40:43], v22 offset:2048
    ds_read_b128 v[44:47], v22 offset:4096
    ds_read_b128 v[48:51], v22 offset:6144
    ds_read_b128 v[52:55], v22 offset:8192
    ds_read_b128 v[56:59], v22 offset:10240
    ds_read_b128 v[60:63], v22 offset:12288
    ds_read_b128 v[28:31], v18 offset:0
    ds_read_b128 v[32:35], v18 offset:2048
    s_waitcnt lgkmcnt(0)
    v_mfma_f32_16x16x32_bf16 a[0:3], v[28:31], v[36:39], 0
    v_mfma_f32_16x16x32_bf16 a[4:7], v[28:31], v[40:43], 0
    ds_read_b128 v[72:75], v24 offset:0
    v_mfma_f32_16x16x32_bf16 a[8:11], v[28:31], v[44:47], 0
    v_mfma_f32_16x16x32_bf16 a[12:15], v[28:31], v[48:51], 0
    ds_read_b128 v[76:79], v24 offset:2048
    v_mfma_f32_16x16x32_bf16 a[16:19], v[28:31], v[52:55], 0
    ds_read_b128 v[80:83], v24 offset:4096
    v_mfma_f32_16x16x32_bf16 a[20:23], v[28:31], v[56:59], 0
    v_mfma_f32_16x16x32_bf16 a[24:27], v[28:31], v[60:63], 0
    ds_read_b128 v[84:87], v24 offset:6144
    v_mfma_f32_16x16x32_bf16 a[28:31], v[32:35], v[36:39], 0
    ds_read_b128 v[88:91], v24 offset:8192
    v_mfma_f32_16x16x32_bf16 a[32:35], v[32:35], v[40:43], 0
    v_mfma_f32_16x16x32_bf16 a[36:39], v[32:35], v[44:47], 0
    ds_read_b128 v[92:95], v24 offset:10240
    v_mfma_f32_16x16x32_bf16 a[40:43], v[32:35], v[48:51], 0
    ds_read_b128 v[96:99], v24 offset:12288
    v_mfma_f32_16x16x32_bf16 a[44:47], v[32:35], v[52:55], 0
    v_mfma_f32_16x16x32_bf16 a[48:51], v[32:35], v[56:59], 0
    ds_read_b128 v[64:67], v20 offset:0
    v_mfma_f32_16x16x32_bf16 a[52:55], v[32:35], v[60:63], 0
    ds_read_b128 v[68:71], v20 offset:2048
    s_waitcnt lgkmcnt(0) vmcnt(0)
    s_barrier
    v_mfma_f32_16x16x32_bf16 a[0:3], v[64:67], v[72:75], a[0:3]
    ds_read_b128 v[36:39], v23 offset:0
    v_mfma_f32_16x16x32_bf16 a[4:7], v[64:67], v[76:79], a[4:7]
    s_add_u32 m0, s69, 0
    s_nop 0
    buffer_load_dwordx4 v16, s[4:7], s60 offen  lds
    s_add_u32 s60, s60, 128
    v_mfma_f32_16x16x32_bf16 a[8:11], v[64:67], v[80:83], a[8:11]
    ds_read_b128 v[40:43], v23 offset:2048
    v_mfma_f32_16x16x32_bf16 a[12:15], v[64:67], v[84:87], a[12:15]
    s_add_u32 m0, s69, 4096
    s_nop 0
    buffer_load_dwordx4 v16, s[4:7], s61 offen  lds
    s_add_u32 s61, s61, 128
    ds_read_b128 v[44:47], v23 offset:4096
    v_mfma_f32_16x16x32_bf16 a[16:19], v[64:67], v[88:91], a[16:19]
    s_add_u32 m0, s69, 8192
    s_nop 0
    buffer_load_dwordx4 v17, s[4:7], s62 offen  lds
    s_add_u32 s62, s62, 128
    v_mfma_f32_16x16x32_bf16 a[20:23], v[64:67], v[92:95], a[20:23]
    ds_read_b128 v[48:51], v23 offset:6144
    v_mfma_f32_16x16x32_bf16 a[24:27], v[64:67], v[96:99], a[24:27]
    s_add_u32 m0, s69, 12288
    s_nop 0
    buffer_load_dwordx4 v17, s[4:7], s63 offen  lds
    s_add_u32 s63, s63, 128
    ds_read_b128 v[52:55], v23 offset:8192
    v_mfma_f32_16x16x32_bf16 a[28:31], v[68:71], v[72:75], a[28:31]
    s_add_u32 m0, s69, 16384
    s_nop 0
    buffer_load_dwordx4 v17, s[4:7], s64 offen  lds
    s_add_u32 s64, s64, 128
    v_mfma_f32_16x16x32_bf16 a[32:35], v[68:71], v[76:79], a[32:35]
    ds_read_b128 v[56:59], v23 offset:10240
    v_mfma_f32_16x16x32_bf16 a[36:39], v[68:71], v[80:83], a[36:39]
    s_add_u32 m0, s69, 20480
    s_nop 0
    buffer_load_dwordx4 v17, s[4:7], s65 offen  lds
    s_add_u32 s65, s65, 128
    v_mfma_f32_16x16x32_bf16 a[40:43], v[68:71], v[84:87], a[40:43]
    ds_read_b128 v[60:63], v23 offset:12288
    s_add_u32 m0, s69, 24576
    s_nop 0
    buffer_load_dwordx4 v17, s[4:7], s66 offen  lds
    s_add_u32 s66, s66, 128
    v_mfma_f32_16x16x32_bf16 a[44:47], v[68:71], v[88:91], a[44:47]
    ds_read_b128 v[28:31], v19 offset:0
    v_mfma_f32_16x16x32_bf16 a[48:51], v[68:71], v[92:95], a[48:51]
    s_add_u32 m0, s69, 28672
    s_nop 0
    buffer_load_dwordx4 v17, s[4:7], s67 offen  lds
    s_add_u32 s67, s67, 128
    v_mfma_f32_16x16x32_bf16 a[52:55], v[68:71], v[96:99], a[52:55]
    ds_read_b128 v[32:35], v19 offset:2048
    s_add_u32 m0, s69, 32768
    s_nop 0
    buffer_load_dwordx4 v17, s[4:7], s68 offen  lds
    s_add_u32 s68, s68, 128
    s_waitcnt lgkmcnt(0)
    v_mfma_f32_16x16x32_bf16 a[0:3], v[28:31], v[36:39], a[0:3]
    v_mfma_f32_16x16x32_bf16 a[4:7], v[28:31], v[40:43], a[4:7]
    ds_read_b128 v[72:75], v25 offset:0
    v_mfma_f32_16x16x32_bf16 a[8:11], v[28:31], v[44:47], a[8:11]
    v_mfma_f32_16x16x32_bf16 a[12:15], v[28:31], v[48:51], a[12:15]
    ds_read_b128 v[76:79], v25 offset:2048
    v_mfma_f32_16x16x32_bf16 a[16:19], v[28:31], v[52:55], a[16:19]
    ds_read_b128 v[80:83], v25 offset:4096
    v_mfma_f32_16x16x32_bf16 a[20:23], v[28:31], v[56:59], a[20:23]
    v_mfma_f32_16x16x32_bf16 a[24:27], v[28:31], v[60:63], a[24:27]
    ds_read_b128 v[84:87], v25 offset:6144
    v_mfma_f32_16x16x32_bf16 a[28:31], v[32:35], v[36:39], a[28:31]
    ds_read_b128 v[88:91], v25 offset:8192
    v_mfma_f32_16x16x32_bf16 a[32:35], v[32:35], v[40:43], a[32:35]
    v_mfma_f32_16x16x32_bf16 a[36:39], v[32:35], v[44:47], a[36:39]
    ds_read_b128 v[92:95], v25 offset:10240
    v_mfma_f32_16x16x32_bf16 a[40:43], v[32:35], v[48:51], a[40:43]
    ds_read_b128 v[96:99], v25 offset:12288
    v_mfma_f32_16x16x32_bf16 a[44:47], v[32:35], v[52:55], a[44:47]
    v_mfma_f32_16x16x32_bf16 a[48:51], v[32:35], v[56:59], a[48:51]
    ds_read_b128 v[64:67], v21 offset:0
    v_mfma_f32_16x16x32_bf16 a[52:55], v[32:35], v[60:63], a[52:55]
    ds_read_b128 v[68:71], v21 offset:2048
    s_waitcnt lgkmcnt(0) vmcnt(0)
    s_barrier
    v_mfma_f32_16x16x32_bf16 a[0:3], v[64:67], v[72:75], a[0:3]
    ds_read_b128 v[36:39], v22 offset:0
    v_mfma_f32_16x16x32_bf16 a[4:7], v[64:67], v[76:79], a[4:7]
    s_add_u32 m0, s69, 36864
    s_nop 0
    buffer_load_dwordx4 v16, s[4:7], s60 offen  lds
    s_add_u32 s60, s60, 128
    v_mfma_f32_16x16x32_bf16 a[8:11], v[64:67], v[80:83], a[8:11]
    ds_read_b128 v[40:43], v22 offset:2048
    v_mfma_f32_16x16x32_bf16 a[12:15], v[64:67], v[84:87], a[12:15]
    s_add_u32 m0, s69, 40960
    s_nop 0
    buffer_load_dwordx4 v16, s[4:7], s61 offen  lds
    s_add_u32 s61, s61, 128
    ds_read_b128 v[44:47], v22 offset:4096
    v_mfma_f32_16x16x32_bf16 a[16:19], v[64:67], v[88:91], a[16:19]
    s_add_u32 m0, s69, 45056
    s_nop 0
    buffer_load_dwordx4 v17, s[4:7], s62 offen  lds
    s_add_u32 s62, s62, 128
    v_mfma_f32_16x16x32_bf16 a[20:23], v[64:67], v[92:95], a[20:23]
    ds_read_b128 v[48:51], v22 offset:6144
    v_mfma_f32_16x16x32_bf16 a[24:27], v[64:67], v[96:99], a[24:27]
    s_add_u32 m0, s69, 49152
    s_nop 0
    buffer_load_dwordx4 v17, s[4:7], s63 offen  lds
    s_add_u32 s63, s63, 128
    ds_read_b128 v[52:55], v22 offset:8192
    v_mfma_f32_16x16x32_bf16 a[28:31], v[68:71], v[72:75], a[28:31]
    s_add_u32 m0, s69, 53248
    s_nop 0
    buffer_load_dwordx4 v17, s[4:7], s64 offen  lds
    s_add_u32 s64, s64, 128
    v_mfma_f32_16x16x32_bf16 a[32:35], v[68:71], v[76:79], a[32:35]
    ds_read_b128 v[56:59], v22 offset:10240
    v_mfma_f32_16x16x32_bf16 a[36:39], v[68:71], v[80:83], a[36:39]
    s_add_u32 m0, s69, 57344
    s_nop 0
    buffer_load_dwordx4 v17, s[4:7], s65 offen  lds
    s_add_u32 s65, s65, 128
    v_mfma_f32_16x16x32_bf16 a[40:43], v[68:71], v[84:87], a[40:43]
    ds_read_b128 v[60:63], v22 offset:12288
    s_add_u32 m0, s69, 61440
    s_nop 0
    buffer_load_dwordx4 v17, s[4:7], s66 offen  lds
    s_add_u32 s66, s66, 128
    v_mfma_f32_16x16x32_bf16 a[44:47], v[68:71], v[88:91], a[44:47]
    ds_read_b128 v[28:31], v18 offset:0
    v_mfma_f32_16x16x32_bf16 a[48:51], v[68:71], v[92:95], a[48:51]
    s_add_u32 m0, s69, 65536
    s_nop 0
    buffer_load_dwordx4 v17, s[4:7], s67 offen  lds
    s_add_u32 s67, s67, 128
    v_mfma_f32_16x16x32_bf16 a[52:55], v[68:71], v[96:99], a[52:55]
    ds_read_b128 v[32:35], v18 offset:2048
    s_add_u32 m0, s69, 69632
    s_nop 0
    buffer_load_dwordx4 v17, s[4:7], s68 offen  lds
    s_add_u32 s68, s68, 128
    s_waitcnt lgkmcnt(0)
    v_mfma_f32_16x16x32_bf16 a[0:3], v[28:31], v[36:39], a[0:3]
    v_mfma_f32_16x16x32_bf16 a[4:7], v[28:31], v[40:43], a[4:7]
    ds_read_b128 v[72:75], v24 offset:0
    v_mfma_f32_16x16x32_bf16 a[8:11], v[28:31], v[44:47], a[8:11]
    v_mfma_f32_16x16x32_bf16 a[12:15], v[28:31], v[48:51], a[12:15]
    ds_read_b128 v[76:79], v24 offset:2048
    v_mfma_f32_16x16x32_bf16 a[16:19], v[28:31], v[52:55], a[16:19]
    ds_read_b128 v[80:83], v24 offset:4096
    v_mfma_f32_16x16x32_bf16 a[20:23], v[28:31], v[56:59], a[20:23]
    v_mfma_f32_16x16x32_bf16 a[24:27], v[28:31], v[60:63], a[24:27]
    ds_read_b128 v[84:87], v24 offset:6144
    v_mfma_f32_16x16x32_bf16 a[28:31], v[32:35], v[36:39], a[28:31]
    ds_read_b128 v[88:91], v24 offset:8192
    v_mfma_f32_16x16x32_bf16 a[32:35], v[32:35], v[40:43], a[32:35]
    v_mfma_f32_16x16x32_bf16 a[36:39], v[32:35], v[44:47], a[36:39]
    ds_read_b128 v[92:95], v24 offset:10240
    v_mfma_f32_16x16x32_bf16 a[40:43], v[32:35], v[48:51], a[40:43]
    ds_read_b128 v[96:99], v24 offset:12288
    v_mfma_f32_16x16x32_bf16 a[44:47], v[32:35], v[52:55], a[44:47]
    v_mfma_f32_16x16x32_bf16 a[48:51], v[32:35], v[56:59], a[48:51]
    ds_read_b128 v[64:67], v20 offset:0
    v_mfma_f32_16x16x32_bf16 a[52:55], v[32:35], v[60:63], a[52:55]
    ds_read_b128 v[68:71], v20 offset:2048
    s_waitcnt lgkmcnt(0) vmcnt(0)
    s_barrier
    v_mfma_f32_16x16x32_bf16 a[0:3], v[64:67], v[72:75], a[0:3]
    ds_read_b128 v[36:39], v23 offset:0
    v_mfma_f32_16x16x32_bf16 a[4:7], v[64:67], v[76:79], a[4:7]
    s_add_u32 m0, s69, 0
    s_nop 0
    buffer_load_dwordx4 v16, s[4:7], s60 offen  lds
    s_add_u32 s60, s60, 128
    v_mfma_f32_16x16x32_bf16 a[8:11], v[64:67], v[80:83], a[8:11]
    ds_read_b128 v[40:43], v23 offset:2048
    v_mfma_f32_16x16x32_bf16 a[12:15], v[64:67], v[84:87], a[12:15]
    s_add_u32 m0, s69, 4096
    s_nop 0
    buffer_load_dwordx4 v16, s[4:7], s61 offen  lds
    s_add_u32 s61, s61, 128
    ds_read_b128 v[44:47], v23 offset:4096
    v_mfma_f32_16x16x32_bf16 a[16:19], v[64:67], v[88:91], a[16:19]
    s_add_u32 m0, s69, 8192
    s_nop 0
    buffer_load_dwordx4 v17, s[4:7], s62 offen  lds
    s_add_u32 s62, s62, 128
    v_mfma_f32_16x16x32_bf16 a[20:23], v[64:67], v[92:95], a[20:23]
    ds_read_b128 v[48:51], v23 offset:6144
    v_mfma_f32_16x16x32_bf16 a[24:27], v[64:67], v[96:99], a[24:27]
    s_add_u32 m0, s69, 12288
    s_nop 0
    buffer_load_dwordx4 v17, s[4:7], s63 offen  lds
    s_add_u32 s63, s63, 128
    ds_read_b128 v[52:55], v23 offset:8192
    v_mfma_f32_16x16x32_bf16 a[28:31], v[68:71], v[72:75], a[28:31]
    s_add_u32 m0, s69, 16384
    s_nop 0
    buffer_load_dwordx4 v17, s[4:7], s64 offen  lds
    s_add_u32 s64, s64, 128
    v_mfma_f32_16x16x32_bf16 a[32:35], v[68:71], v[76:79], a[32:35]
    ds_read_b128 v[56:59], v23 offset:10240
    v_mfma_f32_16x16x32_bf16 a[36:39], v[68:71], v[80:83], a[36:39]
    s_add_u32 m0, s69, 20480
    s_nop 0
    buffer_load_dwordx4 v17, s[4:7], s65 offen  lds
    s_add_u32 s65, s65, 128
    v_mfma_f32_16x16x32_bf16 a[40:43], v[68:71], v[84:87], a[40:43]
    ds_read_b128 v[60:63], v23 offset:12288
    s_add_u32 m0, s69, 24576
    s_nop 0
    buffer_load_dwordx4 v17, s[4:7], s66 offen  lds
    s_add_u32 s66, s66, 128
    v_mfma_f32_16x16x32_bf16 a[44:47], v[68:71], v[88:91], a[44:47]
    ds_read_b128 v[28:31], v19 offset:0
    v_mfma_f32_16x16x32_bf16 a[48:51], v[68:71], v[92:95], a[48:51]
    s_add_u32 m0, s69, 28672
    s_nop 0
    buffer_load_dwordx4 v17, s[4:7], s67 offen  lds
    s_add_u32 s67, s67, 128
    v_mfma_f32_16x16x32_bf16 a[52:55], v[68:71], v[96:99], a[52:55]
    ds_read_b128 v[32:35], v19 offset:2048
    s_add_u32 m0, s69, 32768
    s_nop 0
    buffer_load_dwordx4 v17, s[4:7], s68 offen  lds
    s_add_u32 s68, s68, 128
    s_waitcnt lgkmcnt(0)
    v_mfma_f32_16x16x32_bf16 a[0:3], v[28:31], v[36:39], a[0:3]
    v_mfma_f32_16x16x32_bf16 a[4:7], v[28:31], v[40:43], a[4:7]
    ds_read_b128 v[72:75], v25 offset:0
    v_mfma_f32_16x16x32_bf16 a[8:11], v[28:31], v[44:47], a[8:11]
    v_mfma_f32_16x16x32_bf16 a[12:15], v[28:31], v[48:51], a[12:15]
    ds_read_b128 v[76:79], v25 offset:2048
    v_mfma_f32_16x16x32_bf16 a[16:19], v[28:31], v[52:55], a[16:19]
    ds_read_b128 v[80:83], v25 offset:4096
    v_mfma_f32_16x16x32_bf16 a[20:23], v[28:31], v[56:59], a[20:23]
    v_mfma_f32_16x16x32_bf16 a[24:27], v[28:31], v[60:63], a[24:27]
    ds_read_b128 v[84:87], v25 offset:6144
    v_mfma_f32_16x16x32_bf16 a[28:31], v[32:35], v[36:39], a[28:31]
    ds_read_b128 v[88:91], v25 offset:8192
    v_mfma_f32_16x16x32_bf16 a[32:35], v[32:35], v[40:43], a[32:35]
    v_mfma_f32_16x16x32_bf16 a[36:39], v[32:35], v[44:47], a[36:39]
    ds_read_b128 v[92:95], v25 offset:10240
    v_mfma_f32_16x16x32_bf16 a[40:43], v[32:35], v[48:51], a[40:43]
    ds_read_b128 v[96:99], v25 offset:12288
    v_mfma_f32_16x16x32_bf16 a[44:47], v[32:35], v[52:55], a[44:47]
    v_mfma_f32_16x16x32_bf16 a[48:51], v[32:35], v[56:59], a[48:51]
    ds_read_b128 v[64:67], v21 offset:0
    v_mfma_f32_16x16x32_bf16 a[52:55], v[32:35], v[60:63], a[52:55]
    ds_read_b128 v[68:71], v21 offset:2048
    s_waitcnt lgkmcnt(0) vmcnt(0)
    s_barrier
    v_mfma_f32_16x16x32_bf16 a[0:3], v[64:67], v[72:75], a[0:3]
    ds_read_b128 v[36:39], v22 offset:0
    v_mfma_f32_16x16x32_bf16 a[4:7], v[64:67], v[76:79], a[4:7]
    s_add_u32 m0, s69, 36864
    s_nop 0
    buffer_load_dwordx4 v16, s[4:7], s60 offen  lds
    s_add_u32 s60, s60, 128
    v_mfma_f32_16x16x32_bf16 a[8:11], v[64:67], v[80:83], a[8:11]
    ds_read_b128 v[40:43], v22 offset:2048
    v_mfma_f32_16x16x32_bf16 a[12:15], v[64:67], v[84:87], a[12:15]
    s_add_u32 m0, s69, 40960
    s_nop 0
    buffer_load_dwordx4 v16, s[4:7], s61 offen  lds
    s_add_u32 s61, s61, 128
    ds_read_b128 v[44:47], v22 offset:4096
    v_mfma_f32_16x16x32_bf16 a[16:19], v[64:67], v[88:91], a[16:19]
    s_add_u32 m0, s69, 45056
    s_nop 0
    buffer_load_dwordx4 v17, s[4:7], s62 offen  lds
    s_add_u32 s62, s62, 128
    v_mfma_f32_16x16x32_bf16 a[20:23], v[64:67], v[92:95], a[20:23]
    ds_read_b128 v[48:51], v22 offset:6144
    v_mfma_f32_16x16x32_bf16 a[24:27], v[64:67], v[96:99], a[24:27]
    s_add_u32 m0, s69, 49152
    s_nop 0
    buffer_load_dwordx4 v17, s[4:7], s63 offen  lds
    s_add_u32 s63, s63, 128
    ds_read_b128 v[52:55], v22 offset:8192
    v_mfma_f32_16x16x32_bf16 a[28:31], v[68:71], v[72:75], a[28:31]
    s_add_u32 m0, s69, 53248
    s_nop 0
    buffer_load_dwordx4 v17, s[4:7], s64 offen  lds
    s_add_u32 s64, s64, 128
    v_mfma_f32_16x16x32_bf16 a[32:35], v[68:71], v[76:79], a[32:35]
    ds_read_b128 v[56:59], v22 offset:10240
    v_mfma_f32_16x16x32_bf16 a[36:39], v[68:71], v[80:83], a[36:39]
    s_add_u32 m0, s69, 57344
    s_nop 0
    buffer_load_dwordx4 v17, s[4:7], s65 offen  lds
    s_add_u32 s65, s65, 128
    v_mfma_f32_16x16x32_bf16 a[40:43], v[68:71], v[84:87], a[40:43]
    ds_read_b128 v[60:63], v22 offset:12288
    s_add_u32 m0, s69, 61440
    s_nop 0
    buffer_load_dwordx4 v17, s[4:7], s66 offen  lds
    s_add_u32 s66, s66, 128
    v_mfma_f32_16x16x32_bf16 a[44:47], v[68:71], v[88:91], a[44:47]
    ds_read_b128 v[28:31], v18 offset:0
    v_mfma_f32_16x16x32_bf16 a[48:51], v[68:71], v[92:95], a[48:51]
    s_add_u32 m0, s69, 65536
    s_nop 0
    buffer_load_dwordx4 v17, s[4:7], s67 offen  lds
    s_add_u32 s67, s67, 128
    v_mfma_f32_16x16x32_bf16 a[52:55], v[68:71], v[96:99], a[52:55]
    ds_read_b128 v[32:35], v18 offset:2048
    s_add_u32 m0, s69, 69632
    s_nop 0
    buffer_load_dwordx4 v17, s[4:7], s68 offen  lds
    s_add_u32 s68, s68, 128
    s_waitcnt lgkmcnt(0)
    v_mfma_f32_16x16x32_bf16 a[0:3], v[28:31], v[36:39], a[0:3]
    v_mfma_f32_16x16x32_bf16 a[4:7], v[28:31], v[40:43], a[4:7]
    ds_read_b128 v[72:75], v24 offset:0
    v_mfma_f32_16x16x32_bf16 a[8:11], v[28:31], v[44:47], a[8:11]
    v_mfma_f32_16x16x32_bf16 a[12:15], v[28:31], v[48:51], a[12:15]
    ds_read_b128 v[76:79], v24 offset:2048
    v_mfma_f32_16x16x32_bf16 a[16:19], v[28:31], v[52:55], a[16:19]
    ds_read_b128 v[80:83], v24 offset:4096
    v_mfma_f32_16x16x32_bf16 a[20:23], v[28:31], v[56:59], a[20:23]
    v_mfma_f32_16x16x32_bf16 a[24:27], v[28:31], v[60:63], a[24:27]
    ds_read_b128 v[84:87], v24 offset:6144
    v_mfma_f32_16x16x32_bf16 a[28:31], v[32:35], v[36:39], a[28:31]
    ds_read_b128 v[88:91], v24 offset:8192
    v_mfma_f32_16x16x32_bf16 a[32:35], v[32:35], v[40:43], a[32:35]
    v_mfma_f32_16x16x32_bf16 a[36:39], v[32:35], v[44:47], a[36:39]
    ds_read_b128 v[92:95], v24 offset:10240
    v_mfma_f32_16x16x32_bf16 a[40:43], v[32:35], v[48:51], a[40:43]
    ds_read_b128 v[96:99], v24 offset:12288
    v_mfma_f32_16x16x32_bf16 a[44:47], v[32:35], v[52:55], a[44:47]
    v_mfma_f32_16x16x32_bf16 a[48:51], v[32:35], v[56:59], a[48:51]
    ds_read_b128 v[64:67], v20 offset:0
    v_mfma_f32_16x16x32_bf16 a[52:55], v[32:35], v[60:63], a[52:55]
    ds_read_b128 v[68:71], v20 offset:2048
    s_waitcnt lgkmcnt(0) vmcnt(0)
    s_barrier
    v_mfma_f32_16x16x32_bf16 a[0:3], v[64:67], v[72:75], a[0:3]
    ds_read_b128 v[36:39], v23 offset:0
    v_mfma_f32_16x16x32_bf16 a[4:7], v[64:67], v[76:79], a[4:7]
    s_add_u32 m0, s69, 0
    s_nop 0
    buffer_load_dwordx4 v16, s[4:7], s60 offen  lds
    s_add_u32 s60, s60, 128
    v_mfma_f32_16x16x32_bf16 a[8:11], v[64:67], v[80:83], a[8:11]
    ds_read_b128 v[40:43], v23 offset:2048
    v_mfma_f32_16x16x32_bf16 a[12:15], v[64:67], v[84:87], a[12:15]
    s_add_u32 m0, s69, 4096
    s_nop 0
    buffer_load_dwordx4 v16, s[4:7], s61 offen  lds
    s_add_u32 s61, s61, 128
    ds_read_b128 v[44:47], v23 offset:4096
    v_mfma_f32_16x16x32_bf16 a[16:19], v[64:67], v[88:91], a[16:19]
    s_add_u32 m0, s69, 8192
    s_nop 0
    buffer_load_dwordx4 v17, s[4:7], s62 offen  lds
    s_add_u32 s62, s62, 128
    v_mfma_f32_16x16x32_bf16 a[20:23], v[64:67], v[92:95], a[20:23]
    ds_read_b128 v[48:51], v23 offset:6144
    v_mfma_f32_16x16x32_bf16 a[24:27], v[64:67], v[96:99], a[24:27]
    s_add_u32 m0, s69, 12288
    s_nop 0
    buffer_load_dwordx4 v17, s[4:7], s63 offen  lds
    s_add_u32 s63, s63, 128
    ds_read_b128 v[52:55], v23 offset:8192
    v_mfma_f32_16x16x32_bf16 a[28:31], v[68:71], v[72:75], a[28:31]
    s_add_u32 m0, s69, 16384
    s_nop 0
    buffer_load_dwordx4 v17, s[4:7], s64 offen  lds
    s_add_u32 s64, s64, 128
    v_mfma_f32_16x16x32_bf16 a[32:35], v[68:71], v[76:79], a[32:35]
    ds_read_b128 v[56:59], v23 offset:10240
    v_mfma_f32_16x16x32_bf16 a[36:39], v[68:71], v[80:83], a[36:39]
    s_add_u32 m0, s69, 20480
    s_nop 0
    buffer_load_dwordx4 v17, s[4:7], s65 offen  lds
    s_add_u32 s65, s65, 128
    v_mfma_f32_16x16x32_bf16 a[40:43], v[68:71], v[84:87], a[40:43]
    ds_read_b128 v[60:63], v23 offset:12288
    s_add_u32 m0, s69, 24576
    s_nop 0
    buffer_load_dwordx4 v17, s[4:7], s66 offen  lds
    s_add_u32 s66, s66, 128
    v_mfma_f32_16x16x32_bf16 a[44:47], v[68:71], v[88:91], a[44:47]
    ds_read_b128 v[28:31], v19 offset:0
    v_mfma_f32_16x16x32_bf16 a[48:51], v[68:71], v[92:95], a[48:51]
    s_add_u32 m0, s69, 28672
    s_nop 0
    buffer_load_dwordx4 v17, s[4:7], s67 offen  lds
    s_add_u32 s67, s67, 128
    v_mfma_f32_16x16x32_bf16 a[52:55], v[68:71], v[96:99], a[52:55]
    ds_read_b128 v[32:35], v19 offset:2048
    s_add_u32 m0, s69, 32768
    s_nop 0
    buffer_load_dwordx4 v17, s[4:7], s68 offen  lds
    s_add_u32 s68, s68, 128
    s_waitcnt lgkmcnt(0)
    v_mfma_f32_16x16x32_bf16 a[0:3], v[28:31], v[36:39], a[0:3]
    v_mfma_f32_16x16x32_bf16 a[4:7], v[28:31], v[40:43], a[4:7]
    ds_read_b128 v[72:75], v25 offset:0
    v_mfma_f32_16x16x32_bf16 a[8:11], v[28:31], v[44:47], a[8:11]
    v_mfma_f32_16x16x32_bf16 a[12:15], v[28:31], v[48:51], a[12:15]
    ds_read_b128 v[76:79], v25 offset:2048
    v_mfma_f32_16x16x32_bf16 a[16:19], v[28:31], v[52:55], a[16:19]
    ds_read_b128 v[80:83], v25 offset:4096
    v_mfma_f32_16x16x32_bf16 a[20:23], v[28:31], v[56:59], a[20:23]
    v_mfma_f32_16x16x32_bf16 a[24:27], v[28:31], v[60:63], a[24:27]
    ds_read_b128 v[84:87], v25 offset:6144
    v_mfma_f32_16x16x32_bf16 a[28:31], v[32:35], v[36:39], a[28:31]
    ds_read_b128 v[88:91], v25 offset:8192
    v_mfma_f32_16x16x32_bf16 a[32:35], v[32:35], v[40:43], a[32:35]
    v_mfma_f32_16x16x32_bf16 a[36:39], v[32:35], v[44:47], a[36:39]
    ds_read_b128 v[92:95], v25 offset:10240
    v_mfma_f32_16x16x32_bf16 a[40:43], v[32:35], v[48:51], a[40:43]
    ds_read_b128 v[96:99], v25 offset:12288
    v_mfma_f32_16x16x32_bf16 a[44:47], v[32:35], v[52:55], a[44:47]
    v_mfma_f32_16x16x32_bf16 a[48:51], v[32:35], v[56:59], a[48:51]
    ds_read_b128 v[64:67], v21 offset:0
    v_mfma_f32_16x16x32_bf16 a[52:55], v[32:35], v[60:63], a[52:55]
    ds_read_b128 v[68:71], v21 offset:2048
    s_waitcnt lgkmcnt(0) vmcnt(0)
    s_barrier
    v_mfma_f32_16x16x32_bf16 a[0:3], v[64:67], v[72:75], a[0:3]
    v_mfma_f32_16x16x32_bf16 a[4:7], v[64:67], v[76:79], a[4:7]
    ds_read_b128 v[36:39], v22 offset:0
    v_mfma_f32_16x16x32_bf16 a[8:11], v[64:67], v[80:83], a[8:11]
    v_mfma_f32_16x16x32_bf16 a[12:15], v[64:67], v[84:87], a[12:15]
    ds_read_b128 v[40:43], v22 offset:2048
    v_mfma_f32_16x16x32_bf16 a[16:19], v[64:67], v[88:91], a[16:19]
    ds_read_b128 v[44:47], v22 offset:4096
    v_mfma_f32_16x16x32_bf16 a[20:23], v[64:67], v[92:95], a[20:23]
    v_mfma_f32_16x16x32_bf16 a[24:27], v[64:67], v[96:99], a[24:27]
    ds_read_b128 v[48:51], v22 offset:6144
    v_mfma_f32_16x16x32_bf16 a[28:31], v[68:71], v[72:75], a[28:31]
    ds_read_b128 v[52:55], v22 offset:8192
    v_mfma_f32_16x16x32_bf16 a[32:35], v[68:71], v[76:79], a[32:35]
    v_mfma_f32_16x16x32_bf16 a[36:39], v[68:71], v[80:83], a[36:39]
    ds_read_b128 v[56:59], v22 offset:10240
    v_mfma_f32_16x16x32_bf16 a[40:43], v[68:71], v[84:87], a[40:43]
    ds_read_b128 v[60:63], v22 offset:12288
    v_mfma_f32_16x16x32_bf16 a[44:47], v[68:71], v[88:91], a[44:47]
    v_mfma_f32_16x16x32_bf16 a[48:51], v[68:71], v[92:95], a[48:51]
    ds_read_b128 v[28:31], v18 offset:0
    v_mfma_f32_16x16x32_bf16 a[52:55], v[68:71], v[96:99], a[52:55]
    ds_read_b128 v[32:35], v18 offset:2048
    s_waitcnt lgkmcnt(0)
    v_mfma_f32_16x16x32_bf16 a[0:3], v[28:31], v[36:39], a[0:3]
    v_mfma_f32_16x16x32_bf16 a[4:7], v[28:31], v[40:43], a[4:7]
    ds_read_b128 v[72:75], v24 offset:0
    v_mfma_f32_16x16x32_bf16 a[8:11], v[28:31], v[44:47], a[8:11]
    v_mfma_f32_16x16x32_bf16 a[12:15], v[28:31], v[48:51], a[12:15]
    ds_read_b128 v[76:79], v24 offset:2048
    v_mfma_f32_16x16x32_bf16 a[16:19], v[28:31], v[52:55], a[16:19]
    ds_read_b128 v[80:83], v24 offset:4096
    v_mfma_f32_16x16x32_bf16 a[20:23], v[28:31], v[56:59], a[20:23]
    v_mfma_f32_16x16x32_bf16 a[24:27], v[28:31], v[60:63], a[24:27]
    ds_read_b128 v[84:87], v24 offset:6144
    v_mfma_f32_16x16x32_bf16 a[28:31], v[32:35], v[36:39], a[28:31]
    ds_read_b128 v[88:91], v24 offset:8192
    v_mfma_f32_16x16x32_bf16 a[32:35], v[32:35], v[40:43], a[32:35]
    v_mfma_f32_16x16x32_bf16 a[36:39], v[32:35], v[44:47], a[36:39]
    ds_read_b128 v[92:95], v24 offset:10240
    v_mfma_f32_16x16x32_bf16 a[40:43], v[32:35], v[48:51], a[40:43]
    ds_read_b128 v[96:99], v24 offset:12288
    v_mfma_f32_16x16x32_bf16 a[44:47], v[32:35], v[52:55], a[44:47]
    v_mfma_f32_16x16x32_bf16 a[48:51], v[32:35], v[56:59], a[48:51]
    ds_read_b128 v[64:67], v20 offset:0
    v_mfma_f32_16x16x32_bf16 a[52:55], v[32:35], v[60:63], a[52:55]
    ds_read_b128 v[68:71], v20 offset:2048
    s_waitcnt lgkmcnt(0)
    v_mfma_f32_16x16x32_bf16 a[0:3], v[64:67], v[72:75], a[0:3]
    v_mfma_f32_16x16x32_bf16 a[4:7], v[64:67], v[76:79], a[4:7]
    v_mfma_f32_16x16x32_bf16 a[8:11], v[64:67], v[80:83], a[8:11]
    v_mfma_f32_16x16x32_bf16 a[12:15], v[64:67], v[84:87], a[12:15]
    v_mfma_f32_16x16x32_bf16 a[16:19], v[64:67], v[88:91], a[16:19]
    v_mfma_f32_16x16x32_bf16 a[20:23], v[64:67], v[92:95], a[20:23]
    v_mfma_f32_16x16x32_bf16 a[24:27], v[64:67], v[96:99], a[24:27]
    v_mfma_f32_16x16x32_bf16 a[28:31], v[68:71], v[72:75], a[28:31]
    v_mfma_f32_16x16x32_bf16 a[32:35], v[68:71], v[76:79], a[32:35]
    v_mfma_f32_16x16x32_bf16 a[36:39], v[68:71], v[80:83], a[36:39]
    v_mfma_f32_16x16x32_bf16 a[40:43], v[68:71], v[84:87], a[40:43]
    v_mfma_f32_16x16x32_bf16 a[44:47], v[68:71], v[88:91], a[44:47]
    v_mfma_f32_16x16x32_bf16 a[48:51], v[68:71], v[92:95], a[48:51]
    v_mfma_f32_16x16x32_bf16 a[52:55], v[68:71], v[96:99], a[52:55]
    s_nop 7
    s_nop 7
    s_barrier
    v_lshrrev_b32 v5, 1, v3
    v_and_b32 v5, 3, v5
    v_lshrrev_b32 v6, 1, v4
    v_xor_b32 v6, v6, v5
    v_xor_b32 v7, 2, v6
    v_and_b32 v5, 1, v4
    v_lshlrev_b32 v5, 3, v5
    v_lshl_add_u32 v5, v3, 6, v5
    v_mul_u32_u24 v12, 7168, v2
    v_add_u32 v5, v5, v12
    v_lshl_add_u32 v12, v6, 4, v5
    v_lshl_add_u32 v13, v7, 4, v5
    v_accvgpr_read_b32 v28, a0
    v_accvgpr_read_b32 v29, a1
    v_accvgpr_read_b32 v30, a2
    v_accvgpr_read_b32 v31, a3
    v_cvt_pk_bf16_f32 v32, v28, v29
    v_cvt_pk_bf16_f32 v33, v30, v31
    ds_write_b64 v12, v[32:33] offset:0
    v_accvgpr_read_b32 v44, a4
    v_accvgpr_read_b32 v45, a5
    v_accvgpr_read_b32 v46, a6
    v_accvgpr_read_b32 v47, a7
    v_cvt_pk_bf16_f32 v48, v44, v45
    v_cvt_pk_bf16_f32 v49, v46, v47
    ds_write_b64 v12, v[48:49] offset:1024
    v_accvgpr_read_b32 v60, a8
    v_accvgpr_read_b32 v61, a9
    v_accvgpr_read_b32 v62, a10
    v_accvgpr_read_b32 v63, a11
    v_cvt_pk_bf16_f32 v64, v60, v61
    v_cvt_pk_bf16_f32 v65, v62, v63
    ds_write_b64 v12, v[64:65] offset:2048
    v_accvgpr_read_b32 v76, a12
    v_accvgpr_read_b32 v77, a13
    v_accvgpr_read_b32 v78, a14
    v_accvgpr_read_b32 v79, a15
    v_cvt_pk_bf16_f32 v80, v76, v77
    v_cvt_pk_bf16_f32 v81, v78, v79
    ds_write_b64 v12, v[80:81] offset:3072
    v_accvgpr_read_b32 v28, a16
    v_accvgpr_read_b32 v29, a17
    v_accvgpr_read_b32 v30, a18
    v_accvgpr_read_b32 v31, a19
    v_cvt_pk_bf16_f32 v32, v28, v29
    v_cvt_pk_bf16_f32 v33, v30, v31
    ds_write_b64 v12, v[32:33] offset:4096
    v_accvgpr_read_b32 v44, a20
    v_accvgpr_read_b32 v45, a21
    v_accvgpr_read_b32 v46, a22
    v_accvgpr_read_b32 v47, a23
    v_cvt_pk_bf16_f32 v48, v44, v45
    v_cvt_pk_bf16_f32 v49, v46, v47
    ds_write_b64 v12, v[48:49] offset:5120
    v_accvgpr_read_b32 v60, a24
    v_accvgpr_read_b32 v61, a25
    v_accvgpr_read_b32 v62, a26
    v_accvgpr_read_b32 v63, a27
    v_cvt_pk_bf16_f32 v64, v60, v61
    v_cvt_pk_bf16_f32 v65, v62, v63
    ds_write_b64 v12, v[64:65] offset:6144
    v_accvgpr_read_b32 v76, a28
    v_accvgpr_read_b32 v77, a29
    v_accvgpr_read_b32 v78, a30
    v_accvgpr_read_b32 v79, a31
    v_cvt_pk_bf16_f32 v80, v76, v77
    v_cvt_pk_bf16_f32 v81, v78, v79
    ds_write_b64 v13, v[80:81] offset:0
    v_accvgpr_read_b32 v28, a32
    v_accvgpr_read_b32 v29, a33
    v_accvgpr_read_b32 v30, a34
    v_accvgpr_read_b32 v31, a35
    v_cvt_pk_bf16_f32 v32, v28, v29
    v_cvt_pk_bf16_f32 v33, v30, v31
    ds_write_b64 v13, v[32:33] offset:1024
    v_accvgpr_read_b32 v44, a36
    v_accvgpr_read_b32 v45, a37
    v_accvgpr_read_b32 v46, a38
    v_accvgpr_read_b32 v47, a39
    v_cvt_pk_bf16_f32 v48, v44, v45
    v_cvt_pk_bf16_f32 v49, v46, v47
    ds_write_b64 v13, v[48:49] offset:2048
    v_accvgpr_read_b32 v60, a40
    v_accvgpr_read_b32 v61, a41
    v_accvgpr_read_b32 v62, a42
    v_accvgpr_read_b32 v63, a43
    v_cvt_pk_bf16_f32 v64, v60, v61
    v_cvt_pk_bf16_f32 v65, v62, v63
    ds_write_b64 v13, v[64:65] offset:3072
    v_accvgpr_read_b32 v76, a44
    v_accvgpr_read_b32 v77, a45
    v_accvgpr_read_b32 v78, a46
    v_accvgpr_read_b32 v79, a47
    v_cvt_pk_bf16_f32 v80, v76, v77
    v_cvt_pk_bf16_f32 v81, v78, v79
    ds_write_b64 v13, v[80:81] offset:4096
    v_accvgpr_read_b32 v28, a48
    v_accvgpr_read_b32 v29, a49
    v_accvgpr_read_b32 v30, a50
    v_accvgpr_read_b32 v31, a51
    v_cvt_pk_bf16_f32 v32, v28, v29
    v_cvt_pk_bf16_f32 v33, v30, v31
    ds_write_b64 v13, v[32:33] offset:5120
    v_accvgpr_read_b32 v44, a52
    v_accvgpr_read_b32 v45, a53
    v_accvgpr_read_b32 v46, a54
    v_accvgpr_read_b32 v47, a55
    v_cvt_pk_bf16_f32 v48, v44, v45
    v_cvt_pk_bf16_f32 v49, v46, v47
    ds_write_b64 v13, v[48:49] offset:6144
    v_lshlrev_b32 v7, 4, v1
    v_mul_u32_u24 v5, 7168, v2
    v_add_u32 v7, v7, v5
    v_lshrrev_b32 v5, 3, v1
    v_and_b32 v5, 3, v5
    v_and_b32 v6, 3, v1
    v_xor_b32 v6, v6, v5
    v_lshrrev_b32 v5, 2, v1
    v_lshlrev_b32 v5, 6, v5
    v_lshl_add_u32 v5, v6, 4, v5
    s_lshr_b32 s27, s20, 1
    s_and_b32 s26, s20, 1
    s_mul_i32 s26, s26, 224
    s_mul_i32 s27, s27, 448
    s_add_u32 s26, s26, s27
    s_mul_i32 s27, s21, 14336
    s_add_u32 s26, s26, s27
    v_mul_u32_u24 v10, 7168, v8
    v_mul_u32_u24 v11, 112, v9
    v_add3_u32 v10, v10, v11, s26
    v_lshlrev_b32 v10, 6, v10
    v_add_u32 v5, v5, v10
    s_waitcnt lgkmcnt(0)
    ds_read_b128 v[28:31], v7 offset:0
    ds_read_b128 v[32:35], v7 offset:1024
    ds_read_b128 v[36:39], v7 offset:2048
    ds_read_b128 v[40:43], v7 offset:3072
    ds_read_b128 v[44:47], v7 offset:4096
    ds_read_b128 v[48:51], v7 offset:5120
    ds_read_b128 v[52:55], v7 offset:6144
    s_waitcnt lgkmcnt(6)
    s_mov_b32 s28, 67108864
    buffer_store_dwordx4 v[28:31], v5, s[4:7], s28 offen sc0 sc1
    s_waitcnt lgkmcnt(5)
    s_mov_b32 s28, 67109888
    buffer_store_dwordx4 v[32:35], v5, s[4:7], s28 offen sc0 sc1
    s_waitcnt lgkmcnt(4)
    s_mov_b32 s28, 67110912
    buffer_store_dwordx4 v[36:39], v5, s[4:7], s28 offen sc0 sc1
    s_waitcnt lgkmcnt(3)
    s_mov_b32 s28, 67111936
    buffer_store_dwordx4 v[40:43], v5, s[4:7], s28 offen sc0 sc1
    s_waitcnt lgkmcnt(2)
    s_mov_b32 s28, 67112960
    buffer_store_dwordx4 v[44:47], v5, s[4:7], s28 offen sc0 sc1
    s_waitcnt lgkmcnt(1)
    s_mov_b32 s28, 67113984
    buffer_store_dwordx4 v[48:51], v5, s[4:7], s28 offen sc0 sc1
    s_waitcnt lgkmcnt(0)
    s_mov_b32 s28, 67115008
    buffer_store_dwordx4 v[52:55], v5, s[4:7], s28 offen sc0 sc1
    s_mov_b32 s22, 64
    s_waitcnt vmcnt(0) lgkmcnt(0)
    s_barrier
    s_cmp_lg_u32 s14, 0
    s_cbranch_scc1 chain_kernel_sig5
    s_mov_b64 exec, 1
    v_mov_b32 v6, s22
    v_mov_b32 v5, 1
    buffer_atomic_add v5, v6, s[8:11], 0 offen sc1
    s_mov_b64 exec, -1
chain_kernel_sig5:
    s_branch chain_kernel_wu1
chain_kernel_wtr0:
    s_sub_u32 s18, s19, 128
chain_kernel_wtr:
    s_mov_b32 s3, s18
    s_mov_b32 s58, 1605632
    s_mov_b32 s59, 0x00020000
    s_cmp_ge_u32 s3, 392
    s_cbranch_scc1 chain_kernel_ftr6_d
    s_mov_b64 s[56:57], s[78:79]
    s_mov_b32 s51, 0
    s_cmp_ge_u32 s3, 196
    s_cbranch_scc0 chain_kernel_ftr6_g
    s_sub_u32 s3, s3, 196
    s_mov_b64 s[56:57], s[80:81]
    s_mov_b32 s51, 14336
chain_kernel_ftr6_g:
    s_mov_b32 s42, 153391690
    s_mul_hi_u32 s42, s3, s42
    s_mul_i32 s43, s42, 28
    s_sub_u32 s43, s3, s43
    s_mul_i32 s45, s42, 229376
    s_lshl_b32 s46, s43, 7
    s_add_u32 s45, s45, s46
    s_mov_b32 s47, 3584
    s_mul_i32 s53, s43, 114688
    s_lshl_b32 s46, s42, 7
    s_add_u32 s53, s53, s46
    s_add_u32 s53, s53, s51
    s_add_u32 s53, s53, 6291456
    s_mov_b32 s49, 896
    s_mov_b32 s50, 32
    s_branch chain_kernel_ftr6_go
chain_kernel_ftr6_d:
    s_sub_u32 s3, s3, 392
    s_mov_b64 s[56:57], s[82:83]
    s_mov_b32 s42, 613566757
    s_mul_hi_u32 s42, s3, s42
    s_mul_i32 s43, s42, 7
    s_sub_u32 s43, s3, s43
    s_mul_i32 s45, s42, 57344
    s_lshl_b32 s46, s43, 7
    s_add_u32 s45, s45, s46
    s_mov_b32 s47, 896
    s_mul_i32 s53, s43, 229376
    s_lshl_b32 s46, s42, 7
    s_add_u32 s53, s53, s46
    s_add_u32 s53, s53, 10485760
    s_mov_b32 s49, 3584
    s_mov_b32 s50, 16
chain_kernel_ftr6_go:
    v_and_b32 v3, 7, v0
    v_lshrrev_b32 v4, 3, v0
    v_mul_lo_u32 v5, v4, s47
    v_lshl_add_u32 v5, v3, 4, v5
    s_lshl_b32 s52, s47, 5
    s_add_u32 s52, s52, s45
    buffer_load_dwordx4 v[8:11], v5, s[56:59], s45 offen
    buffer_load_dwordx4 v[12:15], v5, s[56:59], s52 offen
    v_mul_u32_u24 v6, 144, v4
    v_lshl_add_u32 v6, v3, 4, v6
    s_waitcnt vmcnt(1)
    ds_write_b128 v6, v[8:11]
    s_waitcnt vmcnt(0)
    ds_write_b128 v6, v[12:15] offset:4608
    s_waitcnt lgkmcnt(0)
    s_barrier
    v_mul_u32_u24 v6, 1152, v3
    v_lshl_add_u32 v6, v4, 1, v6
    ds_read_u16 v8, v6 offset:0
    ds_read_u16 v24, v6 offset:144
    ds_read_u16 v9, v6 offset:288
    ds_read_u16 v25, v6 offset:432
    ds_read_u16 v10, v6 offset:576
    ds_read_u16 v26, v6 offset:720
    ds_read_u16 v11, v6 offset:864
    ds_read_u16 v27, v6 offset:1008
    ds_read_u16 v12, v6 offset:64
    ds_read_u16 v28, v6 offset:208
    ds_read_u16 v13, v6 offset:352
    ds_read_u16 v29, v6 offset:496
    ds_read_u16 v14, v6 offset:640
    ds_read_u16 v30, v6 offset:784
    ds_read_u16 v15, v6 offset:928
    ds_read_u16 v31, v6 offset:1072
    v_add_u32 v7, 0, v4
    v_lshrrev_b32 v16, 4, v7
    v_mul_lo_u32 v16, v16, s50
    v_and_b32 v7, 15, v7
    v_add_u32 v7, v7, v16
    v_mul_lo_u32 v7, v7, s49
    v_lshl_add_u32 v17, v3, 4, v7
    v_add_u32 v7, 32, v4
    v_lshrrev_b32 v16, 4, v7
    v_mul_lo_u32 v16, v16, s50
    v_and_b32 v7, 15, v7
    v_add_u32 v7, v7, v16
    v_mul_lo_u32 v7, v7, s49
    v_lshl_add_u32 v18, v3, 4, v7
    s_waitcnt lgkmcnt(0)
    v_lshl_or_b32 v8, v24, 16, v8
    v_lshl_or_b32 v9, v25, 16, v9
    v_lshl_or_b32 v10, v26, 16, v10
    v_lshl_or_b32 v11, v27, 16, v11
    v_lshl_or_b32 v12, v28, 16, v12
    v_lshl_or_b32 v13, v29, 16, v13
    v_lshl_or_b32 v14, v30, 16, v14
    v_lshl_or_b32 v15, v31, 16, v15
    buffer_store_dwordx4 v[8:11], v17, s[4:7], s53 offen sc0 sc1
    buffer_store_dwordx4 v[12:15], v18, s[4:7], s53 offen sc0 sc1
    s_waitcnt lgkmcnt(0)
    s_barrier
    s_add_u32 s18, s18, 96
    s_cmp_lt_u32 s18, 588
    s_cbranch_scc1 chain_kernel_wtr
    v_and_b32 v3, 15, v1
    v_lshrrev_b32 v4, 4, v1
    s_mov_b32 s22, 44
    s_waitcnt vmcnt(0) lgkmcnt(0)
    s_barrier
    s_cmp_lg_u32 s14, 0
    s_cbranch_scc1 chain_kernel_sig7
    s_mov_b64 exec, 1
    v_mov_b32 v6, s22
    v_mov_b32 v5, 1
    buffer_atomic_add v5, v6, s[8:11], 0 offen sc1
    s_mov_b64 exec, -1
chain_kernel_sig7:
chain_kernel_wu1:
    s_and_b32 s20, s19, 31
    s_lshr_b32 s21, s19, 5
    s_add_u32 s21, s21, 1
    s_mul_i32 s24, s21, 229376
    s_add_u32 s24, s24, 0
    s_mul_i32 s25, s20, 200704
    s_add_u32 s25, s25, 19005440
    v_lshrrev_b32 v6, 3, v1
    v_and_b32 v5, 7, v1
    v_xor_b32 v5, v5, v6
    v_lshl_add_u32 v6, v2, 3, v6
    v_mul_u32_u24 v16, 896, v6
    v_lshl_add_u32 v16, v5, 4, v16
    v_mul_u32_u24 v17, 896, v6
    v_lshl_add_u32 v17, v5, 4, v17
    s_add_u32 s60, s24, 0
    s_add_u32 s61, s24, 28672
    s_add_u32 s62, s24, 57344
    s_add_u32 s63, s24, 86016
    s_add_u32 s64, s24, 114688
    s_add_u32 s65, s24, 143360
    s_add_u32 s66, s24, 172032
    s_add_u32 s67, s24, 200704
    s_add_u32 s68, s25, 0
    s_add_u32 s69, s25, 28672
    s_add_u32 s70, s25, 57344
    s_add_u32 s71, s25, 86016
    s_add_u32 s72, s25, 114688
    s_add_u32 s73, s25, 143360
    s_add_u32 s74, s25, 172032
    s_lshl_b32 s75, s14, 10
    v_and_b32 v7, 7, v3
    v_xor_b32 v7, v7, v4
    v_lshlrev_b32 v7, 4, v7
    v_lshl_add_u32 v7, v3, 7, v7
    v_lshrrev_b32 v8, 1, v2
    v_and_b32 v9, 1, v2
    v_mul_u32_u24 v10, 16384, v8
    v_mul_u32_u24 v11, 14336, v9
    v_add_u32 v10, v10, v7
    v_add_u32 v11, v11, v7
    v_add_u32 v11, 32768, v11
    v_mov_b32 v18, v10
    v_xor_b32 v20, 64, v10
    v_add_u32 v19, 61440, v18
    v_add_u32 v21, 61440, v20
    v_mov_b32 v22, v11
    v_xor_b32 v24, 64, v11
    v_add_u32 v23, 61440, v22
    v_add_u32 v25, 61440, v24
    s_add_u32 m0, s75, 0
    s_nop 0
    buffer_load_dwordx4 v16, s[4:7], s60 offen  lds
    s_add_u32 s60, s60, 128
    s_add_u32 m0, s75, 4096
    s_nop 0
    buffer_load_dwordx4 v16, s[4:7], s61 offen  lds
    s_add_u32 s61, s61, 128
    s_add_u32 m0, s75, 8192
    s_nop 0
    buffer_load_dwordx4 v16, s[4:7], s62 offen  lds
    s_add_u32 s62, s62, 128
    s_add_u32 m0, s75, 12288
    s_nop 0
    buffer_load_dwordx4 v16, s[4:7], s63 offen  lds
    s_add_u32 s63, s63, 128
    s_add_u32 m0, s75, 16384
    s_nop 0
    buffer_load_dwordx4 v16, s[4:7], s64 offen  lds
    s_add_u32 s64, s64, 128
    s_add_u32 m0, s75, 20480
    s_nop 0
    buffer_load_dwordx4 v16, s[4:7], s65 offen  lds
    s_add_u32 s65, s65, 128
    s_add_u32 m0, s75, 24576
    s_nop 0
    buffer_load_dwordx4 v16, s[4:7], s66 offen  lds
    s_add_u32 s66, s66, 128
    s_add_u32 m0, s75, 28672
    s_nop 0
    buffer_load_dwordx4 v16, s[4:7], s67 offen  lds
    s_add_u32 s67, s67, 128
    s_add_u32 m0, s75, 32768
    s_nop 0
    buffer_load_dwordx4 v17, s[4:7], s68 offen  lds
    s_add_u32 s68, s68, 128
    s_add_u32 m0, s75, 36864
    s_nop 0
    buffer_load_dwordx4 v17, s[4:7], s69 offen  lds
    s_add_u32 s69, s69, 128
    s_add_u32 m0, s75, 40960
    s_nop 0
    buffer_load_dwordx4 v17, s[4:7], s70 offen  lds
    s_add_u32 s70, s70, 128
    s_add_u32 m0, s75, 45056
    s_nop 0
    buffer_load_dwordx4 v17, s[4:7], s71 offen  lds
    s_add_u32 s71, s71, 128
    s_add_u32 m0, s75, 49152
    s_nop 0
    buffer_load_dwordx4 v17, s[4:7], s72 offen  lds
    s_add_u32 s72, s72, 128
    s_add_u32 m0, s75, 53248
    s_nop 0
    buffer_load_dwordx4 v17, s[4:7], s73 offen  lds
    s_add_u32 s73, s73, 128
    s_add_u32 m0, s75, 57344
    s_nop 0
    buffer_load_dwordx4 v17, s[4:7], s74 offen  lds
    s_add_u32 s74, s74, 128
    s_add_u32 m0, s75, 61440
    s_nop 0
    buffer_load_dwordx4 v16, s[4:7], s60 offen  lds
    s_add_u32 s60, s60, 128
    s_add_u32 m0, s75, 65536
    s_nop 0
    buffer_load_dwordx4 v16, s[4:7], s61 offen  lds
    s_add_u32 s61, s61, 128
    s_add_u32 m0, s75, 69632
    s_nop 0
    buffer_load_dwordx4 v16, s[4:7], s62 offen  lds
    s_add_u32 s62, s62, 128
    s_add_u32 m0, s75, 73728
    s_nop 0
    buffer_load_dwordx4 v16, s[4:7], s63 offen  lds
    s_add_u32 s63, s63, 128
    s_add_u32 m0, s75, 77824
    s_nop 0
    buffer_load_dwordx4 v16, s[4:7], s64 offen  lds
    s_add_u32 s64, s64, 128
    s_add_u32 m0, s75, 81920
    s_nop 0
    buffer_load_dwordx4 v16, s[4:7], s65 offen  lds
    s_add_u32 s65, s65, 128
    s_add_u32 m0, s75, 86016
    s_nop 0
    buffer_load_dwordx4 v16, s[4:7], s66 offen  lds
    s_add_u32 s66, s66, 128
    s_add_u32 m0, s75, 90112
    s_nop 0
    buffer_load_dwordx4 v16, s[4:7], s67 offen  lds
    s_add_u32 s67, s67, 128
    s_add_u32 m0, s75, 94208
    s_nop 0
    buffer_load_dwordx4 v17, s[4:7], s68 offen  lds
    s_add_u32 s68, s68, 128
    s_add_u32 m0, s75, 98304
    s_nop 0
    buffer_load_dwordx4 v17, s[4:7], s69 offen  lds
    s_add_u32 s69, s69, 128
    s_add_u32 m0, s75, 102400
    s_nop 0
    buffer_load_dwordx4 v17, s[4:7], s70 offen  lds
    s_add_u32 s70, s70, 128
    s_add_u32 m0, s75, 106496
    s_nop 0
    buffer_load_dwordx4 v17, s[4:7], s71 offen  lds
    s_add_u32 s71, s71, 128
    s_add_u32 m0, s75, 110592
    s_nop 0
    buffer_load_dwordx4 v17, s[4:7], s72 offen  lds
    s_add_u32 s72, s72, 128
    s_add_u32 m0, s75, 114688
    s_nop 0
    buffer_load_dwordx4 v17, s[4:7], s73 offen  lds
    s_add_u32 s73, s73, 128
    s_add_u32 m0, s75, 118784
    s_nop 0
    buffer_load_dwordx4 v17, s[4:7], s74 offen  lds
    s_add_u32 s74, s74, 128
    s_waitcnt vmcnt(15)
    s_barrier
    ds_read_b128 v[60:63], v22 offset:0
    ds_read_b128 v[64:67], v22 offset:2048
    ds_read_b128 v[68:71], v22 offset:4096
    ds_read_b128 v[72:75], v22 offset:6144
    ds_read_b128 v[76:79], v22 offset:8192
    ds_read_b128 v[80:83], v22 offset:10240
    ds_read_b128 v[84:87], v22 offset:12288
    ds_read_b128 v[28:31], v18 offset:0
    ds_read_b128 v[32:35], v18 offset:2048
    ds_read_b128 v[36:39], v18 offset:4096
    ds_read_b128 v[40:43], v18 offset:6144
    ds_read_b128 v[44:47], v18 offset:8192
    ds_read_b128 v[48:51], v18 offset:10240
    ds_read_b128 v[52:55], v18 offset:12288
    ds_read_b128 v[56:59], v18 offset:14336
    s_waitcnt lgkmcnt(0)
    v_mfma_f32_16x16x32_bf16 a[0:3], v[28:31], v[60:63], 0
    v_mfma_f32_16x16x32_bf16 a[4:7], v[28:31], v[64:67], 0
    v_mfma_f32_16x16x32_bf16 a[8:11], v[28:31], v[68:71], 0
    v_mfma_f32_16x16x32_bf16 a[12:15], v[28:31], v[72:75], 0
    ds_read_b128 v[120:123], v24 offset:0
    v_mfma_f32_16x16x32_bf16 a[16:19], v[28:31], v[76:79], 0
    v_mfma_f32_16x16x32_bf16 a[20:23], v[28:31], v[80:83], 0
    v_mfma_f32_16x16x32_bf16 a[24:27], v[28:31], v[84:87], 0
    v_mfma_f32_16x16x32_bf16 a[28:31], v[32:35], v[60:63], 0
    ds_read_b128 v[124:127], v24 offset:2048
    v_mfma_f32_16x16x32_bf16 a[32:35], v[32:35], v[64:67], 0
    v_mfma_f32_16x16x32_bf16 a[36:39], v[32:35], v[68:71], 0
    v_mfma_f32_16x16x32_bf16 a[40:43], v[32:35], v[72:75], 0
    v_mfma_f32_16x16x32_bf16 a[44:47], v[32:35], v[76:79], 0
    ds_read_b128 v[128:131], v24 offset:4096
    v_mfma_f32_16x16x32_bf16 a[48:51], v[32:35], v[80:83], 0
    v_mfma_f32_16x16x32_bf16 a[52:55], v[32:35], v[84:87], 0
    v_mfma_f32_16x16x32_bf16 a[56:59], v[36:39], v[60:63], 0
    ds_read_b128 v[132:135], v24 offset:6144
    v_mfma_f32_16x16x32_bf16 a[60:63], v[36:39], v[64:67], 0
    v_mfma_f32_16x16x32_bf16 a[64:67], v[36:39], v[68:71], 0
    v_mfma_f32_16x16x32_bf16 a[68:71], v[36:39], v[72:75], 0
    v_mfma_f32_16x16x32_bf16 a[72:75], v[36:39], v[76:79], 0
    ds_read_b128 v[136:139], v24 offset:8192
    v_mfma_f32_16x16x32_bf16 a[76:79], v[36:39], v[80:83], 0
    v_mfma_f32_16x16x32_bf16 a[80:83], v[36:39], v[84:87], 0
    v_mfma_f32_16x16x32_bf16 a[84:87], v[40:43], v[60:63], 0
    v_mfma_f32_16x16x32_bf16 a[88:91], v[40:43], v[64:67], 0
    ds_read_b128 v[140:143], v24 offset:10240
    v_mfma_f32_16x16x32_bf16 a[92:95], v[40:43], v[68:71], 0
    v_mfma_f32_16x16x32_bf16 a[96:99], v[40:43], v[72:75], 0
    v_mfma_f32_16x16x32_bf16 a[100:103], v[40:43], v[76:79], 0
    v_mfma_f32_16x16x32_bf16 a[104:107], v[40:43], v[80:83], 0
    ds_read_b128 v[144:147], v24 offset:12288
    v_mfma_f32_16x16x32_bf16 a[108:111], v[40:43], v[84:87], 0
    v_mfma_f32_16x16x32_bf16 a[112:115], v[44:47], v[60:63], 0
    v_mfma_f32_16x16x32_bf16 a[116:119], v[44:47], v[64:67], 0
    ds_read_b128 v[88:91], v20 offset:0
    v_mfma_f32_16x16x32_bf16 a[120:123], v[44:47], v[68:71], 0
    v_mfma_f32_16x16x32_bf16 a[124:127], v[44:47], v[72:75], 0
    v_mfma_f32_16x16x32_bf16 a[128:131], v[44:47], v[76:79], 0
    v_mfma_f32_16x16x32_bf16 a[132:135], v[44:47], v[80:83], 0
    ds_read_b128 v[92:95], v20 offset:2048
    v_mfma_f32_16x16x32_bf16 a[136:139], v[44:47], v[84:87], 0
    v_mfma_f32_16x16x32_bf16 a[140:143], v[48:51], v[60:63], 0
    v_mfma_f32_16x16x32_bf16 a[144:147], v[48:51], v[64:67], 0
    v_mfma_f32_16x16x32_bf16 a[148:151], v[48:51], v[68:71], 0
    ds_read_b128 v[96:99], v20 offset:4096
    v_mfma_f32_16x16x32_bf16 a[152:155], v[48:51], v[72:75], 0
    v_mfma_f32_16x16x32_bf16 a[156:159], v[48:51], v[76:79], 0
    v_mfma_f32_16x16x32_bf16 a[160:163], v[48:51], v[80:83], 0
    v_mfma_f32_16x16x32_bf16 a[164:167], v[48:51], v[84:87], 0
    ds_read_b128 v[100:103], v20 offset:6144
    v_mfma_f32_16x16x32_bf16 a[168:171], v[52:55], v[60:63], 0
    v_mfma_f32_16x16x32_bf16 a[172:175], v[52:55], v[64:67], 0
    v_mfma_f32_16x16x32_bf16 a[176:179], v[52:55], v[68:71], 0
    ds_read_b128 v[104:107], v20 offset:8192
    v_mfma_f32_16x16x32_bf16 a[180:183], v[52:55], v[72:75], 0
    v_mfma_f32_16x16x32_bf16 a[184:187], v[52:55], v[76:79], 0
    v_mfma_f32_16x16x32_bf16 a[188:191], v[52:55], v[80:83], 0
    v_mfma_f32_16x16x32_bf16 a[192:195], v[52:55], v[84:87], 0
    ds_read_b128 v[108:111], v20 offset:10240
    v_mfma_f32_16x16x32_bf16 a[196:199], v[56:59], v[60:63], 0
    v_mfma_f32_16x16x32_bf16 a[200:203], v[56:59], v[64:67], 0
    v_mfma_f32_16x16x32_bf16 a[204:207], v[56:59], v[68:71], 0
    v_mfma_f32_16x16x32_bf16 a[208:211], v[56:59], v[72:75], 0
    ds_read_b128 v[112:115], v20 offset:12288
    v_mfma_f32_16x16x32_bf16 a[212:215], v[56:59], v[76:79], 0
    v_mfma_f32_16x16x32_bf16 a[216:219], v[56:59], v[80:83], 0
    v_mfma_f32_16x16x32_bf16 a[220:223], v[56:59], v[84:87], 0
    ds_read_b128 v[116:119], v20 offset:14336
    s_waitcnt lgkmcnt(0) vmcnt(0)
    s_barrier
    v_mfma_f32_16x16x32_bf16 a[0:3], v[88:91], v[120:123], a[0:3]
    v_mfma_f32_16x16x32_bf16 a[4:7], v[88:91], v[124:127], a[4:7]
    ds_read_b128 v[60:63], v23 offset:0
    v_mfma_f32_16x16x32_bf16 a[8:11], v[88:91], v[128:131], a[8:11]
    v_mfma_f32_16x16x32_bf16 a[12:15], v[88:91], v[132:135], a[12:15]
    s_add_u32 m0, s75, 0
    s_nop 0
    buffer_load_dwordx4 v16, s[4:7], s60 offen  lds
    s_add_u32 s60, s60, 128
    v_mfma_f32_16x16x32_bf16 a[16:19], v[88:91], v[136:139], a[16:19]
    v_mfma_f32_16x16x32_bf16 a[20:23], v[88:91], v[140:143], a[20:23]
    ds_read_b128 v[64:67], v23 offset:2048
    v_mfma_f32_16x16x32_bf16 a[24:27], v[88:91], v[144:147], a[24:27]
    v_mfma_f32_16x16x32_bf16 a[28:31], v[92:95], v[120:123], a[28:31]
    s_add_u32 m0, s75, 4096
    s_nop 0
    buffer_load_dwordx4 v16, s[4:7], s61 offen  lds
    s_add_u32 s61, s61, 128
    v_mfma_f32_16x16x32_bf16 a[32:35], v[92:95], v[124:127], a[32:35]
    v_mfma_f32_16x16x32_bf16 a[36:39], v[92:95], v[128:131], a[36:39]
    ds_read_b128 v[68:71], v23 offset:4096
    v_mfma_f32_16x16x32_bf16 a[40:43], v[92:95], v[132:135], a[40:43]
    v_mfma_f32_16x16x32_bf16 a[44:47], v[92:95], v[136:139], a[44:47]
    s_add_u32 m0, s75, 8192
    s_nop 0
    buffer_load_dwordx4 v16, s[4:7], s62 offen  lds
    s_add_u32 s62, s62, 128
    v_mfma_f32_16x16x32_bf16 a[48:51], v[92:95], v[140:143], a[48:51]
    v_mfma_f32_16x16x32_bf16 a[52:55], v[92:95], v[144:147], a[52:55]
    ds_read_b128 v[72:75], v23 offset:6144
    v_mfma_f32_16x16x32_bf16 a[56:59], v[96:99], v[120:123], a[56:59]
    s_add_u32 m0, s75, 12288
    s_nop 0
    buffer_load_dwordx4 v16, s[4:7], s63 offen  lds
    s_add_u32 s63, s63, 128
    v_mfma_f32_16x16x32_bf16 a[60:63], v[96:99], v[124:127], a[60:63]
    v_mfma_f32_16x16x32_bf16 a[64:67], v[96:99], v[128:131], a[64:67]
    ds_read_b128 v[76:79], v23 offset:8192
    v_mfma_f32_16x16x32_bf16 a[68:71], v[96:99], v[132:135], a[68:71]
    v_mfma_f32_16x16x32_bf16 a[72:75], v[96:99], v[136:139], a[72:75]
    s_add_u32 m0, s75, 16384
    s_nop 0
    buffer_load_dwordx4 v16, s[4:7], s64 offen  lds
    s_add_u32 s64, s64, 128
    v_mfma_f32_16x16x32_bf16 a[76:79], v[96:99], v[140:143], a[76:79]
    v_mfma_f32_16x16x32_bf16 a[80:83], v[96:99], v[144:147], a[80:83]
    ds_read_b128 v[80:83], v23 offset:10240
    v_mfma_f32_16x16x32_bf16 a[84:87], v[100:103], v[120:123], a[84:87]
    v_mfma_f32_16x16x32_bf16 a[88:91], v[100:103], v[124:127], a[88:91]
    s_add_u32 m0, s75, 20480
    s_nop 0
    buffer_load_dwordx4 v16, s[4:7], s65 offen  lds
    s_add_u32 s65, s65, 128
    v_mfma_f32_16x16x32_bf16 a[92:95], v[100:103], v[128:131], a[92:95]
    v_mfma_f32_16x16x32_bf16 a[96:99], v[100:103], v[132:135], a[96:99]
    ds_read_b128 v[84:87], v23 offset:12288
    v_mfma_f32_16x16x32_bf16 a[100:103], v[100:103], v[136:139], a[100:103]
    v_mfma_f32_16x16x32_bf16 a[104:107], v[100:103], v[140:143], a[104:107]
    s_add_u32 m0, s75, 24576
    s_nop 0
    buffer_load_dwordx4 v16, s[4:7], s66 offen  lds
    s_add_u32 s66, s66, 128
    v_mfma_f32_16x16x32_bf16 a[108:111], v[100:103], v[144:147], a[108:111]
    ds_read_b128 v[28:31], v19 offset:0
    v_mfma_f32_16x16x32_bf16 a[112:115], v[104:107], v[120:123], a[112:115]
    v_mfma_f32_16x16x32_bf16 a[116:119], v[104:107], v[124:127], a[116:119]
    s_add_u32 m0, s75, 28672
    s_nop 0
    buffer_load_dwordx4 v16, s[4:7], s67 offen  lds
    s_add_u32 s67, s67, 128
    v_mfma_f32_16x16x32_bf16 a[120:123], v[104:107], v[128:131], a[120:123]
    v_mfma_f32_16x16x32_bf16 a[124:127], v[104:107], v[132:135], a[124:127]
    ds_read_b128 v[32:35], v19 offset:2048
    v_mfma_f32_16x16x32_bf16 a[128:131], v[104:107], v[136:139], a[128:131]
    v_mfma_f32_16x16x32_bf16 a[132:135], v[104:107], v[140:143], a[132:135]
    s_add_u32 m0, s75, 32768
    s_nop 0
    buffer_load_dwordx4 v17, s[4:7], s68 offen  lds
    s_add_u32 s68, s68, 128
    v_mfma_f32_16x16x32_bf16 a[136:139], v[104:107], v[144:147], a[136:139]
    v_mfma_f32_16x16x32_bf16 a[140:143], v[108:111], v[120:123], a[140:143]
    ds_read_b128 v[36:39], v19 offset:4096
    v_mfma_f32_16x16x32_bf16 a[144:147], v[108:111], v[124:127], a[144:147]
    v_mfma_f32_16x16x32_bf16 a[148:151], v[108:111], v[128:131], a[148:151]
    s_add_u32 m0, s75, 36864
    s_nop 0
    buffer_load_dwordx4 v17, s[4:7], s69 offen  lds
    s_add_u32 s69, s69, 128
    v_mfma_f32_16x16x32_bf16 a[152:155], v[108:111], v[132:135], a[152:155]
    v_mfma_f32_16x16x32_bf16 a[156:159], v[108:111], v[136:139], a[156:159]
    ds_read_b128 v[40:43], v19 offset:6144
    v_mfma_f32_16x16x32_bf16 a[160:163], v[108:111], v[140:143], a[160:163]
    v_mfma_f32_16x16x32_bf16 a[164:167], v[108:111], v[144:147], a[164:167]
    s_add_u32 m0, s75, 40960
    s_nop 0
    buffer_load_dwordx4 v17, s[4:7], s70 offen  lds
    s_add_u32 s70, s70, 128
    v_mfma_f32_16x16x32_bf16 a[168:171], v[112:115], v[120:123], a[168:171]
    ds_read_b128 v[44:47], v19 offset:8192
    v_mfma_f32_16x16x32_bf16 a[172:175], v[112:115], v[124:127], a[172:175]
    v_mfma_f32_16x16x32_bf16 a[176:179], v[112:115], v[128:131], a[176:179]
    s_add_u32 m0, s75, 45056
    s_nop 0
    buffer_load_dwordx4 v17, s[4:7], s71 offen  lds
    s_add_u32 s71, s71, 128
    v_mfma_f32_16x16x32_bf16 a[180:183], v[112:115], v[132:135], a[180:183]
    v_mfma_f32_16x16x32_bf16 a[184:187], v[112:115], v[136:139], a[184:187]
    ds_read_b128 v[48:51], v19 offset:10240
    v_mfma_f32_16x16x32_bf16 a[188:191], v[112:115], v[140:143], a[188:191]
    v_mfma_f32_16x16x32_bf16 a[192:195], v[112:115], v[144:147], a[192:195]
    s_add_u32 m0, s75, 49152
    s_nop 0
    buffer_load_dwordx4 v17, s[4:7], s72 offen  lds
    s_add_u32 s72, s72, 128
    v_mfma_f32_16x16x32_bf16 a[196:199], v[116:119], v[120:123], a[196:199]
    v_mfma_f32_16x16x32_bf16 a[200:203], v[116:119], v[124:127], a[200:203]
    ds_read_b128 v[52:55], v19 offset:12288
    v_mfma_f32_16x16x32_bf16 a[204:207], v[116:119], v[128:131], a[204:207]
    v_mfma_f32_16x16x32_bf16 a[208:211], v[116:119], v[132:135], a[208:211]
    s_add_u32 m0, s75, 53248
    s_nop 0
    buffer_load_dwordx4 v17, s[4:7], s73 offen  lds
    s_add_u32 s73, s73, 128
    v_mfma_f32_16x16x32_bf16 a[212:215], v[116:119], v[136:139], a[212:215]
    v_mfma_f32_16x16x32_bf16 a[216:219], v[116:119], v[140:143], a[216:219]
    ds_read_b128 v[56:59], v19 offset:14336
    v_mfma_f32_16x16x32_bf16 a[220:223], v[116:119], v[144:147], a[220:223]
    s_add_u32 m0, s75, 57344
    s_nop 0
    buffer_load_dwordx4 v17, s[4:7], s74 offen  lds
    s_add_u32 s74, s74, 128
    s_waitcnt lgkmcnt(0)
    v_mfma_f32_16x16x32_bf16 a[0:3], v[28:31], v[60:63], a[0:3]
    v_mfma_f32_16x16x32_bf16 a[4:7], v[28:31], v[64:67], a[4:7]
    v_mfma_f32_16x16x32_bf16 a[8:11], v[28:31], v[68:71], a[8:11]
    v_mfma_f32_16x16x32_bf16 a[12:15], v[28:31], v[72:75], a[12:15]
    ds_read_b128 v[120:123], v25 offset:0
    v_mfma_f32_16x16x32_bf16 a[16:19], v[28:31], v[76:79], a[16:19]
    v_mfma_f32_16x16x32_bf16 a[20:23], v[28:31], v[80:83], a[20:23]
    v_mfma_f32_16x16x32_bf16 a[24:27], v[28:31], v[84:87], a[24:27]
    v_mfma_f32_16x16x32_bf16 a[28:31], v[32:35], v[60:63], a[28:31]
    ds_read_b128 v[124:127], v25 offset:2048
    v_mfma_f32_16x16x32_bf16 a[32:35], v[32:35], v[64:67], a[32:35]
    v_mfma_f32_16x16x32_bf16 a[36:39], v[32:35], v[68:71], a[36:39]
    v_mfma_f32_16x16x32_bf16 a[40:43], v[32:35], v[72:75], a[40:43]
    v_mfma_f32_16x16x32_bf16 a[44:47], v[32:35], v[76:79], a[44:47]
    ds_read_b128 v[128:131], v25 offset:4096
    v_mfma_f32_16x16x32_bf16 a[48:51], v[32:35], v[80:83], a[48:51]
    v_mfma_f32_16x16x32_bf16 a[52:55], v[32:35], v[84:87], a[52:55]
    v_mfma_f32_16x16x32_bf16 a[56:59], v[36:39], v[60:63], a[56:59]
    ds_read_b128 v[132:135], v25 offset:6144
    v_mfma_f32_16x16x32_bf16 a[60:63], v[36:39], v[64:67], a[60:63]
    v_mfma_f32_16x16x32_bf16 a[64:67], v[36:39], v[68:71], a[64:67]
    v_mfma_f32_16x16x32_bf16 a[68:71], v[36:39], v[72:75], a[68:71]
    v_mfma_f32_16x16x32_bf16 a[72:75], v[36:39], v[76:79], a[72:75]
    ds_read_b128 v[136:139], v25 offset:8192
    v_mfma_f32_16x16x32_bf16 a[76:79], v[36:39], v[80:83], a[76:79]
    v_mfma_f32_16x16x32_bf16 a[80:83], v[36:39], v[84:87], a[80:83]
    v_mfma_f32_16x16x32_bf16 a[84:87], v[40:43], v[60:63], a[84:87]
    v_mfma_f32_16x16x32_bf16 a[88:91], v[40:43], v[64:67], a[88:91]
    ds_read_b128 v[140:143], v25 offset:10240
    v_mfma_f32_16x16x32_bf16 a[92:95], v[40:43], v[68:71], a[92:95]
    v_mfma_f32_16x16x32_bf16 a[96:99], v[40:43], v[72:75], a[96:99]
    v_mfma_f32_16x16x32_bf16 a[100:103], v[40:43], v[76:79], a[100:103]
    v_mfma_f32_16x16x32_bf16 a[104:107], v[40:43], v[80:83], a[104:107]
    ds_read_b128 v[144:147], v25 offset:12288
    v_mfma_f32_16x16x32_bf16 a[108:111], v[40:43], v[84:87], a[108:111]
    v_mfma_f32_16x16x32_bf16 a[112:115], v[44:47], v[60:63], a[112:115]
    v_mfma_f32_16x16x32_bf16 a[116:119], v[44:47], v[64:67], a[116:119]
    ds_read_b128 v[88:91], v21 offset:0
    v_mfma_f32_16x16x32_bf16 a[120:123], v[44:47], v[68:71], a[120:123]
    v_mfma_f32_16x16x32_bf16 a[124:127], v[44:47], v[72:75], a[124:127]
    v_mfma_f32_16x16x32_bf16 a[128:131], v[44:47], v[76:79], a[128:131]
    v_mfma_f32_16x16x32_bf16 a[132:135], v[44:47], v[80:83], a[132:135]
    ds_read_b128 v[92:95], v21 offset:2048
    v_mfma_f32_16x16x32_bf16 a[136:139], v[44:47], v[84:87], a[136:139]
    v_mfma_f32_16x16x32_bf16 a[140:143], v[48:51], v[60:63], a[140:143]
    v_mfma_f32_16x16x32_bf16 a[144:147], v[48:51], v[64:67], a[144:147]
    v_mfma_f32_16x16x32_bf16 a[148:151], v[48:51], v[68:71], a[148:151]
    ds_read_b128 v[96:99], v21 offset:4096
    v_mfma_f32_16x16x32_bf16 a[152:155], v[48:51], v[72:75], a[152:155]
    v_mfma_f32_16x16x32_bf16 a[156:159], v[48:51], v[76:79], a[156:159]
    v_mfma_f32_16x16x32_bf16 a[160:163], v[48:51], v[80:83], a[160:163]
    v_mfma_f32_16x16x32_bf16 a[164:167], v[48:51], v[84:87], a[164:167]
    ds_read_b128 v[100:103], v21 offset:6144
    v_mfma_f32_16x16x32_bf16 a[168:171], v[52:55], v[60:63], a[168:171]
    v_mfma_f32_16x16x32_bf16 a[172:175], v[52:55], v[64:67], a[172:175]
    v_mfma_f32_16x16x32_bf16 a[176:179], v[52:55], v[68:71], a[176:179]
    ds_read_b128 v[104:107], v21 offset:8192
    v_mfma_f32_16x16x32_bf16 a[180:183], v[52:55], v[72:75], a[180:183]
    v_mfma_f32_16x16x32_bf16 a[184:187], v[52:55], v[76:79], a[184:187]
    v_mfma_f32_16x16x32_bf16 a[188:191], v[52:55], v[80:83], a[188:191]
    v_mfma_f32_16x16x32_bf16 a[192:195], v[52:55], v[84:87], a[192:195]
    ds_read_b128 v[108:111], v21 offset:10240
    v_mfma_f32_16x16x32_bf16 a[196:199], v[56:59], v[60:63], a[196:199]
    v_mfma_f32_16x16x32_bf16 a[200:203], v[56:59], v[64:67], a[200:203]
    v_mfma_f32_16x16x32_bf16 a[204:207], v[56:59], v[68:71], a[204:207]
    v_mfma_f32_16x16x32_bf16 a[208:211], v[56:59], v[72:75], a[208:211]
    ds_read_b128 v[112:115], v21 offset:12288
    v_mfma_f32_16x16x32_bf16 a[212:215], v[56:59], v[76:79], a[212:215]
    v_mfma_f32_16x16x32_bf16 a[216:219], v[56:59], v[80:83], a[216:219]
    v_mfma_f32_16x16x32_bf16 a[220:223], v[56:59], v[84:87], a[220:223]
    ds_read_b128 v[116:119], v21 offset:14336
    s_waitcnt lgkmcnt(0) vmcnt(0)
    s_barrier
    v_mfma_f32_16x16x32_bf16 a[0:3], v[88:91], v[120:123], a[0:3]
    v_mfma_f32_16x16x32_bf16 a[4:7], v[88:91], v[124:127], a[4:7]
    ds_read_b128 v[60:63], v22 offset:0
    v_mfma_f32_16x16x32_bf16 a[8:11], v[88:91], v[128:131], a[8:11]
    v_mfma_f32_16x16x32_bf16 a[12:15], v[88:91], v[132:135], a[12:15]
    s_add_u32 m0, s75, 61440
    s_nop 0
    buffer_load_dwordx4 v16, s[4:7], s60 offen  lds
    s_add_u32 s60, s60, 128
    v_mfma_f32_16x16x32_bf16 a[16:19], v[88:91], v[136:139], a[16:19]
    v_mfma_f32_16x16x32_bf16 a[20:23], v[88:91], v[140:143], a[20:23]
    ds_read_b128 v[64:67], v22 offset:2048
    v_mfma_f32_16x16x32_bf16 a[24:27], v[88:91], v[144:147], a[24:27]
    v_mfma_f32_16x16x32_bf16 a[28:31], v[92:95], v[120:123], a[28:31]
    s_add_u32 m0, s75, 65536
    s_nop 0
    buffer_load_dwordx4 v16, s[4:7], s61 offen  lds
    s_add_u32 s61, s61, 128
    v_mfma_f32_16x16x32_bf16 a[32:35], v[92:95], v[124:127], a[32:35]
    v_mfma_f32_16x16x32_bf16 a[36:39], v[92:95], v[128:131], a[36:39]
    ds_read_b128 v[68:71], v22 offset:4096
    v_mfma_f32_16x16x32_bf16 a[40:43], v[92:95], v[132:135], a[40:43]
    v_mfma_f32_16x16x32_bf16 a[44:47], v[92:95], v[136:139], a[44:47]
    s_add_u32 m0, s75, 69632
    s_nop 0
    buffer_load_dwordx4 v16, s[4:7], s62 offen  lds
    s_add_u32 s62, s62, 128
    v_mfma_f32_16x16x32_bf16 a[48:51], v[92:95], v[140:143], a[48:51]
    v_mfma_f32_16x16x32_bf16 a[52:55], v[92:95], v[144:147], a[52:55]
    ds_read_b128 v[72:75], v22 offset:6144
    v_mfma_f32_16x16x32_bf16 a[56:59], v[96:99], v[120:123], a[56:59]
    s_add_u32 m0, s75, 73728
    s_nop 0
    buffer_load_dwordx4 v16, s[4:7], s63 offen  lds
    s_add_u32 s63, s63, 128
    v_mfma_f32_16x16x32_bf16 a[60:63], v[96:99], v[124:127], a[60:63]
    v_mfma_f32_16x16x32_bf16 a[64:67], v[96:99], v[128:131], a[64:67]
    ds_read_b128 v[76:79], v22 offset:8192
    v_mfma_f32_16x16x32_bf16 a[68:71], v[96:99], v[132:135], a[68:71]
    v_mfma_f32_16x16x32_bf16 a[72:75], v[96:99], v[136:139], a[72:75]
    s_add_u32 m0, s75, 77824
    s_nop 0
    buffer_load_dwordx4 v16, s[4:7], s64 offen  lds
    s_add_u32 s64, s64, 128
    v_mfma_f32_16x16x32_bf16 a[76:79], v[96:99], v[140:143], a[76:79]
    v_mfma_f32_16x16x32_bf16 a[80:83], v[96:99], v[144:147], a[80:83]
    ds_read_b128 v[80:83], v22 offset:10240
    v_mfma_f32_16x16x32_bf16 a[84:87], v[100:103], v[120:123], a[84:87]
    v_mfma_f32_16x16x32_bf16 a[88:91], v[100:103], v[124:127], a[88:91]
    s_add_u32 m0, s75, 81920
    s_nop 0
    buffer_load_dwordx4 v16, s[4:7], s65 offen  lds
    s_add_u32 s65, s65, 128
    v_mfma_f32_16x16x32_bf16 a[92:95], v[100:103], v[128:131], a[92:95]
    v_mfma_f32_16x16x32_bf16 a[96:99], v[100:103], v[132:135], a[96:99]
    ds_read_b128 v[84:87], v22 offset:12288
    v_mfma_f32_16x16x32_bf16 a[100:103], v[100:103], v[136:139], a[100:103]
    v_mfma_f32_16x16x32_bf16 a[104:107], v[100:103], v[140:143], a[104:107]
    s_add_u32 m0, s75, 86016
    s_nop 0
    buffer_load_dwordx4 v16, s[4:7], s66 offen  lds
    s_add_u32 s66, s66, 128
    v_mfma_f32_16x16x32_bf16 a[108:111], v[100:103], v[144:147], a[108:111]
    ds_read_b128 v[28:31], v18 offset:0
    v_mfma_f32_16x16x32_bf16 a[112:115], v[104:107], v[120:123], a[112:115]
    v_mfma_f32_16x16x32_bf16 a[116:119], v[104:107], v[124:127], a[116:119]
    s_add_u32 m0, s75, 90112
    s_nop 0
    buffer_load_dwordx4 v16, s[4:7], s67 offen  lds
    s_add_u32 s67, s67, 128
    v_mfma_f32_16x16x32_bf16 a[120:123], v[104:107], v[128:131], a[120:123]
    v_mfma_f32_16x16x32_bf16 a[124:127], v[104:107], v[132:135], a[124:127]
    ds_read_b128 v[32:35], v18 offset:2048
    v_mfma_f32_16x16x32_bf16 a[128:131], v[104:107], v[136:139], a[128:131]
    v_mfma_f32_16x16x32_bf16 a[132:135], v[104:107], v[140:143], a[132:135]
    s_add_u32 m0, s75, 94208
    s_nop 0
    buffer_load_dwordx4 v17, s[4:7], s68 offen  lds
    s_add_u32 s68, s68, 128
    v_mfma_f32_16x16x32_bf16 a[136:139], v[104:107], v[144:147], a[136:139]
    v_mfma_f32_16x16x32_bf16 a[140:143], v[108:111], v[120:123], a[140:143]
    ds_read_b128 v[36:39], v18 offset:4096
    v_mfma_f32_16x16x32_bf16 a[144:147], v[108:111], v[124:127], a[144:147]
    v_mfma_f32_16x16x32_bf16 a[148:151], v[108:111], v[128:131], a[148:151]
    s_add_u32 m0, s75, 98304
    s_nop 0
    buffer_load_dwordx4 v17, s[4:7], s69 offen  lds
    s_add_u32 s69, s69, 128
    v_mfma_f32_16x16x32_bf16 a[152:155], v[108:111], v[132:135], a[152:155]
    v_mfma_f32_16x16x32_bf16 a[156:159], v[108:111], v[136:139], a[156:159]
    ds_read_b128 v[40:43], v18 offset:6144
    v_mfma_f32_16x16x32_bf16 a[160:163], v[108:111], v[140:143], a[160:163]
    v_mfma_f32_16x16x32_bf16 a[164:167], v[108:111], v[144:147], a[164:167]
    s_add_u32 m0, s75, 102400
    s_nop 0
    buffer_load_dwordx4 v17, s[4:7], s70 offen  lds
    s_add_u32 s70, s70, 128
    v_mfma_f32_16x16x32_bf16 a[168:171], v[112:115], v[120:123], a[168:171]
    ds_read_b128 v[44:47], v18 offset:8192
    v_mfma_f32_16x16x32_bf16 a[172:175], v[112:115], v[124:127], a[172:175]
    v_mfma_f32_16x16x32_bf16 a[176:179], v[112:115], v[128:131], a[176:179]
    s_add_u32 m0, s75, 106496
    s_nop 0
    buffer_load_dwordx4 v17, s[4:7], s71 offen  lds
    s_add_u32 s71, s71, 128
    v_mfma_f32_16x16x32_bf16 a[180:183], v[112:115], v[132:135], a[180:183]
    v_mfma_f32_16x16x32_bf16 a[184:187], v[112:115], v[136:139], a[184:187]
    ds_read_b128 v[48:51], v18 offset:10240
    v_mfma_f32_16x16x32_bf16 a[188:191], v[112:115], v[140:143], a[188:191]
    v_mfma_f32_16x16x32_bf16 a[192:195], v[112:115], v[144:147], a[192:195]
    s_add_u32 m0, s75, 110592
    s_nop 0
    buffer_load_dwordx4 v17, s[4:7], s72 offen  lds
    s_add_u32 s72, s72, 128
    v_mfma_f32_16x16x32_bf16 a[196:199], v[116:119], v[120:123], a[196:199]
    v_mfma_f32_16x16x32_bf16 a[200:203], v[116:119], v[124:127], a[200:203]
    ds_read_b128 v[52:55], v18 offset:12288
    v_mfma_f32_16x16x32_bf16 a[204:207], v[116:119], v[128:131], a[204:207]
    v_mfma_f32_16x16x32_bf16 a[208:211], v[116:119], v[132:135], a[208:211]
    s_add_u32 m0, s75, 114688
    s_nop 0
    buffer_load_dwordx4 v17, s[4:7], s73 offen  lds
    s_add_u32 s73, s73, 128
    v_mfma_f32_16x16x32_bf16 a[212:215], v[116:119], v[136:139], a[212:215]
    v_mfma_f32_16x16x32_bf16 a[216:219], v[116:119], v[140:143], a[216:219]
    ds_read_b128 v[56:59], v18 offset:14336
    v_mfma_f32_16x16x32_bf16 a[220:223], v[116:119], v[144:147], a[220:223]
    s_add_u32 m0, s75, 118784
    s_nop 0
    buffer_load_dwordx4 v17, s[4:7], s74 offen  lds
    s_add_u32 s74, s74, 128
    s_waitcnt lgkmcnt(0)
    v_mfma_f32_16x16x32_bf16 a[0:3], v[28:31], v[60:63], a[0:3]
    v_mfma_f32_16x16x32_bf16 a[4:7], v[28:31], v[64:67], a[4:7]
    v_mfma_f32_16x16x32_bf16 a[8:11], v[28:31], v[68:71], a[8:11]
    v_mfma_f32_16x16x32_bf16 a[12:15], v[28:31], v[72:75], a[12:15]
    ds_read_b128 v[120:123], v24 offset:0
    v_mfma_f32_16x16x32_bf16 a[16:19], v[28:31], v[76:79], a[16:19]
    v_mfma_f32_16x16x32_bf16 a[20:23], v[28:31], v[80:83], a[20:23]
    v_mfma_f32_16x16x32_bf16 a[24:27], v[28:31], v[84:87], a[24:27]
    v_mfma_f32_16x16x32_bf16 a[28:31], v[32:35], v[60:63], a[28:31]
    ds_read_b128 v[124:127], v24 offset:2048
    v_mfma_f32_16x16x32_bf16 a[32:35], v[32:35], v[64:67], a[32:35]
    v_mfma_f32_16x16x32_bf16 a[36:39], v[32:35], v[68:71], a[36:39]
    v_mfma_f32_16x16x32_bf16 a[40:43], v[32:35], v[72:75], a[40:43]
    v_mfma_f32_16x16x32_bf16 a[44:47], v[32:35], v[76:79], a[44:47]
    ds_read_b128 v[128:131], v24 offset:4096
    v_mfma_f32_16x16x32_bf16 a[48:51], v[32:35], v[80:83], a[48:51]
    v_mfma_f32_16x16x32_bf16 a[52:55], v[32:35], v[84:87], a[52:55]
    v_mfma_f32_16x16x32_bf16 a[56:59], v[36:39], v[60:63], a[56:59]
    ds_read_b128 v[132:135], v24 offset:6144
    v_mfma_f32_16x16x32_bf16 a[60:63], v[36:39], v[64:67], a[60:63]
    v_mfma_f32_16x16x32_bf16 a[64:67], v[36:39], v[68:71], a[64:67]
    v_mfma_f32_16x16x32_bf16 a[68:71], v[36:39], v[72:75], a[68:71]
    v_mfma_f32_16x16x32_bf16 a[72:75], v[36:39], v[76:79], a[72:75]
    ds_read_b128 v[136:139], v24 offset:8192
    v_mfma_f32_16x16x32_bf16 a[76:79], v[36:39], v[80:83], a[76:79]
    v_mfma_f32_16x16x32_bf16 a[80:83], v[36:39], v[84:87], a[80:83]
    v_mfma_f32_16x16x32_bf16 a[84:87], v[40:43], v[60:63], a[84:87]
    v_mfma_f32_16x16x32_bf16 a[88:91], v[40:43], v[64:67], a[88:91]
    ds_read_b128 v[140:143], v24 offset:10240
    v_mfma_f32_16x16x32_bf16 a[92:95], v[40:43], v[68:71], a[92:95]
    v_mfma_f32_16x16x32_bf16 a[96:99], v[40:43], v[72:75], a[96:99]
    v_mfma_f32_16x16x32_bf16 a[100:103], v[40:43], v[76:79], a[100:103]
    v_mfma_f32_16x16x32_bf16 a[104:107], v[40:43], v[80:83], a[104:107]
    ds_read_b128 v[144:147], v24 offset:12288
    v_mfma_f32_16x16x32_bf16 a[108:111], v[40:43], v[84:87], a[108:111]
    v_mfma_f32_16x16x32_bf16 a[112:115], v[44:47], v[60:63], a[112:115]
    v_mfma_f32_16x16x32_bf16 a[116:119], v[44:47], v[64:67], a[116:119]
    ds_read_b128 v[88:91], v20 offset:0
    v_mfma_f32_16x16x32_bf16 a[120:123], v[44:47], v[68:71], a[120:123]
    v_mfma_f32_16x16x32_bf16 a[124:127], v[44:47], v[72:75], a[124:127]
    v_mfma_f32_16x16x32_bf16 a[128:131], v[44:47], v[76:79], a[128:131]
    v_mfma_f32_16x16x32_bf16 a[132:135], v[44:47], v[80:83], a[132:135]
    ds_read_b128 v[92:95], v20 offset:2048
    v_mfma_f32_16x16x32_bf16 a[136:139], v[44:47], v[84:87], a[136:139]
    v_mfma_f32_16x16x32_bf16 a[140:143], v[48:51], v[60:63], a[140:143]
    v_mfma_f32_16x16x32_bf16 a[144:147], v[48:51], v[64:67], a[144:147]
    v_mfma_f32_16x16x32_bf16 a[148:151], v[48:51], v[68:71], a[148:151]
    ds_read_b128 v[96:99], v20 offset:4096
    v_mfma_f32_16x16x32_bf16 a[152:155], v[48:51], v[72:75], a[152:155]
    v_mfma_f32_16x16x32_bf16 a[156:159], v[48:51], v[76:79], a[156:159]
    v_mfma_f32_16x16x32_bf16 a[160:163], v[48:51], v[80:83], a[160:163]
    v_mfma_f32_16x16x32_bf16 a[164:167], v[48:51], v[84:87], a[164:167]
    ds_read_b128 v[100:103], v20 offset:6144
    v_mfma_f32_16x16x32_bf16 a[168:171], v[52:55], v[60:63], a[168:171]
    v_mfma_f32_16x16x32_bf16 a[172:175], v[52:55], v[64:67], a[172:175]
    v_mfma_f32_16x16x32_bf16 a[176:179], v[52:55], v[68:71], a[176:179]
    ds_read_b128 v[104:107], v20 offset:8192
    v_mfma_f32_16x16x32_bf16 a[180:183], v[52:55], v[72:75], a[180:183]
    v_mfma_f32_16x16x32_bf16 a[184:187], v[52:55], v[76:79], a[184:187]
    v_mfma_f32_16x16x32_bf16 a[188:191], v[52:55], v[80:83], a[188:191]
    v_mfma_f32_16x16x32_bf16 a[192:195], v[52:55], v[84:87], a[192:195]
    ds_read_b128 v[108:111], v20 offset:10240
    v_mfma_f32_16x16x32_bf16 a[196:199], v[56:59], v[60:63], a[196:199]
    v_mfma_f32_16x16x32_bf16 a[200:203], v[56:59], v[64:67], a[200:203]
    v_mfma_f32_16x16x32_bf16 a[204:207], v[56:59], v[68:71], a[204:207]
    v_mfma_f32_16x16x32_bf16 a[208:211], v[56:59], v[72:75], a[208:211]
    ds_read_b128 v[112:115], v20 offset:12288
    v_mfma_f32_16x16x32_bf16 a[212:215], v[56:59], v[76:79], a[212:215]
    v_mfma_f32_16x16x32_bf16 a[216:219], v[56:59], v[80:83], a[216:219]
    v_mfma_f32_16x16x32_bf16 a[220:223], v[56:59], v[84:87], a[220:223]
    ds_read_b128 v[116:119], v20 offset:14336
    s_waitcnt lgkmcnt(0) vmcnt(0)
    s_barrier
    v_mfma_f32_16x16x32_bf16 a[0:3], v[88:91], v[120:123], a[0:3]
    v_mfma_f32_16x16x32_bf16 a[4:7], v[88:91], v[124:127], a[4:7]
    ds_read_b128 v[60:63], v23 offset:0
    v_mfma_f32_16x16x32_bf16 a[8:11], v[88:91], v[128:131], a[8:11]
    v_mfma_f32_16x16x32_bf16 a[12:15], v[88:91], v[132:135], a[12:15]
    s_add_u32 m0, s75, 0
    s_nop 0
    buffer_load_dwordx4 v16, s[4:7], s60 offen  lds
    s_add_u32 s60, s60, 128
    v_mfma_f32_16x16x32_bf16 a[16:19], v[88:91], v[136:139], a[16:19]
    v_mfma_f32_16x16x32_bf16 a[20:23], v[88:91], v[140:143], a[20:23]
    ds_read_b128 v[64:67], v23 offset:2048
    v_mfma_f32_16x16x32_bf16 a[24:27], v[88:91], v[144:147], a[24:27]
    v_mfma_f32_16x16x32_bf16 a[28:31], v[92:95], v[120:123], a[28:31]
    s_add_u32 m0, s75, 4096
    s_nop 0
    buffer_load_dwordx4 v16, s[4:7], s61 offen  lds
    s_add_u32 s61, s61, 128
    v_mfma_f32_16x16x32_bf16 a[32:35], v[92:95], v[124:127], a[32:35]
    v_mfma_f32_16x16x32_bf16 a[36:39], v[92:95], v[128:131], a[36:39]
    ds_read_b128 v[68:71], v23 offset:4096
    v_mfma_f32_16x16x32_bf16 a[40:43], v[92:95], v[132:135], a[40:43]
    v_mfma_f32_16x16x32_bf16 a[44:47], v[92:95], v[136:139], a[44:47]
    s_add_u32 m0, s75, 8192
    s_nop 0
    buffer_load_dwordx4 v16, s[4:7], s62 offen  lds
    s_add_u32 s62, s62, 128
    v_mfma_f32_16x16x32_bf16 a[48:51], v[92:95], v[140:143], a[48:51]
    v_mfma_f32_16x16x32_bf16 a[52:55], v[92:95], v[144:147], a[52:55]
    ds_read_b128 v[72:75], v23 offset:6144
    v_mfma_f32_16x16x32_bf16 a[56:59], v[96:99], v[120:123], a[56:59]
    s_add_u32 m0, s75, 12288
    s_nop 0
    buffer_load_dwordx4 v16, s[4:7], s63 offen  lds
    s_add_u32 s63, s63, 128
    v_mfma_f32_16x16x32_bf16 a[60:63], v[96:99], v[124:127], a[60:63]
    v_mfma_f32_16x16x32_bf16 a[64:67], v[96:99], v[128:131], a[64:67]
    ds_read_b128 v[76:79], v23 offset:8192
    v_mfma_f32_16x16x32_bf16 a[68:71], v[96:99], v[132:135], a[68:71]
    v_mfma_f32_16x16x32_bf16 a[72:75], v[96:99], v[136:139], a[72:75]
    s_add_u32 m0, s75, 16384
    s_nop 0
    buffer_load_dwordx4 v16, s[4:7], s64 offen  lds
    s_add_u32 s64, s64, 128
    v_mfma_f32_16x16x32_bf16 a[76:79], v[96:99], v[140:143], a[76:79]
    v_mfma_f32_16x16x32_bf16 a[80:83], v[96:99], v[144:147], a[80:83]
    ds_read_b128 v[80:83], v23 offset:10240
    v_mfma_f32_16x16x32_bf16 a[84:87], v[100:103], v[120:123], a[84:87]
    v_mfma_f32_16x16x32_bf16 a[88:91], v[100:103], v[124:127], a[88:91]
    s_add_u32 m0, s75, 20480
    s_nop 0
    buffer_load_dwordx4 v16, s[4:7], s65 offen  lds
    s_add_u32 s65, s65, 128
    v_mfma_f32_16x16x32_bf16 a[92:95], v[100:103], v[128:131], a[92:95]
    v_mfma_f32_16x16x32_bf16 a[96:99], v[100:103], v[132:135], a[96:99]
    ds_read_b128 v[84:87], v23 offset:12288
    v_mfma_f32_16x16x32_bf16 a[100:103], v[100:103], v[136:139], a[100:103]
    v_mfma_f32_16x16x32_bf16 a[104:107], v[100:103], v[140:143], a[104:107]
    s_add_u32 m0, s75, 24576
    s_nop 0
    buffer_load_dwordx4 v16, s[4:7], s66 offen  lds
    s_add_u32 s66, s66, 128
    v_mfma_f32_16x16x32_bf16 a[108:111], v[100:103], v[144:147], a[108:111]
    ds_read_b128 v[28:31], v19 offset:0
    v_mfma_f32_16x16x32_bf16 a[112:115], v[104:107], v[120:123], a[112:115]
    v_mfma_f32_16x16x32_bf16 a[116:119], v[104:107], v[124:127], a[116:119]
    s_add_u32 m0, s75, 28672
    s_nop 0
    buffer_load_dwordx4 v16, s[4:7], s67 offen  lds
    s_add_u32 s67, s67, 128
    v_mfma_f32_16x16x32_bf16 a[120:123], v[104:107], v[128:131], a[120:123]
    v_mfma_f32_16x16x32_bf16 a[124:127], v[104:107], v[132:135], a[124:127]
    ds_read_b128 v[32:35], v19 offset:2048
    v_mfma_f32_16x16x32_bf16 a[128:131], v[104:107], v[136:139], a[128:131]
    v_mfma_f32_16x16x32_bf16 a[132:135], v[104:107], v[140:143], a[132:135]
    s_add_u32 m0, s75, 32768
    s_nop 0
    buffer_load_dwordx4 v17, s[4:7], s68 offen  lds
    s_add_u32 s68, s68, 128
    v_mfma_f32_16x16x32_bf16 a[136:139], v[104:107], v[144:147], a[136:139]
    v_mfma_f32_16x16x32_bf16 a[140:143], v[108:111], v[120:123], a[140:143]
    ds_read_b128 v[36:39], v19 offset:4096
    v_mfma_f32_16x16x32_bf16 a[144:147], v[108:111], v[124:127], a[144:147]
    v_mfma_f32_16x16x32_bf16 a[148:151], v[108:111], v[128:131], a[148:151]
    s_add_u32 m0, s75, 36864
    s_nop 0
    buffer_load_dwordx4 v17, s[4:7], s69 offen  lds
    s_add_u32 s69, s69, 128
    v_mfma_f32_16x16x32_bf16 a[152:155], v[108:111], v[132:135], a[152:155]
    v_mfma_f32_16x16x32_bf16 a[156:159], v[108:111], v[136:139], a[156:159]
    ds_read_b128 v[40:43], v19 offset:6144
    v_mfma_f32_16x16x32_bf16 a[160:163], v[108:111], v[140:143], a[160:163]
    v_mfma_f32_16x16x32_bf16 a[164:167], v[108:111], v[144:147], a[164:167]
    s_add_u32 m0, s75, 40960
    s_nop 0
    buffer_load_dwordx4 v17, s[4:7], s70 offen  lds
    s_add_u32 s70, s70, 128
    v_mfma_f32_16x16x32_bf16 a[168:171], v[112:115], v[120:123], a[168:171]
    ds_read_b128 v[44:47], v19 offset:8192
    v_mfma_f32_16x16x32_bf16 a[172:175], v[112:115], v[124:127], a[172:175]
    v_mfma_f32_16x16x32_bf16 a[176:179], v[112:115], v[128:131], a[176:179]
    s_add_u32 m0, s75, 45056
    s_nop 0
    buffer_load_dwordx4 v17, s[4:7], s71 offen  lds
    s_add_u32 s71, s71, 128
    v_mfma_f32_16x16x32_bf16 a[180:183], v[112:115], v[132:135], a[180:183]
    v_mfma_f32_16x16x32_bf16 a[184:187], v[112:115], v[136:139], a[184:187]
    ds_read_b128 v[48:51], v19 offset:10240
    v_mfma_f32_16x16x32_bf16 a[188:191], v[112:115], v[140:143], a[188:191]
    v_mfma_f32_16x16x32_bf16 a[192:195], v[112:115], v[144:147], a[192:195]
    s_add_u32 m0, s75, 49152
    s_nop 0
    buffer_load_dwordx4 v17, s[4:7], s72 offen  lds
    s_add_u32 s72, s72, 128
    v_mfma_f32_16x16x32_bf16 a[196:199], v[116:119], v[120:123], a[196:199]
    v_mfma_f32_16x16x32_bf16 a[200:203], v[116:119], v[124:127], a[200:203]
    ds_read_b128 v[52:55], v19 offset:12288
    v_mfma_f32_16x16x32_bf16 a[204:207], v[116:119], v[128:131], a[204:207]
    v_mfma_f32_16x16x32_bf16 a[208:211], v[116:119], v[132:135], a[208:211]
    s_add_u32 m0, s75, 53248
    s_nop 0
    buffer_load_dwordx4 v17, s[4:7], s73 offen  lds
    s_add_u32 s73, s73, 128
    v_mfma_f32_16x16x32_bf16 a[212:215], v[116:119], v[136:139], a[212:215]
    v_mfma_f32_16x16x32_bf16 a[216:219], v[116:119], v[140:143], a[216:219]
    ds_read_b128 v[56:59], v19 offset:14336
    v_mfma_f32_16x16x32_bf16 a[220:223], v[116:119], v[144:147], a[220:223]
    s_add_u32 m0, s75, 57344
    s_nop 0
    buffer_load_dwordx4 v17, s[4:7], s74 offen  lds
    s_add_u32 s74, s74, 128
    s_waitcnt lgkmcnt(0)
    v_mfma_f32_16x16x32_bf16 a[0:3], v[28:31], v[60:63], a[0:3]
    v_mfma_f32_16x16x32_bf16 a[4:7], v[28:31], v[64:67], a[4:7]
    v_mfma_f32_16x16x32_bf16 a[8:11], v[28:31], v[68:71], a[8:11]
    v_mfma_f32_16x16x32_bf16 a[12:15], v[28:31], v[72:75], a[12:15]
    ds_read_b128 v[120:123], v25 offset:0
    v_mfma_f32_16x16x32_bf16 a[16:19], v[28:31], v[76:79], a[16:19]
    v_mfma_f32_16x16x32_bf16 a[20:23], v[28:31], v[80:83], a[20:23]
    v_mfma_f32_16x16x32_bf16 a[24:27], v[28:31], v[84:87], a[24:27]
    v_mfma_f32_16x16x32_bf16 a[28:31], v[32:35], v[60:63], a[28:31]
    ds_read_b128 v[124:127], v25 offset:2048
    v_mfma_f32_16x16x32_bf16 a[32:35], v[32:35], v[64:67], a[32:35]
    v_mfma_f32_16x16x32_bf16 a[36:39], v[32:35], v[68:71], a[36:39]
    v_mfma_f32_16x16x32_bf16 a[40:43], v[32:35], v[72:75], a[40:43]
    v_mfma_f32_16x16x32_bf16 a[44:47], v[32:35], v[76:79], a[44:47]
    ds_read_b128 v[128:131], v25 offset:4096
    v_mfma_f32_16x16x32_bf16 a[48:51], v[32:35], v[80:83], a[48:51]
    v_mfma_f32_16x16x32_bf16 a[52:55], v[32:35], v[84:87], a[52:55]
    v_mfma_f32_16x16x32_bf16 a[56:59], v[36:39], v[60:63], a[56:59]
    ds_read_b128 v[132:135], v25 offset:6144
    v_mfma_f32_16x16x32_bf16 a[60:63], v[36:39], v[64:67], a[60:63]
    v_mfma_f32_16x16x32_bf16 a[64:67], v[36:39], v[68:71], a[64:67]
    v_mfma_f32_16x16x32_bf16 a[68:71], v[36:39], v[72:75], a[68:71]
    v_mfma_f32_16x16x32_bf16 a[72:75], v[36:39], v[76:79], a[72:75]
    ds_read_b128 v[136:139], v25 offset:8192
    v_mfma_f32_16x16x32_bf16 a[76:79], v[36:39], v[80:83], a[76:79]
    v_mfma_f32_16x16x32_bf16 a[80:83], v[36:39], v[84:87], a[80:83]
    v_mfma_f32_16x16x32_bf16 a[84:87], v[40:43], v[60:63], a[84:87]
    v_mfma_f32_16x16x32_bf16 a[88:91], v[40:43], v[64:67], a[88:91]
    ds_read_b128 v[140:143], v25 offset:10240
    v_mfma_f32_16x16x32_bf16 a[92:95], v[40:43], v[68:71], a[92:95]
    v_mfma_f32_16x16x32_bf16 a[96:99], v[40:43], v[72:75], a[96:99]
    v_mfma_f32_16x16x32_bf16 a[100:103], v[40:43], v[76:79], a[100:103]
    v_mfma_f32_16x16x32_bf16 a[104:107], v[40:43], v[80:83], a[104:107]
    ds_read_b128 v[144:147], v25 offset:12288
    v_mfma_f32_16x16x32_bf16 a[108:111], v[40:43], v[84:87], a[108:111]
    v_mfma_f32_16x16x32_bf16 a[112:115], v[44:47], v[60:63], a[112:115]
    v_mfma_f32_16x16x32_bf16 a[116:119], v[44:47], v[64:67], a[116:119]
    ds_read_b128 v[88:91], v21 offset:0
    v_mfma_f32_16x16x32_bf16 a[120:123], v[44:47], v[68:71], a[120:123]
    v_mfma_f32_16x16x32_bf16 a[124:127], v[44:47], v[72:75], a[124:127]
    v_mfma_f32_16x16x32_bf16 a[128:131], v[44:47], v[76:79], a[128:131]
    v_mfma_f32_16x16x32_bf16 a[132:135], v[44:47], v[80:83], a[132:135]
    ds_read_b128 v[92:95], v21 offset:2048
    v_mfma_f32_16x16x32_bf16 a[136:139], v[44:47], v[84:87], a[136:139]
    v_mfma_f32_16x16x32_bf16 a[140:143], v[48:51], v[60:63], a[140:143]
    v_mfma_f32_16x16x32_bf16 a[144:147], v[48:51], v[64:67], a[144:147]
    v_mfma_f32_16x16x32_bf16 a[148:151], v[48:51], v[68:71], a[148:151]
    ds_read_b128 v[96:99], v21 offset:4096
    v_mfma_f32_16x16x32_bf16 a[152:155], v[48:51], v[72:75], a[152:155]
    v_mfma_f32_16x16x32_bf16 a[156:159], v[48:51], v[76:79], a[156:159]
    v_mfma_f32_16x16x32_bf16 a[160:163], v[48:51], v[80:83], a[160:163]
    v_mfma_f32_16x16x32_bf16 a[164:167], v[48:51], v[84:87], a[164:167]
    ds_read_b128 v[100:103], v21 offset:6144
    v_mfma_f32_16x16x32_bf16 a[168:171], v[52:55], v[60:63], a[168:171]
    v_mfma_f32_16x16x32_bf16 a[172:175], v[52:55], v[64:67], a[172:175]
    v_mfma_f32_16x16x32_bf16 a[176:179], v[52:55], v[68:71], a[176:179]
    ds_read_b128 v[104:107], v21 offset:8192
    v_mfma_f32_16x16x32_bf16 a[180:183], v[52:55], v[72:75], a[180:183]
    v_mfma_f32_16x16x32_bf16 a[184:187], v[52:55], v[76:79], a[184:187]
    v_mfma_f32_16x16x32_bf16 a[188:191], v[52:55], v[80:83], a[188:191]
    v_mfma_f32_16x16x32_bf16 a[192:195], v[52:55], v[84:87], a[192:195]
    ds_read_b128 v[108:111], v21 offset:10240
    v_mfma_f32_16x16x32_bf16 a[196:199], v[56:59], v[60:63], a[196:199]
    v_mfma_f32_16x16x32_bf16 a[200:203], v[56:59], v[64:67], a[200:203]
    v_mfma_f32_16x16x32_bf16 a[204:207], v[56:59], v[68:71], a[204:207]
    v_mfma_f32_16x16x32_bf16 a[208:211], v[56:59], v[72:75], a[208:211]
    ds_read_b128 v[112:115], v21 offset:12288
    v_mfma_f32_16x16x32_bf16 a[212:215], v[56:59], v[76:79], a[212:215]
    v_mfma_f32_16x16x32_bf16 a[216:219], v[56:59], v[80:83], a[216:219]
    v_mfma_f32_16x16x32_bf16 a[220:223], v[56:59], v[84:87], a[220:223]
    ds_read_b128 v[116:119], v21 offset:14336
    s_waitcnt lgkmcnt(0) vmcnt(0)
    s_barrier
    v_mfma_f32_16x16x32_bf16 a[0:3], v[88:91], v[120:123], a[0:3]
    v_mfma_f32_16x16x32_bf16 a[4:7], v[88:91], v[124:127], a[4:7]
    ds_read_b128 v[60:63], v22 offset:0
    v_mfma_f32_16x16x32_bf16 a[8:11], v[88:91], v[128:131], a[8:11]
    v_mfma_f32_16x16x32_bf16 a[12:15], v[88:91], v[132:135], a[12:15]
    s_add_u32 m0, s75, 61440
    s_nop 0
    buffer_load_dwordx4 v16, s[4:7], s60 offen  lds
    s_add_u32 s60, s60, 128
    v_mfma_f32_16x16x32_bf16 a[16:19], v[88:91], v[136:139], a[16:19]
    v_mfma_f32_16x16x32_bf16 a[20:23], v[88:91], v[140:143], a[20:23]
    ds_read_b128 v[64:67], v22 offset:2048
    v_mfma_f32_16x16x32_bf16 a[24:27], v[88:91], v[144:147], a[24:27]
    v_mfma_f32_16x16x32_bf16 a[28:31], v[92:95], v[120:123], a[28:31]
    s_add_u32 m0, s75, 65536
    s_nop 0
    buffer_load_dwordx4 v16, s[4:7], s61 offen  lds
    s_add_u32 s61, s61, 128
    v_mfma_f32_16x16x32_bf16 a[32:35], v[92:95], v[124:127], a[32:35]
    v_mfma_f32_16x16x32_bf16 a[36:39], v[92:95], v[128:131], a[36:39]
    ds_read_b128 v[68:71], v22 offset:4096
    v_mfma_f32_16x16x32_bf16 a[40:43], v[92:95], v[132:135], a[40:43]
    v_mfma_f32_16x16x32_bf16 a[44:47], v[92:95], v[136:139], a[44:47]
    s_add_u32 m0, s75, 69632
    s_nop 0
    buffer_load_dwordx4 v16, s[4:7], s62 offen  lds
    s_add_u32 s62, s62, 128
    v_mfma_f32_16x16x32_bf16 a[48:51], v[92:95], v[140:143], a[48:51]
    v_mfma_f32_16x16x32_bf16 a[52:55], v[92:95], v[144:147], a[52:55]
    ds_read_b128 v[72:75], v22 offset:6144
    v_mfma_f32_16x16x32_bf16 a[56:59], v[96:99], v[120:123], a[56:59]
    s_add_u32 m0, s75, 73728
    s_nop 0
    buffer_load_dwordx4 v16, s[4:7], s63 offen  lds
    s_add_u32 s63, s63, 128
    v_mfma_f32_16x16x32_bf16 a[60:63], v[96:99], v[124:127], a[60:63]
    v_mfma_f32_16x16x32_bf16 a[64:67], v[96:99], v[128:131], a[64:67]
    ds_read_b128 v[76:79], v22 offset:8192
    v_mfma_f32_16x16x32_bf16 a[68:71], v[96:99], v[132:135], a[68:71]
    v_mfma_f32_16x16x32_bf16 a[72:75], v[96:99], v[136:139], a[72:75]
    s_add_u32 m0, s75, 77824
    s_nop 0
    buffer_load_dwordx4 v16, s[4:7], s64 offen  lds
    s_add_u32 s64, s64, 128
    v_mfma_f32_16x16x32_bf16 a[76:79], v[96:99], v[140:143], a[76:79]
    v_mfma_f32_16x16x32_bf16 a[80:83], v[96:99], v[144:147], a[80:83]
    ds_read_b128 v[80:83], v22 offset:10240
    v_mfma_f32_16x16x32_bf16 a[84:87], v[100:103], v[120:123], a[84:87]
    v_mfma_f32_16x16x32_bf16 a[88:91], v[100:103], v[124:127], a[88:91]
    s_add_u32 m0, s75, 81920
    s_nop 0
    buffer_load_dwordx4 v16, s[4:7], s65 offen  lds
    s_add_u32 s65, s65, 128
    v_mfma_f32_16x16x32_bf16 a[92:95], v[100:103], v[128:131], a[92:95]
    v_mfma_f32_16x16x32_bf16 a[96:99], v[100:103], v[132:135], a[96:99]
    ds_read_b128 v[84:87], v22 offset:12288
    v_mfma_f32_16x16x32_bf16 a[100:103], v[100:103], v[136:139], a[100:103]
    v_mfma_f32_16x16x32_bf16 a[104:107], v[100:103], v[140:143], a[104:107]
    s_add_u32 m0, s75, 86016
    s_nop 0
    buffer_load_dwordx4 v16, s[4:7], s66 offen  lds
    s_add_u32 s66, s66, 128
    v_mfma_f32_16x16x32_bf16 a[108:111], v[100:103], v[144:147], a[108:111]
    ds_read_b128 v[28:31], v18 offset:0
    v_mfma_f32_16x16x32_bf16 a[112:115], v[104:107], v[120:123], a[112:115]
    v_mfma_f32_16x16x32_bf16 a[116:119], v[104:107], v[124:127], a[116:119]
    s_add_u32 m0, s75, 90112
    s_nop 0
    buffer_load_dwordx4 v16, s[4:7], s67 offen  lds
    s_add_u32 s67, s67, 128
    v_mfma_f32_16x16x32_bf16 a[120:123], v[104:107], v[128:131], a[120:123]
    v_mfma_f32_16x16x32_bf16 a[124:127], v[104:107], v[132:135], a[124:127]
    ds_read_b128 v[32:35], v18 offset:2048
    v_mfma_f32_16x16x32_bf16 a[128:131], v[104:107], v[136:139], a[128:131]
    v_mfma_f32_16x16x32_bf16 a[132:135], v[104:107], v[140:143], a[132:135]
    s_add_u32 m0, s75, 94208
    s_nop 0
    buffer_load_dwordx4 v17, s[4:7], s68 offen  lds
    s_add_u32 s68, s68, 128
    v_mfma_f32_16x16x32_bf16 a[136:139], v[104:107], v[144:147], a[136:139]
    v_mfma_f32_16x16x32_bf16 a[140:143], v[108:111], v[120:123], a[140:143]
    ds_read_b128 v[36:39], v18 offset:4096
    v_mfma_f32_16x16x32_bf16 a[144:147], v[108:111], v[124:127], a[144:147]
    v_mfma_f32_16x16x32_bf16 a[148:151], v[108:111], v[128:131], a[148:151]
    s_add_u32 m0, s75, 98304
    s_nop 0
    buffer_load_dwordx4 v17, s[4:7], s69 offen  lds
    s_add_u32 s69, s69, 128
    v_mfma_f32_16x16x32_bf16 a[152:155], v[108:111], v[132:135], a[152:155]
    v_mfma_f32_16x16x32_bf16 a[156:159], v[108:111], v[136:139], a[156:159]
    ds_read_b128 v[40:43], v18 offset:6144
    v_mfma_f32_16x16x32_bf16 a[160:163], v[108:111], v[140:143], a[160:163]
    v_mfma_f32_16x16x32_bf16 a[164:167], v[108:111], v[144:147], a[164:167]
    s_add_u32 m0, s75, 102400
    s_nop 0
    buffer_load_dwordx4 v17, s[4:7], s70 offen  lds
    s_add_u32 s70, s70, 128
    v_mfma_f32_16x16x32_bf16 a[168:171], v[112:115], v[120:123], a[168:171]
    ds_read_b128 v[44:47], v18 offset:8192
    v_mfma_f32_16x16x32_bf16 a[172:175], v[112:115], v[124:127], a[172:175]
    v_mfma_f32_16x16x32_bf16 a[176:179], v[112:115], v[128:131], a[176:179]
    s_add_u32 m0, s75, 106496
    s_nop 0
    buffer_load_dwordx4 v17, s[4:7], s71 offen  lds
    s_add_u32 s71, s71, 128
    v_mfma_f32_16x16x32_bf16 a[180:183], v[112:115], v[132:135], a[180:183]
    v_mfma_f32_16x16x32_bf16 a[184:187], v[112:115], v[136:139], a[184:187]
    ds_read_b128 v[48:51], v18 offset:10240
    v_mfma_f32_16x16x32_bf16 a[188:191], v[112:115], v[140:143], a[188:191]
    v_mfma_f32_16x16x32_bf16 a[192:195], v[112:115], v[144:147], a[192:195]
    s_add_u32 m0, s75, 110592
    s_nop 0
    buffer_load_dwordx4 v17, s[4:7], s72 offen  lds
    s_add_u32 s72, s72, 128
    v_mfma_f32_16x16x32_bf16 a[196:199], v[116:119], v[120:123], a[196:199]
    v_mfma_f32_16x16x32_bf16 a[200:203], v[116:119], v[124:127], a[200:203]
    ds_read_b128 v[52:55], v18 offset:12288
    v_mfma_f32_16x16x32_bf16 a[204:207], v[116:119], v[128:131], a[204:207]
    v_mfma_f32_16x16x32_bf16 a[208:211], v[116:119], v[132:135], a[208:211]
    s_add_u32 m0, s75, 114688
    s_nop 0
    buffer_load_dwordx4 v17, s[4:7], s73 offen  lds
    s_add_u32 s73, s73, 128
    v_mfma_f32_16x16x32_bf16 a[212:215], v[116:119], v[136:139], a[212:215]
    v_mfma_f32_16x16x32_bf16 a[216:219], v[116:119], v[140:143], a[216:219]
    ds_read_b128 v[56:59], v18 offset:14336
    v_mfma_f32_16x16x32_bf16 a[220:223], v[116:119], v[144:147], a[220:223]
    s_add_u32 m0, s75, 118784
    s_nop 0
    buffer_load_dwordx4 v17, s[4:7], s74 offen  lds
    s_add_u32 s74, s74, 128
    s_waitcnt lgkmcnt(0)
    v_mfma_f32_16x16x32_bf16 a[0:3], v[28:31], v[60:63], a[0:3]
    v_mfma_f32_16x16x32_bf16 a[4:7], v[28:31], v[64:67], a[4:7]
    v_mfma_f32_16x16x32_bf16 a[8:11], v[28:31], v[68:71], a[8:11]
    v_mfma_f32_16x16x32_bf16 a[12:15], v[28:31], v[72:75], a[12:15]
    ds_read_b128 v[120:123], v24 offset:0
    v_mfma_f32_16x16x32_bf16 a[16:19], v[28:31], v[76:79], a[16:19]
    v_mfma_f32_16x16x32_bf16 a[20:23], v[28:31], v[80:83], a[20:23]
    v_mfma_f32_16x16x32_bf16 a[24:27], v[28:31], v[84:87], a[24:27]
    v_mfma_f32_16x16x32_bf16 a[28:31], v[32:35], v[60:63], a[28:31]
    ds_read_b128 v[124:127], v24 offset:2048
    v_mfma_f32_16x16x32_bf16 a[32:35], v[32:35], v[64:67], a[32:35]
    v_mfma_f32_16x16x32_bf16 a[36:39], v[32:35], v[68:71], a[36:39]
    v_mfma_f32_16x16x32_bf16 a[40:43], v[32:35], v[72:75], a[40:43]
    v_mfma_f32_16x16x32_bf16 a[44:47], v[32:35], v[76:79], a[44:47]
    ds_read_b128 v[128:131], v24 offset:4096
    v_mfma_f32_16x16x32_bf16 a[48:51], v[32:35], v[80:83], a[48:51]
    v_mfma_f32_16x16x32_bf16 a[52:55], v[32:35], v[84:87], a[52:55]
    v_mfma_f32_16x16x32_bf16 a[56:59], v[36:39], v[60:63], a[56:59]
    ds_read_b128 v[132:135], v24 offset:6144
    v_mfma_f32_16x16x32_bf16 a[60:63], v[36:39], v[64:67], a[60:63]
    v_mfma_f32_16x16x32_bf16 a[64:67], v[36:39], v[68:71], a[64:67]
    v_mfma_f32_16x16x32_bf16 a[68:71], v[36:39], v[72:75], a[68:71]
    v_mfma_f32_16x16x32_bf16 a[72:75], v[36:39], v[76:79], a[72:75]
    ds_read_b128 v[136:139], v24 offset:8192
    v_mfma_f32_16x16x32_bf16 a[76:79], v[36:39], v[80:83], a[76:79]
    v_mfma_f32_16x16x32_bf16 a[80:83], v[36:39], v[84:87], a[80:83]
    v_mfma_f32_16x16x32_bf16 a[84:87], v[40:43], v[60:63], a[84:87]
    v_mfma_f32_16x16x32_bf16 a[88:91], v[40:43], v[64:67], a[88:91]
    ds_read_b128 v[140:143], v24 offset:10240
    v_mfma_f32_16x16x32_bf16 a[92:95], v[40:43], v[68:71], a[92:95]
    v_mfma_f32_16x16x32_bf16 a[96:99], v[40:43], v[72:75], a[96:99]
    v_mfma_f32_16x16x32_bf16 a[100:103], v[40:43], v[76:79], a[100:103]
    v_mfma_f32_16x16x32_bf16 a[104:107], v[40:43], v[80:83], a[104:107]
    ds_read_b128 v[144:147], v24 offset:12288
    v_mfma_f32_16x16x32_bf16 a[108:111], v[40:43], v[84:87], a[108:111]
    v_mfma_f32_16x16x32_bf16 a[112:115], v[44:47], v[60:63], a[112:115]
    v_mfma_f32_16x16x32_bf16 a[116:119], v[44:47], v[64:67], a[116:119]
    ds_read_b128 v[88:91], v20 offset:0
    v_mfma_f32_16x16x32_bf16 a[120:123], v[44:47], v[68:71], a[120:123]
    v_mfma_f32_16x16x32_bf16 a[124:127], v[44:47], v[72:75], a[124:127]
    v_mfma_f32_16x16x32_bf16 a[128:131], v[44:47], v[76:79], a[128:131]
    v_mfma_f32_16x16x32_bf16 a[132:135], v[44:47], v[80:83], a[132:135]
    ds_read_b128 v[92:95], v20 offset:2048
    v_mfma_f32_16x16x32_bf16 a[136:139], v[44:47], v[84:87], a[136:139]
    v_mfma_f32_16x16x32_bf16 a[140:143], v[48:51], v[60:63], a[140:143]
    v_mfma_f32_16x16x32_bf16 a[144:147], v[48:51], v[64:67], a[144:147]
    v_mfma_f32_16x16x32_bf16 a[148:151], v[48:51], v[68:71], a[148:151]
    ds_read_b128 v[96:99], v20 offset:4096
    v_mfma_f32_16x16x32_bf16 a[152:155], v[48:51], v[72:75], a[152:155]
    v_mfma_f32_16x16x32_bf16 a[156:159], v[48:51], v[76:79], a[156:159]
    v_mfma_f32_16x16x32_bf16 a[160:163], v[48:51], v[80:83], a[160:163]
    v_mfma_f32_16x16x32_bf16 a[164:167], v[48:51], v[84:87], a[164:167]
    ds_read_b128 v[100:103], v20 offset:6144
    v_mfma_f32_16x16x32_bf16 a[168:171], v[52:55], v[60:63], a[168:171]
    v_mfma_f32_16x16x32_bf16 a[172:175], v[52:55], v[64:67], a[172:175]
    v_mfma_f32_16x16x32_bf16 a[176:179], v[52:55], v[68:71], a[176:179]
    ds_read_b128 v[104:107], v20 offset:8192
    v_mfma_f32_16x16x32_bf16 a[180:183], v[52:55], v[72:75], a[180:183]
    v_mfma_f32_16x16x32_bf16 a[184:187], v[52:55], v[76:79], a[184:187]
    v_mfma_f32_16x16x32_bf16 a[188:191], v[52:55], v[80:83], a[188:191]
    v_mfma_f32_16x16x32_bf16 a[192:195], v[52:55], v[84:87], a[192:195]
    ds_read_b128 v[108:111], v20 offset:10240
    v_mfma_f32_16x16x32_bf16 a[196:199], v[56:59], v[60:63], a[196:199]
    v_mfma_f32_16x16x32_bf16 a[200:203], v[56:59], v[64:67], a[200:203]
    v_mfma_f32_16x16x32_bf16 a[204:207], v[56:59], v[68:71], a[204:207]
    v_mfma_f32_16x16x32_bf16 a[208:211], v[56:59], v[72:75], a[208:211]
    ds_read_b128 v[112:115], v20 offset:12288
    v_mfma_f32_16x16x32_bf16 a[212:215], v[56:59], v[76:79], a[212:215]
    v_mfma_f32_16x16x32_bf16 a[216:219], v[56:59], v[80:83], a[216:219]
    v_mfma_f32_16x16x32_bf16 a[220:223], v[56:59], v[84:87], a[220:223]
    ds_read_b128 v[116:119], v20 offset:14336
    s_waitcnt lgkmcnt(0) vmcnt(0)
    s_barrier
    v_mfma_f32_16x16x32_bf16 a[0:3], v[88:91], v[120:123], a[0:3]
    v_mfma_f32_16x16x32_bf16 a[4:7], v[88:91], v[124:127], a[4:7]
    ds_read_b128 v[60:63], v23 offset:0
    v_mfma_f32_16x16x32_bf16 a[8:11], v[88:91], v[128:131], a[8:11]
    v_mfma_f32_16x16x32_bf16 a[12:15], v[88:91], v[132:135], a[12:15]
    s_add_u32 m0, s75, 0
    s_nop 0
    buffer_load_dwordx4 v16, s[4:7], s60 offen  lds
    s_add_u32 s60, s60, 128
    v_mfma_f32_16x16x32_bf16 a[16:19], v[88:91], v[136:139], a[16:19]
    v_mfma_f32_16x16x32_bf16 a[20:23], v[88:91], v[140:143], a[20:23]
    ds_read_b128 v[64:67], v23 offset:2048
    v_mfma_f32_16x16x32_bf16 a[24:27], v[88:91], v[144:147], a[24:27]
    v_mfma_f32_16x16x32_bf16 a[28:31], v[92:95], v[120:123], a[28:31]
    s_add_u32 m0, s75, 4096
    s_nop 0
    buffer_load_dwordx4 v16, s[4:7], s61 offen  lds
    s_add_u32 s61, s61, 128
    v_mfma_f32_16x16x32_bf16 a[32:35], v[92:95], v[124:127], a[32:35]
    v_mfma_f32_16x16x32_bf16 a[36:39], v[92:95], v[128:131], a[36:39]
    ds_read_b128 v[68:71], v23 offset:4096
    v_mfma_f32_16x16x32_bf16 a[40:43], v[92:95], v[132:135], a[40:43]
    v_mfma_f32_16x16x32_bf16 a[44:47], v[92:95], v[136:139], a[44:47]
    s_add_u32 m0, s75, 8192
    s_nop 0
    buffer_load_dwordx4 v16, s[4:7], s62 offen  lds
    s_add_u32 s62, s62, 128
    v_mfma_f32_16x16x32_bf16 a[48:51], v[92:95], v[140:143], a[48:51]
    v_mfma_f32_16x16x32_bf16 a[52:55], v[92:95], v[144:147], a[52:55]
    ds_read_b128 v[72:75], v23 offset:6144
    v_mfma_f32_16x16x32_bf16 a[56:59], v[96:99], v[120:123], a[56:59]
    s_add_u32 m0, s75, 12288
    s_nop 0
    buffer_load_dwordx4 v16, s[4:7], s63 offen  lds
    s_add_u32 s63, s63, 128
    v_mfma_f32_16x16x32_bf16 a[60:63], v[96:99], v[124:127], a[60:63]
    v_mfma_f32_16x16x32_bf16 a[64:67], v[96:99], v[128:131], a[64:67]
    ds_read_b128 v[76:79], v23 offset:8192
    v_mfma_f32_16x16x32_bf16 a[68:71], v[96:99], v[132:135], a[68:71]
    v_mfma_f32_16x16x32_bf16 a[72:75], v[96:99], v[136:139], a[72:75]
    s_add_u32 m0, s75, 16384
    s_nop 0
    buffer_load_dwordx4 v16, s[4:7], s64 offen  lds
    s_add_u32 s64, s64, 128
    v_mfma_f32_16x16x32_bf16 a[76:79], v[96:99], v[140:143], a[76:79]
    v_mfma_f32_16x16x32_bf16 a[80:83], v[96:99], v[144:147], a[80:83]
    ds_read_b128 v[80:83], v23 offset:10240
    v_mfma_f32_16x16x32_bf16 a[84:87], v[100:103], v[120:123], a[84:87]
    v_mfma_f32_16x16x32_bf16 a[88:91], v[100:103], v[124:127], a[88:91]
    s_add_u32 m0, s75, 20480
    s_nop 0
    buffer_load_dwordx4 v16, s[4:7], s65 offen  lds
    s_add_u32 s65, s65, 128
    v_mfma_f32_16x16x32_bf16 a[92:95], v[100:103], v[128:131], a[92:95]
    v_mfma_f32_16x16x32_bf16 a[96:99], v[100:103], v[132:135], a[96:99]
    ds_read_b128 v[84:87], v23 offset:12288
    v_mfma_f32_16x16x32_bf16 a[100:103], v[100:103], v[136:139], a[100:103]
    v_mfma_f32_16x16x32_bf16 a[104:107], v[100:103], v[140:143], a[104:107]
    s_add_u32 m0, s75, 24576
    s_nop 0
    buffer_load_dwordx4 v16, s[4:7], s66 offen  lds
    s_add_u32 s66, s66, 128
    v_mfma_f32_16x16x32_bf16 a[108:111], v[100:103], v[144:147], a[108:111]
    ds_read_b128 v[28:31], v19 offset:0
    v_mfma_f32_16x16x32_bf16 a[112:115], v[104:107], v[120:123], a[112:115]
    v_mfma_f32_16x16x32_bf16 a[116:119], v[104:107], v[124:127], a[116:119]
    s_add_u32 m0, s75, 28672
    s_nop 0
    buffer_load_dwordx4 v16, s[4:7], s67 offen  lds
    s_add_u32 s67, s67, 128
    v_mfma_f32_16x16x32_bf16 a[120:123], v[104:107], v[128:131], a[120:123]
    v_mfma_f32_16x16x32_bf16 a[124:127], v[104:107], v[132:135], a[124:127]
    ds_read_b128 v[32:35], v19 offset:2048
    v_mfma_f32_16x16x32_bf16 a[128:131], v[104:107], v[136:139], a[128:131]
    v_mfma_f32_16x16x32_bf16 a[132:135], v[104:107], v[140:143], a[132:135]
    s_add_u32 m0, s75, 32768
    s_nop 0
    buffer_load_dwordx4 v17, s[4:7], s68 offen  lds
    s_add_u32 s68, s68, 128
    v_mfma_f32_16x16x32_bf16 a[136:139], v[104:107], v[144:147], a[136:139]
    v_mfma_f32_16x16x32_bf16 a[140:143], v[108:111], v[120:123], a[140:143]
    ds_read_b128 v[36:39], v19 offset:4096
    v_mfma_f32_16x16x32_bf16 a[144:147], v[108:111], v[124:127], a[144:147]
    v_mfma_f32_16x16x32_bf16 a[148:151], v[108:111], v[128:131], a[148:151]
    s_add_u32 m0, s75, 36864
    s_nop 0
    buffer_load_dwordx4 v17, s[4:7], s69 offen  lds
    s_add_u32 s69, s69, 128
    v_mfma_f32_16x16x32_bf16 a[152:155], v[108:111], v[132:135], a[152:155]
    v_mfma_f32_16x16x32_bf16 a[156:159], v[108:111], v[136:139], a[156:159]
    ds_read_b128 v[40:43], v19 offset:6144
    v_mfma_f32_16x16x32_bf16 a[160:163], v[108:111], v[140:143], a[160:163]
    v_mfma_f32_16x16x32_bf16 a[164:167], v[108:111], v[144:147], a[164:167]
    s_add_u32 m0, s75, 40960
    s_nop 0
    buffer_load_dwordx4 v17, s[4:7], s70 offen  lds
    s_add_u32 s70, s70, 128
    v_mfma_f32_16x16x32_bf16 a[168:171], v[112:115], v[120:123], a[168:171]
    ds_read_b128 v[44:47], v19 offset:8192
    v_mfma_f32_16x16x32_bf16 a[172:175], v[112:115], v[124:127], a[172:175]
    v_mfma_f32_16x16x32_bf16 a[176:179], v[112:115], v[128:131], a[176:179]
    s_add_u32 m0, s75, 45056
    s_nop 0
    buffer_load_dwordx4 v17, s[4:7], s71 offen  lds
    s_add_u32 s71, s71, 128
    v_mfma_f32_16x16x32_bf16 a[180:183], v[112:115], v[132:135], a[180:183]
    v_mfma_f32_16x16x32_bf16 a[184:187], v[112:115], v[136:139], a[184:187]
    ds_read_b128 v[48:51], v19 offset:10240
    v_mfma_f32_16x16x32_bf16 a[188:191], v[112:115], v[140:143], a[188:191]
    v_mfma_f32_16x16x32_bf16 a[192:195], v[112:115], v[144:147], a[192:195]
    s_add_u32 m0, s75, 49152
    s_nop 0
    buffer_load_dwordx4 v17, s[4:7], s72 offen  lds
    s_add_u32 s72, s72, 128
    v_mfma_f32_16x16x32_bf16 a[196:199], v[116:119], v[120:123], a[196:199]
    v_mfma_f32_16x16x32_bf16 a[200:203], v[116:119], v[124:127], a[200:203]
    ds_read_b128 v[52:55], v19 offset:12288
    v_mfma_f32_16x16x32_bf16 a[204:207], v[116:119], v[128:131], a[204:207]
    v_mfma_f32_16x16x32_bf16 a[208:211], v[116:119], v[132:135], a[208:211]
    s_add_u32 m0, s75, 53248
    s_nop 0
    buffer_load_dwordx4 v17, s[4:7], s73 offen  lds
    s_add_u32 s73, s73, 128
    v_mfma_f32_16x16x32_bf16 a[212:215], v[116:119], v[136:139], a[212:215]
    v_mfma_f32_16x16x32_bf16 a[216:219], v[116:119], v[140:143], a[216:219]
    ds_read_b128 v[56:59], v19 offset:14336
    v_mfma_f32_16x16x32_bf16 a[220:223], v[116:119], v[144:147], a[220:223]
    s_add_u32 m0, s75, 57344
    s_nop 0
    buffer_load_dwordx4 v17, s[4:7], s74 offen  lds
    s_add_u32 s74, s74, 128
    s_waitcnt lgkmcnt(0)
    v_mfma_f32_16x16x32_bf16 a[0:3], v[28:31], v[60:63], a[0:3]
    v_mfma_f32_16x16x32_bf16 a[4:7], v[28:31], v[64:67], a[4:7]
    v_mfma_f32_16x16x32_bf16 a[8:11], v[28:31], v[68:71], a[8:11]
    v_mfma_f32_16x16x32_bf16 a[12:15], v[28:31], v[72:75], a[12:15]
    ds_read_b128 v[120:123], v25 offset:0
    v_mfma_f32_16x16x32_bf16 a[16:19], v[28:31], v[76:79], a[16:19]
    v_mfma_f32_16x16x32_bf16 a[20:23], v[28:31], v[80:83], a[20:23]
    v_mfma_f32_16x16x32_bf16 a[24:27], v[28:31], v[84:87], a[24:27]
    v_mfma_f32_16x16x32_bf16 a[28:31], v[32:35], v[60:63], a[28:31]
    ds_read_b128 v[124:127], v25 offset:2048
    v_mfma_f32_16x16x32_bf16 a[32:35], v[32:35], v[64:67], a[32:35]
    v_mfma_f32_16x16x32_bf16 a[36:39], v[32:35], v[68:71], a[36:39]
    v_mfma_f32_16x16x32_bf16 a[40:43], v[32:35], v[72:75], a[40:43]
    v_mfma_f32_16x16x32_bf16 a[44:47], v[32:35], v[76:79], a[44:47]
    ds_read_b128 v[128:131], v25 offset:4096
    v_mfma_f32_16x16x32_bf16 a[48:51], v[32:35], v[80:83], a[48:51]
    v_mfma_f32_16x16x32_bf16 a[52:55], v[32:35], v[84:87], a[52:55]
    v_mfma_f32_16x16x32_bf16 a[56:59], v[36:39], v[60:63], a[56:59]
    ds_read_b128 v[132:135], v25 offset:6144
    v_mfma_f32_16x16x32_bf16 a[60:63], v[36:39], v[64:67], a[60:63]
    v_mfma_f32_16x16x32_bf16 a[64:67], v[36:39], v[68:71], a[64:67]
    v_mfma_f32_16x16x32_bf16 a[68:71], v[36:39], v[72:75], a[68:71]
    v_mfma_f32_16x16x32_bf16 a[72:75], v[36:39], v[76:79], a[72:75]
    ds_read_b128 v[136:139], v25 offset:8192
    v_mfma_f32_16x16x32_bf16 a[76:79], v[36:39], v[80:83], a[76:79]
    v_mfma_f32_16x16x32_bf16 a[80:83], v[36:39], v[84:87], a[80:83]
    v_mfma_f32_16x16x32_bf16 a[84:87], v[40:43], v[60:63], a[84:87]
    v_mfma_f32_16x16x32_bf16 a[88:91], v[40:43], v[64:67], a[88:91]
    ds_read_b128 v[140:143], v25 offset:10240
    v_mfma_f32_16x16x32_bf16 a[92:95], v[40:43], v[68:71], a[92:95]
    v_mfma_f32_16x16x32_bf16 a[96:99], v[40:43], v[72:75], a[96:99]
    v_mfma_f32_16x16x32_bf16 a[100:103], v[40:43], v[76:79], a[100:103]
    v_mfma_f32_16x16x32_bf16 a[104:107], v[40:43], v[80:83], a[104:107]
    ds_read_b128 v[144:147], v25 offset:12288
    v_mfma_f32_16x16x32_bf16 a[108:111], v[40:43], v[84:87], a[108:111]
    v_mfma_f32_16x16x32_bf16 a[112:115], v[44:47], v[60:63], a[112:115]
    v_mfma_f32_16x16x32_bf16 a[116:119], v[44:47], v[64:67], a[116:119]
    ds_read_b128 v[88:91], v21 offset:0
    v_mfma_f32_16x16x32_bf16 a[120:123], v[44:47], v[68:71], a[120:123]
    v_mfma_f32_16x16x32_bf16 a[124:127], v[44:47], v[72:75], a[124:127]
    v_mfma_f32_16x16x32_bf16 a[128:131], v[44:47], v[76:79], a[128:131]
    v_mfma_f32_16x16x32_bf16 a[132:135], v[44:47], v[80:83], a[132:135]
    ds_read_b128 v[92:95], v21 offset:2048
    v_mfma_f32_16x16x32_bf16 a[136:139], v[44:47], v[84:87], a[136:139]
    v_mfma_f32_16x16x32_bf16 a[140:143], v[48:51], v[60:63], a[140:143]
    v_mfma_f32_16x16x32_bf16 a[144:147], v[48:51], v[64:67], a[144:147]
    v_mfma_f32_16x16x32_bf16 a[148:151], v[48:51], v[68:71], a[148:151]
    ds_read_b128 v[96:99], v21 offset:4096
    v_mfma_f32_16x16x32_bf16 a[152:155], v[48:51], v[72:75], a[152:155]
    v_mfma_f32_16x16x32_bf16 a[156:159], v[48:51], v[76:79], a[156:159]
    v_mfma_f32_16x16x32_bf16 a[160:163], v[48:51], v[80:83], a[160:163]
    v_mfma_f32_16x16x32_bf16 a[164:167], v[48:51], v[84:87], a[164:167]
    ds_read_b128 v[100:103], v21 offset:6144
    v_mfma_f32_16x16x32_bf16 a[168:171], v[52:55], v[60:63], a[168:171]
    v_mfma_f32_16x16x32_bf16 a[172:175], v[52:55], v[64:67], a[172:175]
    v_mfma_f32_16x16x32_bf16 a[176:179], v[52:55], v[68:71], a[176:179]
    ds_read_b128 v[104:107], v21 offset:8192
    v_mfma_f32_16x16x32_bf16 a[180:183], v[52:55], v[72:75], a[180:183]
    v_mfma_f32_16x16x32_bf16 a[184:187], v[52:55], v[76:79], a[184:187]
    v_mfma_f32_16x16x32_bf16 a[188:191], v[52:55], v[80:83], a[188:191]
    v_mfma_f32_16x16x32_bf16 a[192:195], v[52:55], v[84:87], a[192:195]
    ds_read_b128 v[108:111], v21 offset:10240
    v_mfma_f32_16x16x32_bf16 a[196:199], v[56:59], v[60:63], a[196:199]
    v_mfma_f32_16x16x32_bf16 a[200:203], v[56:59], v[64:67], a[200:203]
    v_mfma_f32_16x16x32_bf16 a[204:207], v[56:59], v[68:71], a[204:207]
    v_mfma_f32_16x16x32_bf16 a[208:211], v[56:59], v[72:75], a[208:211]
    ds_read_b128 v[112:115], v21 offset:12288
    v_mfma_f32_16x16x32_bf16 a[212:215], v[56:59], v[76:79], a[212:215]
    v_mfma_f32_16x16x32_bf16 a[216:219], v[56:59], v[80:83], a[216:219]
    v_mfma_f32_16x16x32_bf16 a[220:223], v[56:59], v[84:87], a[220:223]
    ds_read_b128 v[116:119], v21 offset:14336
    s_waitcnt lgkmcnt(0) vmcnt(0)
    s_barrier
    v_mfma_f32_16x16x32_bf16 a[0:3], v[88:91], v[120:123], a[0:3]
    v_mfma_f32_16x16x32_bf16 a[4:7], v[88:91], v[124:127], a[4:7]
    v_mfma_f32_16x16x32_bf16 a[8:11], v[88:91], v[128:131], a[8:11]
    v_mfma_f32_16x16x32_bf16 a[12:15], v[88:91], v[132:135], a[12:15]
    ds_read_b128 v[60:63], v22 offset:0
    v_mfma_f32_16x16x32_bf16 a[16:19], v[88:91], v[136:139], a[16:19]
    v_mfma_f32_16x16x32_bf16 a[20:23], v[88:91], v[140:143], a[20:23]
    v_mfma_f32_16x16x32_bf16 a[24:27], v[88:91], v[144:147], a[24:27]
    v_mfma_f32_16x16x32_bf16 a[28:31], v[92:95], v[120:123], a[28:31]
    ds_read_b128 v[64:67], v22 offset:2048
    v_mfma_f32_16x16x32_bf16 a[32:35], v[92:95], v[124:127], a[32:35]
    v_mfma_f32_16x16x32_bf16 a[36:39], v[92:95], v[128:131], a[36:39]
    v_mfma_f32_16x16x32_bf16 a[40:43], v[92:95], v[132:135], a[40:43]
    v_mfma_f32_16x16x32_bf16 a[44:47], v[92:95], v[136:139], a[44:47]
    ds_read_b128 v[68:71], v22 offset:4096
    v_mfma_f32_16x16x32_bf16 a[48:51], v[92:95], v[140:143], a[48:51]
    v_mfma_f32_16x16x32_bf16 a[52:55], v[92:95], v[144:147], a[52:55]
    v_mfma_f32_16x16x32_bf16 a[56:59], v[96:99], v[120:123], a[56:59]
    ds_read_b128 v[72:75], v22 offset:6144
    v_mfma_f32_16x16x32_bf16 a[60:63], v[96:99], v[124:127], a[60:63]
    v_mfma_f32_16x16x32_bf16 a[64:67], v[96:99], v[128:131], a[64:67]
    v_mfma_f32_16x16x32_bf16 a[68:71], v[96:99], v[132:135], a[68:71]
    v_mfma_f32_16x16x32_bf16 a[72:75], v[96:99], v[136:139], a[72:75]
    ds_read_b128 v[76:79], v22 offset:8192
    v_mfma_f32_16x16x32_bf16 a[76:79], v[96:99], v[140:143], a[76:79]
    v_mfma_f32_16x16x32_bf16 a[80:83], v[96:99], v[144:147], a[80:83]
    v_mfma_f32_16x16x32_bf16 a[84:87], v[100:103], v[120:123], a[84:87]
    v_mfma_f32_16x16x32_bf16 a[88:91], v[100:103], v[124:127], a[88:91]
    ds_read_b128 v[80:83], v22 offset:10240
    v_mfma_f32_16x16x32_bf16 a[92:95], v[100:103], v[128:131], a[92:95]
    v_mfma_f32_16x16x32_bf16 a[96:99], v[100:103], v[132:135], a[96:99]
    v_mfma_f32_16x16x32_bf16 a[100:103], v[100:103], v[136:139], a[100:103]
    v_mfma_f32_16x16x32_bf16 a[104:107], v[100:103], v[140:143], a[104:107]
    ds_read_b128 v[84:87], v22 offset:12288
    v_mfma_f32_16x16x32_bf16 a[108:111], v[100:103], v[144:147], a[108:111]
    v_mfma_f32_16x16x32_bf16 a[112:115], v[104:107], v[120:123], a[112:115]
    v_mfma_f32_16x16x32_bf16 a[116:119], v[104:107], v[124:127], a[116:119]
    ds_read_b128 v[28:31], v18 offset:0
    v_mfma_f32_16x16x32_bf16 a[120:123], v[104:107], v[128:131], a[120:123]
    v_mfma_f32_16x16x32_bf16 a[124:127], v[104:107], v[132:135], a[124:127]
    v_mfma_f32_16x16x32_bf16 a[128:131], v[104:107], v[136:139], a[128:131]
    v_mfma_f32_16x16x32_bf16 a[132:135], v[104:107], v[140:143], a[132:135]
    ds_read_b128 v[32:35], v18 offset:2048
    v_mfma_f32_16x16x32_bf16 a[136:139], v[104:107], v[144:147], a[136:139]
    v_mfma_f32_16x16x32_bf16 a[140:143], v[108:111], v[120:123], a[140:143]
    v_mfma_f32_16x16x32_bf16 a[144:147], v[108:111], v[124:127], a[144:147]
    v_mfma_f32_16x16x32_bf16 a[148:151], v[108:111], v[128:131], a[148:151]
    ds_read_b128 v[36:39], v18 offset:4096
    v_mfma_f32_16x16x32_bf16 a[152:155], v[108:111], v[132:135], a[152:155]
    v_mfma_f32_16x16x32_bf16 a[156:159], v[108:111], v[136:139], a[156:159]
    v_mfma_f32_16x16x32_bf16 a[160:163], v[108:111], v[140:143], a[160:163]
    v_mfma_f32_16x16x32_bf16 a[164:167], v[108:111], v[144:147], a[164:167]
    ds_read_b128 v[40:43], v18 offset:6144
    v_mfma_f32_16x16x32_bf16 a[168:171], v[112:115], v[120:123], a[168:171]
    v_mfma_f32_16x16x32_bf16 a[172:175], v[112:115], v[124:127], a[172:175]
    v_mfma_f32_16x16x32_bf16 a[176:179], v[112:115], v[128:131], a[176:179]
    ds_read_b128 v[44:47], v18 offset:8192
    v_mfma_f32_16x16x32_bf16 a[180:183], v[112:115], v[132:135], a[180:183]
    v_mfma_f32_16x16x32_bf16 a[184:187], v[112:115], v[136:139], a[184:187]
    v_mfma_f32_16x16x32_bf16 a[188:191], v[112:115], v[140:143], a[188:191]
    v_mfma_f32_16x16x32_bf16 a[192:195], v[112:115], v[144:147], a[192:195]
    ds_read_b128 v[48:51], v18 offset:10240
    v_mfma_f32_16x16x32_bf16 a[196:199], v[116:119], v[120:123], a[196:199]
    v_mfma_f32_16x16x32_bf16 a[200:203], v[116:119], v[124:127], a[200:203]
    v_mfma_f32_16x16x32_bf16 a[204:207], v[116:119], v[128:131], a[204:207]
    v_mfma_f32_16x16x32_bf16 a[208:211], v[116:119], v[132:135], a[208:211]
    ds_read_b128 v[52:55], v18 offset:12288
    v_mfma_f32_16x16x32_bf16 a[212:215], v[116:119], v[136:139], a[212:215]
    v_mfma_f32_16x16x32_bf16 a[216:219], v[116:119], v[140:143], a[216:219]
    v_mfma_f32_16x16x32_bf16 a[220:223], v[116:119], v[144:147], a[220:223]
    ds_read_b128 v[56:59], v18 offset:14336
    s_waitcnt lgkmcnt(0)
    v_mfma_f32_16x16x32_bf16 a[0:3], v[28:31], v[60:63], a[0:3]
    v_mfma_f32_16x16x32_bf16 a[4:7], v[28:31], v[64:67], a[4:7]
    v_mfma_f32_16x16x32_bf16 a[8:11], v[28:31], v[68:71], a[8:11]
    v_mfma_f32_16x16x32_bf16 a[12:15], v[28:31], v[72:75], a[12:15]
    ds_read_b128 v[120:123], v24 offset:0
    v_mfma_f32_16x16x32_bf16 a[16:19], v[28:31], v[76:79], a[16:19]
    v_mfma_f32_16x16x32_bf16 a[20:23], v[28:31], v[80:83], a[20:23]
    v_mfma_f32_16x16x32_bf16 a[24:27], v[28:31], v[84:87], a[24:27]
    v_mfma_f32_16x16x32_bf16 a[28:31], v[32:35], v[60:63], a[28:31]
    ds_read_b128 v[124:127], v24 offset:2048
    v_mfma_f32_16x16x32_bf16 a[32:35], v[32:35], v[64:67], a[32:35]
    v_mfma_f32_16x16x32_bf16 a[36:39], v[32:35], v[68:71], a[36:39]
    v_mfma_f32_16x16x32_bf16 a[40:43], v[32:35], v[72:75], a[40:43]
    v_mfma_f32_16x16x32_bf16 a[44:47], v[32:35], v[76:79], a[44:47]
    ds_read_b128 v[128:131], v24 offset:4096
    v_mfma_f32_16x16x32_bf16 a[48:51], v[32:35], v[80:83], a[48:51]
    v_mfma_f32_16x16x32_bf16 a[52:55], v[32:35], v[84:87], a[52:55]
    v_mfma_f32_16x16x32_bf16 a[56:59], v[36:39], v[60:63], a[56:59]
    ds_read_b128 v[132:135], v24 offset:6144
    v_mfma_f32_16x16x32_bf16 a[60:63], v[36:39], v[64:67], a[60:63]
    v_mfma_f32_16x16x32_bf16 a[64:67], v[36:39], v[68:71], a[64:67]
    v_mfma_f32_16x16x32_bf16 a[68:71], v[36:39], v[72:75], a[68:71]
    v_mfma_f32_16x16x32_bf16 a[72:75], v[36:39], v[76:79], a[72:75]
    ds_read_b128 v[136:139], v24 offset:8192
    v_mfma_f32_16x16x32_bf16 a[76:79], v[36:39], v[80:83], a[76:79]
    v_mfma_f32_16x16x32_bf16 a[80:83], v[36:39], v[84:87], a[80:83]
    v_mfma_f32_16x16x32_bf16 a[84:87], v[40:43], v[60:63], a[84:87]
    v_mfma_f32_16x16x32_bf16 a[88:91], v[40:43], v[64:67], a[88:91]
    ds_read_b128 v[140:143], v24 offset:10240
    v_mfma_f32_16x16x32_bf16 a[92:95], v[40:43], v[68:71], a[92:95]
    v_mfma_f32_16x16x32_bf16 a[96:99], v[40:43], v[72:75], a[96:99]
    v_mfma_f32_16x16x32_bf16 a[100:103], v[40:43], v[76:79], a[100:103]
    v_mfma_f32_16x16x32_bf16 a[104:107], v[40:43], v[80:83], a[104:107]
    ds_read_b128 v[144:147], v24 offset:12288
    v_mfma_f32_16x16x32_bf16 a[108:111], v[40:43], v[84:87], a[108:111]
    v_mfma_f32_16x16x32_bf16 a[112:115], v[44:47], v[60:63], a[112:115]
    v_mfma_f32_16x16x32_bf16 a[116:119], v[44:47], v[64:67], a[116:119]
    ds_read_b128 v[88:91], v20 offset:0
    v_mfma_f32_16x16x32_bf16 a[120:123], v[44:47], v[68:71], a[120:123]
    v_mfma_f32_16x16x32_bf16 a[124:127], v[44:47], v[72:75], a[124:127]
    v_mfma_f32_16x16x32_bf16 a[128:131], v[44:47], v[76:79], a[128:131]
    v_mfma_f32_16x16x32_bf16 a[132:135], v[44:47], v[80:83], a[132:135]
    ds_read_b128 v[92:95], v20 offset:2048
    v_mfma_f32_16x16x32_bf16 a[136:139], v[44:47], v[84:87], a[136:139]
    v_mfma_f32_16x16x32_bf16 a[140:143], v[48:51], v[60:63], a[140:143]
    v_mfma_f32_16x16x32_bf16 a[144:147], v[48:51], v[64:67], a[144:147]
    v_mfma_f32_16x16x32_bf16 a[148:151], v[48:51], v[68:71], a[148:151]
    ds_read_b128 v[96:99], v20 offset:4096
    v_mfma_f32_16x16x32_bf16 a[152:155], v[48:51], v[72:75], a[152:155]
    v_mfma_f32_16x16x32_bf16 a[156:159], v[48:51], v[76:79], a[156:159]
    v_mfma_f32_16x16x32_bf16 a[160:163], v[48:51], v[80:83], a[160:163]
    v_mfma_f32_16x16x32_bf16 a[164:167], v[48:51], v[84:87], a[164:167]
    ds_read_b128 v[100:103], v20 offset:6144
    v_mfma_f32_16x16x32_bf16 a[168:171], v[52:55], v[60:63], a[168:171]
    v_mfma_f32_16x16x32_bf16 a[172:175], v[52:55], v[64:67], a[172:175]
    v_mfma_f32_16x16x32_bf16 a[176:179], v[52:55], v[68:71], a[176:179]
    ds_read_b128 v[104:107], v20 offset:8192
    v_mfma_f32_16x16x32_bf16 a[180:183], v[52:55], v[72:75], a[180:183]
    v_mfma_f32_16x16x32_bf16 a[184:187], v[52:55], v[76:79], a[184:187]
    v_mfma_f32_16x16x32_bf16 a[188:191], v[52:55], v[80:83], a[188:191]
    v_mfma_f32_16x16x32_bf16 a[192:195], v[52:55], v[84:87], a[192:195]
    ds_read_b128 v[108:111], v20 offset:10240
    v_mfma_f32_16x16x32_bf16 a[196:199], v[56:59], v[60:63], a[196:199]
    v_mfma_f32_16x16x32_bf16 a[200:203], v[56:59], v[64:67], a[200:203]
    v_mfma_f32_16x16x32_bf16 a[204:207], v[56:59], v[68:71], a[204:207]
    v_mfma_f32_16x16x32_bf16 a[208:211], v[56:59], v[72:75], a[208:211]
    ds_read_b128 v[112:115], v20 offset:12288
    v_mfma_f32_16x16x32_bf16 a[212:215], v[56:59], v[76:79], a[212:215]
    v_mfma_f32_16x16x32_bf16 a[216:219], v[56:59], v[80:83], a[216:219]
    v_mfma_f32_16x16x32_bf16 a[220:223], v[56:59], v[84:87], a[220:223]
    ds_read_b128 v[116:119], v20 offset:14336
    s_waitcnt lgkmcnt(0)
    v_mfma_f32_16x16x32_bf16 a[0:3], v[88:91], v[120:123], a[0:3]
    v_mfma_f32_16x16x32_bf16 a[4:7], v[88:91], v[124:127], a[4:7]
    v_mfma_f32_16x16x32_bf16 a[8:11], v[88:91], v[128:131], a[8:11]
    v_mfma_f32_16x16x32_bf16 a[12:15], v[88:91], v[132:135], a[12:15]
    v_mfma_f32_16x16x32_bf16 a[16:19], v[88:91], v[136:139], a[16:19]
    v_mfma_f32_16x16x32_bf16 a[20:23], v[88:91], v[140:143], a[20:23]
    v_mfma_f32_16x16x32_bf16 a[24:27], v[88:91], v[144:147], a[24:27]
    v_mfma_f32_16x16x32_bf16 a[28:31], v[92:95], v[120:123], a[28:31]
    v_mfma_f32_16x16x32_bf16 a[32:35], v[92:95], v[124:127], a[32:35]
    v_mfma_f32_16x16x32_bf16 a[36:39], v[92:95], v[128:131], a[36:39]
    v_mfma_f32_16x16x32_bf16 a[40:43], v[92:95], v[132:135], a[40:43]
    v_mfma_f32_16x16x32_bf16 a[44:47], v[92:95], v[136:139], a[44:47]
    v_mfma_f32_16x16x32_bf16 a[48:51], v[92:95], v[140:143], a[48:51]
    v_mfma_f32_16x16x32_bf16 a[52:55], v[92:95], v[144:147], a[52:55]
    v_mfma_f32_16x16x32_bf16 a[56:59], v[96:99], v[120:123], a[56:59]
    v_mfma_f32_16x16x32_bf16 a[60:63], v[96:99], v[124:127], a[60:63]
    v_mfma_f32_16x16x32_bf16 a[64:67], v[96:99], v[128:131], a[64:67]
    v_mfma_f32_16x16x32_bf16 a[68:71], v[96:99], v[132:135], a[68:71]
    v_mfma_f32_16x16x32_bf16 a[72:75], v[96:99], v[136:139], a[72:75]
    v_mfma_f32_16x16x32_bf16 a[76:79], v[96:99], v[140:143], a[76:79]
    v_mfma_f32_16x16x32_bf16 a[80:83], v[96:99], v[144:147], a[80:83]
    v_mfma_f32_16x16x32_bf16 a[84:87], v[100:103], v[120:123], a[84:87]
    v_mfma_f32_16x16x32_bf16 a[88:91], v[100:103], v[124:127], a[88:91]
    v_mfma_f32_16x16x32_bf16 a[92:95], v[100:103], v[128:131], a[92:95]
    v_mfma_f32_16x16x32_bf16 a[96:99], v[100:103], v[132:135], a[96:99]
    v_mfma_f32_16x16x32_bf16 a[100:103], v[100:103], v[136:139], a[100:103]
    v_mfma_f32_16x16x32_bf16 a[104:107], v[100:103], v[140:143], a[104:107]
    v_mfma_f32_16x16x32_bf16 a[108:111], v[100:103], v[144:147], a[108:111]
    v_mfma_f32_16x16x32_bf16 a[112:115], v[104:107], v[120:123], a[112:115]
    v_mfma_f32_16x16x32_bf16 a[116:119], v[104:107], v[124:127], a[116:119]
    v_mfma_f32_16x16x32_bf16 a[120:123], v[104:107], v[128:131], a[120:123]
    v_mfma_f32_16x16x32_bf16 a[124:127], v[104:107], v[132:135], a[124:127]
    v_mfma_f32_16x16x32_bf16 a[128:131], v[104:107], v[136:139], a[128:131]
    v_mfma_f32_16x16x32_bf16 a[132:135], v[104:107], v[140:143], a[132:135]
    v_mfma_f32_16x16x32_bf16 a[136:139], v[104:107], v[144:147], a[136:139]
    v_mfma_f32_16x16x32_bf16 a[140:143], v[108:111], v[120:123], a[140:143]
    v_mfma_f32_16x16x32_bf16 a[144:147], v[108:111], v[124:127], a[144:147]
    v_mfma_f32_16x16x32_bf16 a[148:151], v[108:111], v[128:131], a[148:151]
    v_mfma_f32_16x16x32_bf16 a[152:155], v[108:111], v[132:135], a[152:155]
    v_mfma_f32_16x16x32_bf16 a[156:159], v[108:111], v[136:139], a[156:159]
    v_mfma_f32_16x16x32_bf16 a[160:163], v[108:111], v[140:143], a[160:163]
    v_mfma_f32_16x16x32_bf16 a[164:167], v[108:111], v[144:147], a[164:167]
    v_mfma_f32_16x16x32_bf16 a[168:171], v[112:115], v[120:123], a[168:171]
    v_mfma_f32_16x16x32_bf16 a[172:175], v[112:115], v[124:127], a[172:175]
    v_mfma_f32_16x16x32_bf16 a[176:179], v[112:115], v[128:131], a[176:179]
    v_mfma_f32_16x16x32_bf16 a[180:183], v[112:115], v[132:135], a[180:183]
    v_mfma_f32_16x16x32_bf16 a[184:187], v[112:115], v[136:139], a[184:187]
    v_mfma_f32_16x16x32_bf16 a[188:191], v[112:115], v[140:143], a[188:191]
    v_mfma_f32_16x16x32_bf16 a[192:195], v[112:115], v[144:147], a[192:195]
    v_mfma_f32_16x16x32_bf16 a[196:199], v[116:119], v[120:123], a[196:199]
    v_mfma_f32_16x16x32_bf16 a[200:203], v[116:119], v[124:127], a[200:203]
    v_mfma_f32_16x16x32_bf16 a[204:207], v[116:119], v[128:131], a[204:207]
    v_mfma_f32_16x16x32_bf16 a[208:211], v[116:119], v[132:135], a[208:211]
    v_mfma_f32_16x16x32_bf16 a[212:215], v[116:119], v[136:139], a[212:215]
    v_mfma_f32_16x16x32_bf16 a[216:219], v[116:119], v[140:143], a[216:219]
    v_mfma_f32_16x16x32_bf16 a[220:223], v[116:119], v[144:147], a[220:223]
    s_nop 7
    s_nop 7
    s_barrier
    v_lshrrev_b32 v5, 1, v3
    v_and_b32 v5, 3, v5
    v_lshrrev_b32 v6, 1, v4
    v_xor_b32 v6, v6, v5
    v_xor_b32 v7, 2, v6
    v_and_b32 v5, 1, v4
    v_lshlrev_b32 v5, 3, v5
    v_lshl_add_u32 v5, v3, 6, v5
    v_mul_u32_u24 v12, 28672, v2
    v_add_u32 v5, v5, v12
    v_lshl_add_u32 v12, v6, 4, v5
    v_lshl_add_u32 v13, v7, 4, v5
    v_accvgpr_read_b32 v28, a0
    v_accvgpr_read_b32 v29, a1
    v_accvgpr_read_b32 v30, a2
    v_accvgpr_read_b32 v31, a3
    v_cvt_pk_bf16_f32 v32, v28, v29
    v_cvt_pk_bf16_f32 v33, v30, v31
    ds_write_b64 v12, v[32:33] offset:0
    v_accvgpr_read_b32 v44, a4
    v_accvgpr_read_b32 v45, a5
    v_accvgpr_read_b32 v46, a6
    v_accvgpr_read_b32 v47, a7
    v_cvt_pk_bf16_f32 v48, v44, v45
    v_cvt_pk_bf16_f32 v49, v46, v47
    ds_write_b64 v12, v[48:49] offset:1024
    v_accvgpr_read_b32 v60, a8
    v_accvgpr_read_b32 v61, a9
    v_accvgpr_read_b32 v62, a10
    v_accvgpr_read_b32 v63, a11
    v_cvt_pk_bf16_f32 v64, v60, v61
    v_cvt_pk_bf16_f32 v65, v62, v63
    ds_write_b64 v12, v[64:65] offset:2048
    v_accvgpr_read_b32 v76, a12
    v_accvgpr_read_b32 v77, a13
    v_accvgpr_read_b32 v78, a14
    v_accvgpr_read_b32 v79, a15
    v_cvt_pk_bf16_f32 v80, v76, v77
    v_cvt_pk_bf16_f32 v81, v78, v79
    ds_write_b64 v12, v[80:81] offset:3072
    v_accvgpr_read_b32 v28, a16
    v_accvgpr_read_b32 v29, a17
    v_accvgpr_read_b32 v30, a18
    v_accvgpr_read_b32 v31, a19
    v_cvt_pk_bf16_f32 v32, v28, v29
    v_cvt_pk_bf16_f32 v33, v30, v31
    ds_write_b64 v12, v[32:33] offset:4096
    v_accvgpr_read_b32 v44, a20
    v_accvgpr_read_b32 v45, a21
    v_accvgpr_read_b32 v46, a22
    v_accvgpr_read_b32 v47, a23
    v_cvt_pk_bf16_f32 v48, v44, v45
    v_cvt_pk_bf16_f32 v49, v46, v47
    ds_write_b64 v12, v[48:49] offset:5120
    v_accvgpr_read_b32 v60, a24
    v_accvgpr_read_b32 v61, a25
    v_accvgpr_read_b32 v62, a26
    v_accvgpr_read_b32 v63, a27
    v_cvt_pk_bf16_f32 v64, v60, v61
    v_cvt_pk_bf16_f32 v65, v62, v63
    ds_write_b64 v12, v[64:65] offset:6144
    v_accvgpr_read_b32 v76, a28
    v_accvgpr_read_b32 v77, a29
    v_accvgpr_read_b32 v78, a30
    v_accvgpr_read_b32 v79, a31
    v_cvt_pk_bf16_f32 v80, v76, v77
    v_cvt_pk_bf16_f32 v81, v78, v79
    ds_write_b64 v13, v[80:81] offset:0
    v_accvgpr_read_b32 v28, a32
    v_accvgpr_read_b32 v29, a33
    v_accvgpr_read_b32 v30, a34
    v_accvgpr_read_b32 v31, a35
    v_cvt_pk_bf16_f32 v32, v28, v29
    v_cvt_pk_bf16_f32 v33, v30, v31
    ds_write_b64 v13, v[32:33] offset:1024
    v_accvgpr_read_b32 v44, a36
    v_accvgpr_read_b32 v45, a37
    v_accvgpr_read_b32 v46, a38
    v_accvgpr_read_b32 v47, a39
    v_cvt_pk_bf16_f32 v48, v44, v45
    v_cvt_pk_bf16_f32 v49, v46, v47
    ds_write_b64 v13, v[48:49] offset:2048
    v_accvgpr_read_b32 v60, a40
    v_accvgpr_read_b32 v61, a41
    v_accvgpr_read_b32 v62, a42
    v_accvgpr_read_b32 v63, a43
    v_cvt_pk_bf16_f32 v64, v60, v61
    v_cvt_pk_bf16_f32 v65, v62, v63
    ds_write_b64 v13, v[64:65] offset:3072
    v_accvgpr_read_b32 v76, a44
    v_accvgpr_read_b32 v77, a45
    v_accvgpr_read_b32 v78, a46
    v_accvgpr_read_b32 v79, a47
    v_cvt_pk_bf16_f32 v80, v76, v77
    v_cvt_pk_bf16_f32 v81, v78, v79
    ds_write_b64 v13, v[80:81] offset:4096
    v_accvgpr_read_b32 v28, a48
    v_accvgpr_read_b32 v29, a49
    v_accvgpr_read_b32 v30, a50
    v_accvgpr_read_b32 v31, a51
    v_cvt_pk_bf16_f32 v32, v28, v29
    v_cvt_pk_bf16_f32 v33, v30, v31
    ds_write_b64 v13, v[32:33] offset:5120
    v_accvgpr_read_b32 v44, a52
    v_accvgpr_read_b32 v45, a53
    v_accvgpr_read_b32 v46, a54
    v_accvgpr_read_b32 v47, a55
    v_cvt_pk_bf16_f32 v48, v44, v45
    v_cvt_pk_bf16_f32 v49, v46, v47
    ds_write_b64 v13, v[48:49] offset:6144
    v_accvgpr_read_b32 v60, a56
    v_accvgpr_read_b32 v61, a57
    v_accvgpr_read_b32 v62, a58
    v_accvgpr_read_b32 v63, a59
    v_cvt_pk_bf16_f32 v64, v60, v61
    v_cvt_pk_bf16_f32 v65, v62, v63
    ds_write_b64 v12, v[64:65] offset:7168
    v_accvgpr_read_b32 v76, a60
    v_accvgpr_read_b32 v77, a61
    v_accvgpr_read_b32 v78, a62
    v_accvgpr_read_b32 v79, a63
    v_cvt_pk_bf16_f32 v80, v76, v77
    v_cvt_pk_bf16_f32 v81, v78, v79
    ds_write_b64 v12, v[80:81] offset:8192
    v_accvgpr_read_b32 v28, a64
    v_accvgpr_read_b32 v29, a65
    v_accvgpr_read_b32 v30, a66
    v_accvgpr_read_b32 v31, a67
    v_cvt_pk_bf16_f32 v32, v28, v29
    v_cvt_pk_bf16_f32 v33, v30, v31
    ds_write_b64 v12, v[32:33] offset:9216
    v_accvgpr_read_b32 v44, a68
    v_accvgpr_read_b32 v45, a69
    v_accvgpr_read_b32 v46, a70
    v_accvgpr_read_b32 v47, a71
    v_cvt_pk_bf16_f32 v48, v44, v45
    v_cvt_pk_bf16_f32 v49, v46, v47
    ds_write_b64 v12, v[48:49] offset:10240
    v_accvgpr_read_b32 v60, a72
    v_accvgpr_read_b32 v61, a73
    v_accvgpr_read_b32 v62, a74
    v_accvgpr_read_b32 v63, a75
    v_cvt_pk_bf16_f32 v64, v60, v61
    v_cvt_pk_bf16_f32 v65, v62, v63
    ds_write_b64 v12, v[64:65] offset:11264
    v_accvgpr_read_b32 v76, a76
    v_accvgpr_read_b32 v77, a77
    v_accvgpr_read_b32 v78, a78
    v_accvgpr_read_b32 v79, a79
    v_cvt_pk_bf16_f32 v80, v76, v77
    v_cvt_pk_bf16_f32 v81, v78, v79
    ds_write_b64 v12, v[80:81] offset:12288
    v_accvgpr_read_b32 v28, a80
    v_accvgpr_read_b32 v29, a81
    v_accvgpr_read_b32 v30, a82
    v_accvgpr_read_b32 v31, a83
    v_cvt_pk_bf16_f32 v32, v28, v29
    v_cvt_pk_bf16_f32 v33, v30, v31
    ds_write_b64 v12, v[32:33] offset:13312
    v_accvgpr_read_b32 v44, a84
    v_accvgpr_read_b32 v45, a85
    v_accvgpr_read_b32 v46, a86
    v_accvgpr_read_b32 v47, a87
    v_cvt_pk_bf16_f32 v48, v44, v45
    v_cvt_pk_bf16_f32 v49, v46, v47
    ds_write_b64 v13, v[48:49] offset:7168
    v_accvgpr_read_b32 v60, a88
    v_accvgpr_read_b32 v61, a89
    v_accvgpr_read_b32 v62, a90
    v_accvgpr_read_b32 v63, a91
    v_cvt_pk_bf16_f32 v64, v60, v61
    v_cvt_pk_bf16_f32 v65, v62, v63
    ds_write_b64 v13, v[64:65] offset:8192
    v_accvgpr_read_b32 v76, a92
    v_accvgpr_read_b32 v77, a93
    v_accvgpr_read_b32 v78, a94
    v_accvgpr_read_b32 v79, a95
    v_cvt_pk_bf16_f32 v80, v76, v77
    v_cvt_pk_bf16_f32 v81, v78, v79
    ds_write_b64 v13, v[80:81] offset:9216
    v_accvgpr_read_b32 v28, a96
    v_accvgpr_read_b32 v29, a97
    v_accvgpr_read_b32 v30, a98
    v_accvgpr_read_b32 v31, a99
    v_cvt_pk_bf16_f32 v32, v28, v29
    v_cvt_pk_bf16_f32 v33, v30, v31
    ds_write_b64 v13, v[32:33] offset:10240
    v_accvgpr_read_b32 v44, a100
    v_accvgpr_read_b32 v45, a101
    v_accvgpr_read_b32 v46, a102
    v_accvgpr_read_b32 v47, a103
    v_cvt_pk_bf16_f32 v48, v44, v45
    v_cvt_pk_bf16_f32 v49, v46, v47
    ds_write_b64 v13, v[48:49] offset:11264
    v_accvgpr_read_b32 v60, a104
    v_accvgpr_read_b32 v61, a105
    v_accvgpr_read_b32 v62, a106
    v_accvgpr_read_b32 v63, a107
    v_cvt_pk_bf16_f32 v64, v60, v61
    v_cvt_pk_bf16_f32 v65, v62, v63
    ds_write_b64 v13, v[64:65] offset:12288
    v_accvgpr_read_b32 v76, a108
    v_accvgpr_read_b32 v77, a109
    v_accvgpr_read_b32 v78, a110
    v_accvgpr_read_b32 v79, a111
    v_cvt_pk_bf16_f32 v80, v76, v77
    v_cvt_pk_bf16_f32 v81, v78, v79
    ds_write_b64 v13, v[80:81] offset:13312
    v_accvgpr_read_b32 v28, a112
    v_accvgpr_read_b32 v29, a113
    v_accvgpr_read_b32 v30, a114
    v_accvgpr_read_b32 v31, a115
    v_cvt_pk_bf16_f32 v32, v28, v29
    v_cvt_pk_bf16_f32 v33, v30, v31
    ds_write_b64 v12, v[32:33] offset:14336
    v_accvgpr_read_b32 v44, a116
    v_accvgpr_read_b32 v45, a117
    v_accvgpr_read_b32 v46, a118
    v_accvgpr_read_b32 v47, a119
    v_cvt_pk_bf16_f32 v48, v44, v45
    v_cvt_pk_bf16_f32 v49, v46, v47
    ds_write_b64 v12, v[48:49] offset:15360
    v_accvgpr_read_b32 v60, a120
    v_accvgpr_read_b32 v61, a121
    v_accvgpr_read_b32 v62, a122
    v_accvgpr_read_b32 v63, a123
    v_cvt_pk_bf16_f32 v64, v60, v61
    v_cvt_pk_bf16_f32 v65, v62, v63
    ds_write_b64 v12, v[64:65] offset:16384
    v_accvgpr_read_b32 v76, a124
    v_accvgpr_read_b32 v77, a125
    v_accvgpr_read_b32 v78, a126
    v_accvgpr_read_b32 v79, a127
    v_cvt_pk_bf16_f32 v80, v76, v77
    v_cvt_pk_bf16_f32 v81, v78, v79
    ds_write_b64 v12, v[80:81] offset:17408
    v_accvgpr_read_b32 v28, a128
    v_accvgpr_read_b32 v29, a129
    v_accvgpr_read_b32 v30, a130
    v_accvgpr_read_b32 v31, a131
    v_cvt_pk_bf16_f32 v32, v28, v29
    v_cvt_pk_bf16_f32 v33, v30, v31
    ds_write_b64 v12, v[32:33] offset:18432
    v_accvgpr_read_b32 v44, a132
    v_accvgpr_read_b32 v45, a133
    v_accvgpr_read_b32 v46, a134
    v_accvgpr_read_b32 v47, a135
    v_cvt_pk_bf16_f32 v48, v44, v45
    v_cvt_pk_bf16_f32 v49, v46, v47
    ds_write_b64 v12, v[48:49] offset:19456
    v_accvgpr_read_b32 v60, a136
    v_accvgpr_read_b32 v61, a137
    v_accvgpr_read_b32 v62, a138
    v_accvgpr_read_b32 v63, a139
    v_cvt_pk_bf16_f32 v64, v60, v61
    v_cvt_pk_bf16_f32 v65, v62, v63
    ds_write_b64 v12, v[64:65] offset:20480
    v_accvgpr_read_b32 v76, a140
    v_accvgpr_read_b32 v77, a141
    v_accvgpr_read_b32 v78, a142
    v_accvgpr_read_b32 v79, a143
    v_cvt_pk_bf16_f32 v80, v76, v77
    v_cvt_pk_bf16_f32 v81, v78, v79
    ds_write_b64 v13, v[80:81] offset:14336
    v_accvgpr_read_b32 v28, a144
    v_accvgpr_read_b32 v29, a145
    v_accvgpr_read_b32 v30, a146
    v_accvgpr_read_b32 v31, a147
    v_cvt_pk_bf16_f32 v32, v28, v29
    v_cvt_pk_bf16_f32 v33, v30, v31
    ds_write_b64 v13, v[32:33] offset:15360
    v_accvgpr_read_b32 v44, a148
    v_accvgpr_read_b32 v45, a149
    v_accvgpr_read_b32 v46, a150
    v_accvgpr_read_b32 v47, a151
    v_cvt_pk_bf16_f32 v48, v44, v45
    v_cvt_pk_bf16_f32 v49, v46, v47
    ds_write_b64 v13, v[48:49] offset:16384
    v_accvgpr_read_b32 v60, a152
    v_accvgpr_read_b32 v61, a153
    v_accvgpr_read_b32 v62, a154
    v_accvgpr_read_b32 v63, a155
    v_cvt_pk_bf16_f32 v64, v60, v61
    v_cvt_pk_bf16_f32 v65, v62, v63
    ds_write_b64 v13, v[64:65] offset:17408
    v_accvgpr_read_b32 v76, a156
    v_accvgpr_read_b32 v77, a157
    v_accvgpr_read_b32 v78, a158
    v_accvgpr_read_b32 v79, a159
    v_cvt_pk_bf16_f32 v80, v76, v77
    v_cvt_pk_bf16_f32 v81, v78, v79
    ds_write_b64 v13, v[80:81] offset:18432
    v_accvgpr_read_b32 v28, a160
    v_accvgpr_read_b32 v29, a161
    v_accvgpr_read_b32 v30, a162
    v_accvgpr_read_b32 v31, a163
    v_cvt_pk_bf16_f32 v32, v28, v29
    v_cvt_pk_bf16_f32 v33, v30, v31
    ds_write_b64 v13, v[32:33] offset:19456
    v_accvgpr_read_b32 v44, a164
    v_accvgpr_read_b32 v45, a165
    v_accvgpr_read_b32 v46, a166
    v_accvgpr_read_b32 v47, a167
    v_cvt_pk_bf16_f32 v48, v44, v45
    v_cvt_pk_bf16_f32 v49, v46, v47
    ds_write_b64 v13, v[48:49] offset:20480
    v_accvgpr_read_b32 v60, a168
    v_accvgpr_read_b32 v61, a169
    v_accvgpr_read_b32 v62, a170
    v_accvgpr_read_b32 v63, a171
    v_cvt_pk_bf16_f32 v64, v60, v61
    v_cvt_pk_bf16_f32 v65, v62, v63
    ds_write_b64 v12, v[64:65] offset:21504
    v_accvgpr_read_b32 v76, a172
    v_accvgpr_read_b32 v77, a173
    v_accvgpr_read_b32 v78, a174
    v_accvgpr_read_b32 v79, a175
    v_cvt_pk_bf16_f32 v80, v76, v77
    v_cvt_pk_bf16_f32 v81, v78, v79
    ds_write_b64 v12, v[80:81] offset:22528
    v_accvgpr_read_b32 v28, a176
    v_accvgpr_read_b32 v29, a177
    v_accvgpr_read_b32 v30, a178
    v_accvgpr_read_b32 v31, a179
    v_cvt_pk_bf16_f32 v32, v28, v29
    v_cvt_pk_bf16_f32 v33, v30, v31
    ds_write_b64 v12, v[32:33] offset:23552
    v_accvgpr_read_b32 v44, a180
    v_accvgpr_read_b32 v45, a181
    v_accvgpr_read_b32 v46, a182
    v_accvgpr_read_b32 v47, a183
    v_cvt_pk_bf16_f32 v48, v44, v45
    v_cvt_pk_bf16_f32 v49, v46, v47
    ds_write_b64 v12, v[48:49] offset:24576
    v_accvgpr_read_b32 v60, a184
    v_accvgpr_read_b32 v61, a185
    v_accvgpr_read_b32 v62, a186
    v_accvgpr_read_b32 v63, a187
    v_cvt_pk_bf16_f32 v64, v60, v61
    v_cvt_pk_bf16_f32 v65, v62, v63
    ds_write_b64 v12, v[64:65] offset:25600
    v_accvgpr_read_b32 v76, a188
    v_accvgpr_read_b32 v77, a189
    v_accvgpr_read_b32 v78, a190
    v_accvgpr_read_b32 v79, a191
    v_cvt_pk_bf16_f32 v80, v76, v77
    v_cvt_pk_bf16_f32 v81, v78, v79
    ds_write_b64 v12, v[80:81] offset:26624
    v_accvgpr_read_b32 v28, a192
    v_accvgpr_read_b32 v29, a193
    v_accvgpr_read_b32 v30, a194
    v_accvgpr_read_b32 v31, a195
    v_cvt_pk_bf16_f32 v32, v28, v29
    v_cvt_pk_bf16_f32 v33, v30, v31
    ds_write_b64 v12, v[32:33] offset:27648
    v_accvgpr_read_b32 v44, a196
    v_accvgpr_read_b32 v45, a197
    v_accvgpr_read_b32 v46, a198
    v_accvgpr_read_b32 v47, a199
    v_cvt_pk_bf16_f32 v48, v44, v45
    v_cvt_pk_bf16_f32 v49, v46, v47
    ds_write_b64 v13, v[48:49] offset:21504
    v_accvgpr_read_b32 v60, a200
    v_accvgpr_read_b32 v61, a201
    v_accvgpr_read_b32 v62, a202
    v_accvgpr_read_b32 v63, a203
    v_cvt_pk_bf16_f32 v64, v60, v61
    v_cvt_pk_bf16_f32 v65, v62, v63
    ds_write_b64 v13, v[64:65] offset:22528
    v_accvgpr_read_b32 v76, a204
    v_accvgpr_read_b32 v77, a205
    v_accvgpr_read_b32 v78, a206
    v_accvgpr_read_b32 v79, a207
    v_cvt_pk_bf16_f32 v80, v76, v77
    v_cvt_pk_bf16_f32 v81, v78, v79
    ds_write_b64 v13, v[80:81] offset:23552
    v_accvgpr_read_b32 v28, a208
    v_accvgpr_read_b32 v29, a209
    v_accvgpr_read_b32 v30, a210
    v_accvgpr_read_b32 v31, a211
    v_cvt_pk_bf16_f32 v32, v28, v29
    v_cvt_pk_bf16_f32 v33, v30, v31
    ds_write_b64 v13, v[32:33] offset:24576
    v_accvgpr_read_b32 v44, a212
    v_accvgpr_read_b32 v45, a213
    v_accvgpr_read_b32 v46, a214
    v_accvgpr_read_b32 v47, a215
    v_cvt_pk_bf16_f32 v48, v44, v45
    v_cvt_pk_bf16_f32 v49, v46, v47
    ds_write_b64 v13, v[48:49] offset:25600
    v_accvgpr_read_b32 v60, a216
    v_accvgpr_read_b32 v61, a217
    v_accvgpr_read_b32 v62, a218
    v_accvgpr_read_b32 v63, a219
    v_cvt_pk_bf16_f32 v64, v60, v61
    v_cvt_pk_bf16_f32 v65, v62, v63
    ds_write_b64 v13, v[64:65] offset:26624
    v_accvgpr_read_b32 v76, a220
    v_accvgpr_read_b32 v77, a221
    v_accvgpr_read_b32 v78, a222
    v_accvgpr_read_b32 v79, a223
    v_cvt_pk_bf16_f32 v80, v76, v77
    v_cvt_pk_bf16_f32 v81, v78, v79
    ds_write_b64 v13, v[80:81] offset:27648
    v_lshlrev_b32 v7, 4, v1
    v_mul_u32_u24 v5, 28672, v2
    v_add_u32 v7, v7, v5
    v_lshrrev_b32 v5, 3, v1
    v_and_b32 v5, 3, v5
    v_and_b32 v6, 3, v1
    v_xor_b32 v6, v6, v5
    v_lshrrev_b32 v5, 2, v1
    v_lshlrev_b32 v5, 6, v5
    v_lshl_add_u32 v5, v6, 4, v5
    s_lshr_b32 s27, s20, 1
    s_and_b32 s26, s20, 1
    s_mul_i32 s26, s26, 224
    s_mul_i32 s27, s27, 448
    s_add_u32 s26, s26, s27
    s_mul_i32 s27, s21, 57344
    s_add_u32 s26, s26, s27
    v_mul_u32_u24 v10, 28672, v8
    v_mul_u32_u24 v11, 112, v9
    v_add3_u32 v10, v10, v11, s26
    v_lshlrev_b32 v10, 6, v10
    v_add_u32 v5, v5, v10
    s_waitcnt lgkmcnt(0)
    ds_read_b128 v[28:31], v7 offset:0
    ds_read_b128 v[32:35], v7 offset:1024
    ds_read_b128 v[36:39], v7 offset:2048
    ds_read_b128 v[40:43], v7 offset:3072
    ds_read_b128 v[44:47], v7 offset:4096
    ds_read_b128 v[48:51], v7 offset:5120
    ds_read_b128 v[52:55], v7 offset:6144
    s_waitcnt lgkmcnt(6)
    s_mov_b32 s28, 67108864
    buffer_store_dwordx4 v[28:31], v5, s[4:7], s28 offen sc0 sc1
    s_waitcnt lgkmcnt(5)
    s_mov_b32 s28, 67109888
    buffer_store_dwordx4 v[32:35], v5, s[4:7], s28 offen sc0 sc1
    s_waitcnt lgkmcnt(4)
    s_mov_b32 s28, 67110912
    buffer_store_dwordx4 v[36:39], v5, s[4:7], s28 offen sc0 sc1
    s_waitcnt lgkmcnt(3)
    s_mov_b32 s28, 67111936
    buffer_store_dwordx4 v[40:43], v5, s[4:7], s28 offen sc0 sc1
    s_waitcnt lgkmcnt(2)
    s_mov_b32 s28, 67112960
    buffer_store_dwordx4 v[44:47], v5, s[4:7], s28 offen sc0 sc1
    s_waitcnt lgkmcnt(1)
    s_mov_b32 s28, 67113984
    buffer_store_dwordx4 v[48:51], v5, s[4:7], s28 offen sc0 sc1
    s_waitcnt lgkmcnt(0)
    s_mov_b32 s28, 67115008
    buffer_store_dwordx4 v[52:55], v5, s[4:7], s28 offen sc0 sc1
    ds_read_b128 v[28:31], v7 offset:7168
    ds_read_b128 v[32:35], v7 offset:8192
    ds_read_b128 v[36:39], v7 offset:9216
    ds_read_b128 v[40:43], v7 offset:10240
    ds_read_b128 v[44:47], v7 offset:11264
    ds_read_b128 v[48:51], v7 offset:12288
    ds_read_b128 v[52:55], v7 offset:13312
    s_waitcnt lgkmcnt(6)
    s_mov_b32 s28, 67567616
    buffer_store_dwordx4 v[28:31], v5, s[4:7], s28 offen sc0 sc1
    s_waitcnt lgkmcnt(5)
    s_mov_b32 s28, 67568640
    buffer_store_dwordx4 v[32:35], v5, s[4:7], s28 offen sc0 sc1
    s_waitcnt lgkmcnt(4)
    s_mov_b32 s28, 67569664
    buffer_store_dwordx4 v[36:39], v5, s[4:7], s28 offen sc0 sc1
    s_waitcnt lgkmcnt(3)
    s_mov_b32 s28, 67570688
    buffer_store_dwordx4 v[40:43], v5, s[4:7], s28 offen sc0 sc1
    s_waitcnt lgkmcnt(2)
    s_mov_b32 s28, 67571712
    buffer_store_dwordx4 v[44:47], v5, s[4:7], s28 offen sc0 sc1
    s_waitcnt lgkmcnt(1)
    s_mov_b32 s28, 67572736
    buffer_store_dwordx4 v[48:51], v5, s[4:7], s28 offen sc0 sc1
    s_waitcnt lgkmcnt(0)
    s_mov_b32 s28, 67573760
    buffer_store_dwordx4 v[52:55], v5, s[4:7], s28 offen sc0 sc1
    ds_read_b128 v[28:31], v7 offset:14336
    ds_read_b128 v[32:35], v7 offset:15360
    ds_read_b128 v[36:39], v7 offset:16384
    ds_read_b128 v[40:43], v7 offset:17408
    ds_read_b128 v[44:47], v7 offset:18432
    ds_read_b128 v[48:51], v7 offset:19456
    ds_read_b128 v[52:55], v7 offset:20480
    s_waitcnt lgkmcnt(6)
    s_mov_b32 s28, 68026368
    buffer_store_dwordx4 v[28:31], v5, s[4:7], s28 offen sc0 sc1
    s_waitcnt lgkmcnt(5)
    s_mov_b32 s28, 68027392
    buffer_store_dwordx4 v[32:35], v5, s[4:7], s28 offen sc0 sc1
    s_waitcnt lgkmcnt(4)
    s_mov_b32 s28, 68028416
    buffer_store_dwordx4 v[36:39], v5, s[4:7], s28 offen sc0 sc1
    s_waitcnt lgkmcnt(3)
    s_mov_b32 s28, 68029440
    buffer_store_dwordx4 v[40:43], v5, s[4:7], s28 offen sc0 sc1
    s_waitcnt lgkmcnt(2)
    s_mov_b32 s28, 68030464
    buffer_store_dwordx4 v[44:47], v5, s[4:7], s28 offen sc0 sc1
    s_waitcnt lgkmcnt(1)
    s_mov_b32 s28, 68031488
    buffer_store_dwordx4 v[48:51], v5, s[4:7], s28 offen sc0 sc1
    s_waitcnt lgkmcnt(0)
    s_mov_b32 s28, 68032512
    buffer_store_dwordx4 v[52:55], v5, s[4:7], s28 offen sc0 sc1
    ds_read_b128 v[28:31], v7 offset:21504
    ds_read_b128 v[32:35], v7 offset:22528
    ds_read_b128 v[36:39], v7 offset:23552
    ds_read_b128 v[40:43], v7 offset:24576
    ds_read_b128 v[44:47], v7 offset:25600
    ds_read_b128 v[48:51], v7 offset:26624
    ds_read_b128 v[52:55], v7 offset:27648
    s_waitcnt lgkmcnt(6)
    s_mov_b32 s28, 68485120
    buffer_store_dwordx4 v[28:31], v5, s[4:7], s28 offen sc0 sc1
    s_waitcnt lgkmcnt(5)
    s_mov_b32 s28, 68486144
    buffer_store_dwordx4 v[32:35], v5, s[4:7], s28 offen sc0 sc1
    s_waitcnt lgkmcnt(4)
    s_mov_b32 s28, 68487168
    buffer_store_dwordx4 v[36:39], v5, s[4:7], s28 offen sc0 sc1
    s_waitcnt lgkmcnt(3)
    s_mov_b32 s28, 68488192
    buffer_store_dwordx4 v[40:43], v5, s[4:7], s28 offen sc0 sc1
    s_waitcnt lgkmcnt(2)
    s_mov_b32 s28, 68489216
    buffer_store_dwordx4 v[44:47], v5, s[4:7], s28 offen sc0 sc1
    s_waitcnt lgkmcnt(1)
    s_mov_b32 s28, 68490240
    buffer_store_dwordx4 v[48:51], v5, s[4:7], s28 offen sc0 sc1
    s_waitcnt lgkmcnt(0)
    s_mov_b32 s28, 68491264
    buffer_store_dwordx4 v[52:55], v5, s[4:7], s28 offen sc0 sc1
    s_lshl_b32 s22, s21, 2
    s_add_u32 s22, s22, 64
    s_waitcnt vmcnt(0) lgkmcnt(0)
    s_barrier
    s_cmp_lg_u32 s14, 0
    s_cbranch_scc1 chain_kernel_sig8
    s_mov_b64 exec, 1
    v_mov_b32 v6, s22
    v_mov_b32 v5, 1
    buffer_atomic_add v5, v6, s[8:11], 0 offen sc1
    s_mov_b64 exec, -1
chain_kernel_sig8:
    s_mov_b32 s18, s19
chain_kernel_wq:
    s_and_b32 s20, s18, 31
    s_lshr_b32 s21, s18, 5
    s_mul_i32 s24, s21, 229376
    s_add_u32 s24, s24, 0
    s_mul_i32 s25, s20, 200704
    s_add_u32 s25, s25, 12582912
    v_lshrrev_b32 v6, 3, v1
    v_and_b32 v5, 7, v1
    v_xor_b32 v5, v5, v6
    v_lshl_add_u32 v6, v2, 3, v6
    v_mul_u32_u24 v16, 896, v6
    v_lshl_add_u32 v16, v5, 4, v16
    v_mul_u32_u24 v17, 896, v6
    v_lshl_add_u32 v17, v5, 4, v17
    s_add_u32 s60, s24, 0
    s_add_u32 s61, s24, 28672
    s_add_u32 s62, s24, 57344
    s_add_u32 s63, s24, 86016
    s_add_u32 s64, s24, 114688
    s_add_u32 s65, s24, 143360
    s_add_u32 s66, s24, 172032
    s_add_u32 s67, s24, 200704
    s_add_u32 s68, s25, 0
    s_add_u32 s69, s25, 28672
    s_add_u32 s70, s25, 57344
    s_add_u32 s71, s25, 86016
    s_add_u32 s72, s25, 114688
    s_add_u32 s73, s25, 143360
    s_add_u32 s74, s25, 172032
    s_lshl_b32 s75, s14, 10
    v_and_b32 v7, 7, v3
    v_xor_b32 v7, v7, v4
    v_lshlrev_b32 v7, 4, v7
    v_lshl_add_u32 v7, v3, 7, v7
    v_lshrrev_b32 v8, 1, v2
    v_and_b32 v9, 1, v2
    v_mul_u32_u24 v10, 16384, v8
    v_mul_u32_u24 v11, 14336, v9
    v_add_u32 v10, v10, v7
    v_add_u32 v11, v11, v7
    v_add_u32 v11, 32768, v11
    v_mov_b32 v18, v10
    v_xor_b32 v20, 64, v10
    v_add_u32 v19, 61440, v18
    v_add_u32 v21, 61440, v20
    v_mov_b32 v22, v11
    v_xor_b32 v24, 64, v11
    v_add_u32 v23, 61440, v22
    v_add_u32 v25, 61440, v24
    s_add_u32 m0, s75, 0
    s_nop 0
    buffer_load_dwordx4 v16, s[4:7], s60 offen  lds
    s_add_u32 s60, s60, 128
    s_add_u32 m0, s75, 4096
    s_nop 0
    buffer_load_dwordx4 v16, s[4:7], s61 offen  lds
    s_add_u32 s61, s61, 128
    s_add_u32 m0, s75, 8192
    s_nop 0
    buffer_load_dwordx4 v16, s[4:7], s62 offen  lds
    s_add_u32 s62, s62, 128
    s_add_u32 m0, s75, 12288
    s_nop 0
    buffer_load_dwordx4 v16, s[4:7], s63 offen  lds
    s_add_u32 s63, s63, 128
    s_add_u32 m0, s75, 16384
    s_nop 0
    buffer_load_dwordx4 v16, s[4:7], s64 offen  lds
    s_add_u32 s64, s64, 128
    s_add_u32 m0, s75, 20480
    s_nop 0
    buffer_load_dwordx4 v16, s[4:7], s65 offen  lds
    s_add_u32 s65, s65, 128
    s_add_u32 m0, s75, 24576
    s_nop 0
    buffer_load_dwordx4 v16, s[4:7], s66 offen  lds
    s_add_u32 s66, s66, 128
    s_add_u32 m0, s75, 28672
    s_nop 0
    buffer_load_dwordx4 v16, s[4:7], s67 offen  lds
    s_add_u32 s67, s67, 128
    s_add_u32 m0, s75, 32768
    s_nop 0
    buffer_load_dwordx4 v17, s[4:7], s68 offen  lds
    s_add_u32 s68, s68, 128
    s_add_u32 m0, s75, 36864
    s_nop 0
    buffer_load_dwordx4 v17, s[4:7], s69 offen  lds
    s_add_u32 s69, s69, 128
    s_add_u32 m0, s75, 40960
    s_nop 0
    buffer_load_dwordx4 v17, s[4:7], s70 offen  lds
    s_add_u32 s70, s70, 128
    s_add_u32 m0, s75, 45056
    s_nop 0
    buffer_load_dwordx4 v17, s[4:7], s71 offen  lds
    s_add_u32 s71, s71, 128
    s_add_u32 m0, s75, 49152
    s_nop 0
    buffer_load_dwordx4 v17, s[4:7], s72 offen  lds
    s_add_u32 s72, s72, 128
    s_add_u32 m0, s75, 53248
    s_nop 0
    buffer_load_dwordx4 v17, s[4:7], s73 offen  lds
    s_add_u32 s73, s73, 128
    s_add_u32 m0, s75, 57344
    s_nop 0
    buffer_load_dwordx4 v17, s[4:7], s74 offen  lds
    s_add_u32 s74, s74, 128
    s_add_u32 m0, s75, 61440
    s_nop 0
    buffer_load_dwordx4 v16, s[4:7], s60 offen  lds
    s_add_u32 s60, s60, 128
    s_add_u32 m0, s75, 65536
    s_nop 0
    buffer_load_dwordx4 v16, s[4:7], s61 offen  lds
    s_add_u32 s61, s61, 128
    s_add_u32 m0, s75, 69632
    s_nop 0
    buffer_load_dwordx4 v16, s[4:7], s62 offen  lds
    s_add_u32 s62, s62, 128
    s_add_u32 m0, s75, 73728
    s_nop 0
    buffer_load_dwordx4 v16, s[4:7], s63 offen  lds
    s_add_u32 s63, s63, 128
    s_add_u32 m0, s75, 77824
    s_nop 0
    buffer_load_dwordx4 v16, s[4:7], s64 offen  lds
    s_add_u32 s64, s64, 128
    s_add_u32 m0, s75, 81920
    s_nop 0
    buffer_load_dwordx4 v16, s[4:7], s65 offen  lds
    s_add_u32 s65, s65, 128
    s_add_u32 m0, s75, 86016
    s_nop 0
    buffer_load_dwordx4 v16, s[4:7], s66 offen  lds
    s_add_u32 s66, s66, 128
    s_add_u32 m0, s75, 90112
    s_nop 0
    buffer_load_dwordx4 v16, s[4:7], s67 offen  lds
    s_add_u32 s67, s67, 128
    s_add_u32 m0, s75, 94208
    s_nop 0
    buffer_load_dwordx4 v17, s[4:7], s68 offen  lds
    s_add_u32 s68, s68, 128
    s_add_u32 m0, s75, 98304
    s_nop 0
    buffer_load_dwordx4 v17, s[4:7], s69 offen  lds
    s_add_u32 s69, s69, 128
    s_add_u32 m0, s75, 102400
    s_nop 0
    buffer_load_dwordx4 v17, s[4:7], s70 offen  lds
    s_add_u32 s70, s70, 128
    s_add_u32 m0, s75, 106496
    s_nop 0
    buffer_load_dwordx4 v17, s[4:7], s71 offen  lds
    s_add_u32 s71, s71, 128
    s_add_u32 m0, s75, 110592
    s_nop 0
    buffer_load_dwordx4 v17, s[4:7], s72 offen  lds
    s_add_u32 s72, s72, 128
    s_add_u32 m0, s75, 114688
    s_nop 0
    buffer_load_dwordx4 v17, s[4:7], s73 offen  lds
    s_add_u32 s73, s73, 128
    s_add_u32 m0, s75, 118784
    s_nop 0
    buffer_load_dwordx4 v17, s[4:7], s74 offen  lds
    s_add_u32 s74, s74, 128
    s_waitcnt vmcnt(15)
    s_barrier
    ds_read_b128 v[60:63], v22 offset:0
    ds_read_b128 v[64:67], v22 offset:2048
    ds_read_b128 v[68:71], v22 offset:4096
    ds_read_b128 v[72:75], v22 offset:6144
    ds_read_b128 v[76:79], v22 offset:8192
    ds_read_b128 v[80:83], v22 offset:10240
    ds_read_b128 v[84:87], v22 offset:12288
    ds_read_b128 v[28:31], v18 offset:0
    ds_read_b128 v[32:35], v18 offset:2048
    ds_read_b128 v[36:39], v18 offset:4096
    ds_read_b128 v[40:43], v18 offset:6144
    ds_read_b128 v[44:47], v18 offset:8192
    ds_read_b128 v[48:51], v18 offset:10240
    ds_read_b128 v[52:55], v18 offset:12288
    ds_read_b128 v[56:59], v18 offset:14336
    s_waitcnt lgkmcnt(0)
    v_mfma_f32_16x16x32_bf16 a[0:3], v[60:63], v[28:31], 0
    v_mfma_f32_16x16x32_bf16 a[4:7], v[64:67], v[28:31], 0
    v_mfma_f32_16x16x32_bf16 a[8:11], v[68:71], v[28:31], 0
    v_mfma_f32_16x16x32_bf16 a[12:15], v[72:75], v[28:31], 0
    ds_read_b128 v[120:123], v24 offset:0
    v_mfma_f32_16x16x32_bf16 a[16:19], v[76:79], v[28:31], 0
    v_mfma_f32_16x16x32_bf16 a[20:23], v[80:83], v[28:31], 0
    v_mfma_f32_16x16x32_bf16 a[24:27], v[84:87], v[28:31], 0
    v_mfma_f32_16x16x32_bf16 a[28:31], v[60:63], v[32:35], 0
    ds_read_b128 v[124:127], v24 offset:2048
    v_mfma_f32_16x16x32_bf16 a[32:35], v[64:67], v[32:35], 0
    v_mfma_f32_16x16x32_bf16 a[36:39], v[68:71], v[32:35], 0
    v_mfma_f32_16x16x32_bf16 a[40:43], v[72:75], v[32:35], 0
    v_mfma_f32_16x16x32_bf16 a[44:47], v[76:79], v[32:35], 0
    ds_read_b128 v[128:131], v24 offset:4096
    v_mfma_f32_16x16x32_bf16 a[48:51], v[80:83], v[32:35], 0
    v_mfma_f32_16x16x32_bf16 a[52:55], v[84:87], v[32:35], 0
    v_mfma_f32_16x16x32_bf16 a[56:59], v[60:63], v[36:39], 0
    ds_read_b128 v[132:135], v24 offset:6144
    v_mfma_f32_16x16x32_bf16 a[60:63], v[64:67], v[36:39], 0
    v_mfma_f32_16x16x32_bf16 a[64:67], v[68:71], v[36:39], 0
    v_mfma_f32_16x16x32_bf16 a[68:71], v[72:75], v[36:39], 0
    v_mfma_f32_16x16x32_bf16 a[72:75], v[76:79], v[36:39], 0
    ds_read_b128 v[136:139], v24 offset:8192
    v_mfma_f32_16x16x32_bf16 a[76:79], v[80:83], v[36:39], 0
    v_mfma_f32_16x16x32_bf16 a[80:83], v[84:87], v[36:39], 0
    v_mfma_f32_16x16x32_bf16 a[84:87], v[60:63], v[40:43], 0
    v_mfma_f32_16x16x32_bf16 a[88:91], v[64:67], v[40:43], 0
    ds_read_b128 v[140:143], v24 offset:10240
    v_mfma_f32_16x16x32_bf16 a[92:95], v[68:71], v[40:43], 0
    v_mfma_f32_16x16x32_bf16 a[96:99], v[72:75], v[40:43], 0
    v_mfma_f32_16x16x32_bf16 a[100:103], v[76:79], v[40:43], 0
    v_mfma_f32_16x16x32_bf16 a[104:107], v[80:83], v[40:43], 0
    ds_read_b128 v[144:147], v24 offset:12288
    v_mfma_f32_16x16x32_bf16 a[108:111], v[84:87], v[40:43], 0
    v_mfma_f32_16x16x32_bf16 a[112:115], v[60:63], v[44:47], 0
    v_mfma_f32_16x16x32_bf16 a[116:119], v[64:67], v[44:47], 0
    ds_read_b128 v[88:91], v20 offset:0
    v_mfma_f32_16x16x32_bf16 a[120:123], v[68:71], v[44:47], 0
    v_mfma_f32_16x16x32_bf16 a[124:127], v[72:75], v[44:47], 0
    v_mfma_f32_16x16x32_bf16 a[128:131], v[76:79], v[44:47], 0
    v_mfma_f32_16x16x32_bf16 a[132:135], v[80:83], v[44:47], 0
    ds_read_b128 v[92:95], v20 offset:2048
    v_mfma_f32_16x16x32_bf16 a[136:139], v[84:87], v[44:47], 0
    v_mfma_f32_16x16x32_bf16 a[140:143], v[60:63], v[48:51], 0
    v_mfma_f32_16x16x32_bf16 a[144:147], v[64:67], v[48:51], 0
    v_mfma_f32_16x16x32_bf16 a[148:151], v[68:71], v[48:51], 0
    ds_read_b128 v[96:99], v20 offset:4096
    v_mfma_f32_16x16x32_bf16 a[152:155], v[72:75], v[48:51], 0
    v_mfma_f32_16x16x32_bf16 a[156:159], v[76:79], v[48:51], 0
    v_mfma_f32_16x16x32_bf16 a[160:163], v[80:83], v[48:51], 0
    v_mfma_f32_16x16x32_bf16 a[164:167], v[84:87], v[48:51], 0
    ds_read_b128 v[100:103], v20 offset:6144
    v_mfma_f32_16x16x32_bf16 a[168:171], v[60:63], v[52:55], 0
    v_mfma_f32_16x16x32_bf16 a[172:175], v[64:67], v[52:55], 0
    v_mfma_f32_16x16x32_bf16 a[176:179], v[68:71], v[52:55], 0
    ds_read_b128 v[104:107], v20 offset:8192
    v_mfma_f32_16x16x32_bf16 a[180:183], v[72:75], v[52:55], 0
    v_mfma_f32_16x16x32_bf16 a[184:187], v[76:79], v[52:55], 0
    v_mfma_f32_16x16x32_bf16 a[188:191], v[80:83], v[52:55], 0
    v_mfma_f32_16x16x32_bf16 a[192:195], v[84:87], v[52:55], 0
    ds_read_b128 v[108:111], v20 offset:10240
    v_mfma_f32_16x16x32_bf16 a[196:199], v[60:63], v[56:59], 0
    v_mfma_f32_16x16x32_bf16 a[200:203], v[64:67], v[56:59], 0
    v_mfma_f32_16x16x32_bf16 a[204:207], v[68:71], v[56:59], 0
    v_mfma_f32_16x16x32_bf16 a[208:211], v[72:75], v[56:59], 0
    ds_read_b128 v[112:115], v20 offset:12288
    v_mfma_f32_16x16x32_bf16 a[212:215], v[76:79], v[56:59], 0
    v_mfma_f32_16x16x32_bf16 a[216:219], v[80:83], v[56:59], 0
    v_mfma_f32_16x16x32_bf16 a[220:223], v[84:87], v[56:59], 0
    ds_read_b128 v[116:119], v20 offset:14336
    s_waitcnt lgkmcnt(0) vmcnt(0)
    s_barrier
    v_mfma_f32_16x16x32_bf16 a[0:3], v[120:123], v[88:91], a[0:3]
    v_mfma_f32_16x16x32_bf16 a[4:7], v[124:127], v[88:91], a[4:7]
    ds_read_b128 v[60:63], v23 offset:0
    v_mfma_f32_16x16x32_bf16 a[8:11], v[128:131], v[88:91], a[8:11]
    v_mfma_f32_16x16x32_bf16 a[12:15], v[132:135], v[88:91], a[12:15]
    s_add_u32 m0, s75, 0
    s_nop 0
    buffer_load_dwordx4 v16, s[4:7], s60 offen  lds
    s_add_u32 s60, s60, 128
    v_mfma_f32_16x16x32_bf16 a[16:19], v[136:139], v[88:91], a[16:19]
    v_mfma_f32_16x16x32_bf16 a[20:23], v[140:143], v[88:91], a[20:23]
    ds_read_b128 v[64:67], v23 offset:2048
    v_mfma_f32_16x16x32_bf16 a[24:27], v[144:147], v[88:91], a[24:27]
    v_mfma_f32_16x16x32_bf16 a[28:31], v[120:123], v[92:95], a[28:31]
    s_add_u32 m0, s75, 4096
    s_nop 0
    buffer_load_dwordx4 v16, s[4:7], s61 offen  lds
    s_add_u32 s61, s61, 128
    v_mfma_f32_16x16x32_bf16 a[32:35], v[124:127], v[92:95], a[32:35]
    v_mfma_f32_16x16x32_bf16 a[36:39], v[128:131], v[92:95], a[36:39]
    ds_read_b128 v[68:71], v23 offset:4096
    v_mfma_f32_16x16x32_bf16 a[40:43], v[132:135], v[92:95], a[40:43]
    v_mfma_f32_16x16x32_bf16 a[44:47], v[136:139], v[92:95], a[44:47]
    s_add_u32 m0, s75, 8192
    s_nop 0
    buffer_load_dwordx4 v16, s[4:7], s62 offen  lds
    s_add_u32 s62, s62, 128
    v_mfma_f32_16x16x32_bf16 a[48:51], v[140:143], v[92:95], a[48:51]
    v_mfma_f32_16x16x32_bf16 a[52:55], v[144:147], v[92:95], a[52:55]
    ds_read_b128 v[72:75], v23 offset:6144
    v_mfma_f32_16x16x32_bf16 a[56:59], v[120:123], v[96:99], a[56:59]
    s_add_u32 m0, s75, 12288
    s_nop 0
    buffer_load_dwordx4 v16, s[4:7], s63 offen  lds
    s_add_u32 s63, s63, 128
    v_mfma_f32_16x16x32_bf16 a[60:63], v[124:127], v[96:99], a[60:63]
    v_mfma_f32_16x16x32_bf16 a[64:67], v[128:131], v[96:99], a[64:67]
    ds_read_b128 v[76:79], v23 offset:8192
    v_mfma_f32_16x16x32_bf16 a[68:71], v[132:135], v[96:99], a[68:71]
    v_mfma_f32_16x16x32_bf16 a[72:75], v[136:139], v[96:99], a[72:75]
    s_add_u32 m0, s75, 16384
    s_nop 0
    buffer_load_dwordx4 v16, s[4:7], s64 offen  lds
    s_add_u32 s64, s64, 128
    v_mfma_f32_16x16x32_bf16 a[76:79], v[140:143], v[96:99], a[76:79]
    v_mfma_f32_16x16x32_bf16 a[80:83], v[144:147], v[96:99], a[80:83]
    ds_read_b128 v[80:83], v23 offset:10240
    v_mfma_f32_16x16x32_bf16 a[84:87], v[120:123], v[100:103], a[84:87]
    v_mfma_f32_16x16x32_bf16 a[88:91], v[124:127], v[100:103], a[88:91]
    s_add_u32 m0, s75, 20480
    s_nop 0
    buffer_load_dwordx4 v16, s[4:7], s65 offen  lds
    s_add_u32 s65, s65, 128
    v_mfma_f32_16x16x32_bf16 a[92:95], v[128:131], v[100:103], a[92:95]
    v_mfma_f32_16x16x32_bf16 a[96:99], v[132:135], v[100:103], a[96:99]
    ds_read_b128 v[84:87], v23 offset:12288
    v_mfma_f32_16x16x32_bf16 a[100:103], v[136:139], v[100:103], a[100:103]
    v_mfma_f32_16x16x32_bf16 a[104:107], v[140:143], v[100:103], a[104:107]
    s_add_u32 m0, s75, 24576
    s_nop 0
    buffer_load_dwordx4 v16, s[4:7], s66 offen  lds
    s_add_u32 s66, s66, 128
    v_mfma_f32_16x16x32_bf16 a[108:111], v[144:147], v[100:103], a[108:111]
    ds_read_b128 v[28:31], v19 offset:0
    v_mfma_f32_16x16x32_bf16 a[112:115], v[120:123], v[104:107], a[112:115]
    v_mfma_f32_16x16x32_bf16 a[116:119], v[124:127], v[104:107], a[116:119]
    s_add_u32 m0, s75, 28672
    s_nop 0
    buffer_load_dwordx4 v16, s[4:7], s67 offen  lds
    s_add_u32 s67, s67, 128
    v_mfma_f32_16x16x32_bf16 a[120:123], v[128:131], v[104:107], a[120:123]
    v_mfma_f32_16x16x32_bf16 a[124:127], v[132:135], v[104:107], a[124:127]
    ds_read_b128 v[32:35], v19 offset:2048
    v_mfma_f32_16x16x32_bf16 a[128:131], v[136:139], v[104:107], a[128:131]
    v_mfma_f32_16x16x32_bf16 a[132:135], v[140:143], v[104:107], a[132:135]
    s_add_u32 m0, s75, 32768
    s_nop 0
    buffer_load_dwordx4 v17, s[4:7], s68 offen  lds
    s_add_u32 s68, s68, 128
    v_mfma_f32_16x16x32_bf16 a[136:139], v[144:147], v[104:107], a[136:139]
    v_mfma_f32_16x16x32_bf16 a[140:143], v[120:123], v[108:111], a[140:143]
    ds_read_b128 v[36:39], v19 offset:4096
    v_mfma_f32_16x16x32_bf16 a[144:147], v[124:127], v[108:111], a[144:147]
    v_mfma_f32_16x16x32_bf16 a[148:151], v[128:131], v[108:111], a[148:151]
    s_add_u32 m0, s75, 36864
    s_nop 0
    buffer_load_dwordx4 v17, s[4:7], s69 offen  lds
    s_add_u32 s69, s69, 128
    v_mfma_f32_16x16x32_bf16 a[152:155], v[132:135], v[108:111], a[152:155]
    v_mfma_f32_16x16x32_bf16 a[156:159], v[136:139], v[108:111], a[156:159]
    ds_read_b128 v[40:43], v19 offset:6144
    v_mfma_f32_16x16x32_bf16 a[160:163], v[140:143], v[108:111], a[160:163]
    v_mfma_f32_16x16x32_bf16 a[164:167], v[144:147], v[108:111], a[164:167]
    s_add_u32 m0, s75, 40960
    s_nop 0
    buffer_load_dwordx4 v17, s[4:7], s70 offen  lds
    s_add_u32 s70, s70, 128
    v_mfma_f32_16x16x32_bf16 a[168:171], v[120:123], v[112:115], a[168:171]
    ds_read_b128 v[44:47], v19 offset:8192
    v_mfma_f32_16x16x32_bf16 a[172:175], v[124:127], v[112:115], a[172:175]
    v_mfma_f32_16x16x32_bf16 a[176:179], v[128:131], v[112:115], a[176:179]
    s_add_u32 m0, s75, 45056
    s_nop 0
    buffer_load_dwordx4 v17, s[4:7], s71 offen  lds
    s_add_u32 s71, s71, 128
    v_mfma_f32_16x16x32_bf16 a[180:183], v[132:135], v[112:115], a[180:183]
    v_mfma_f32_16x16x32_bf16 a[184:187], v[136:139], v[112:115], a[184:187]
    ds_read_b128 v[48:51], v19 offset:10240
    v_mfma_f32_16x16x32_bf16 a[188:191], v[140:143], v[112:115], a[188:191]
    v_mfma_f32_16x16x32_bf16 a[192:195], v[144:147], v[112:115], a[192:195]
    s_add_u32 m0, s75, 49152
    s_nop 0
    buffer_load_dwordx4 v17, s[4:7], s72 offen  lds
    s_add_u32 s72, s72, 128
    v_mfma_f32_16x16x32_bf16 a[196:199], v[120:123], v[116:119], a[196:199]
    v_mfma_f32_16x16x32_bf16 a[200:203], v[124:127], v[116:119], a[200:203]
    ds_read_b128 v[52:55], v19 offset:12288
    v_mfma_f32_16x16x32_bf16 a[204:207], v[128:131], v[116:119], a[204:207]
    v_mfma_f32_16x16x32_bf16 a[208:211], v[132:135], v[116:119], a[208:211]
    s_add_u32 m0, s75, 53248
    s_nop 0
    buffer_load_dwordx4 v17, s[4:7], s73 offen  lds
    s_add_u32 s73, s73, 128
    v_mfma_f32_16x16x32_bf16 a[212:215], v[136:139], v[116:119], a[212:215]
    v_mfma_f32_16x16x32_bf16 a[216:219], v[140:143], v[116:119], a[216:219]
    ds_read_b128 v[56:59], v19 offset:14336
    v_mfma_f32_16x16x32_bf16 a[220:223], v[144:147], v[116:119], a[220:223]
    s_add_u32 m0, s75, 57344
    s_nop 0
    buffer_load_dwordx4 v17, s[4:7], s74 offen  lds
    s_add_u32 s74, s74, 128
    s_waitcnt lgkmcnt(0)
    v_mfma_f32_16x16x32_bf16 a[0:3], v[60:63], v[28:31], a[0:3]
    v_mfma_f32_16x16x32_bf16 a[4:7], v[64:67], v[28:31], a[4:7]
    v_mfma_f32_16x16x32_bf16 a[8:11], v[68:71], v[28:31], a[8:11]
    v_mfma_f32_16x16x32_bf16 a[12:15], v[72:75], v[28:31], a[12:15]
    ds_read_b128 v[120:123], v25 offset:0
    v_mfma_f32_16x16x32_bf16 a[16:19], v[76:79], v[28:31], a[16:19]
    v_mfma_f32_16x16x32_bf16 a[20:23], v[80:83], v[28:31], a[20:23]
    v_mfma_f32_16x16x32_bf16 a[24:27], v[84:87], v[28:31], a[24:27]
    v_mfma_f32_16x16x32_bf16 a[28:31], v[60:63], v[32:35], a[28:31]
    ds_read_b128 v[124:127], v25 offset:2048
    v_mfma_f32_16x16x32_bf16 a[32:35], v[64:67], v[32:35], a[32:35]
    v_mfma_f32_16x16x32_bf16 a[36:39], v[68:71], v[32:35], a[36:39]
    v_mfma_f32_16x16x32_bf16 a[40:43], v[72:75], v[32:35], a[40:43]
    v_mfma_f32_16x16x32_bf16 a[44:47], v[76:79], v[32:35], a[44:47]
    ds_read_b128 v[128:131], v25 offset:4096
    v_mfma_f32_16x16x32_bf16 a[48:51], v[80:83], v[32:35], a[48:51]
    v_mfma_f32_16x16x32_bf16 a[52:55], v[84:87], v[32:35], a[52:55]
    v_mfma_f32_16x16x32_bf16 a[56:59], v[60:63], v[36:39], a[56:59]
    ds_read_b128 v[132:135], v25 offset:6144
    v_mfma_f32_16x16x32_bf16 a[60:63], v[64:67], v[36:39], a[60:63]
    v_mfma_f32_16x16x32_bf16 a[64:67], v[68:71], v[36:39], a[64:67]
    v_mfma_f32_16x16x32_bf16 a[68:71], v[72:75], v[36:39], a[68:71]
    v_mfma_f32_16x16x32_bf16 a[72:75], v[76:79], v[36:39], a[72:75]
    ds_read_b128 v[136:139], v25 offset:8192
    v_mfma_f32_16x16x32_bf16 a[76:79], v[80:83], v[36:39], a[76:79]
    v_mfma_f32_16x16x32_bf16 a[80:83], v[84:87], v[36:39], a[80:83]
    v_mfma_f32_16x16x32_bf16 a[84:87], v[60:63], v[40:43], a[84:87]
    v_mfma_f32_16x16x32_bf16 a[88:91], v[64:67], v[40:43], a[88:91]
    ds_read_b128 v[140:143], v25 offset:10240
    v_mfma_f32_16x16x32_bf16 a[92:95], v[68:71], v[40:43], a[92:95]
    v_mfma_f32_16x16x32_bf16 a[96:99], v[72:75], v[40:43], a[96:99]
    v_mfma_f32_16x16x32_bf16 a[100:103], v[76:79], v[40:43], a[100:103]
    v_mfma_f32_16x16x32_bf16 a[104:107], v[80:83], v[40:43], a[104:107]
    ds_read_b128 v[144:147], v25 offset:12288
    v_mfma_f32_16x16x32_bf16 a[108:111], v[84:87], v[40:43], a[108:111]
    v_mfma_f32_16x16x32_bf16 a[112:115], v[60:63], v[44:47], a[112:115]
    v_mfma_f32_16x16x32_bf16 a[116:119], v[64:67], v[44:47], a[116:119]
    ds_read_b128 v[88:91], v21 offset:0
    v_mfma_f32_16x16x32_bf16 a[120:123], v[68:71], v[44:47], a[120:123]
    v_mfma_f32_16x16x32_bf16 a[124:127], v[72:75], v[44:47], a[124:127]
    v_mfma_f32_16x16x32_bf16 a[128:131], v[76:79], v[44:47], a[128:131]
    v_mfma_f32_16x16x32_bf16 a[132:135], v[80:83], v[44:47], a[132:135]
    ds_read_b128 v[92:95], v21 offset:2048
    v_mfma_f32_16x16x32_bf16 a[136:139], v[84:87], v[44:47], a[136:139]
    v_mfma_f32_16x16x32_bf16 a[140:143], v[60:63], v[48:51], a[140:143]
    v_mfma_f32_16x16x32_bf16 a[144:147], v[64:67], v[48:51], a[144:147]
    v_mfma_f32_16x16x32_bf16 a[148:151], v[68:71], v[48:51], a[148:151]
    ds_read_b128 v[96:99], v21 offset:4096
    v_mfma_f32_16x16x32_bf16 a[152:155], v[72:75], v[48:51], a[152:155]
    v_mfma_f32_16x16x32_bf16 a[156:159], v[76:79], v[48:51], a[156:159]
    v_mfma_f32_16x16x32_bf16 a[160:163], v[80:83], v[48:51], a[160:163]
    v_mfma_f32_16x16x32_bf16 a[164:167], v[84:87], v[48:51], a[164:167]
    ds_read_b128 v[100:103], v21 offset:6144
    v_mfma_f32_16x16x32_bf16 a[168:171], v[60:63], v[52:55], a[168:171]
    v_mfma_f32_16x16x32_bf16 a[172:175], v[64:67], v[52:55], a[172:175]
    v_mfma_f32_16x16x32_bf16 a[176:179], v[68:71], v[52:55], a[176:179]
    ds_read_b128 v[104:107], v21 offset:8192
    v_mfma_f32_16x16x32_bf16 a[180:183], v[72:75], v[52:55], a[180:183]
    v_mfma_f32_16x16x32_bf16 a[184:187], v[76:79], v[52:55], a[184:187]
    v_mfma_f32_16x16x32_bf16 a[188:191], v[80:83], v[52:55], a[188:191]
    v_mfma_f32_16x16x32_bf16 a[192:195], v[84:87], v[52:55], a[192:195]
    ds_read_b128 v[108:111], v21 offset:10240
    v_mfma_f32_16x16x32_bf16 a[196:199], v[60:63], v[56:59], a[196:199]
    v_mfma_f32_16x16x32_bf16 a[200:203], v[64:67], v[56:59], a[200:203]
    v_mfma_f32_16x16x32_bf16 a[204:207], v[68:71], v[56:59], a[204:207]
    v_mfma_f32_16x16x32_bf16 a[208:211], v[72:75], v[56:59], a[208:211]
    ds_read_b128 v[112:115], v21 offset:12288
    v_mfma_f32_16x16x32_bf16 a[212:215], v[76:79], v[56:59], a[212:215]
    v_mfma_f32_16x16x32_bf16 a[216:219], v[80:83], v[56:59], a[216:219]
    v_mfma_f32_16x16x32_bf16 a[220:223], v[84:87], v[56:59], a[220:223]
    ds_read_b128 v[116:119], v21 offset:14336
    s_waitcnt lgkmcnt(0) vmcnt(0)
    s_barrier
    v_mfma_f32_16x16x32_bf16 a[0:3], v[120:123], v[88:91], a[0:3]
    v_mfma_f32_16x16x32_bf16 a[4:7], v[124:127], v[88:91], a[4:7]
    ds_read_b128 v[60:63], v22 offset:0
    v_mfma_f32_16x16x32_bf16 a[8:11], v[128:131], v[88:91], a[8:11]
    v_mfma_f32_16x16x32_bf16 a[12:15], v[132:135], v[88:91], a[12:15]
    s_add_u32 m0, s75, 61440
    s_nop 0
    buffer_load_dwordx4 v16, s[4:7], s60 offen  lds
    s_add_u32 s60, s60, 128
    v_mfma_f32_16x16x32_bf16 a[16:19], v[136:139], v[88:91], a[16:19]
    v_mfma_f32_16x16x32_bf16 a[20:23], v[140:143], v[88:91], a[20:23]
    ds_read_b128 v[64:67], v22 offset:2048
    v_mfma_f32_16x16x32_bf16 a[24:27], v[144:147], v[88:91], a[24:27]
    v_mfma_f32_16x16x32_bf16 a[28:31], v[120:123], v[92:95], a[28:31]
    s_add_u32 m0, s75, 65536
    s_nop 0
    buffer_load_dwordx4 v16, s[4:7], s61 offen  lds
    s_add_u32 s61, s61, 128
    v_mfma_f32_16x16x32_bf16 a[32:35], v[124:127], v[92:95], a[32:35]
    v_mfma_f32_16x16x32_bf16 a[36:39], v[128:131], v[92:95], a[36:39]
    ds_read_b128 v[68:71], v22 offset:4096
    v_mfma_f32_16x16x32_bf16 a[40:43], v[132:135], v[92:95], a[40:43]
    v_mfma_f32_16x16x32_bf16 a[44:47], v[136:139], v[92:95], a[44:47]
    s_add_u32 m0, s75, 69632
    s_nop 0
    buffer_load_dwordx4 v16, s[4:7], s62 offen  lds
    s_add_u32 s62, s62, 128
    v_mfma_f32_16x16x32_bf16 a[48:51], v[140:143], v[92:95], a[48:51]
    v_mfma_f32_16x16x32_bf16 a[52:55], v[144:147], v[92:95], a[52:55]
    ds_read_b128 v[72:75], v22 offset:6144
    v_mfma_f32_16x16x32_bf16 a[56:59], v[120:123], v[96:99], a[56:59]
    s_add_u32 m0, s75, 73728
    s_nop 0
    buffer_load_dwordx4 v16, s[4:7], s63 offen  lds
    s_add_u32 s63, s63, 128
    v_mfma_f32_16x16x32_bf16 a[60:63], v[124:127], v[96:99], a[60:63]
    v_mfma_f32_16x16x32_bf16 a[64:67], v[128:131], v[96:99], a[64:67]
    ds_read_b128 v[76:79], v22 offset:8192
    v_mfma_f32_16x16x32_bf16 a[68:71], v[132:135], v[96:99], a[68:71]
    v_mfma_f32_16x16x32_bf16 a[72:75], v[136:139], v[96:99], a[72:75]
    s_add_u32 m0, s75, 77824
    s_nop 0
    buffer_load_dwordx4 v16, s[4:7], s64 offen  lds
    s_add_u32 s64, s64, 128
    v_mfma_f32_16x16x32_bf16 a[76:79], v[140:143], v[96:99], a[76:79]
    v_mfma_f32_16x16x32_bf16 a[80:83], v[144:147], v[96:99], a[80:83]
    ds_read_b128 v[80:83], v22 offset:10240
    v_mfma_f32_16x16x32_bf16 a[84:87], v[120:123], v[100:103], a[84:87]
    v_mfma_f32_16x16x32_bf16 a[88:91], v[124:127], v[100:103], a[88:91]
    s_add_u32 m0, s75, 81920
    s_nop 0
    buffer_load_dwordx4 v16, s[4:7], s65 offen  lds
    s_add_u32 s65, s65, 128
    v_mfma_f32_16x16x32_bf16 a[92:95], v[128:131], v[100:103], a[92:95]
    v_mfma_f32_16x16x32_bf16 a[96:99], v[132:135], v[100:103], a[96:99]
    ds_read_b128 v[84:87], v22 offset:12288
    v_mfma_f32_16x16x32_bf16 a[100:103], v[136:139], v[100:103], a[100:103]
    v_mfma_f32_16x16x32_bf16 a[104:107], v[140:143], v[100:103], a[104:107]
    s_add_u32 m0, s75, 86016
    s_nop 0
    buffer_load_dwordx4 v16, s[4:7], s66 offen  lds
    s_add_u32 s66, s66, 128
    v_mfma_f32_16x16x32_bf16 a[108:111], v[144:147], v[100:103], a[108:111]
    ds_read_b128 v[28:31], v18 offset:0
    v_mfma_f32_16x16x32_bf16 a[112:115], v[120:123], v[104:107], a[112:115]
    v_mfma_f32_16x16x32_bf16 a[116:119], v[124:127], v[104:107], a[116:119]
    s_add_u32 m0, s75, 90112
    s_nop 0
    buffer_load_dwordx4 v16, s[4:7], s67 offen  lds
    s_add_u32 s67, s67, 128
    v_mfma_f32_16x16x32_bf16 a[120:123], v[128:131], v[104:107], a[120:123]
    v_mfma_f32_16x16x32_bf16 a[124:127], v[132:135], v[104:107], a[124:127]
    ds_read_b128 v[32:35], v18 offset:2048
    v_mfma_f32_16x16x32_bf16 a[128:131], v[136:139], v[104:107], a[128:131]
    v_mfma_f32_16x16x32_bf16 a[132:135], v[140:143], v[104:107], a[132:135]
    s_add_u32 m0, s75, 94208
    s_nop 0
    buffer_load_dwordx4 v17, s[4:7], s68 offen  lds
    s_add_u32 s68, s68, 128
    v_mfma_f32_16x16x32_bf16 a[136:139], v[144:147], v[104:107], a[136:139]
    v_mfma_f32_16x16x32_bf16 a[140:143], v[120:123], v[108:111], a[140:143]
    ds_read_b128 v[36:39], v18 offset:4096
    v_mfma_f32_16x16x32_bf16 a[144:147], v[124:127], v[108:111], a[144:147]
    v_mfma_f32_16x16x32_bf16 a[148:151], v[128:131], v[108:111], a[148:151]
    s_add_u32 m0, s75, 98304
    s_nop 0
    buffer_load_dwordx4 v17, s[4:7], s69 offen  lds
    s_add_u32 s69, s69, 128
    v_mfma_f32_16x16x32_bf16 a[152:155], v[132:135], v[108:111], a[152:155]
    v_mfma_f32_16x16x32_bf16 a[156:159], v[136:139], v[108:111], a[156:159]
    ds_read_b128 v[40:43], v18 offset:6144
    v_mfma_f32_16x16x32_bf16 a[160:163], v[140:143], v[108:111], a[160:163]
    v_mfma_f32_16x16x32_bf16 a[164:167], v[144:147], v[108:111], a[164:167]
    s_add_u32 m0, s75, 102400
    s_nop 0
    buffer_load_dwordx4 v17, s[4:7], s70 offen  lds
    s_add_u32 s70, s70, 128
    v_mfma_f32_16x16x32_bf16 a[168:171], v[120:123], v[112:115], a[168:171]
    ds_read_b128 v[44:47], v18 offset:8192
    v_mfma_f32_16x16x32_bf16 a[172:175], v[124:127], v[112:115], a[172:175]
    v_mfma_f32_16x16x32_bf16 a[176:179], v[128:131], v[112:115], a[176:179]
    s_add_u32 m0, s75, 106496
    s_nop 0
    buffer_load_dwordx4 v17, s[4:7], s71 offen  lds
    s_add_u32 s71, s71, 128
    v_mfma_f32_16x16x32_bf16 a[180:183], v[132:135], v[112:115], a[180:183]
    v_mfma_f32_16x16x32_bf16 a[184:187], v[136:139], v[112:115], a[184:187]
    ds_read_b128 v[48:51], v18 offset:10240
    v_mfma_f32_16x16x32_bf16 a[188:191], v[140:143], v[112:115], a[188:191]
    v_mfma_f32_16x16x32_bf16 a[192:195], v[144:147], v[112:115], a[192:195]
    s_add_u32 m0, s75, 110592
    s_nop 0
    buffer_load_dwordx4 v17, s[4:7], s72 offen  lds
    s_add_u32 s72, s72, 128
    v_mfma_f32_16x16x32_bf16 a[196:199], v[120:123], v[116:119], a[196:199]
    v_mfma_f32_16x16x32_bf16 a[200:203], v[124:127], v[116:119], a[200:203]
    ds_read_b128 v[52:55], v18 offset:12288
    v_mfma_f32_16x16x32_bf16 a[204:207], v[128:131], v[116:119], a[204:207]
    v_mfma_f32_16x16x32_bf16 a[208:211], v[132:135], v[116:119], a[208:211]
    s_add_u32 m0, s75, 114688
    s_nop 0
    buffer_load_dwordx4 v17, s[4:7], s73 offen  lds
    s_add_u32 s73, s73, 128
    v_mfma_f32_16x16x32_bf16 a[212:215], v[136:139], v[116:119], a[212:215]
    v_mfma_f32_16x16x32_bf16 a[216:219], v[140:143], v[116:119], a[216:219]
    ds_read_b128 v[56:59], v18 offset:14336
    v_mfma_f32_16x16x32_bf16 a[220:223], v[144:147], v[116:119], a[220:223]
    s_add_u32 m0, s75, 118784
    s_nop 0
    buffer_load_dwordx4 v17, s[4:7], s74 offen  lds
    s_add_u32 s74, s74, 128
    s_waitcnt lgkmcnt(0)
    v_mfma_f32_16x16x32_bf16 a[0:3], v[60:63], v[28:31], a[0:3]
    v_mfma_f32_16x16x32_bf16 a[4:7], v[64:67], v[28:31], a[4:7]
    v_mfma_f32_16x16x32_bf16 a[8:11], v[68:71], v[28:31], a[8:11]
    v_mfma_f32_16x16x32_bf16 a[12:15], v[72:75], v[28:31], a[12:15]
    ds_read_b128 v[120:123], v24 offset:0
    v_mfma_f32_16x16x32_bf16 a[16:19], v[76:79], v[28:31], a[16:19]
    v_mfma_f32_16x16x32_bf16 a[20:23], v[80:83], v[28:31], a[20:23]
    v_mfma_f32_16x16x32_bf16 a[24:27], v[84:87], v[28:31], a[24:27]
    v_mfma_f32_16x16x32_bf16 a[28:31], v[60:63], v[32:35], a[28:31]
    ds_read_b128 v[124:127], v24 offset:2048
    v_mfma_f32_16x16x32_bf16 a[32:35], v[64:67], v[32:35], a[32:35]
    v_mfma_f32_16x16x32_bf16 a[36:39], v[68:71], v[32:35], a[36:39]
    v_mfma_f32_16x16x32_bf16 a[40:43], v[72:75], v[32:35], a[40:43]
    v_mfma_f32_16x16x32_bf16 a[44:47], v[76:79], v[32:35], a[44:47]
    ds_read_b128 v[128:131], v24 offset:4096
    v_mfma_f32_16x16x32_bf16 a[48:51], v[80:83], v[32:35], a[48:51]
    v_mfma_f32_16x16x32_bf16 a[52:55], v[84:87], v[32:35], a[52:55]
    v_mfma_f32_16x16x32_bf16 a[56:59], v[60:63], v[36:39], a[56:59]
    ds_read_b128 v[132:135], v24 offset:6144
    v_mfma_f32_16x16x32_bf16 a[60:63], v[64:67], v[36:39], a[60:63]
    v_mfma_f32_16x16x32_bf16 a[64:67], v[68:71], v[36:39], a[64:67]
    v_mfma_f32_16x16x32_bf16 a[68:71], v[72:75], v[36:39], a[68:71]
    v_mfma_f32_16x16x32_bf16 a[72:75], v[76:79], v[36:39], a[72:75]
    ds_read_b128 v[136:139], v24 offset:8192
    v_mfma_f32_16x16x32_bf16 a[76:79], v[80:83], v[36:39], a[76:79]
    v_mfma_f32_16x16x32_bf16 a[80:83], v[84:87], v[36:39], a[80:83]
    v_mfma_f32_16x16x32_bf16 a[84:87], v[60:63], v[40:43], a[84:87]
    v_mfma_f32_16x16x32_bf16 a[88:91], v[64:67], v[40:43], a[88:91]
    ds_read_b128 v[140:143], v24 offset:10240
    v_mfma_f32_16x16x32_bf16 a[92:95], v[68:71], v[40:43], a[92:95]
    v_mfma_f32_16x16x32_bf16 a[96:99], v[72:75], v[40:43], a[96:99]
    v_mfma_f32_16x16x32_bf16 a[100:103], v[76:79], v[40:43], a[100:103]
    v_mfma_f32_16x16x32_bf16 a[104:107], v[80:83], v[40:43], a[104:107]
    ds_read_b128 v[144:147], v24 offset:12288
    v_mfma_f32_16x16x32_bf16 a[108:111], v[84:87], v[40:43], a[108:111]
    v_mfma_f32_16x16x32_bf16 a[112:115], v[60:63], v[44:47], a[112:115]
    v_mfma_f32_16x16x32_bf16 a[116:119], v[64:67], v[44:47], a[116:119]
    ds_read_b128 v[88:91], v20 offset:0
    v_mfma_f32_16x16x32_bf16 a[120:123], v[68:71], v[44:47], a[120:123]
    v_mfma_f32_16x16x32_bf16 a[124:127], v[72:75], v[44:47], a[124:127]
    v_mfma_f32_16x16x32_bf16 a[128:131], v[76:79], v[44:47], a[128:131]
    v_mfma_f32_16x16x32_bf16 a[132:135], v[80:83], v[44:47], a[132:135]
    ds_read_b128 v[92:95], v20 offset:2048
    v_mfma_f32_16x16x32_bf16 a[136:139], v[84:87], v[44:47], a[136:139]
    v_mfma_f32_16x16x32_bf16 a[140:143], v[60:63], v[48:51], a[140:143]
    v_mfma_f32_16x16x32_bf16 a[144:147], v[64:67], v[48:51], a[144:147]
    v_mfma_f32_16x16x32_bf16 a[148:151], v[68:71], v[48:51], a[148:151]
    ds_read_b128 v[96:99], v20 offset:4096
    v_mfma_f32_16x16x32_bf16 a[152:155], v[72:75], v[48:51], a[152:155]
    v_mfma_f32_16x16x32_bf16 a[156:159], v[76:79], v[48:51], a[156:159]
    v_mfma_f32_16x16x32_bf16 a[160:163], v[80:83], v[48:51], a[160:163]
    v_mfma_f32_16x16x32_bf16 a[164:167], v[84:87], v[48:51], a[164:167]
    ds_read_b128 v[100:103], v20 offset:6144
    v_mfma_f32_16x16x32_bf16 a[168:171], v[60:63], v[52:55], a[168:171]
    v_mfma_f32_16x16x32_bf16 a[172:175], v[64:67], v[52:55], a[172:175]
    v_mfma_f32_16x16x32_bf16 a[176:179], v[68:71], v[52:55], a[176:179]
    ds_read_b128 v[104:107], v20 offset:8192
    v_mfma_f32_16x16x32_bf16 a[180:183], v[72:75], v[52:55], a[180:183]
    v_mfma_f32_16x16x32_bf16 a[184:187], v[76:79], v[52:55], a[184:187]
    v_mfma_f32_16x16x32_bf16 a[188:191], v[80:83], v[52:55], a[188:191]
    v_mfma_f32_16x16x32_bf16 a[192:195], v[84:87], v[52:55], a[192:195]
    ds_read_b128 v[108:111], v20 offset:10240
    v_mfma_f32_16x16x32_bf16 a[196:199], v[60:63], v[56:59], a[196:199]
    v_mfma_f32_16x16x32_bf16 a[200:203], v[64:67], v[56:59], a[200:203]
    v_mfma_f32_16x16x32_bf16 a[204:207], v[68:71], v[56:59], a[204:207]
    v_mfma_f32_16x16x32_bf16 a[208:211], v[72:75], v[56:59], a[208:211]
    ds_read_b128 v[112:115], v20 offset:12288
    v_mfma_f32_16x16x32_bf16 a[212:215], v[76:79], v[56:59], a[212:215]
    v_mfma_f32_16x16x32_bf16 a[216:219], v[80:83], v[56:59], a[216:219]
    v_mfma_f32_16x16x32_bf16 a[220:223], v[84:87], v[56:59], a[220:223]
    ds_read_b128 v[116:119], v20 offset:14336
    s_waitcnt lgkmcnt(0) vmcnt(0)
    s_barrier
    v_mfma_f32_16x16x32_bf16 a[0:3], v[120:123], v[88:91], a[0:3]
    v_mfma_f32_16x16x32_bf16 a[4:7], v[124:127], v[88:91], a[4:7]
    ds_read_b128 v[60:63], v23 offset:0
    v_mfma_f32_16x16x32_bf16 a[8:11], v[128:131], v[88:91], a[8:11]
    v_mfma_f32_16x16x32_bf16 a[12:15], v[132:135], v[88:91], a[12:15]
    s_add_u32 m0, s75, 0
    s_nop 0
    buffer_load_dwordx4 v16, s[4:7], s60 offen  lds
    s_add_u32 s60, s60, 128
    v_mfma_f32_16x16x32_bf16 a[16:19], v[136:139], v[88:91], a[16:19]
    v_mfma_f32_16x16x32_bf16 a[20:23], v[140:143], v[88:91], a[20:23]
    ds_read_b128 v[64:67], v23 offset:2048
    v_mfma_f32_16x16x32_bf16 a[24:27], v[144:147], v[88:91], a[24:27]
    v_mfma_f32_16x16x32_bf16 a[28:31], v[120:123], v[92:95], a[28:31]
    s_add_u32 m0, s75, 4096
    s_nop 0
    buffer_load_dwordx4 v16, s[4:7], s61 offen  lds
    s_add_u32 s61, s61, 128
    v_mfma_f32_16x16x32_bf16 a[32:35], v[124:127], v[92:95], a[32:35]
    v_mfma_f32_16x16x32_bf16 a[36:39], v[128:131], v[92:95], a[36:39]
    ds_read_b128 v[68:71], v23 offset:4096
    v_mfma_f32_16x16x32_bf16 a[40:43], v[132:135], v[92:95], a[40:43]
    v_mfma_f32_16x16x32_bf16 a[44:47], v[136:139], v[92:95], a[44:47]
    s_add_u32 m0, s75, 8192
    s_nop 0
    buffer_load_dwordx4 v16, s[4:7], s62 offen  lds
    s_add_u32 s62, s62, 128
    v_mfma_f32_16x16x32_bf16 a[48:51], v[140:143], v[92:95], a[48:51]
    v_mfma_f32_16x16x32_bf16 a[52:55], v[144:147], v[92:95], a[52:55]
    ds_read_b128 v[72:75], v23 offset:6144
    v_mfma_f32_16x16x32_bf16 a[56:59], v[120:123], v[96:99], a[56:59]
    s_add_u32 m0, s75, 12288
    s_nop 0
    buffer_load_dwordx4 v16, s[4:7], s63 offen  lds
    s_add_u32 s63, s63, 128
    v_mfma_f32_16x16x32_bf16 a[60:63], v[124:127], v[96:99], a[60:63]
    v_mfma_f32_16x16x32_bf16 a[64:67], v[128:131], v[96:99], a[64:67]
    ds_read_b128 v[76:79], v23 offset:8192
    v_mfma_f32_16x16x32_bf16 a[68:71], v[132:135], v[96:99], a[68:71]
    v_mfma_f32_16x16x32_bf16 a[72:75], v[136:139], v[96:99], a[72:75]
    s_add_u32 m0, s75, 16384
    s_nop 0
    buffer_load_dwordx4 v16, s[4:7], s64 offen  lds
    s_add_u32 s64, s64, 128
    v_mfma_f32_16x16x32_bf16 a[76:79], v[140:143], v[96:99], a[76:79]
    v_mfma_f32_16x16x32_bf16 a[80:83], v[144:147], v[96:99], a[80:83]
    ds_read_b128 v[80:83], v23 offset:10240
    v_mfma_f32_16x16x32_bf16 a[84:87], v[120:123], v[100:103], a[84:87]
    v_mfma_f32_16x16x32_bf16 a[88:91], v[124:127], v[100:103], a[88:91]
    s_add_u32 m0, s75, 20480
    s_nop 0
    buffer_load_dwordx4 v16, s[4:7], s65 offen  lds
    s_add_u32 s65, s65, 128
    v_mfma_f32_16x16x32_bf16 a[92:95], v[128:131], v[100:103], a[92:95]
    v_mfma_f32_16x16x32_bf16 a[96:99], v[132:135], v[100:103], a[96:99]
    ds_read_b128 v[84:87], v23 offset:12288
    v_mfma_f32_16x16x32_bf16 a[100:103], v[136:139], v[100:103], a[100:103]
    v_mfma_f32_16x16x32_bf16 a[104:107], v[140:143], v[100:103], a[104:107]
    s_add_u32 m0, s75, 24576
    s_nop 0
    buffer_load_dwordx4 v16, s[4:7], s66 offen  lds
    s_add_u32 s66, s66, 128
    v_mfma_f32_16x16x32_bf16 a[108:111], v[144:147], v[100:103], a[108:111]
    ds_read_b128 v[28:31], v19 offset:0
    v_mfma_f32_16x16x32_bf16 a[112:115], v[120:123], v[104:107], a[112:115]
    v_mfma_f32_16x16x32_bf16 a[116:119], v[124:127], v[104:107], a[116:119]
    s_add_u32 m0, s75, 28672
    s_nop 0
    buffer_load_dwordx4 v16, s[4:7], s67 offen  lds
    s_add_u32 s67, s67, 128
    v_mfma_f32_16x16x32_bf16 a[120:123], v[128:131], v[104:107], a[120:123]
    v_mfma_f32_16x16x32_bf16 a[124:127], v[132:135], v[104:107], a[124:127]
    ds_read_b128 v[32:35], v19 offset:2048
    v_mfma_f32_16x16x32_bf16 a[128:131], v[136:139], v[104:107], a[128:131]
    v_mfma_f32_16x16x32_bf16 a[132:135], v[140:143], v[104:107], a[132:135]
    s_add_u32 m0, s75, 32768
    s_nop 0
    buffer_load_dwordx4 v17, s[4:7], s68 offen  lds
    s_add_u32 s68, s68, 128
    v_mfma_f32_16x16x32_bf16 a[136:139], v[144:147], v[104:107], a[136:139]
    v_mfma_f32_16x16x32_bf16 a[140:143], v[120:123], v[108:111], a[140:143]
    ds_read_b128 v[36:39], v19 offset:4096
    v_mfma_f32_16x16x32_bf16 a[144:147], v[124:127], v[108:111], a[144:147]
    v_mfma_f32_16x16x32_bf16 a[148:151], v[128:131], v[108:111], a[148:151]
    s_add_u32 m0, s75, 36864
    s_nop 0
    buffer_load_dwordx4 v17, s[4:7], s69 offen  lds
    s_add_u32 s69, s69, 128
    v_mfma_f32_16x16x32_bf16 a[152:155], v[132:135], v[108:111], a[152:155]
    v_mfma_f32_16x16x32_bf16 a[156:159], v[136:139], v[108:111], a[156:159]
    ds_read_b128 v[40:43], v19 offset:6144
    v_mfma_f32_16x16x32_bf16 a[160:163], v[140:143], v[108:111], a[160:163]
    v_mfma_f32_16x16x32_bf16 a[164:167], v[144:147], v[108:111], a[164:167]
    s_add_u32 m0, s75, 40960
    s_nop 0
    buffer_load_dwordx4 v17, s[4:7], s70 offen  lds
    s_add_u32 s70, s70, 128
    v_mfma_f32_16x16x32_bf16 a[168:171], v[120:123], v[112:115], a[168:171]
    ds_read_b128 v[44:47], v19 offset:8192
    v_mfma_f32_16x16x32_bf16 a[172:175], v[124:127], v[112:115], a[172:175]
    v_mfma_f32_16x16x32_bf16 a[176:179], v[128:131], v[112:115], a[176:179]
    s_add_u32 m0, s75, 45056
    s_nop 0
    buffer_load_dwordx4 v17, s[4:7], s71 offen  lds
    s_add_u32 s71, s71, 128
    v_mfma_f32_16x16x32_bf16 a[180:183], v[132:135], v[112:115], a[180:183]
    v_mfma_f32_16x16x32_bf16 a[184:187], v[136:139], v[112:115], a[184:187]
    ds_read_b128 v[48:51], v19 offset:10240
    v_mfma_f32_16x16x32_bf16 a[188:191], v[140:143], v[112:115], a[188:191]
    v_mfma_f32_16x16x32_bf16 a[192:195], v[144:147], v[112:115], a[192:195]
    s_add_u32 m0, s75, 49152
    s_nop 0
    buffer_load_dwordx4 v17, s[4:7], s72 offen  lds
    s_add_u32 s72, s72, 128
    v_mfma_f32_16x16x32_bf16 a[196:199], v[120:123], v[116:119], a[196:199]
    v_mfma_f32_16x16x32_bf16 a[200:203], v[124:127], v[116:119], a[200:203]
    ds_read_b128 v[52:55], v19 offset:12288
    v_mfma_f32_16x16x32_bf16 a[204:207], v[128:131], v[116:119], a[204:207]
    v_mfma_f32_16x16x32_bf16 a[208:211], v[132:135], v[116:119], a[208:211]
    s_add_u32 m0, s75, 53248
    s_nop 0
    buffer_load_dwordx4 v17, s[4:7], s73 offen  lds
    s_add_u32 s73, s73, 128
    v_mfma_f32_16x16x32_bf16 a[212:215], v[136:139], v[116:119], a[212:215]
    v_mfma_f32_16x16x32_bf16 a[216:219], v[140:143], v[116:119], a[216:219]
    ds_read_b128 v[56:59], v19 offset:14336
    v_mfma_f32_16x16x32_bf16 a[220:223], v[144:147], v[116:119], a[220:223]
    s_add_u32 m0, s75, 57344
    s_nop 0
    buffer_load_dwordx4 v17, s[4:7], s74 offen  lds
    s_add_u32 s74, s74, 128
    s_waitcnt lgkmcnt(0)
    v_mfma_f32_16x16x32_bf16 a[0:3], v[60:63], v[28:31], a[0:3]
    v_mfma_f32_16x16x32_bf16 a[4:7], v[64:67], v[28:31], a[4:7]
    v_mfma_f32_16x16x32_bf16 a[8:11], v[68:71], v[28:31], a[8:11]
    v_mfma_f32_16x16x32_bf16 a[12:15], v[72:75], v[28:31], a[12:15]
    ds_read_b128 v[120:123], v25 offset:0
    v_mfma_f32_16x16x32_bf16 a[16:19], v[76:79], v[28:31], a[16:19]
    v_mfma_f32_16x16x32_bf16 a[20:23], v[80:83], v[28:31], a[20:23]
    v_mfma_f32_16x16x32_bf16 a[24:27], v[84:87], v[28:31], a[24:27]
    v_mfma_f32_16x16x32_bf16 a[28:31], v[60:63], v[32:35], a[28:31]
    ds_read_b128 v[124:127], v25 offset:2048
    v_mfma_f32_16x16x32_bf16 a[32:35], v[64:67], v[32:35], a[32:35]
    v_mfma_f32_16x16x32_bf16 a[36:39], v[68:71], v[32:35], a[36:39]
    v_mfma_f32_16x16x32_bf16 a[40:43], v[72:75], v[32:35], a[40:43]
    v_mfma_f32_16x16x32_bf16 a[44:47], v[76:79], v[32:35], a[44:47]
    ds_read_b128 v[128:131], v25 offset:4096
    v_mfma_f32_16x16x32_bf16 a[48:51], v[80:83], v[32:35], a[48:51]
    v_mfma_f32_16x16x32_bf16 a[52:55], v[84:87], v[32:35], a[52:55]
    v_mfma_f32_16x16x32_bf16 a[56:59], v[60:63], v[36:39], a[56:59]
    ds_read_b128 v[132:135], v25 offset:6144
    v_mfma_f32_16x16x32_bf16 a[60:63], v[64:67], v[36:39], a[60:63]
    v_mfma_f32_16x16x32_bf16 a[64:67], v[68:71], v[36:39], a[64:67]
    v_mfma_f32_16x16x32_bf16 a[68:71], v[72:75], v[36:39], a[68:71]
    v_mfma_f32_16x16x32_bf16 a[72:75], v[76:79], v[36:39], a[72:75]
    ds_read_b128 v[136:139], v25 offset:8192
    v_mfma_f32_16x16x32_bf16 a[76:79], v[80:83], v[36:39], a[76:79]
    v_mfma_f32_16x16x32_bf16 a[80:83], v[84:87], v[36:39], a[80:83]
    v_mfma_f32_16x16x32_bf16 a[84:87], v[60:63], v[40:43], a[84:87]
    v_mfma_f32_16x16x32_bf16 a[88:91], v[64:67], v[40:43], a[88:91]
    ds_read_b128 v[140:143], v25 offset:10240
    v_mfma_f32_16x16x32_bf16 a[92:95], v[68:71], v[40:43], a[92:95]
    v_mfma_f32_16x16x32_bf16 a[96:99], v[72:75], v[40:43], a[96:99]
    v_mfma_f32_16x16x32_bf16 a[100:103], v[76:79], v[40:43], a[100:103]
    v_mfma_f32_16x16x32_bf16 a[104:107], v[80:83], v[40:43], a[104:107]
    ds_read_b128 v[144:147], v25 offset:12288
    v_mfma_f32_16x16x32_bf16 a[108:111], v[84:87], v[40:43], a[108:111]
    v_mfma_f32_16x16x32_bf16 a[112:115], v[60:63], v[44:47], a[112:115]
    v_mfma_f32_16x16x32_bf16 a[116:119], v[64:67], v[44:47], a[116:119]
    ds_read_b128 v[88:91], v21 offset:0
    v_mfma_f32_16x16x32_bf16 a[120:123], v[68:71], v[44:47], a[120:123]
    v_mfma_f32_16x16x32_bf16 a[124:127], v[72:75], v[44:47], a[124:127]
    v_mfma_f32_16x16x32_bf16 a[128:131], v[76:79], v[44:47], a[128:131]
    v_mfma_f32_16x16x32_bf16 a[132:135], v[80:83], v[44:47], a[132:135]
    ds_read_b128 v[92:95], v21 offset:2048
    v_mfma_f32_16x16x32_bf16 a[136:139], v[84:87], v[44:47], a[136:139]
    v_mfma_f32_16x16x32_bf16 a[140:143], v[60:63], v[48:51], a[140:143]
    v_mfma_f32_16x16x32_bf16 a[144:147], v[64:67], v[48:51], a[144:147]
    v_mfma_f32_16x16x32_bf16 a[148:151], v[68:71], v[48:51], a[148:151]
    ds_read_b128 v[96:99], v21 offset:4096
    v_mfma_f32_16x16x32_bf16 a[152:155], v[72:75], v[48:51], a[152:155]
    v_mfma_f32_16x16x32_bf16 a[156:159], v[76:79], v[48:51], a[156:159]
    v_mfma_f32_16x16x32_bf16 a[160:163], v[80:83], v[48:51], a[160:163]
    v_mfma_f32_16x16x32_bf16 a[164:167], v[84:87], v[48:51], a[164:167]
    ds_read_b128 v[100:103], v21 offset:6144
    v_mfma_f32_16x16x32_bf16 a[168:171], v[60:63], v[52:55], a[168:171]
    v_mfma_f32_16x16x32_bf16 a[172:175], v[64:67], v[52:55], a[172:175]
    v_mfma_f32_16x16x32_bf16 a[176:179], v[68:71], v[52:55], a[176:179]
    ds_read_b128 v[104:107], v21 offset:8192
    v_mfma_f32_16x16x32_bf16 a[180:183], v[72:75], v[52:55], a[180:183]
    v_mfma_f32_16x16x32_bf16 a[184:187], v[76:79], v[52:55], a[184:187]
    v_mfma_f32_16x16x32_bf16 a[188:191], v[80:83], v[52:55], a[188:191]
    v_mfma_f32_16x16x32_bf16 a[192:195], v[84:87], v[52:55], a[192:195]
    ds_read_b128 v[108:111], v21 offset:10240
    v_mfma_f32_16x16x32_bf16 a[196:199], v[60:63], v[56:59], a[196:199]
    v_mfma_f32_16x16x32_bf16 a[200:203], v[64:67], v[56:59], a[200:203]
    v_mfma_f32_16x16x32_bf16 a[204:207], v[68:71], v[56:59], a[204:207]
    v_mfma_f32_16x16x32_bf16 a[208:211], v[72:75], v[56:59], a[208:211]
    ds_read_b128 v[112:115], v21 offset:12288
    v_mfma_f32_16x16x32_bf16 a[212:215], v[76:79], v[56:59], a[212:215]
    v_mfma_f32_16x16x32_bf16 a[216:219], v[80:83], v[56:59], a[216:219]
    v_mfma_f32_16x16x32_bf16 a[220:223], v[84:87], v[56:59], a[220:223]
    ds_read_b128 v[116:119], v21 offset:14336
    s_waitcnt lgkmcnt(0) vmcnt(0)
    s_barrier
    v_mfma_f32_16x16x32_bf16 a[0:3], v[120:123], v[88:91], a[0:3]
    v_mfma_f32_16x16x32_bf16 a[4:7], v[124:127], v[88:91], a[4:7]
    ds_read_b128 v[60:63], v22 offset:0
    v_mfma_f32_16x16x32_bf16 a[8:11], v[128:131], v[88:91], a[8:11]
    v_mfma_f32_16x16x32_bf16 a[12:15], v[132:135], v[88:91], a[12:15]
    s_add_u32 m0, s75, 61440
    s_nop 0
    buffer_load_dwordx4 v16, s[4:7], s60 offen  lds
    s_add_u32 s60, s60, 128
    v_mfma_f32_16x16x32_bf16 a[16:19], v[136:139], v[88:91], a[16:19]
    v_mfma_f32_16x16x32_bf16 a[20:23], v[140:143], v[88:91], a[20:23]
    ds_read_b128 v[64:67], v22 offset:2048
    v_mfma_f32_16x16x32_bf16 a[24:27], v[144:147], v[88:91], a[24:27]
    v_mfma_f32_16x16x32_bf16 a[28:31], v[120:123], v[92:95], a[28:31]
    s_add_u32 m0, s75, 65536
    s_nop 0
    buffer_load_dwordx4 v16, s[4:7], s61 offen  lds
    s_add_u32 s61, s61, 128
    v_mfma_f32_16x16x32_bf16 a[32:35], v[124:127], v[92:95], a[32:35]
    v_mfma_f32_16x16x32_bf16 a[36:39], v[128:131], v[92:95], a[36:39]
    ds_read_b128 v[68:71], v22 offset:4096
    v_mfma_f32_16x16x32_bf16 a[40:43], v[132:135], v[92:95], a[40:43]
    v_mfma_f32_16x16x32_bf16 a[44:47], v[136:139], v[92:95], a[44:47]
    s_add_u32 m0, s75, 69632
    s_nop 0
    buffer_load_dwordx4 v16, s[4:7], s62 offen  lds
    s_add_u32 s62, s62, 128
    v_mfma_f32_16x16x32_bf16 a[48:51], v[140:143], v[92:95], a[48:51]
    v_mfma_f32_16x16x32_bf16 a[52:55], v[144:147], v[92:95], a[52:55]
    ds_read_b128 v[72:75], v22 offset:6144
    v_mfma_f32_16x16x32_bf16 a[56:59], v[120:123], v[96:99], a[56:59]
    s_add_u32 m0, s75, 73728
    s_nop 0
    buffer_load_dwordx4 v16, s[4:7], s63 offen  lds
    s_add_u32 s63, s63, 128
    v_mfma_f32_16x16x32_bf16 a[60:63], v[124:127], v[96:99], a[60:63]
    v_mfma_f32_16x16x32_bf16 a[64:67], v[128:131], v[96:99], a[64:67]
    ds_read_b128 v[76:79], v22 offset:8192
    v_mfma_f32_16x16x32_bf16 a[68:71], v[132:135], v[96:99], a[68:71]
    v_mfma_f32_16x16x32_bf16 a[72:75], v[136:139], v[96:99], a[72:75]
    s_add_u32 m0, s75, 77824
    s_nop 0
    buffer_load_dwordx4 v16, s[4:7], s64 offen  lds
    s_add_u32 s64, s64, 128
    v_mfma_f32_16x16x32_bf16 a[76:79], v[140:143], v[96:99], a[76:79]
    v_mfma_f32_16x16x32_bf16 a[80:83], v[144:147], v[96:99], a[80:83]
    ds_read_b128 v[80:83], v22 offset:10240
    v_mfma_f32_16x16x32_bf16 a[84:87], v[120:123], v[100:103], a[84:87]
    v_mfma_f32_16x16x32_bf16 a[88:91], v[124:127], v[100:103], a[88:91]
    s_add_u32 m0, s75, 81920
    s_nop 0
    buffer_load_dwordx4 v16, s[4:7], s65 offen  lds
    s_add_u32 s65, s65, 128
    v_mfma_f32_16x16x32_bf16 a[92:95], v[128:131], v[100:103], a[92:95]
    v_mfma_f32_16x16x32_bf16 a[96:99], v[132:135], v[100:103], a[96:99]
    ds_read_b128 v[84:87], v22 offset:12288
    v_mfma_f32_16x16x32_bf16 a[100:103], v[136:139], v[100:103], a[100:103]
    v_mfma_f32_16x16x32_bf16 a[104:107], v[140:143], v[100:103], a[104:107]
    s_add_u32 m0, s75, 86016
    s_nop 0
    buffer_load_dwordx4 v16, s[4:7], s66 offen  lds
    s_add_u32 s66, s66, 128
    v_mfma_f32_16x16x32_bf16 a[108:111], v[144:147], v[100:103], a[108:111]
    ds_read_b128 v[28:31], v18 offset:0
    v_mfma_f32_16x16x32_bf16 a[112:115], v[120:123], v[104:107], a[112:115]
    v_mfma_f32_16x16x32_bf16 a[116:119], v[124:127], v[104:107], a[116:119]
    s_add_u32 m0, s75, 90112
    s_nop 0
    buffer_load_dwordx4 v16, s[4:7], s67 offen  lds
    s_add_u32 s67, s67, 128
    v_mfma_f32_16x16x32_bf16 a[120:123], v[128:131], v[104:107], a[120:123]
    v_mfma_f32_16x16x32_bf16 a[124:127], v[132:135], v[104:107], a[124:127]
    ds_read_b128 v[32:35], v18 offset:2048
    v_mfma_f32_16x16x32_bf16 a[128:131], v[136:139], v[104:107], a[128:131]
    v_mfma_f32_16x16x32_bf16 a[132:135], v[140:143], v[104:107], a[132:135]
    s_add_u32 m0, s75, 94208
    s_nop 0
    buffer_load_dwordx4 v17, s[4:7], s68 offen  lds
    s_add_u32 s68, s68, 128
    v_mfma_f32_16x16x32_bf16 a[136:139], v[144:147], v[104:107], a[136:139]
    v_mfma_f32_16x16x32_bf16 a[140:143], v[120:123], v[108:111], a[140:143]
    ds_read_b128 v[36:39], v18 offset:4096
    v_mfma_f32_16x16x32_bf16 a[144:147], v[124:127], v[108:111], a[144:147]
    v_mfma_f32_16x16x32_bf16 a[148:151], v[128:131], v[108:111], a[148:151]
    s_add_u32 m0, s75, 98304
    s_nop 0
    buffer_load_dwordx4 v17, s[4:7], s69 offen  lds
    s_add_u32 s69, s69, 128
    v_mfma_f32_16x16x32_bf16 a[152:155], v[132:135], v[108:111], a[152:155]
    v_mfma_f32_16x16x32_bf16 a[156:159], v[136:139], v[108:111], a[156:159]
    ds_read_b128 v[40:43], v18 offset:6144
    v_mfma_f32_16x16x32_bf16 a[160:163], v[140:143], v[108:111], a[160:163]
    v_mfma_f32_16x16x32_bf16 a[164:167], v[144:147], v[108:111], a[164:167]
    s_add_u32 m0, s75, 102400
    s_nop 0
    buffer_load_dwordx4 v17, s[4:7], s70 offen  lds
    s_add_u32 s70, s70, 128
    v_mfma_f32_16x16x32_bf16 a[168:171], v[120:123], v[112:115], a[168:171]
    ds_read_b128 v[44:47], v18 offset:8192
    v_mfma_f32_16x16x32_bf16 a[172:175], v[124:127], v[112:115], a[172:175]
    v_mfma_f32_16x16x32_bf16 a[176:179], v[128:131], v[112:115], a[176:179]
    s_add_u32 m0, s75, 106496
    s_nop 0
    buffer_load_dwordx4 v17, s[4:7], s71 offen  lds
    s_add_u32 s71, s71, 128
    v_mfma_f32_16x16x32_bf16 a[180:183], v[132:135], v[112:115], a[180:183]
    v_mfma_f32_16x16x32_bf16 a[184:187], v[136:139], v[112:115], a[184:187]
    ds_read_b128 v[48:51], v18 offset:10240
    v_mfma_f32_16x16x32_bf16 a[188:191], v[140:143], v[112:115], a[188:191]
    v_mfma_f32_16x16x32_bf16 a[192:195], v[144:147], v[112:115], a[192:195]
    s_add_u32 m0, s75, 110592
    s_nop 0
    buffer_load_dwordx4 v17, s[4:7], s72 offen  lds
    s_add_u32 s72, s72, 128
    v_mfma_f32_16x16x32_bf16 a[196:199], v[120:123], v[116:119], a[196:199]
    v_mfma_f32_16x16x32_bf16 a[200:203], v[124:127], v[116:119], a[200:203]
    ds_read_b128 v[52:55], v18 offset:12288
    v_mfma_f32_16x16x32_bf16 a[204:207], v[128:131], v[116:119], a[204:207]
    v_mfma_f32_16x16x32_bf16 a[208:211], v[132:135], v[116:119], a[208:211]
    s_add_u32 m0, s75, 114688
    s_nop 0
    buffer_load_dwordx4 v17, s[4:7], s73 offen  lds
    s_add_u32 s73, s73, 128
    v_mfma_f32_16x16x32_bf16 a[212:215], v[136:139], v[116:119], a[212:215]
    v_mfma_f32_16x16x32_bf16 a[216:219], v[140:143], v[116:119], a[216:219]
    ds_read_b128 v[56:59], v18 offset:14336
    v_mfma_f32_16x16x32_bf16 a[220:223], v[144:147], v[116:119], a[220:223]
    s_add_u32 m0, s75, 118784
    s_nop 0
    buffer_load_dwordx4 v17, s[4:7], s74 offen  lds
    s_add_u32 s74, s74, 128
    s_waitcnt lgkmcnt(0)
    v_mfma_f32_16x16x32_bf16 a[0:3], v[60:63], v[28:31], a[0:3]
    v_mfma_f32_16x16x32_bf16 a[4:7], v[64:67], v[28:31], a[4:7]
    v_mfma_f32_16x16x32_bf16 a[8:11], v[68:71], v[28:31], a[8:11]
    v_mfma_f32_16x16x32_bf16 a[12:15], v[72:75], v[28:31], a[12:15]
    ds_read_b128 v[120:123], v24 offset:0
    v_mfma_f32_16x16x32_bf16 a[16:19], v[76:79], v[28:31], a[16:19]
    v_mfma_f32_16x16x32_bf16 a[20:23], v[80:83], v[28:31], a[20:23]
    v_mfma_f32_16x16x32_bf16 a[24:27], v[84:87], v[28:31], a[24:27]
    v_mfma_f32_16x16x32_bf16 a[28:31], v[60:63], v[32:35], a[28:31]
    ds_read_b128 v[124:127], v24 offset:2048
    v_mfma_f32_16x16x32_bf16 a[32:35], v[64:67], v[32:35], a[32:35]
    v_mfma_f32_16x16x32_bf16 a[36:39], v[68:71], v[32:35], a[36:39]
    v_mfma_f32_16x16x32_bf16 a[40:43], v[72:75], v[32:35], a[40:43]
    v_mfma_f32_16x16x32_bf16 a[44:47], v[76:79], v[32:35], a[44:47]
    ds_read_b128 v[128:131], v24 offset:4096
    v_mfma_f32_16x16x32_bf16 a[48:51], v[80:83], v[32:35], a[48:51]
    v_mfma_f32_16x16x32_bf16 a[52:55], v[84:87], v[32:35], a[52:55]
    v_mfma_f32_16x16x32_bf16 a[56:59], v[60:63], v[36:39], a[56:59]
    ds_read_b128 v[132:135], v24 offset:6144
    v_mfma_f32_16x16x32_bf16 a[60:63], v[64:67], v[36:39], a[60:63]
    v_mfma_f32_16x16x32_bf16 a[64:67], v[68:71], v[36:39], a[64:67]
    v_mfma_f32_16x16x32_bf16 a[68:71], v[72:75], v[36:39], a[68:71]
    v_mfma_f32_16x16x32_bf16 a[72:75], v[76:79], v[36:39], a[72:75]
    ds_read_b128 v[136:139], v24 offset:8192
    v_mfma_f32_16x16x32_bf16 a[76:79], v[80:83], v[36:39], a[76:79]
    v_mfma_f32_16x16x32_bf16 a[80:83], v[84:87], v[36:39], a[80:83]
    v_mfma_f32_16x16x32_bf16 a[84:87], v[60:63], v[40:43], a[84:87]
    v_mfma_f32_16x16x32_bf16 a[88:91], v[64:67], v[40:43], a[88:91]
    ds_read_b128 v[140:143], v24 offset:10240
    v_mfma_f32_16x16x32_bf16 a[92:95], v[68:71], v[40:43], a[92:95]
    v_mfma_f32_16x16x32_bf16 a[96:99], v[72:75], v[40:43], a[96:99]
    v_mfma_f32_16x16x32_bf16 a[100:103], v[76:79], v[40:43], a[100:103]
    v_mfma_f32_16x16x32_bf16 a[104:107], v[80:83], v[40:43], a[104:107]
    ds_read_b128 v[144:147], v24 offset:12288
    v_mfma_f32_16x16x32_bf16 a[108:111], v[84:87], v[40:43], a[108:111]
    v_mfma_f32_16x16x32_bf16 a[112:115], v[60:63], v[44:47], a[112:115]
    v_mfma_f32_16x16x32_bf16 a[116:119], v[64:67], v[44:47], a[116:119]
    ds_read_b128 v[88:91], v20 offset:0
    v_mfma_f32_16x16x32_bf16 a[120:123], v[68:71], v[44:47], a[120:123]
    v_mfma_f32_16x16x32_bf16 a[124:127], v[72:75], v[44:47], a[124:127]
    v_mfma_f32_16x16x32_bf16 a[128:131], v[76:79], v[44:47], a[128:131]
    v_mfma_f32_16x16x32_bf16 a[132:135], v[80:83], v[44:47], a[132:135]
    ds_read_b128 v[92:95], v20 offset:2048
    v_mfma_f32_16x16x32_bf16 a[136:139], v[84:87], v[44:47], a[136:139]
    v_mfma_f32_16x16x32_bf16 a[140:143], v[60:63], v[48:51], a[140:143]
    v_mfma_f32_16x16x32_bf16 a[144:147], v[64:67], v[48:51], a[144:147]
    v_mfma_f32_16x16x32_bf16 a[148:151], v[68:71], v[48:51], a[148:151]
    ds_read_b128 v[96:99], v20 offset:4096
    v_mfma_f32_16x16x32_bf16 a[152:155], v[72:75], v[48:51], a[152:155]
    v_mfma_f32_16x16x32_bf16 a[156:159], v[76:79], v[48:51], a[156:159]
    v_mfma_f32_16x16x32_bf16 a[160:163], v[80:83], v[48:51], a[160:163]
    v_mfma_f32_16x16x32_bf16 a[164:167], v[84:87], v[48:51], a[164:167]
    ds_read_b128 v[100:103], v20 offset:6144
    v_mfma_f32_16x16x32_bf16 a[168:171], v[60:63], v[52:55], a[168:171]
    v_mfma_f32_16x16x32_bf16 a[172:175], v[64:67], v[52:55], a[172:175]
    v_mfma_f32_16x16x32_bf16 a[176:179], v[68:71], v[52:55], a[176:179]
    ds_read_b128 v[104:107], v20 offset:8192
    v_mfma_f32_16x16x32_bf16 a[180:183], v[72:75], v[52:55], a[180:183]
    v_mfma_f32_16x16x32_bf16 a[184:187], v[76:79], v[52:55], a[184:187]
    v_mfma_f32_16x16x32_bf16 a[188:191], v[80:83], v[52:55], a[188:191]
    v_mfma_f32_16x16x32_bf16 a[192:195], v[84:87], v[52:55], a[192:195]
    ds_read_b128 v[108:111], v20 offset:10240
    v_mfma_f32_16x16x32_bf16 a[196:199], v[60:63], v[56:59], a[196:199]
    v_mfma_f32_16x16x32_bf16 a[200:203], v[64:67], v[56:59], a[200:203]
    v_mfma_f32_16x16x32_bf16 a[204:207], v[68:71], v[56:59], a[204:207]
    v_mfma_f32_16x16x32_bf16 a[208:211], v[72:75], v[56:59], a[208:211]
    ds_read_b128 v[112:115], v20 offset:12288
    v_mfma_f32_16x16x32_bf16 a[212:215], v[76:79], v[56:59], a[212:215]
    v_mfma_f32_16x16x32_bf16 a[216:219], v[80:83], v[56:59], a[216:219]
    v_mfma_f32_16x16x32_bf16 a[220:223], v[84:87], v[56:59], a[220:223]
    ds_read_b128 v[116:119], v20 offset:14336
    s_waitcnt lgkmcnt(0) vmcnt(0)
    s_barrier
    v_mfma_f32_16x16x32_bf16 a[0:3], v[120:123], v[88:91], a[0:3]
    v_mfma_f32_16x16x32_bf16 a[4:7], v[124:127], v[88:91], a[4:7]
    ds_read_b128 v[60:63], v23 offset:0
    v_mfma_f32_16x16x32_bf16 a[8:11], v[128:131], v[88:91], a[8:11]
    v_mfma_f32_16x16x32_bf16 a[12:15], v[132:135], v[88:91], a[12:15]
    s_add_u32 m0, s75, 0
    s_nop 0
    buffer_load_dwordx4 v16, s[4:7], s60 offen  lds
    s_add_u32 s60, s60, 128
    v_mfma_f32_16x16x32_bf16 a[16:19], v[136:139], v[88:91], a[16:19]
    v_mfma_f32_16x16x32_bf16 a[20:23], v[140:143], v[88:91], a[20:23]
    ds_read_b128 v[64:67], v23 offset:2048
    v_mfma_f32_16x16x32_bf16 a[24:27], v[144:147], v[88:91], a[24:27]
    v_mfma_f32_16x16x32_bf16 a[28:31], v[120:123], v[92:95], a[28:31]
    s_add_u32 m0, s75, 4096
    s_nop 0
    buffer_load_dwordx4 v16, s[4:7], s61 offen  lds
    s_add_u32 s61, s61, 128
    v_mfma_f32_16x16x32_bf16 a[32:35], v[124:127], v[92:95], a[32:35]
    v_mfma_f32_16x16x32_bf16 a[36:39], v[128:131], v[92:95], a[36:39]
    ds_read_b128 v[68:71], v23 offset:4096
    v_mfma_f32_16x16x32_bf16 a[40:43], v[132:135], v[92:95], a[40:43]
    v_mfma_f32_16x16x32_bf16 a[44:47], v[136:139], v[92:95], a[44:47]
    s_add_u32 m0, s75, 8192
    s_nop 0
    buffer_load_dwordx4 v16, s[4:7], s62 offen  lds
    s_add_u32 s62, s62, 128
    v_mfma_f32_16x16x32_bf16 a[48:51], v[140:143], v[92:95], a[48:51]
    v_mfma_f32_16x16x32_bf16 a[52:55], v[144:147], v[92:95], a[52:55]
    ds_read_b128 v[72:75], v23 offset:6144
    v_mfma_f32_16x16x32_bf16 a[56:59], v[120:123], v[96:99], a[56:59]
    s_add_u32 m0, s75, 12288
    s_nop 0
    buffer_load_dwordx4 v16, s[4:7], s63 offen  lds
    s_add_u32 s63, s63, 128
    v_mfma_f32_16x16x32_bf16 a[60:63], v[124:127], v[96:99], a[60:63]
    v_mfma_f32_16x16x32_bf16 a[64:67], v[128:131], v[96:99], a[64:67]
    ds_read_b128 v[76:79], v23 offset:8192
    v_mfma_f32_16x16x32_bf16 a[68:71], v[132:135], v[96:99], a[68:71]
    v_mfma_f32_16x16x32_bf16 a[72:75], v[136:139], v[96:99], a[72:75]
    s_add_u32 m0, s75, 16384
    s_nop 0
    buffer_load_dwordx4 v16, s[4:7], s64 offen  lds
    s_add_u32 s64, s64, 128
    v_mfma_f32_16x16x32_bf16 a[76:79], v[140:143], v[96:99], a[76:79]
    v_mfma_f32_16x16x32_bf16 a[80:83], v[144:147], v[96:99], a[80:83]
    ds_read_b128 v[80:83], v23 offset:10240
    v_mfma_f32_16x16x32_bf16 a[84:87], v[120:123], v[100:103], a[84:87]
    v_mfma_f32_16x16x32_bf16 a[88:91], v[124:127], v[100:103], a[88:91]
    s_add_u32 m0, s75, 20480
    s_nop 0
    buffer_load_dwordx4 v16, s[4:7], s65 offen  lds
    s_add_u32 s65, s65, 128
    v_mfma_f32_16x16x32_bf16 a[92:95], v[128:131], v[100:103], a[92:95]
    v_mfma_f32_16x16x32_bf16 a[96:99], v[132:135], v[100:103], a[96:99]
    ds_read_b128 v[84:87], v23 offset:12288
    v_mfma_f32_16x16x32_bf16 a[100:103], v[136:139], v[100:103], a[100:103]
    v_mfma_f32_16x16x32_bf16 a[104:107], v[140:143], v[100:103], a[104:107]
    s_add_u32 m0, s75, 24576
    s_nop 0
    buffer_load_dwordx4 v16, s[4:7], s66 offen  lds
    s_add_u32 s66, s66, 128
    v_mfma_f32_16x16x32_bf16 a[108:111], v[144:147], v[100:103], a[108:111]
    ds_read_b128 v[28:31], v19 offset:0
    v_mfma_f32_16x16x32_bf16 a[112:115], v[120:123], v[104:107], a[112:115]
    v_mfma_f32_16x16x32_bf16 a[116:119], v[124:127], v[104:107], a[116:119]
    s_add_u32 m0, s75, 28672
    s_nop 0
    buffer_load_dwordx4 v16, s[4:7], s67 offen  lds
    s_add_u32 s67, s67, 128
    v_mfma_f32_16x16x32_bf16 a[120:123], v[128:131], v[104:107], a[120:123]
    v_mfma_f32_16x16x32_bf16 a[124:127], v[132:135], v[104:107], a[124:127]
    ds_read_b128 v[32:35], v19 offset:2048
    v_mfma_f32_16x16x32_bf16 a[128:131], v[136:139], v[104:107], a[128:131]
    v_mfma_f32_16x16x32_bf16 a[132:135], v[140:143], v[104:107], a[132:135]
    s_add_u32 m0, s75, 32768
    s_nop 0
    buffer_load_dwordx4 v17, s[4:7], s68 offen  lds
    s_add_u32 s68, s68, 128
    v_mfma_f32_16x16x32_bf16 a[136:139], v[144:147], v[104:107], a[136:139]
    v_mfma_f32_16x16x32_bf16 a[140:143], v[120:123], v[108:111], a[140:143]
    ds_read_b128 v[36:39], v19 offset:4096
    v_mfma_f32_16x16x32_bf16 a[144:147], v[124:127], v[108:111], a[144:147]
    v_mfma_f32_16x16x32_bf16 a[148:151], v[128:131], v[108:111], a[148:151]
    s_add_u32 m0, s75, 36864
    s_nop 0
    buffer_load_dwordx4 v17, s[4:7], s69 offen  lds
    s_add_u32 s69, s69, 128
    v_mfma_f32_16x16x32_bf16 a[152:155], v[132:135], v[108:111], a[152:155]
    v_mfma_f32_16x16x32_bf16 a[156:159], v[136:139], v[108:111], a[156:159]
    ds_read_b128 v[40:43], v19 offset:6144
    v_mfma_f32_16x16x32_bf16 a[160:163], v[140:143], v[108:111], a[160:163]
    v_mfma_f32_16x16x32_bf16 a[164:167], v[144:147], v[108:111], a[164:167]
    s_add_u32 m0, s75, 40960
    s_nop 0
    buffer_load_dwordx4 v17, s[4:7], s70 offen  lds
    s_add_u32 s70, s70, 128
    v_mfma_f32_16x16x32_bf16 a[168:171], v[120:123], v[112:115], a[168:171]
    ds_read_b128 v[44:47], v19 offset:8192
    v_mfma_f32_16x16x32_bf16 a[172:175], v[124:127], v[112:115], a[172:175]
    v_mfma_f32_16x16x32_bf16 a[176:179], v[128:131], v[112:115], a[176:179]
    s_add_u32 m0, s75, 45056
    s_nop 0
    buffer_load_dwordx4 v17, s[4:7], s71 offen  lds
    s_add_u32 s71, s71, 128
    v_mfma_f32_16x16x32_bf16 a[180:183], v[132:135], v[112:115], a[180:183]
    v_mfma_f32_16x16x32_bf16 a[184:187], v[136:139], v[112:115], a[184:187]
    ds_read_b128 v[48:51], v19 offset:10240
    v_mfma_f32_16x16x32_bf16 a[188:191], v[140:143], v[112:115], a[188:191]
    v_mfma_f32_16x16x32_bf16 a[192:195], v[144:147], v[112:115], a[192:195]
    s_add_u32 m0, s75, 49152
    s_nop 0
    buffer_load_dwordx4 v17, s[4:7], s72 offen  lds
    s_add_u32 s72, s72, 128
    v_mfma_f32_16x16x32_bf16 a[196:199], v[120:123], v[116:119], a[196:199]
    v_mfma_f32_16x16x32_bf16 a[200:203], v[124:127], v[116:119], a[200:203]
    ds_read_b128 v[52:55], v19 offset:12288
    v_mfma_f32_16x16x32_bf16 a[204:207], v[128:131], v[116:119], a[204:207]
    v_mfma_f32_16x16x32_bf16 a[208:211], v[132:135], v[116:119], a[208:211]
    s_add_u32 m0, s75, 53248
    s_nop 0
    buffer_load_dwordx4 v17, s[4:7], s73 offen  lds
    s_add_u32 s73, s73, 128
    v_mfma_f32_16x16x32_bf16 a[212:215], v[136:139], v[116:119], a[212:215]
    v_mfma_f32_16x16x32_bf16 a[216:219], v[140:143], v[116:119], a[216:219]
    ds_read_b128 v[56:59], v19 offset:14336
    v_mfma_f32_16x16x32_bf16 a[220:223], v[144:147], v[116:119], a[220:223]
    s_add_u32 m0, s75, 57344
    s_nop 0
    buffer_load_dwordx4 v17, s[4:7], s74 offen  lds
    s_add_u32 s74, s74, 128
    s_waitcnt lgkmcnt(0)
    v_mfma_f32_16x16x32_bf16 a[0:3], v[60:63], v[28:31], a[0:3]
    v_mfma_f32_16x16x32_bf16 a[4:7], v[64:67], v[28:31], a[4:7]
    v_mfma_f32_16x16x32_bf16 a[8:11], v[68:71], v[28:31], a[8:11]
    v_mfma_f32_16x16x32_bf16 a[12:15], v[72:75], v[28:31], a[12:15]
    ds_read_b128 v[120:123], v25 offset:0
    v_mfma_f32_16x16x32_bf16 a[16:19], v[76:79], v[28:31], a[16:19]
    v_mfma_f32_16x16x32_bf16 a[20:23], v[80:83], v[28:31], a[20:23]
    v_mfma_f32_16x16x32_bf16 a[24:27], v[84:87], v[28:31], a[24:27]
    v_mfma_f32_16x16x32_bf16 a[28:31], v[60:63], v[32:35], a[28:31]
    ds_read_b128 v[124:127], v25 offset:2048
    v_mfma_f32_16x16x32_bf16 a[32:35], v[64:67], v[32:35], a[32:35]
    v_mfma_f32_16x16x32_bf16 a[36:39], v[68:71], v[32:35], a[36:39]
    v_mfma_f32_16x16x32_bf16 a[40:43], v[72:75], v[32:35], a[40:43]
    v_mfma_f32_16x16x32_bf16 a[44:47], v[76:79], v[32:35], a[44:47]
    ds_read_b128 v[128:131], v25 offset:4096
    v_mfma_f32_16x16x32_bf16 a[48:51], v[80:83], v[32:35], a[48:51]
    v_mfma_f32_16x16x32_bf16 a[52:55], v[84:87], v[32:35], a[52:55]
    v_mfma_f32_16x16x32_bf16 a[56:59], v[60:63], v[36:39], a[56:59]
    ds_read_b128 v[132:135], v25 offset:6144
    v_mfma_f32_16x16x32_bf16 a[60:63], v[64:67], v[36:39], a[60:63]
    v_mfma_f32_16x16x32_bf16 a[64:67], v[68:71], v[36:39], a[64:67]
    v_mfma_f32_16x16x32_bf16 a[68:71], v[72:75], v[36:39], a[68:71]
    v_mfma_f32_16x16x32_bf16 a[72:75], v[76:79], v[36:39], a[72:75]
    ds_read_b128 v[136:139], v25 offset:8192
    v_mfma_f32_16x16x32_bf16 a[76:79], v[80:83], v[36:39], a[76:79]
    v_mfma_f32_16x16x32_bf16 a[80:83], v[84:87], v[36:39], a[80:83]
    v_mfma_f32_16x16x32_bf16 a[84:87], v[60:63], v[40:43], a[84:87]
    v_mfma_f32_16x16x32_bf16 a[88:91], v[64:67], v[40:43], a[88:91]
    ds_read_b128 v[140:143], v25 offset:10240
    v_mfma_f32_16x16x32_bf16 a[92:95], v[68:71], v[40:43], a[92:95]
    v_mfma_f32_16x16x32_bf16 a[96:99], v[72:75], v[40:43], a[96:99]
    v_mfma_f32_16x16x32_bf16 a[100:103], v[76:79], v[40:43], a[100:103]
    v_mfma_f32_16x16x32_bf16 a[104:107], v[80:83], v[40:43], a[104:107]
    ds_read_b128 v[144:147], v25 offset:12288
    v_mfma_f32_16x16x32_bf16 a[108:111], v[84:87], v[40:43], a[108:111]
    v_mfma_f32_16x16x32_bf16 a[112:115], v[60:63], v[44:47], a[112:115]
    v_mfma_f32_16x16x32_bf16 a[116:119], v[64:67], v[44:47], a[116:119]
    ds_read_b128 v[88:91], v21 offset:0
    v_mfma_f32_16x16x32_bf16 a[120:123], v[68:71], v[44:47], a[120:123]
    v_mfma_f32_16x16x32_bf16 a[124:127], v[72:75], v[44:47], a[124:127]
    v_mfma_f32_16x16x32_bf16 a[128:131], v[76:79], v[44:47], a[128:131]
    v_mfma_f32_16x16x32_bf16 a[132:135], v[80:83], v[44:47], a[132:135]
    ds_read_b128 v[92:95], v21 offset:2048
    v_mfma_f32_16x16x32_bf16 a[136:139], v[84:87], v[44:47], a[136:139]
    v_mfma_f32_16x16x32_bf16 a[140:143], v[60:63], v[48:51], a[140:143]
    v_mfma_f32_16x16x32_bf16 a[144:147], v[64:67], v[48:51], a[144:147]
    v_mfma_f32_16x16x32_bf16 a[148:151], v[68:71], v[48:51], a[148:151]
    ds_read_b128 v[96:99], v21 offset:4096
    v_mfma_f32_16x16x32_bf16 a[152:155], v[72:75], v[48:51], a[152:155]
    v_mfma_f32_16x16x32_bf16 a[156:159], v[76:79], v[48:51], a[156:159]
    v_mfma_f32_16x16x32_bf16 a[160:163], v[80:83], v[48:51], a[160:163]
    v_mfma_f32_16x16x32_bf16 a[164:167], v[84:87], v[48:51], a[164:167]
    ds_read_b128 v[100:103], v21 offset:6144
    v_mfma_f32_16x16x32_bf16 a[168:171], v[60:63], v[52:55], a[168:171]
    v_mfma_f32_16x16x32_bf16 a[172:175], v[64:67], v[52:55], a[172:175]
    v_mfma_f32_16x16x32_bf16 a[176:179], v[68:71], v[52:55], a[176:179]
    ds_read_b128 v[104:107], v21 offset:8192
    v_mfma_f32_16x16x32_bf16 a[180:183], v[72:75], v[52:55], a[180:183]
    v_mfma_f32_16x16x32_bf16 a[184:187], v[76:79], v[52:55], a[184:187]
    v_mfma_f32_16x16x32_bf16 a[188:191], v[80:83], v[52:55], a[188:191]
    v_mfma_f32_16x16x32_bf16 a[192:195], v[84:87], v[52:55], a[192:195]
    ds_read_b128 v[108:111], v21 offset:10240
    v_mfma_f32_16x16x32_bf16 a[196:199], v[60:63], v[56:59], a[196:199]
    v_mfma_f32_16x16x32_bf16 a[200:203], v[64:67], v[56:59], a[200:203]
    v_mfma_f32_16x16x32_bf16 a[204:207], v[68:71], v[56:59], a[204:207]
    v_mfma_f32_16x16x32_bf16 a[208:211], v[72:75], v[56:59], a[208:211]
    ds_read_b128 v[112:115], v21 offset:12288
    v_mfma_f32_16x16x32_bf16 a[212:215], v[76:79], v[56:59], a[212:215]
    v_mfma_f32_16x16x32_bf16 a[216:219], v[80:83], v[56:59], a[216:219]
    v_mfma_f32_16x16x32_bf16 a[220:223], v[84:87], v[56:59], a[220:223]
    ds_read_b128 v[116:119], v21 offset:14336
    s_waitcnt lgkmcnt(0) vmcnt(0)
    s_barrier
    v_mfma_f32_16x16x32_bf16 a[0:3], v[120:123], v[88:91], a[0:3]
    v_mfma_f32_16x16x32_bf16 a[4:7], v[124:127], v[88:91], a[4:7]
    v_mfma_f32_16x16x32_bf16 a[8:11], v[128:131], v[88:91], a[8:11]
    v_mfma_f32_16x16x32_bf16 a[12:15], v[132:135], v[88:91], a[12:15]
    ds_read_b128 v[60:63], v22 offset:0
    v_mfma_f32_16x16x32_bf16 a[16:19], v[136:139], v[88:91], a[16:19]
    v_mfma_f32_16x16x32_bf16 a[20:23], v[140:143], v[88:91], a[20:23]
    v_mfma_f32_16x16x32_bf16 a[24:27], v[144:147], v[88:91], a[24:27]
    v_mfma_f32_16x16x32_bf16 a[28:31], v[120:123], v[92:95], a[28:31]
    ds_read_b128 v[64:67], v22 offset:2048
    v_mfma_f32_16x16x32_bf16 a[32:35], v[124:127], v[92:95], a[32:35]
    v_mfma_f32_16x16x32_bf16 a[36:39], v[128:131], v[92:95], a[36:39]
    v_mfma_f32_16x16x32_bf16 a[40:43], v[132:135], v[92:95], a[40:43]
    v_mfma_f32_16x16x32_bf16 a[44:47], v[136:139], v[92:95], a[44:47]
    ds_read_b128 v[68:71], v22 offset:4096
    v_mfma_f32_16x16x32_bf16 a[48:51], v[140:143], v[92:95], a[48:51]
    v_mfma_f32_16x16x32_bf16 a[52:55], v[144:147], v[92:95], a[52:55]
    v_mfma_f32_16x16x32_bf16 a[56:59], v[120:123], v[96:99], a[56:59]
    ds_read_b128 v[72:75], v22 offset:6144
    v_mfma_f32_16x16x32_bf16 a[60:63], v[124:127], v[96:99], a[60:63]
    v_mfma_f32_16x16x32_bf16 a[64:67], v[128:131], v[96:99], a[64:67]
    v_mfma_f32_16x16x32_bf16 a[68:71], v[132:135], v[96:99], a[68:71]
    v_mfma_f32_16x16x32_bf16 a[72:75], v[136:139], v[96:99], a[72:75]
    ds_read_b128 v[76:79], v22 offset:8192
    v_mfma_f32_16x16x32_bf16 a[76:79], v[140:143], v[96:99], a[76:79]
    v_mfma_f32_16x16x32_bf16 a[80:83], v[144:147], v[96:99], a[80:83]
    v_mfma_f32_16x16x32_bf16 a[84:87], v[120:123], v[100:103], a[84:87]
    v_mfma_f32_16x16x32_bf16 a[88:91], v[124:127], v[100:103], a[88:91]
    ds_read_b128 v[80:83], v22 offset:10240
    v_mfma_f32_16x16x32_bf16 a[92:95], v[128:131], v[100:103], a[92:95]
    v_mfma_f32_16x16x32_bf16 a[96:99], v[132:135], v[100:103], a[96:99]
    v_mfma_f32_16x16x32_bf16 a[100:103], v[136:139], v[100:103], a[100:103]
    v_mfma_f32_16x16x32_bf16 a[104:107], v[140:143], v[100:103], a[104:107]
    ds_read_b128 v[84:87], v22 offset:12288
    v_mfma_f32_16x16x32_bf16 a[108:111], v[144:147], v[100:103], a[108:111]
    v_mfma_f32_16x16x32_bf16 a[112:115], v[120:123], v[104:107], a[112:115]
    v_mfma_f32_16x16x32_bf16 a[116:119], v[124:127], v[104:107], a[116:119]
    ds_read_b128 v[28:31], v18 offset:0
    v_mfma_f32_16x16x32_bf16 a[120:123], v[128:131], v[104:107], a[120:123]
    v_mfma_f32_16x16x32_bf16 a[124:127], v[132:135], v[104:107], a[124:127]
    v_mfma_f32_16x16x32_bf16 a[128:131], v[136:139], v[104:107], a[128:131]
    v_mfma_f32_16x16x32_bf16 a[132:135], v[140:143], v[104:107], a[132:135]
    ds_read_b128 v[32:35], v18 offset:2048
    v_mfma_f32_16x16x32_bf16 a[136:139], v[144:147], v[104:107], a[136:139]
    v_mfma_f32_16x16x32_bf16 a[140:143], v[120:123], v[108:111], a[140:143]
    v_mfma_f32_16x16x32_bf16 a[144:147], v[124:127], v[108:111], a[144:147]
    v_mfma_f32_16x16x32_bf16 a[148:151], v[128:131], v[108:111], a[148:151]
    ds_read_b128 v[36:39], v18 offset:4096
    v_mfma_f32_16x16x32_bf16 a[152:155], v[132:135], v[108:111], a[152:155]
    v_mfma_f32_16x16x32_bf16 a[156:159], v[136:139], v[108:111], a[156:159]
    v_mfma_f32_16x16x32_bf16 a[160:163], v[140:143], v[108:111], a[160:163]
    v_mfma_f32_16x16x32_bf16 a[164:167], v[144:147], v[108:111], a[164:167]
    ds_read_b128 v[40:43], v18 offset:6144
    v_mfma_f32_16x16x32_bf16 a[168:171], v[120:123], v[112:115], a[168:171]
    v_mfma_f32_16x16x32_bf16 a[172:175], v[124:127], v[112:115], a[172:175]
    v_mfma_f32_16x16x32_bf16 a[176:179], v[128:131], v[112:115], a[176:179]
    ds_read_b128 v[44:47], v18 offset:8192
    v_mfma_f32_16x16x32_bf16 a[180:183], v[132:135], v[112:115], a[180:183]
    v_mfma_f32_16x16x32_bf16 a[184:187], v[136:139], v[112:115], a[184:187]
    v_mfma_f32_16x16x32_bf16 a[188:191], v[140:143], v[112:115], a[188:191]
    v_mfma_f32_16x16x32_bf16 a[192:195], v[144:147], v[112:115], a[192:195]
    ds_read_b128 v[48:51], v18 offset:10240
    v_mfma_f32_16x16x32_bf16 a[196:199], v[120:123], v[116:119], a[196:199]
    v_mfma_f32_16x16x32_bf16 a[200:203], v[124:127], v[116:119], a[200:203]
    v_mfma_f32_16x16x32_bf16 a[204:207], v[128:131], v[116:119], a[204:207]
    v_mfma_f32_16x16x32_bf16 a[208:211], v[132:135], v[116:119], a[208:211]
    ds_read_b128 v[52:55], v18 offset:12288
    v_mfma_f32_16x16x32_bf16 a[212:215], v[136:139], v[116:119], a[212:215]
    v_mfma_f32_16x16x32_bf16 a[216:219], v[140:143], v[116:119], a[216:219]
    v_mfma_f32_16x16x32_bf16 a[220:223], v[144:147], v[116:119], a[220:223]
    ds_read_b128 v[56:59], v18 offset:14336
    s_waitcnt lgkmcnt(0)
    v_mfma_f32_16x16x32_bf16 a[0:3], v[60:63], v[28:31], a[0:3]
    v_mfma_f32_16x16x32_bf16 a[4:7], v[64:67], v[28:31], a[4:7]
    v_mfma_f32_16x16x32_bf16 a[8:11], v[68:71], v[28:31], a[8:11]
    v_mfma_f32_16x16x32_bf16 a[12:15], v[72:75], v[28:31], a[12:15]
    ds_read_b128 v[120:123], v24 offset:0
    v_mfma_f32_16x16x32_bf16 a[16:19], v[76:79], v[28:31], a[16:19]
    v_mfma_f32_16x16x32_bf16 a[20:23], v[80:83], v[28:31], a[20:23]
    v_mfma_f32_16x16x32_bf16 a[24:27], v[84:87], v[28:31], a[24:27]
    v_mfma_f32_16x16x32_bf16 a[28:31], v[60:63], v[32:35], a[28:31]
    ds_read_b128 v[124:127], v24 offset:2048
    v_mfma_f32_16x16x32_bf16 a[32:35], v[64:67], v[32:35], a[32:35]
    v_mfma_f32_16x16x32_bf16 a[36:39], v[68:71], v[32:35], a[36:39]
    v_mfma_f32_16x16x32_bf16 a[40:43], v[72:75], v[32:35], a[40:43]
    v_mfma_f32_16x16x32_bf16 a[44:47], v[76:79], v[32:35], a[44:47]
    ds_read_b128 v[128:131], v24 offset:4096
    v_mfma_f32_16x16x32_bf16 a[48:51], v[80:83], v[32:35], a[48:51]
    v_mfma_f32_16x16x32_bf16 a[52:55], v[84:87], v[32:35], a[52:55]
    v_mfma_f32_16x16x32_bf16 a[56:59], v[60:63], v[36:39], a[56:59]
    ds_read_b128 v[132:135], v24 offset:6144
    v_mfma_f32_16x16x32_bf16 a[60:63], v[64:67], v[36:39], a[60:63]
    v_mfma_f32_16x16x32_bf16 a[64:67], v[68:71], v[36:39], a[64:67]
    v_mfma_f32_16x16x32_bf16 a[68:71], v[72:75], v[36:39], a[68:71]
    v_mfma_f32_16x16x32_bf16 a[72:75], v[76:79], v[36:39], a[72:75]
    ds_read_b128 v[136:139], v24 offset:8192
    v_mfma_f32_16x16x32_bf16 a[76:79], v[80:83], v[36:39], a[76:79]
    v_mfma_f32_16x16x32_bf16 a[80:83], v[84:87], v[36:39], a[80:83]
    v_mfma_f32_16x16x32_bf16 a[84:87], v[60:63], v[40:43], a[84:87]
    v_mfma_f32_16x16x32_bf16 a[88:91], v[64:67], v[40:43], a[88:91]
    ds_read_b128 v[140:143], v24 offset:10240
    v_mfma_f32_16x16x32_bf16 a[92:95], v[68:71], v[40:43], a[92:95]
    v_mfma_f32_16x16x32_bf16 a[96:99], v[72:75], v[40:43], a[96:99]
    v_mfma_f32_16x16x32_bf16 a[100:103], v[76:79], v[40:43], a[100:103]
    v_mfma_f32_16x16x32_bf16 a[104:107], v[80:83], v[40:43], a[104:107]
    ds_read_b128 v[144:147], v24 offset:12288
    v_mfma_f32_16x16x32_bf16 a[108:111], v[84:87], v[40:43], a[108:111]
    v_mfma_f32_16x16x32_bf16 a[112:115], v[60:63], v[44:47], a[112:115]
    v_mfma_f32_16x16x32_bf16 a[116:119], v[64:67], v[44:47], a[116:119]
    ds_read_b128 v[88:91], v20 offset:0
    v_mfma_f32_16x16x32_bf16 a[120:123], v[68:71], v[44:47], a[120:123]
    v_mfma_f32_16x16x32_bf16 a[124:127], v[72:75], v[44:47], a[124:127]
    v_mfma_f32_16x16x32_bf16 a[128:131], v[76:79], v[44:47], a[128:131]
    v_mfma_f32_16x16x32_bf16 a[132:135], v[80:83], v[44:47], a[132:135]
    ds_read_b128 v[92:95], v20 offset:2048
    v_mfma_f32_16x16x32_bf16 a[136:139], v[84:87], v[44:47], a[136:139]
    v_mfma_f32_16x16x32_bf16 a[140:143], v[60:63], v[48:51], a[140:143]
    v_mfma_f32_16x16x32_bf16 a[144:147], v[64:67], v[48:51], a[144:147]
    v_mfma_f32_16x16x32_bf16 a[148:151], v[68:71], v[48:51], a[148:151]
    ds_read_b128 v[96:99], v20 offset:4096
    v_mfma_f32_16x16x32_bf16 a[152:155], v[72:75], v[48:51], a[152:155]
    v_mfma_f32_16x16x32_bf16 a[156:159], v[76:79], v[48:51], a[156:159]
    v_mfma_f32_16x16x32_bf16 a[160:163], v[80:83], v[48:51], a[160:163]
    v_mfma_f32_16x16x32_bf16 a[164:167], v[84:87], v[48:51], a[164:167]
    ds_read_b128 v[100:103], v20 offset:6144
    v_mfma_f32_16x16x32_bf16 a[168:171], v[60:63], v[52:55], a[168:171]
    v_mfma_f32_16x16x32_bf16 a[172:175], v[64:67], v[52:55], a[172:175]
    v_mfma_f32_16x16x32_bf16 a[176:179], v[68:71], v[52:55], a[176:179]
    ds_read_b128 v[104:107], v20 offset:8192
    v_mfma_f32_16x16x32_bf16 a[180:183], v[72:75], v[52:55], a[180:183]
    v_mfma_f32_16x16x32_bf16 a[184:187], v[76:79], v[52:55], a[184:187]
    v_mfma_f32_16x16x32_bf16 a[188:191], v[80:83], v[52:55], a[188:191]
    v_mfma_f32_16x16x32_bf16 a[192:195], v[84:87], v[52:55], a[192:195]
    ds_read_b128 v[108:111], v20 offset:10240
    v_mfma_f32_16x16x32_bf16 a[196:199], v[60:63], v[56:59], a[196:199]
    v_mfma_f32_16x16x32_bf16 a[200:203], v[64:67], v[56:59], a[200:203]
    v_mfma_f32_16x16x32_bf16 a[204:207], v[68:71], v[56:59], a[204:207]
    v_mfma_f32_16x16x32_bf16 a[208:211], v[72:75], v[56:59], a[208:211]
    ds_read_b128 v[112:115], v20 offset:12288
    v_mfma_f32_16x16x32_bf16 a[212:215], v[76:79], v[56:59], a[212:215]
    v_mfma_f32_16x16x32_bf16 a[216:219], v[80:83], v[56:59], a[216:219]
    v_mfma_f32_16x16x32_bf16 a[220:223], v[84:87], v[56:59], a[220:223]
    ds_read_b128 v[116:119], v20 offset:14336
    s_waitcnt lgkmcnt(0)
    v_mfma_f32_16x16x32_bf16 a[0:3], v[120:123], v[88:91], a[0:3]
    v_mfma_f32_16x16x32_bf16 a[4:7], v[124:127], v[88:91], a[4:7]
    v_mfma_f32_16x16x32_bf16 a[8:11], v[128:131], v[88:91], a[8:11]
    v_mfma_f32_16x16x32_bf16 a[12:15], v[132:135], v[88:91], a[12:15]
    v_mfma_f32_16x16x32_bf16 a[16:19], v[136:139], v[88:91], a[16:19]
    v_mfma_f32_16x16x32_bf16 a[20:23], v[140:143], v[88:91], a[20:23]
    v_mfma_f32_16x16x32_bf16 a[24:27], v[144:147], v[88:91], a[24:27]
    v_mfma_f32_16x16x32_bf16 a[28:31], v[120:123], v[92:95], a[28:31]
    v_mfma_f32_16x16x32_bf16 a[32:35], v[124:127], v[92:95], a[32:35]
    v_mfma_f32_16x16x32_bf16 a[36:39], v[128:131], v[92:95], a[36:39]
    v_mfma_f32_16x16x32_bf16 a[40:43], v[132:135], v[92:95], a[40:43]
    v_mfma_f32_16x16x32_bf16 a[44:47], v[136:139], v[92:95], a[44:47]
    v_mfma_f32_16x16x32_bf16 a[48:51], v[140:143], v[92:95], a[48:51]
    v_mfma_f32_16x16x32_bf16 a[52:55], v[144:147], v[92:95], a[52:55]
    v_mfma_f32_16x16x32_bf16 a[56:59], v[120:123], v[96:99], a[56:59]
    v_mfma_f32_16x16x32_bf16 a[60:63], v[124:127], v[96:99], a[60:63]
    v_mfma_f32_16x16x32_bf16 a[64:67], v[128:131], v[96:99], a[64:67]
    v_mfma_f32_16x16x32_bf16 a[68:71], v[132:135], v[96:99], a[68:71]
    v_mfma_f32_16x16x32_bf16 a[72:75], v[136:139], v[96:99], a[72:75]
    v_mfma_f32_16x16x32_bf16 a[76:79], v[140:143], v[96:99], a[76:79]
    v_mfma_f32_16x16x32_bf16 a[80:83], v[144:147], v[96:99], a[80:83]
    v_mfma_f32_16x16x32_bf16 a[84:87], v[120:123], v[100:103], a[84:87]
    v_mfma_f32_16x16x32_bf16 a[88:91], v[124:127], v[100:103], a[88:91]
    v_mfma_f32_16x16x32_bf16 a[92:95], v[128:131], v[100:103], a[92:95]
    v_mfma_f32_16x16x32_bf16 a[96:99], v[132:135], v[100:103], a[96:99]
    v_mfma_f32_16x16x32_bf16 a[100:103], v[136:139], v[100:103], a[100:103]
    v_mfma_f32_16x16x32_bf16 a[104:107], v[140:143], v[100:103], a[104:107]
    v_mfma_f32_16x16x32_bf16 a[108:111], v[144:147], v[100:103], a[108:111]
    v_mfma_f32_16x16x32_bf16 a[112:115], v[120:123], v[104:107], a[112:115]
    v_mfma_f32_16x16x32_bf16 a[116:119], v[124:127], v[104:107], a[116:119]
    v_mfma_f32_16x16x32_bf16 a[120:123], v[128:131], v[104:107], a[120:123]
    v_mfma_f32_16x16x32_bf16 a[124:127], v[132:135], v[104:107], a[124:127]
    v_mfma_f32_16x16x32_bf16 a[128:131], v[136:139], v[104:107], a[128:131]
    v_mfma_f32_16x16x32_bf16 a[132:135], v[140:143], v[104:107], a[132:135]
    v_mfma_f32_16x16x32_bf16 a[136:139], v[144:147], v[104:107], a[136:139]
    v_mfma_f32_16x16x32_bf16 a[140:143], v[120:123], v[108:111], a[140:143]
    v_mfma_f32_16x16x32_bf16 a[144:147], v[124:127], v[108:111], a[144:147]
    v_mfma_f32_16x16x32_bf16 a[148:151], v[128:131], v[108:111], a[148:151]
    v_mfma_f32_16x16x32_bf16 a[152:155], v[132:135], v[108:111], a[152:155]
    v_mfma_f32_16x16x32_bf16 a[156:159], v[136:139], v[108:111], a[156:159]
    v_mfma_f32_16x16x32_bf16 a[160:163], v[140:143], v[108:111], a[160:163]
    v_mfma_f32_16x16x32_bf16 a[164:167], v[144:147], v[108:111], a[164:167]
    v_mfma_f32_16x16x32_bf16 a[168:171], v[120:123], v[112:115], a[168:171]
    v_mfma_f32_16x16x32_bf16 a[172:175], v[124:127], v[112:115], a[172:175]
    v_mfma_f32_16x16x32_bf16 a[176:179], v[128:131], v[112:115], a[176:179]
    v_mfma_f32_16x16x32_bf16 a[180:183], v[132:135], v[112:115], a[180:183]
    v_mfma_f32_16x16x32_bf16 a[184:187], v[136:139], v[112:115], a[184:187]
    v_mfma_f32_16x16x32_bf16 a[188:191], v[140:143], v[112:115], a[188:191]
    v_mfma_f32_16x16x32_bf16 a[192:195], v[144:147], v[112:115], a[192:195]
    v_mfma_f32_16x16x32_bf16 a[196:199], v[120:123], v[116:119], a[196:199]
    v_mfma_f32_16x16x32_bf16 a[200:203], v[124:127], v[116:119], a[200:203]
    v_mfma_f32_16x16x32_bf16 a[204:207], v[128:131], v[116:119], a[204:207]
    v_mfma_f32_16x16x32_bf16 a[208:211], v[132:135], v[116:119], a[208:211]
    v_mfma_f32_16x16x32_bf16 a[212:215], v[136:139], v[116:119], a[212:215]
    v_mfma_f32_16x16x32_bf16 a[216:219], v[140:143], v[116:119], a[216:219]
    v_mfma_f32_16x16x32_bf16 a[220:223], v[144:147], v[116:119], a[220:223]
    s_nop 7
    s_nop 7
    s_barrier
    v_mul_u32_u24 v12, 240, v3
    v_lshl_add_u32 v12, v4, 3, v12
    v_mul_u32_u24 v13, 30720, v2
    v_add_u32 v12, v12, v13
    v_accvgpr_read_b32 v28, a0
    v_accvgpr_read_b32 v29, a1
    v_accvgpr_read_b32 v30, a2
    v_accvgpr_read_b32 v31, a3
    v_cvt_pk_bf16_f32 v32, v28, v29
    v_cvt_pk_bf16_f32 v33, v30, v31
    ds_write_b64 v12, v[32:33] offset:0
    v_accvgpr_read_b32 v44, a4
    v_accvgpr_read_b32 v45, a5
    v_accvgpr_read_b32 v46, a6
    v_accvgpr_read_b32 v47, a7
    v_cvt_pk_bf16_f32 v48, v44, v45
    v_cvt_pk_bf16_f32 v49, v46, v47
    ds_write_b64 v12, v[48:49] offset:32
    v_accvgpr_read_b32 v60, a8
    v_accvgpr_read_b32 v61, a9
    v_accvgpr_read_b32 v62, a10
    v_accvgpr_read_b32 v63, a11
    v_cvt_pk_bf16_f32 v64, v60, v61
    v_cvt_pk_bf16_f32 v65, v62, v63
    ds_write_b64 v12, v[64:65] offset:64
    v_accvgpr_read_b32 v76, a12
    v_accvgpr_read_b32 v77, a13
    v_accvgpr_read_b32 v78, a14
    v_accvgpr_read_b32 v79, a15
    v_cvt_pk_bf16_f32 v80, v76, v77
    v_cvt_pk_bf16_f32 v81, v78, v79
    ds_write_b64 v12, v[80:81] offset:96
    v_accvgpr_read_b32 v28, a16
    v_accvgpr_read_b32 v29, a17
    v_accvgpr_read_b32 v30, a18
    v_accvgpr_read_b32 v31, a19
    v_cvt_pk_bf16_f32 v32, v28, v29
    v_cvt_pk_bf16_f32 v33, v30, v31
    ds_write_b64 v12, v[32:33] offset:128
    v_accvgpr_read_b32 v44, a20
    v_accvgpr_read_b32 v45, a21
    v_accvgpr_read_b32 v46, a22
    v_accvgpr_read_b32 v47, a23
    v_cvt_pk_bf16_f32 v48, v44, v45
    v_cvt_pk_bf16_f32 v49, v46, v47
    ds_write_b64 v12, v[48:49] offset:160
    v_accvgpr_read_b32 v60, a24
    v_accvgpr_read_b32 v61, a25
    v_accvgpr_read_b32 v62, a26
    v_accvgpr_read_b32 v63, a27
    v_cvt_pk_bf16_f32 v64, v60, v61
    v_cvt_pk_bf16_f32 v65, v62, v63
    ds_write_b64 v12, v[64:65] offset:192
    v_accvgpr_read_b32 v76, a28
    v_accvgpr_read_b32 v77, a29
    v_accvgpr_read_b32 v78, a30
    v_accvgpr_read_b32 v79, a31
    v_cvt_pk_bf16_f32 v80, v76, v77
    v_cvt_pk_bf16_f32 v81, v78, v79
    ds_write_b64 v12, v[80:81] offset:3840
    v_accvgpr_read_b32 v28, a32
    v_accvgpr_read_b32 v29, a33
    v_accvgpr_read_b32 v30, a34
    v_accvgpr_read_b32 v31, a35
    v_cvt_pk_bf16_f32 v32, v28, v29
    v_cvt_pk_bf16_f32 v33, v30, v31
    ds_write_b64 v12, v[32:33] offset:3872
    v_accvgpr_read_b32 v44, a36
    v_accvgpr_read_b32 v45, a37
    v_accvgpr_read_b32 v46, a38
    v_accvgpr_read_b32 v47, a39
    v_cvt_pk_bf16_f32 v48, v44, v45
    v_cvt_pk_bf16_f32 v49, v46, v47
    ds_write_b64 v12, v[48:49] offset:3904
    v_accvgpr_read_b32 v60, a40
    v_accvgpr_read_b32 v61, a41
    v_accvgpr_read_b32 v62, a42
    v_accvgpr_read_b32 v63, a43
    v_cvt_pk_bf16_f32 v64, v60, v61
    v_cvt_pk_bf16_f32 v65, v62, v63
    ds_write_b64 v12, v[64:65] offset:3936
    v_accvgpr_read_b32 v76, a44
    v_accvgpr_read_b32 v77, a45
    v_accvgpr_read_b32 v78, a46
    v_accvgpr_read_b32 v79, a47
    v_cvt_pk_bf16_f32 v80, v76, v77
    v_cvt_pk_bf16_f32 v81, v78, v79
    ds_write_b64 v12, v[80:81] offset:3968
    v_accvgpr_read_b32 v28, a48
    v_accvgpr_read_b32 v29, a49
    v_accvgpr_read_b32 v30, a50
    v_accvgpr_read_b32 v31, a51
    v_cvt_pk_bf16_f32 v32, v28, v29
    v_cvt_pk_bf16_f32 v33, v30, v31
    ds_write_b64 v12, v[32:33] offset:4000
    v_accvgpr_read_b32 v44, a52
    v_accvgpr_read_b32 v45, a53
    v_accvgpr_read_b32 v46, a54
    v_accvgpr_read_b32 v47, a55
    v_cvt_pk_bf16_f32 v48, v44, v45
    v_cvt_pk_bf16_f32 v49, v46, v47
    ds_write_b64 v12, v[48:49] offset:4032
    v_accvgpr_read_b32 v60, a56
    v_accvgpr_read_b32 v61, a57
    v_accvgpr_read_b32 v62, a58
    v_accvgpr_read_b32 v63, a59
    v_cvt_pk_bf16_f32 v64, v60, v61
    v_cvt_pk_bf16_f32 v65, v62, v63
    ds_write_b64 v12, v[64:65] offset:7680
    v_accvgpr_read_b32 v76, a60
    v_accvgpr_read_b32 v77, a61
    v_accvgpr_read_b32 v78, a62
    v_accvgpr_read_b32 v79, a63
    v_cvt_pk_bf16_f32 v80, v76, v77
    v_cvt_pk_bf16_f32 v81, v78, v79
    ds_write_b64 v12, v[80:81] offset:7712
    v_accvgpr_read_b32 v28, a64
    v_accvgpr_read_b32 v29, a65
    v_accvgpr_read_b32 v30, a66
    v_accvgpr_read_b32 v31, a67
    v_cvt_pk_bf16_f32 v32, v28, v29
    v_cvt_pk_bf16_f32 v33, v30, v31
    ds_write_b64 v12, v[32:33] offset:7744
    v_accvgpr_read_b32 v44, a68
    v_accvgpr_read_b32 v45, a69
    v_accvgpr_read_b32 v46, a70
    v_accvgpr_read_b32 v47, a71
    v_cvt_pk_bf16_f32 v48, v44, v45
    v_cvt_pk_bf16_f32 v49, v46, v47
    ds_write_b64 v12, v[48:49] offset:7776
    v_accvgpr_read_b32 v60, a72
    v_accvgpr_read_b32 v61, a73
    v_accvgpr_read_b32 v62, a74
    v_accvgpr_read_b32 v63, a75
    v_cvt_pk_bf16_f32 v64, v60, v61
    v_cvt_pk_bf16_f32 v65, v62, v63
    ds_write_b64 v12, v[64:65] offset:7808
    v_accvgpr_read_b32 v76, a76
    v_accvgpr_read_b32 v77, a77
    v_accvgpr_read_b32 v78, a78
    v_accvgpr_read_b32 v79, a79
    v_cvt_pk_bf16_f32 v80, v76, v77
    v_cvt_pk_bf16_f32 v81, v78, v79
    ds_write_b64 v12, v[80:81] offset:7840
    v_accvgpr_read_b32 v28, a80
    v_accvgpr_read_b32 v29, a81
    v_accvgpr_read_b32 v30, a82
    v_accvgpr_read_b32 v31, a83
    v_cvt_pk_bf16_f32 v32, v28, v29
    v_cvt_pk_bf16_f32 v33, v30, v31
    ds_write_b64 v12, v[32:33] offset:7872
    v_accvgpr_read_b32 v44, a84
    v_accvgpr_read_b32 v45, a85
    v_accvgpr_read_b32 v46, a86
    v_accvgpr_read_b32 v47, a87
    v_cvt_pk_bf16_f32 v48, v44, v45
    v_cvt_pk_bf16_f32 v49, v46, v47
    ds_write_b64 v12, v[48:49] offset:11520
    v_accvgpr_read_b32 v60, a88
    v_accvgpr_read_b32 v61, a89
    v_accvgpr_read_b32 v62, a90
    v_accvgpr_read_b32 v63, a91
    v_cvt_pk_bf16_f32 v64, v60, v61
    v_cvt_pk_bf16_f32 v65, v62, v63
    ds_write_b64 v12, v[64:65] offset:11552
    v_accvgpr_read_b32 v76, a92
    v_accvgpr_read_b32 v77, a93
    v_accvgpr_read_b32 v78, a94
    v_accvgpr_read_b32 v79, a95
    v_cvt_pk_bf16_f32 v80, v76, v77
    v_cvt_pk_bf16_f32 v81, v78, v79
    ds_write_b64 v12, v[80:81] offset:11584
    v_accvgpr_read_b32 v28, a96
    v_accvgpr_read_b32 v29, a97
    v_accvgpr_read_b32 v30, a98
    v_accvgpr_read_b32 v31, a99
    v_cvt_pk_bf16_f32 v32, v28, v29
    v_cvt_pk_bf16_f32 v33, v30, v31
    ds_write_b64 v12, v[32:33] offset:11616
    v_accvgpr_read_b32 v44, a100
    v_accvgpr_read_b32 v45, a101
    v_accvgpr_read_b32 v46, a102
    v_accvgpr_read_b32 v47, a103
    v_cvt_pk_bf16_f32 v48, v44, v45
    v_cvt_pk_bf16_f32 v49, v46, v47
    ds_write_b64 v12, v[48:49] offset:11648
    v_accvgpr_read_b32 v60, a104
    v_accvgpr_read_b32 v61, a105
    v_accvgpr_read_b32 v62, a106
    v_accvgpr_read_b32 v63, a107
    v_cvt_pk_bf16_f32 v64, v60, v61
    v_cvt_pk_bf16_f32 v65, v62, v63
    ds_write_b64 v12, v[64:65] offset:11680
    v_accvgpr_read_b32 v76, a108
    v_accvgpr_read_b32 v77, a109
    v_accvgpr_read_b32 v78, a110
    v_accvgpr_read_b32 v79, a111
    v_cvt_pk_bf16_f32 v80, v76, v77
    v_cvt_pk_bf16_f32 v81, v78, v79
    ds_write_b64 v12, v[80:81] offset:11712
    v_accvgpr_read_b32 v28, a112
    v_accvgpr_read_b32 v29, a113
    v_accvgpr_read_b32 v30, a114
    v_accvgpr_read_b32 v31, a115
    v_cvt_pk_bf16_f32 v32, v28, v29
    v_cvt_pk_bf16_f32 v33, v30, v31
    ds_write_b64 v12, v[32:33] offset:15360
    v_accvgpr_read_b32 v44, a116
    v_accvgpr_read_b32 v45, a117
    v_accvgpr_read_b32 v46, a118
    v_accvgpr_read_b32 v47, a119
    v_cvt_pk_bf16_f32 v48, v44, v45
    v_cvt_pk_bf16_f32 v49, v46, v47
    ds_write_b64 v12, v[48:49] offset:15392
    v_accvgpr_read_b32 v60, a120
    v_accvgpr_read_b32 v61, a121
    v_accvgpr_read_b32 v62, a122
    v_accvgpr_read_b32 v63, a123
    v_cvt_pk_bf16_f32 v64, v60, v61
    v_cvt_pk_bf16_f32 v65, v62, v63
    ds_write_b64 v12, v[64:65] offset:15424
    v_accvgpr_read_b32 v76, a124
    v_accvgpr_read_b32 v77, a125
    v_accvgpr_read_b32 v78, a126
    v_accvgpr_read_b32 v79, a127
    v_cvt_pk_bf16_f32 v80, v76, v77
    v_cvt_pk_bf16_f32 v81, v78, v79
    ds_write_b64 v12, v[80:81] offset:15456
    v_accvgpr_read_b32 v28, a128
    v_accvgpr_read_b32 v29, a129
    v_accvgpr_read_b32 v30, a130
    v_accvgpr_read_b32 v31, a131
    v_cvt_pk_bf16_f32 v32, v28, v29
    v_cvt_pk_bf16_f32 v33, v30, v31
    ds_write_b64 v12, v[32:33] offset:15488
    v_accvgpr_read_b32 v44, a132
    v_accvgpr_read_b32 v45, a133
    v_accvgpr_read_b32 v46, a134
    v_accvgpr_read_b32 v47, a135
    v_cvt_pk_bf16_f32 v48, v44, v45
    v_cvt_pk_bf16_f32 v49, v46, v47
    ds_write_b64 v12, v[48:49] offset:15520
    v_accvgpr_read_b32 v60, a136
    v_accvgpr_read_b32 v61, a137
    v_accvgpr_read_b32 v62, a138
    v_accvgpr_read_b32 v63, a139
    v_cvt_pk_bf16_f32 v64, v60, v61
    v_cvt_pk_bf16_f32 v65, v62, v63
    ds_write_b64 v12, v[64:65] offset:15552
    v_accvgpr_read_b32 v76, a140
    v_accvgpr_read_b32 v77, a141
    v_accvgpr_read_b32 v78, a142
    v_accvgpr_read_b32 v79, a143
    v_cvt_pk_bf16_f32 v80, v76, v77
    v_cvt_pk_bf16_f32 v81, v78, v79
    ds_write_b64 v12, v[80:81] offset:19200
    v_accvgpr_read_b32 v28, a144
    v_accvgpr_read_b32 v29, a145
    v_accvgpr_read_b32 v30, a146
    v_accvgpr_read_b32 v31, a147
    v_cvt_pk_bf16_f32 v32, v28, v29
    v_cvt_pk_bf16_f32 v33, v30, v31
    ds_write_b64 v12, v[32:33] offset:19232
    v_accvgpr_read_b32 v44, a148
    v_accvgpr_read_b32 v45, a149
    v_accvgpr_read_b32 v46, a150
    v_accvgpr_read_b32 v47, a151
    v_cvt_pk_bf16_f32 v48, v44, v45
    v_cvt_pk_bf16_f32 v49, v46, v47
    ds_write_b64 v12, v[48:49] offset:19264
    v_accvgpr_read_b32 v60, a152
    v_accvgpr_read_b32 v61, a153
    v_accvgpr_read_b32 v62, a154
    v_accvgpr_read_b32 v63, a155
    v_cvt_pk_bf16_f32 v64, v60, v61
    v_cvt_pk_bf16_f32 v65, v62, v63
    ds_write_b64 v12, v[64:65] offset:19296
    v_accvgpr_read_b32 v76, a156
    v_accvgpr_read_b32 v77, a157
    v_accvgpr_read_b32 v78, a158
    v_accvgpr_read_b32 v79, a159
    v_cvt_pk_bf16_f32 v80, v76, v77
    v_cvt_pk_bf16_f32 v81, v78, v79
    ds_write_b64 v12, v[80:81] offset:19328
    v_accvgpr_read_b32 v28, a160
    v_accvgpr_read_b32 v29, a161
    v_accvgpr_read_b32 v30, a162
    v_accvgpr_read_b32 v31, a163
    v_cvt_pk_bf16_f32 v32, v28, v29
    v_cvt_pk_bf16_f32 v33, v30, v31
    ds_write_b64 v12, v[32:33] offset:19360
    v_accvgpr_read_b32 v44, a164
    v_accvgpr_read_b32 v45, a165
    v_accvgpr_read_b32 v46, a166
    v_accvgpr_read_b32 v47, a167
    v_cvt_pk_bf16_f32 v48, v44, v45
    v_cvt_pk_bf16_f32 v49, v46, v47
    ds_write_b64 v12, v[48:49] offset:19392
    v_accvgpr_read_b32 v60, a168
    v_accvgpr_read_b32 v61, a169
    v_accvgpr_read_b32 v62, a170
    v_accvgpr_read_b32 v63, a171
    v_cvt_pk_bf16_f32 v64, v60, v61
    v_cvt_pk_bf16_f32 v65, v62, v63
    ds_write_b64 v12, v[64:65] offset:23040
    v_accvgpr_read_b32 v76, a172
    v_accvgpr_read_b32 v77, a173
    v_accvgpr_read_b32 v78, a174
    v_accvgpr_read_b32 v79, a175
    v_cvt_pk_bf16_f32 v80, v76, v77
    v_cvt_pk_bf16_f32 v81, v78, v79
    ds_write_b64 v12, v[80:81] offset:23072
    v_accvgpr_read_b32 v28, a176
    v_accvgpr_read_b32 v29, a177
    v_accvgpr_read_b32 v30, a178
    v_accvgpr_read_b32 v31, a179
    v_cvt_pk_bf16_f32 v32, v28, v29
    v_cvt_pk_bf16_f32 v33, v30, v31
    ds_write_b64 v12, v[32:33] offset:23104
    v_accvgpr_read_b32 v44, a180
    v_accvgpr_read_b32 v45, a181
    v_accvgpr_read_b32 v46, a182
    v_accvgpr_read_b32 v47, a183
    v_cvt_pk_bf16_f32 v48, v44, v45
    v_cvt_pk_bf16_f32 v49, v46, v47
    ds_write_b64 v12, v[48:49] offset:23136
    v_accvgpr_read_b32 v60, a184
    v_accvgpr_read_b32 v61, a185
    v_accvgpr_read_b32 v62, a186
    v_accvgpr_read_b32 v63, a187
    v_cvt_pk_bf16_f32 v64, v60, v61
    v_cvt_pk_bf16_f32 v65, v62, v63
    ds_write_b64 v12, v[64:65] offset:23168
    v_accvgpr_read_b32 v76, a188
    v_accvgpr_read_b32 v77, a189
    v_accvgpr_read_b32 v78, a190
    v_accvgpr_read_b32 v79, a191
    v_cvt_pk_bf16_f32 v80, v76, v77
    v_cvt_pk_bf16_f32 v81, v78, v79
    ds_write_b64 v12, v[80:81] offset:23200
    v_accvgpr_read_b32 v28, a192
    v_accvgpr_read_b32 v29, a193
    v_accvgpr_read_b32 v30, a194
    v_accvgpr_read_b32 v31, a195
    v_cvt_pk_bf16_f32 v32, v28, v29
    v_cvt_pk_bf16_f32 v33, v30, v31
    ds_write_b64 v12, v[32:33] offset:23232
    v_accvgpr_read_b32 v44, a196
    v_accvgpr_read_b32 v45, a197
    v_accvgpr_read_b32 v46, a198
    v_accvgpr_read_b32 v47, a199
    v_cvt_pk_bf16_f32 v48, v44, v45
    v_cvt_pk_bf16_f32 v49, v46, v47
    ds_write_b64 v12, v[48:49] offset:26880
    v_accvgpr_read_b32 v60, a200
    v_accvgpr_read_b32 v61, a201
    v_accvgpr_read_b32 v62, a202
    v_accvgpr_read_b32 v63, a203
    v_cvt_pk_bf16_f32 v64, v60, v61
    v_cvt_pk_bf16_f32 v65, v62, v63
    ds_write_b64 v12, v[64:65] offset:26912
    v_accvgpr_read_b32 v76, a204
    v_accvgpr_read_b32 v77, a205
    v_accvgpr_read_b32 v78, a206
    v_accvgpr_read_b32 v79, a207
    v_cvt_pk_bf16_f32 v80, v76, v77
    v_cvt_pk_bf16_f32 v81, v78, v79
    ds_write_b64 v12, v[80:81] offset:26944
    v_accvgpr_read_b32 v28, a208
    v_accvgpr_read_b32 v29, a209
    v_accvgpr_read_b32 v30, a210
    v_accvgpr_read_b32 v31, a211
    v_cvt_pk_bf16_f32 v32, v28, v29
    v_cvt_pk_bf16_f32 v33, v30, v31
    ds_write_b64 v12, v[32:33] offset:26976
    v_accvgpr_read_b32 v44, a212
    v_accvgpr_read_b32 v45, a213
    v_accvgpr_read_b32 v46, a214
    v_accvgpr_read_b32 v47, a215
    v_cvt_pk_bf16_f32 v48, v44, v45
    v_cvt_pk_bf16_f32 v49, v46, v47
    ds_write_b64 v12, v[48:49] offset:27008
    v_accvgpr_read_b32 v60, a216
    v_accvgpr_read_b32 v61, a217
    v_accvgpr_read_b32 v62, a218
    v_accvgpr_read_b32 v63, a219
    v_cvt_pk_bf16_f32 v64, v60, v61
    v_cvt_pk_bf16_f32 v65, v62, v63
    ds_write_b64 v12, v[64:65] offset:27040
    v_accvgpr_read_b32 v76, a220
    v_accvgpr_read_b32 v77, a221
    v_accvgpr_read_b32 v78, a222
    v_accvgpr_read_b32 v79, a223
    v_cvt_pk_bf16_f32 v80, v76, v77
    v_cvt_pk_bf16_f32 v81, v78, v79
    ds_write_b64 v12, v[80:81] offset:27072
    s_mul_i32 s26, s21, 256
    v_mul_u32_u24 v10, 128, v8
    v_add_u32 v10, s26, v10
    v_mul_u32_u24 v10, 14336, v10
    s_mul_i32 s27, s20, 448
    v_mul_u32_u24 v11, 224, v9
    v_add3_u32 v10, v10, v11, s27
    s_mov_b32 s28, 37748736
    v_mul_u32_u24 v5, 4682, v1
    v_lshrrev_b32 v5, 16, v5
    v_mul_u32_u24 v6, 14, v5
    v_sub_u32 v6, v1, v6
    v_mul_u32_u24 v7, 240, v5
    v_lshl_add_u32 v7, v6, 4, v7
    v_mul_u32_u24 v13, 30720, v2
    v_add_u32 v7, v7, v13
    v_mul_u32_u24 v5, 14336, v5
    v_lshl_add_u32 v5, v6, 4, v5
    v_add_u32 v5, v5, v10
    v_cmp_gt_u32 vcc, 56, v1
    s_waitcnt lgkmcnt(0)
    s_and_saveexec_b64 s[44:45], vcc
    ds_read_b128 v[28:31], v7 offset:0
    ds_read_b128 v[32:35], v7 offset:960
    ds_read_b128 v[36:39], v7 offset:1920
    ds_read_b128 v[40:43], v7 offset:2880
    ds_read_b128 v[44:47], v7 offset:3840
    ds_read_b128 v[48:51], v7 offset:4800
    ds_read_b128 v[52:55], v7 offset:5760
    ds_read_b128 v[56:59], v7 offset:6720
    s_waitcnt lgkmcnt(7)
    s_add_u32 s46, s28, 0
    buffer_store_dwordx4 v[28:31], v5, s[4:7], s46 offen sc0 sc1
    s_waitcnt lgkmcnt(6)
    s_add_u32 s46, s28, 57344
    buffer_store_dwordx4 v[32:35], v5, s[4:7], s46 offen sc0 sc1
    s_waitcnt lgkmcnt(5)
    s_add_u32 s46, s28, 114688
    buffer_store_dwordx4 v[36:39], v5, s[4:7], s46 offen sc0 sc1
    s_waitcnt lgkmcnt(4)
    s_add_u32 s46, s28, 172032
    buffer_store_dwordx4 v[40:43], v5, s[4:7], s46 offen sc0 sc1
    s_waitcnt lgkmcnt(3)
    s_add_u32 s46, s28, 229376
    buffer_store_dwordx4 v[44:47], v5, s[4:7], s46 offen sc0 sc1
    s_waitcnt lgkmcnt(2)
    s_add_u32 s46, s28, 286720
    buffer_store_dwordx4 v[48:51], v5, s[4:7], s46 offen sc0 sc1
    s_waitcnt lgkmcnt(1)
    s_add_u32 s46, s28, 344064
    buffer_store_dwordx4 v[52:55], v5, s[4:7], s46 offen sc0 sc1
    s_waitcnt lgkmcnt(0)
    s_add_u32 s46, s28, 401408
    buffer_store_dwordx4 v[56:59], v5, s[4:7], s46 offen sc0 sc1
    ds_read_b128 v[28:31], v7 offset:7680
    ds_read_b128 v[32:35], v7 offset:8640
    ds_read_b128 v[36:39], v7 offset:9600
    ds_read_b128 v[40:43], v7 offset:10560
    ds_read_b128 v[44:47], v7 offset:11520
    ds_read_b128 v[48:51], v7 offset:12480
    ds_read_b128 v[52:55], v7 offset:13440
    ds_read_b128 v[56:59], v7 offset:14400
    s_waitcnt lgkmcnt(7)
    s_add_u32 s46, s28, 458752
    buffer_store_dwordx4 v[28:31], v5, s[4:7], s46 offen sc0 sc1
    s_waitcnt lgkmcnt(6)
    s_add_u32 s46, s28, 516096
    buffer_store_dwordx4 v[32:35], v5, s[4:7], s46 offen sc0 sc1
    s_waitcnt lgkmcnt(5)
    s_add_u32 s46, s28, 573440
    buffer_store_dwordx4 v[36:39], v5, s[4:7], s46 offen sc0 sc1
    s_waitcnt lgkmcnt(4)
    s_add_u32 s46, s28, 630784
    buffer_store_dwordx4 v[40:43], v5, s[4:7], s46 offen sc0 sc1
    s_waitcnt lgkmcnt(3)
    s_add_u32 s46, s28, 688128
    buffer_store_dwordx4 v[44:47], v5, s[4:7], s46 offen sc0 sc1
    s_waitcnt lgkmcnt(2)
    s_add_u32 s46, s28, 745472
    buffer_store_dwordx4 v[48:51], v5, s[4:7], s46 offen sc0 sc1
    s_waitcnt lgkmcnt(1)
    s_add_u32 s46, s28, 802816
    buffer_store_dwordx4 v[52:55], v5, s[4:7], s46 offen sc0 sc1
    s_waitcnt lgkmcnt(0)
    s_add_u32 s46, s28, 860160
    buffer_store_dwordx4 v[56:59], v5, s[4:7], s46 offen sc0 sc1
    ds_read_b128 v[28:31], v7 offset:15360
    ds_read_b128 v[32:35], v7 offset:16320
    ds_read_b128 v[36:39], v7 offset:17280
    ds_read_b128 v[40:43], v7 offset:18240
    ds_read_b128 v[44:47], v7 offset:19200
    ds_read_b128 v[48:51], v7 offset:20160
    ds_read_b128 v[52:55], v7 offset:21120
    ds_read_b128 v[56:59], v7 offset:22080
    s_waitcnt lgkmcnt(7)
    s_add_u32 s46, s28, 917504
    buffer_store_dwordx4 v[28:31], v5, s[4:7], s46 offen sc0 sc1
    s_waitcnt lgkmcnt(6)
    s_add_u32 s46, s28, 974848
    buffer_store_dwordx4 v[32:35], v5, s[4:7], s46 offen sc0 sc1
    s_waitcnt lgkmcnt(5)
    s_add_u32 s46, s28, 1032192
    buffer_store_dwordx4 v[36:39], v5, s[4:7], s46 offen sc0 sc1
    s_waitcnt lgkmcnt(4)
    s_add_u32 s46, s28, 1089536
    buffer_store_dwordx4 v[40:43], v5, s[4:7], s46 offen sc0 sc1
    s_waitcnt lgkmcnt(3)
    s_add_u32 s46, s28, 1146880
    buffer_store_dwordx4 v[44:47], v5, s[4:7], s46 offen sc0 sc1
    s_waitcnt lgkmcnt(2)
    s_add_u32 s46, s28, 1204224
    buffer_store_dwordx4 v[48:51], v5, s[4:7], s46 offen sc0 sc1
    s_waitcnt lgkmcnt(1)
    s_add_u32 s46, s28, 1261568
    buffer_store_dwordx4 v[52:55], v5, s[4:7], s46 offen sc0 sc1
    s_waitcnt lgkmcnt(0)
    s_add_u32 s46, s28, 1318912
    buffer_store_dwordx4 v[56:59], v5, s[4:7], s46 offen sc0 sc1
    ds_read_b128 v[28:31], v7 offset:23040
    ds_read_b128 v[32:35], v7 offset:24000
    ds_read_b128 v[36:39], v7 offset:24960
    ds_read_b128 v[40:43], v7 offset:25920
    ds_read_b128 v[44:47], v7 offset:26880
    ds_read_b128 v[48:51], v7 offset:27840
    ds_read_b128 v[52:55], v7 offset:28800
    ds_read_b128 v[56:59], v7 offset:29760
    s_waitcnt lgkmcnt(7)
    s_add_u32 s46, s28, 1376256
    buffer_store_dwordx4 v[28:31], v5, s[4:7], s46 offen sc0 sc1
    s_waitcnt lgkmcnt(6)
    s_add_u32 s46, s28, 1433600
    buffer_store_dwordx4 v[32:35], v5, s[4:7], s46 offen sc0 sc1
    s_waitcnt lgkmcnt(5)
    s_add_u32 s46, s28, 1490944
    buffer_store_dwordx4 v[36:39], v5, s[4:7], s46 offen sc0 sc1
    s_waitcnt lgkmcnt(4)
    s_add_u32 s46, s28, 1548288
    buffer_store_dwordx4 v[40:43], v5, s[4:7], s46 offen sc0 sc1
    s_waitcnt lgkmcnt(3)
    s_add_u32 s46, s28, 1605632
    buffer_store_dwordx4 v[44:47], v5, s[4:7], s46 offen sc0 sc1
    s_waitcnt lgkmcnt(2)
    s_add_u32 s46, s28, 1662976
    buffer_store_dwordx4 v[48:51], v5, s[4:7], s46 offen sc0 sc1
    s_waitcnt lgkmcnt(1)
    s_add_u32 s46, s28, 1720320
    buffer_store_dwordx4 v[52:55], v5, s[4:7], s46 offen sc0 sc1
    s_waitcnt lgkmcnt(0)
    s_add_u32 s46, s28, 1777664
    buffer_store_dwordx4 v[56:59], v5, s[4:7], s46 offen sc0 sc1
    s_mov_b64 exec, s[44:45]
    s_lshl_b32 s22, s21, 2
    s_add_u32 s22, s22, 96
    s_waitcnt vmcnt(0) lgkmcnt(0)
    s_barrier
    s_cmp_lg_u32 s14, 0
    s_cbranch_scc1 chain_kernel_sig9
    s_mov_b64 exec, 1
    v_mov_b32 v6, s22
    v_mov_b32 v5, 1
    buffer_atomic_add v5, v6, s[8:11], 0 offen sc1
    s_mov_b64 exec, -1
chain_kernel_sig9:
    s_add_u32 s18, s18, 224
    s_cmp_lt_u32 s18, 256
    s_cbranch_scc1 chain_kernel_wq
    s_mov_b32 s22, 44
    v_mov_b32 v241, s22
chain_kernel_wc10:
    buffer_load_dword v240, v241, s[8:11], 0 offen sc0 sc1
    s_add_u32 s48, s48, 1
    s_cmp_gt_u32 s48, 0x400000
    s_cbranch_scc1 chain_kernel_end
    s_sleep 1
    s_waitcnt vmcnt(0)
    v_cmp_gt_u32 vcc, 96, v240
    s_cbranch_vccnz chain_kernel_wc10
    s_lshr_b32 s17, s19, 5
    s_and_b32 s16, s19, 31
chain_kernel_wteam:
    s_lshl_b32 s15, s17, 2
    s_add_u32 s22, s15, 96
    v_mov_b32 v241, s22
chain_kernel_wc11:
    buffer_load_dword v240, v241, s[8:11], 0 offen sc0 sc1
    s_add_u32 s48, s48, 1
    s_cmp_gt_u32 s48, 0x400000
    s_cbranch_scc1 chain_kernel_end
    s_sleep 1
    s_waitcnt vmcnt(0)
    v_cmp_gt_u32 vcc, 32, v240
    s_cbranch_vccnz chain_kernel_wc11
    s_add_u32 s22, s15, 64
    s_cmp_eq_u32 s17, 0
    s_cselect_b32 s36, 128, 32
    v_mov_b32 v241, s22
chain_kernel_wu12:
    buffer_load_dword v240, v241, s[8:11], 0 offen sc0 sc1
    s_add_u32 s48, s48, 1
    s_cmp_gt_u32 s48, 0x400000
    s_cbranch_scc1 chain_kernel_end
    s_sleep 1
    s_waitcnt vmcnt(0)
    v_cmp_gt_u32 vcc, s36, v240
    s_cbranch_vccnz chain_kernel_wu12
    s_lshl_b32 s20, s17, 3
    s_lshr_b32 s21, s16, 2
    s_add_u32 s20, s20, s21
    s_and_b32 s21, s16, 3
    s_mul_i32 s22, s21, 1792
    v_mul_u32_u24 v5, 112, v2
    v_add3_u32 v5, v5, v3, s22
    v_lshlrev_b32 v6, 6, v5
    v_lshl_add_u32 v6, v4, 4, v6
    v_add_u32 v7, 4096, v6
    s_mul_i32 s23, s20, 458752
    s_add_u32 s23, s23, 67108864
    v_mul_u32_u24 v8, 448, v4
    v_add_u32 v8, v8, v5
    v_lshlrev_b32 v8, 4, v8
    s_mul_i32 s24, s20, 114688
    s_add_u32 s24, s24, 28311552
    s_add_u32 s25, s23, 0
    buffer_load_dwordx4 a[0:3], v6, s[4:7], s25 offen offset:0 sc0 sc1
    buffer_load_dwordx4 a[4:7], v6, s[4:7], s25 offen offset:1024 sc0 sc1
    buffer_load_dwordx4 a[8:11], v6, s[4:7], s25 offen offset:2048 sc0 sc1
    buffer_load_dwordx4 a[12:15], v6, s[4:7], s25 offen offset:3072 sc0 sc1
    buffer_load_dwordx4 a[16:19], v7, s[4:7], s25 offen offset:0 sc0 sc1
    buffer_load_dwordx4 a[20:23], v7, s[4:7], s25 offen offset:1024 sc0 sc1
    buffer_load_dwordx4 a[24:27], v7, s[4:7], s25 offen offset:2048 sc0 sc1
    s_add_u32 s25, s23, 28672
    buffer_load_dwordx4 a[28:31], v6, s[4:7], s25 offen offset:0 sc0 sc1
    buffer_load_dwordx4 a[32:35], v6, s[4:7], s25 offen offset:1024 sc0 sc1
    buffer_load_dwordx4 a[36:39], v6, s[4:7], s25 offen offset:2048 sc0 sc1
    buffer_load_dwordx4 a[40:43], v6, s[4:7], s25 offen offset:3072 sc0 sc1
    buffer_load_dwordx4 a[44:47], v7, s[4:7], s25 offen offset:0 sc0 sc1
    buffer_load_dwordx4 a[48:51], v7, s[4:7], s25 offen offset:1024 sc0 sc1
    buffer_load_dwordx4 a[52:55], v7, s[4:7], s25 offen offset:2048 sc0 sc1
    s_add_u32 s25, s23, 57344
    buffer_load_dwordx4 a[56:59], v6, s[4:7], s25 offen offset:0 sc0 sc1
    buffer_load_dwordx4 a[60:63], v6, s[4:7], s25 offen offset:1024 sc0 sc1
    buffer_load_dwordx4 a[64:67], v6, s[4:7], s25 offen offset:2048 sc0 sc1
    buffer_load_dwordx4 a[68:71], v6, s[4:7], s25 offen offset:3072 sc0 sc1
    buffer_load_dwordx4 a[72:75], v7, s[4:7], s25 offen offset:0 sc0 sc1
    buffer_load_dwordx4 a[76:79], v7, s[4:7], s25 offen offset:1024 sc0 sc1
    buffer_load_dwordx4 a[80:83], v7, s[4:7], s25 offen offset:2048 sc0 sc1
    s_add_u32 s25, s23, 86016
    buffer_load_dwordx4 a[84:87], v6, s[4:7], s25 offen offset:0 sc0 sc1
    buffer_load_dwordx4 a[88:91], v6, s[4:7], s25 offen offset:1024 sc0 sc1
    buffer_load_dwordx4 a[92:95], v6, s[4:7], s25 offen offset:2048 sc0 sc1
    buffer_load_dwordx4 a[96:99], v6, s[4:7], s25 offen offset:3072 sc0 sc1
    buffer_load_dwordx4 a[100:103], v7, s[4:7], s25 offen offset:0 sc0 sc1
    buffer_load_dwordx4 a[104:107], v7, s[4:7], s25 offen offset:1024 sc0 sc1
    buffer_load_dwordx4 a[108:111], v7, s[4:7], s25 offen offset:2048 sc0 sc1
    v_lshrrev_b32 v9, 2, v3
    v_lshlrev_b32 v9, 3, v9
    v_and_b32 v10, 3, v3
    v_add_u32 v9, v9, v10
    v_mul_u32_u24 v9, 896, v9
    v_lshl_add_u32 v9, v4, 4, v9
    s_mul_i32 s26, s20, 28672
    s_add_u32 s26, s26, 0
    s_add_u32 s27, s26, 3584
    v_and_b32 v10, 7, v3
    v_mul_u32_u24 v10, 896, v10
    v_lshl_add_u32 v10, v4, 4, v10
    s_mul_i32 s28, s20, 7168
    s_add_u32 s28, s28, 36175872
    v_mul_u32_u24 v11, 14336, v3
    v_mul_u32_u24 v12, 896, v2
    v_add_u32 v11, v11, v12
    v_lshl_add_u32 v11, v4, 4, v11
    s_mul_i32 s29, s21, 3584
    v_add_u32 v11, s29, v11
    s_mul_i32 s29, s20, 458752
    s_add_u32 s29, s29, 37748736
    s_add_u32 s30, s29, 229376
    buffer_load_dwordx4 v[176:179], v9, s[4:7], s26 offen offset:0 sc0 sc1
    buffer_load_dwordx4 v[180:183], v9, s[4:7], s27 offen offset:0 sc0 sc1
    buffer_load_dwordx4 v[64:67], v11, s[4:7], s29 offen offset:0 sc0 sc1
    buffer_load_dwordx4 v[68:71], v11, s[4:7], s30 offen offset:0 sc0 sc1
    buffer_load_dwordx4 v[184:187], v9, s[4:7], s26 offen offset:64 sc0 sc1
    buffer_load_dwordx4 v[188:191], v9, s[4:7], s27 offen offset:64 sc0 sc1
    buffer_load_dwordx4 v[72:75], v11, s[4:7], s29 offen offset:64 sc0 sc1
    buffer_load_dwordx4 v[76:79], v11, s[4:7], s30 offen offset:64 sc0 sc1
    buffer_load_dwordx4 v[192:195], v9, s[4:7], s26 offen offset:128 sc0 sc1
    buffer_load_dwordx4 v[196:199], v9, s[4:7], s27 offen offset:128 sc0 sc1
    buffer_load_dwordx4 v[80:83], v11, s[4:7], s29 offen offset:128 sc0 sc1
    buffer_load_dwordx4 v[84:87], v11, s[4:7], s30 offen offset:128 sc0 sc1
    buffer_load_dwordx4 v[200:203], v9, s[4:7], s26 offen offset:192 sc0 sc1
    buffer_load_dwordx4 v[204:207], v9, s[4:7], s27 offen offset:192 sc0 sc1
    buffer_load_dwordx4 v[88:91], v11, s[4:7], s29 offen offset:192 sc0 sc1
    buffer_load_dwordx4 v[92:95], v11, s[4:7], s30 offen offset:192 sc0 sc1
    buffer_load_dwordx4 v[208:211], v9, s[4:7], s26 offen offset:256 sc0 sc1
    buffer_load_dwordx4 v[212:215], v9, s[4:7], s27 offen offset:256 sc0 sc1
    buffer_load_dwordx4 v[96:99], v11, s[4:7], s29 offen offset:256 sc0 sc1
    buffer_load_dwordx4 v[100:103], v11, s[4:7], s30 offen offset:256 sc0 sc1
    buffer_load_dwordx4 v[216:219], v9, s[4:7], s26 offen offset:320 sc0 sc1
    buffer_load_dwordx4 v[220:223], v9, s[4:7], s27 offen offset:320 sc0 sc1
    buffer_load_dwordx4 v[104:107], v11, s[4:7], s29 offen offset:320 sc0 sc1
    buffer_load_dwordx4 v[108:111], v11, s[4:7], s30 offen offset:320 sc0 sc1
    buffer_load_dwordx4 v[224:227], v9, s[4:7], s26 offen offset:384 sc0 sc1
    buffer_load_dwordx4 v[228:231], v9, s[4:7], s27 offen offset:384 sc0 sc1
    buffer_load_dwordx4 v[112:115], v11, s[4:7], s29 offen offset:384 sc0 sc1
    buffer_load_dwordx4 v[116:119], v11, s[4:7], s30 offen offset:384 sc0 sc1
    s_waitcnt vmcnt(24)
    v_mfma_f32_16x16x32_bf16 v[16:19], v[176:179], v[64:67], 0
    v_mfma_f32_16x16x32_bf16 v[20:23], v[180:183], v[64:67], 0
    v_mfma_f32_16x16x32_bf16 v[28:31], v[176:179], v[68:71], 0
    v_mfma_f32_16x16x32_bf16 v[32:35], v[180:183], v[68:71], 0
    buffer_load_dwordx4 v[176:179], v9, s[4:7], s26 offen offset:448 sc0 sc1
    buffer_load_dwordx4 v[180:183], v9, s[4:7], s27 offen offset:448 sc0 sc1
    buffer_load_dwordx4 v[120:123], v11, s[4:7], s29 offen offset:448 sc0 sc1
    buffer_load_dwordx4 v[124:127], v11, s[4:7], s30 offen offset:448 sc0 sc1
    s_waitcnt vmcnt(24)
    v_mfma_f32_16x16x32_bf16 v[16:19], v[184:187], v[72:75], v[16:19]
    v_mfma_f32_16x16x32_bf16 v[20:23], v[188:191], v[72:75], v[20:23]
    v_mfma_f32_16x16x32_bf16 v[28:31], v[184:187], v[76:79], v[28:31]
    v_mfma_f32_16x16x32_bf16 v[32:35], v[188:191], v[76:79], v[32:35]
    buffer_load_dwordx4 v[184:187], v9, s[4:7], s26 offen offset:512 sc0 sc1
    buffer_load_dwordx4 v[188:191], v9, s[4:7], s27 offen offset:512 sc0 sc1
    buffer_load_dwordx4 v[128:131], v11, s[4:7], s29 offen offset:512 sc0 sc1
    buffer_load_dwordx4 v[132:135], v11, s[4:7], s30 offen offset:512 sc0 sc1
    s_waitcnt vmcnt(24)
    v_mfma_f32_16x16x32_bf16 v[16:19], v[192:195], v[80:83], v[16:19]
    v_mfma_f32_16x16x32_bf16 v[20:23], v[196:199], v[80:83], v[20:23]
    v_mfma_f32_16x16x32_bf16 v[28:31], v[192:195], v[84:87], v[28:31]
    v_mfma_f32_16x16x32_bf16 v[32:35], v[196:199], v[84:87], v[32:35]
    buffer_load_dwordx4 v[192:195], v9, s[4:7], s26 offen offset:576 sc0 sc1
    buffer_load_dwordx4 v[196:199], v9, s[4:7], s27 offen offset:576 sc0 sc1
    buffer_load_dwordx4 v[136:139], v11, s[4:7], s29 offen offset:576 sc0 sc1
    buffer_load_dwordx4 v[140:143], v11, s[4:7], s30 offen offset:576 sc0 sc1
    s_waitcnt vmcnt(24)
    v_mfma_f32_16x16x32_bf16 v[16:19], v[200:203], v[88:91], v[16:19]
    v_mfma_f32_16x16x32_bf16 v[20:23], v[204:207], v[88:91], v[20:23]
    v_mfma_f32_16x16x32_bf16 v[28:31], v[200:203], v[92:95], v[28:31]
    v_mfma_f32_16x16x32_bf16 v[32:35], v[204:207], v[92:95], v[32:35]
    buffer_load_dwordx4 v[200:203], v9, s[4:7], s26 offen offset:640 sc0 sc1
    buffer_load_dwordx4 v[204:207], v9, s[4:7], s27 offen offset:640 sc0 sc1
    buffer_load_dwordx4 v[144:147], v11, s[4:7], s29 offen offset:640 sc0 sc1
    buffer_load_dwordx4 v[148:151], v11, s[4:7], s30 offen offset:640 sc0 sc1
    s_waitcnt vmcnt(24)
    v_mfma_f32_16x16x32_bf16 v[16:19], v[208:211], v[96:99], v[16:19]
    v_mfma_f32_16x16x32_bf16 v[20:23], v[212:215], v[96:99], v[20:23]
    v_mfma_f32_16x16x32_bf16 v[28:31], v[208:211], v[100:103], v[28:31]
    v_mfma_f32_16x16x32_bf16 v[32:35], v[212:215], v[100:103], v[32:35]
    buffer_load_dwordx4 v[208:211], v9, s[4:7], s26 offen offset:704 sc0 sc1
    buffer_load_dwordx4 v[212:215], v9, s[4:7], s27 offen offset:704 sc0 sc1
    buffer_load_dwordx4 v[152:155], v11, s[4:7], s29 offen offset:704 sc0 sc1
    buffer_load_dwordx4 v[156:159], v11, s[4:7], s30 offen offset:704 sc0 sc1
    s_waitcnt vmcnt(24)
    v_mfma_f32_16x16x32_bf16 v[16:19], v[216:219], v[104:107], v[16:19]
    v_mfma_f32_16x16x32_bf16 v[20:23], v[220:223], v[104:107], v[20:23]
    v_mfma_f32_16x16x32_bf16 v[28:31], v[216:219], v[108:111], v[28:31]
    v_mfma_f32_16x16x32_bf16 v[32:35], v[220:223], v[108:111], v[32:35]
    buffer_load_dwordx4 v[216:219], v9, s[4:7], s26 offen offset:768 sc0 sc1
    buffer_load_dwordx4 v[220:223], v9, s[4:7], s27 offen offset:768 sc0 sc1
    buffer_load_dwordx4 v[160:163], v11, s[4:7], s29 offen offset:768 sc0 sc1
    buffer_load_dwordx4 v[164:167], v11, s[4:7], s30 offen offset:768 sc0 sc1
    s_waitcnt vmcnt(24)
    v_mfma_f32_16x16x32_bf16 v[16:19], v[224:227], v[112:115], v[16:19]
    v_mfma_f32_16x16x32_bf16 v[20:23], v[228:231], v[112:115], v[20:23]
    v_mfma_f32_16x16x32_bf16 v[28:31], v[224:227], v[116:119], v[28:31]
    v_mfma_f32_16x16x32_bf16 v[32:35], v[228:231], v[116:119], v[32:35]
    buffer_load_dwordx4 v[224:227], v9, s[4:7], s26 offen offset:832 sc0 sc1
    buffer_load_dwordx4 v[228:231], v9, s[4:7], s27 offen offset:832 sc0 sc1
    buffer_load_dwordx4 v[168:171], v11, s[4:7], s29 offen offset:832 sc0 sc1
    buffer_load_dwordx4 v[172:175], v11, s[4:7], s30 offen offset:832 sc0 sc1
    s_waitcnt vmcnt(24)
    v_mfma_f32_16x16x32_bf16 v[16:19], v[176:179], v[120:123], v[16:19]
    v_mfma_f32_16x16x32_bf16 v[20:23], v[180:183], v[120:123], v[20:23]
    v_mfma_f32_16x16x32_bf16 v[28:31], v[176:179], v[124:127], v[28:31]
    v_mfma_f32_16x16x32_bf16 v[32:35], v[180:183], v[124:127], v[32:35]
    s_waitcnt vmcnt(20)
    v_mfma_f32_16x16x32_bf16 v[16:19], v[184:187], v[128:131], v[16:19]
    v_mfma_f32_16x16x32_bf16 v[20:23], v[188:191], v[128:131], v[20:23]
    v_mfma_f32_16x16x32_bf16 v[28:31], v[184:187], v[132:135], v[28:31]
    v_mfma_f32_16x16x32_bf16 v[32:35], v[188:191], v[132:135], v[32:35]
    s_waitcnt vmcnt(16)
    v_mfma_f32_16x16x32_bf16 v[16:19], v[192:195], v[136:139], v[16:19]
    v_mfma_f32_16x16x32_bf16 v[20:23], v[196:199], v[136:139], v[20:23]
    v_mfma_f32_16x16x32_bf16 v[28:31], v[192:195], v[140:143], v[28:31]
    v_mfma_f32_16x16x32_bf16 v[32:35], v[196:199], v[140:143], v[32:35]
    s_waitcnt vmcnt(12)
    v_mfma_f32_16x16x32_bf16 v[16:19], v[200:203], v[144:147], v[16:19]
    v_mfma_f32_16x16x32_bf16 v[20:23], v[204:207], v[144:147], v[20:23]
    v_mfma_f32_16x16x32_bf16 v[28:31], v[200:203], v[148:151], v[28:31]
    v_mfma_f32_16x16x32_bf16 v[32:35], v[204:207], v[148:151], v[32:35]
    s_waitcnt vmcnt(8)
    v_mfma_f32_16x16x32_bf16 v[16:19], v[208:211], v[152:155], v[16:19]
    v_mfma_f32_16x16x32_bf16 v[20:23], v[212:215], v[152:155], v[20:23]
    v_mfma_f32_16x16x32_bf16 v[28:31], v[208:211], v[156:159], v[28:31]
    v_mfma_f32_16x16x32_bf16 v[32:35], v[212:215], v[156:159], v[32:35]
    s_waitcnt vmcnt(4)
    v_mfma_f32_16x16x32_bf16 v[16:19], v[216:219], v[160:163], v[16:19]
    v_mfma_f32_16x16x32_bf16 v[20:23], v[220:223], v[160:163], v[20:23]
    v_mfma_f32_16x16x32_bf16 v[28:31], v[216:219], v[164:167], v[28:31]
    v_mfma_f32_16x16x32_bf16 v[32:35], v[220:223], v[164:167], v[32:35]
    s_waitcnt vmcnt(0)
    v_mfma_f32_16x16x32_bf16 v[16:19], v[224:227], v[168:171], v[16:19]
    v_mfma_f32_16x16x32_bf16 v[20:23], v[228:231], v[168:171], v[20:23]
    v_mfma_f32_16x16x32_bf16 v[28:31], v[224:227], v[172:175], v[28:31]
    v_mfma_f32_16x16x32_bf16 v[32:35], v[228:231], v[172:175], v[32:35]
    s_add_u32 s35, s15, 128
    v_mov_b32 v241, s35
chain_kernel_wc13:
    buffer_load_dword v240, v241, s[8:11], 0 offen sc0 sc1
    s_add_u32 s48, s48, 1
    s_cmp_gt_u32 s48, 0x400000
    s_cbranch_scc1 chain_kernel_end
    s_sleep 1
    s_waitcnt vmcnt(0)
    v_cmp_gt_u32 vcc, 16, v240
    s_cbranch_vccnz chain_kernel_wc13
    buffer_load_dwordx4 v[176:179], v10, s[4:7], s28 offen offset:0 sc0 sc1
    buffer_load_dwordx4 v[180:183], v10, s[4:7], s28 offen offset:64 sc0 sc1
    buffer_load_dwordx4 v[184:187], v10, s[4:7], s28 offen offset:128 sc0 sc1
    buffer_load_dwordx4 v[188:191], v10, s[4:7], s28 offen offset:192 sc0 sc1
    buffer_load_dwordx4 v[192:195], v10, s[4:7], s28 offen offset:256 sc0 sc1
    buffer_load_dwordx4 v[196:199], v10, s[4:7], s28 offen offset:320 sc0 sc1
    buffer_load_dwordx4 v[200:203], v10, s[4:7], s28 offen offset:384 sc0 sc1
    buffer_load_dwordx4 v[204:207], v10, s[4:7], s28 offen offset:448 sc0 sc1
    buffer_load_dwordx4 v[208:211], v10, s[4:7], s28 offen offset:512 sc0 sc1
    buffer_load_dwordx4 v[212:215], v10, s[4:7], s28 offen offset:576 sc0 sc1
    buffer_load_dwordx4 v[216:219], v10, s[4:7], s28 offen offset:640 sc0 sc1
    buffer_load_dwordx4 v[220:223], v10, s[4:7], s28 offen offset:704 sc0 sc1
    buffer_load_dwordx4 v[224:227], v10, s[4:7], s28 offen offset:768 sc0 sc1
    buffer_load_dwordx4 v[228:231], v10, s[4:7], s28 offen offset:832 sc0 sc1
    buffer_load_dwordx4 a[112:115], v8, s[4:7], s24 offen offset:0 sc0 sc1
    buffer_load_dwordx4 a[116:119], v8, s[4:7], s24 offen offset:256 sc0 sc1
    buffer_load_dwordx4 a[120:123], v8, s[4:7], s24 offen offset:512 sc0 sc1
    buffer_load_dwordx4 a[124:127], v8, s[4:7], s24 offen offset:768 sc0 sc1
    buffer_load_dwordx4 a[128:131], v8, s[4:7], s24 offen offset:1024 sc0 sc1
    buffer_load_dwordx4 a[132:135], v8, s[4:7], s24 offen offset:1280 sc0 sc1
    buffer_load_dwordx4 a[136:139], v8, s[4:7], s24 offen offset:1536 sc0 sc1
    s_waitcnt vmcnt(20)
    v_mfma_f32_16x16x32_bf16 v[24:27], v[176:179], v[64:67], 0
    v_mfma_f32_16x16x32_bf16 v[36:39], v[176:179], v[68:71], 0
    s_waitcnt vmcnt(19)
    v_mfma_f32_16x16x32_bf16 v[24:27], v[180:183], v[72:75], v[24:27]
    v_mfma_f32_16x16x32_bf16 v[36:39], v[180:183], v[76:79], v[36:39]
    s_waitcnt vmcnt(18)
    v_mfma_f32_16x16x32_bf16 v[24:27], v[184:187], v[80:83], v[24:27]
    v_mfma_f32_16x16x32_bf16 v[36:39], v[184:187], v[84:87], v[36:39]
    s_waitcnt vmcnt(17)
    v_mfma_f32_16x16x32_bf16 v[24:27], v[188:191], v[88:91], v[24:27]
    v_mfma_f32_16x16x32_bf16 v[36:39], v[188:191], v[92:95], v[36:39]
    s_waitcnt vmcnt(16)
    v_mfma_f32_16x16x32_bf16 v[24:27], v[192:195], v[96:99], v[24:27]
    v_mfma_f32_16x16x32_bf16 v[36:39], v[192:195], v[100:103], v[36:39]
    s_waitcnt vmcnt(15)
    v_mfma_f32_16x16x32_bf16 v[24:27], v[196:199], v[104:107], v[24:27]
    v_mfma_f32_16x16x32_bf16 v[36:39], v[196:199], v[108:111], v[36:39]
    s_waitcnt vmcnt(14)
    v_mfma_f32_16x16x32_bf16 v[24:27], v[200:203], v[112:115], v[24:27]
    v_mfma_f32_16x16x32_bf16 v[36:39], v[200:203], v[116:119], v[36:39]
    s_waitcnt vmcnt(13)
    v_mfma_f32_16x16x32_bf16 v[24:27], v[204:207], v[120:123], v[24:27]
    v_mfma_f32_16x16x32_bf16 v[36:39], v[204:207], v[124:127], v[36:39]
    s_waitcnt vmcnt(12)
    v_mfma_f32_16x16x32_bf16 v[24:27], v[208:211], v[128:131], v[24:27]
    v_mfma_f32_16x16x32_bf16 v[36:39], v[208:211], v[132:135], v[36:39]
    s_waitcnt vmcnt(11)
    v_mfma_f32_16x16x32_bf16 v[24:27], v[212:215], v[136:139], v[24:27]
    v_mfma_f32_16x16x32_bf16 v[36:39], v[212:215], v[140:143], v[36:39]
    s_waitcnt vmcnt(10)
    v_mfma_f32_16x16x32_bf16 v[24:27], v[216:219], v[144:147], v[24:27]
    v_mfma_f32_16x16x32_bf16 v[36:39], v[216:219], v[148:151], v[36:39]
    s_waitcnt vmcnt(9)
    v_mfma_f32_16x16x32_bf16 v[24:27], v[220:223], v[152:155], v[24:27]
    v_mfma_f32_16x16x32_bf16 v[36:39], v[220:223], v[156:159], v[36:39]
    s_waitcnt vmcnt(8)
    v_mfma_f32_16x16x32_bf16 v[24:27], v[224:227], v[160:163], v[24:27]
    v_mfma_f32_16x16x32_bf16 v[36:39], v[224:227], v[164:167], v[36:39]
    s_waitcnt vmcnt(7)
    v_mfma_f32_16x16x32_bf16 v[24:27], v[228:231], v[168:171], v[24:27]
    v_mfma_f32_16x16x32_bf16 v[36:39], v[228:231], v[172:175], v[36:39]
    s_nop 7
    v_lshlrev_b32 v12, 3, v4
    v_cmp_gt_u32 s[40:41], 2, v4
    v_lshlrev_b32 v13, 4, v1
    v_lshl_add_u32 v13, v2, 11, v13
    v_lshl_add_u32 v14, v3, 2, v2
    v_lshlrev_b32 v14, 4, v14
    v_lshl_add_u32 v14, v4, 3, v14
    v_add_u32 v14, 8192, v14
    v_mov_b32 v15, 0xf149f2ca
    v_add_u32 v40, 0, v3
    v_sub_u32 v40, v40, v12
    v_cmp_le_i32 vcc, 0, v40
    s_nop 1
    v_cndmask_b32 v16, v15, v16, vcc
    v_cmp_le_i32 vcc, 1, v40
    s_nop 1
    v_cndmask_b32 v17, v15, v17, vcc
    v_cmp_le_i32 vcc, 2, v40
    s_nop 1
    v_cndmask_b32 v18, v15, v18, vcc
    v_cmp_le_i32 vcc, 3, v40
    s_nop 1
    v_cndmask_b32 v19, v15, v19, vcc
    v_cmp_le_i32 vcc, 4, v40
    s_nop 1
    v_cndmask_b32 v20, v15, v20, vcc
    v_cmp_le_i32 vcc, 5, v40
    s_nop 1
    v_cndmask_b32 v21, v15, v21, vcc
    v_cmp_le_i32 vcc, 6, v40
    s_nop 1
    v_cndmask_b32 v22, v15, v22, vcc
    v_cmp_le_i32 vcc, 7, v40
    s_nop 1
    v_cndmask_b32 v23, v15, v23, vcc
    v_cndmask_b32 v24, v15, v24, s[40:41]
    v_cndmask_b32 v25, v15, v25, s[40:41]
    v_cndmask_b32 v26, v15, v26, s[40:41]
    v_cndmask_b32 v27, v15, v27, s[40:41]
    v_max3_f32 v41, v16, v17, v18
    v_max3_f32 v42, v19, v20, v21
    v_max3_f32 v41, v41, v22, v23
    v_max3_f32 v42, v42, v24, v25
    v_max3_f32 v41, v41, v26, v27
    v_max_f32 v41, v41, v42
    v_mov_b32 v42, v41
    s_nop 1
    v_permlane16_swap_b32 v42, v41
    s_nop 1
    v_max_f32 v41, v41, v42
    v_mov_b32 v42, v41
    s_nop 1
    v_permlane32_swap_b32 v42, v41
    s_nop 1
    v_max_f32 v41, v41, v42
    v_mul_f32 v41, 0xbfb8aa3b, v41
    v_fmamk_f32 v16, v16, 0x3fb8aa3b, v41
    v_fmamk_f32 v17, v17, 0x3fb8aa3b, v41
    v_fmamk_f32 v18, v18, 0x3fb8aa3b, v41
    v_fmamk_f32 v19, v19, 0x3fb8aa3b, v41
    v_fmamk_f32 v20, v20, 0x3fb8aa3b, v41
    v_fmamk_f32 v21, v21, 0x3fb8aa3b, v41
    v_fmamk_f32 v22, v22, 0x3fb8aa3b, v41
    v_fmamk_f32 v23, v23, 0x3fb8aa3b, v41
    v_fmamk_f32 v24, v24, 0x3fb8aa3b, v41
    v_fmamk_f32 v25, v25, 0x3fb8aa3b, v41
    v_fmamk_f32 v26, v26, 0x3fb8aa3b, v41
    v_fmamk_f32 v27, v27, 0x3fb8aa3b, v41
    v_exp_f32 v16, v16
    v_exp_f32 v17, v17
    v_exp_f32 v18, v18
    v_exp_f32 v19, v19
    v_exp_f32 v20, v20
    v_exp_f32 v21, v21
    v_exp_f32 v22, v22
    v_exp_f32 v23, v23
    v_exp_f32 v24, v24
    v_exp_f32 v25, v25
    v_exp_f32 v26, v26
    v_exp_f32 v27, v27
    s_nop 0
    v_add_f32 v41, v16, v17
    v_add_f32 v41, v41, v18
    v_add_f32 v41, v41, v19
    v_add_f32 v41, v41, v20
    v_add_f32 v41, v41, v21
    v_add_f32 v41, v41, v22
    v_add_f32 v41, v41, v23
    v_add_f32 v41, v41, v24
    v_add_f32 v41, v41, v25
    v_add_f32 v41, v41, v26
    v_add_f32 v41, v41, v27
    v_mov_b32 v42, v41
    s_nop 1
    v_permlane16_swap_b32 v42, v41
    s_nop 1
    v_add_f32 v41, v41, v42
    v_mov_b32 v42, v41
    s_nop 1
    v_permlane32_swap_b32 v42, v41
    s_nop 1
    v_add_f32 v41, v41, v42
    v_rcp_f32 v41, v41
    s_nop 0
    v_mul_f32 v16, v16, v41
    v_mul_f32 v17, v17, v41
    v_mul_f32 v18, v18, v41
    v_mul_f32 v19, v19, v41
    v_mul_f32 v20, v20, v41
    v_mul_f32 v21, v21, v41
    v_mul_f32 v22, v22, v41
    v_mul_f32 v23, v23, v41
    v_mul_f32 v24, v24, v41
    v_mul_f32 v25, v25, v41
    v_mul_f32 v26, v26, v41
    v_mul_f32 v27, v27, v41
    v_cvt_pk_bf16_f32 v44, v16, v17
    v_cvt_pk_bf16_f32 v45, v18, v19
    v_cvt_pk_bf16_f32 v46, v20, v21
    v_cvt_pk_bf16_f32 v47, v22, v23
    v_cvt_pk_bf16_f32 v48, v24, v25
    v_cvt_pk_bf16_f32 v49, v26, v27
    ds_write_b128 v13, v[44:47] offset:0
    s_mov_b64 exec, s[40:41]
    ds_write_b64 v14, v[48:49] offset:0
    s_mov_b64 exec, -1
    v_add_u32 v40, 16, v3
    v_sub_u32 v40, v40, v12
    v_cmp_le_i32 vcc, 0, v40
    s_nop 1
    v_cndmask_b32 v28, v15, v28, vcc
    v_cmp_le_i32 vcc, 1, v40
    s_nop 1
    v_cndmask_b32 v29, v15, v29, vcc
    v_cmp_le_i32 vcc, 2, v40
    s_nop 1
    v_cndmask_b32 v30, v15, v30, vcc
    v_cmp_le_i32 vcc, 3, v40
    s_nop 1
    v_cndmask_b32 v31, v15, v31, vcc
    v_cmp_le_i32 vcc, 4, v40
    s_nop 1
    v_cndmask_b32 v32, v15, v32, vcc
    v_cmp_le_i32 vcc, 5, v40
    s_nop 1
    v_cndmask_b32 v33, v15, v33, vcc
    v_cmp_le_i32 vcc, 6, v40
    s_nop 1
    v_cndmask_b32 v34, v15, v34, vcc
    v_cmp_le_i32 vcc, 7, v40
    s_nop 1
    v_cndmask_b32 v35, v15, v35, vcc
    v_cndmask_b32 v36, v15, v36, s[40:41]
    v_cndmask_b32 v37, v15, v37, s[40:41]
    v_cndmask_b32 v38, v15, v38, s[40:41]
    v_cndmask_b32 v39, v15, v39, s[40:41]
    v_max3_f32 v41, v28, v29, v30
    v_max3_f32 v42, v31, v32, v33
    v_max3_f32 v41, v41, v34, v35
    v_max3_f32 v42, v42, v36, v37
    v_max3_f32 v41, v41, v38, v39
    v_max_f32 v41, v41, v42
    v_mov_b32 v42, v41
    s_nop 1
    v_permlane16_swap_b32 v42, v41
    s_nop 1
    v_max_f32 v41, v41, v42
    v_mov_b32 v42, v41
    s_nop 1
    v_permlane32_swap_b32 v42, v41
    s_nop 1
    v_max_f32 v41, v41, v42
    v_mul_f32 v41, 0xbfb8aa3b, v41
    v_fmamk_f32 v28, v28, 0x3fb8aa3b, v41
    v_fmamk_f32 v29, v29, 0x3fb8aa3b, v41
    v_fmamk_f32 v30, v30, 0x3fb8aa3b, v41
    v_fmamk_f32 v31, v31, 0x3fb8aa3b, v41
    v_fmamk_f32 v32, v32, 0x3fb8aa3b, v41
    v_fmamk_f32 v33, v33, 0x3fb8aa3b, v41
    v_fmamk_f32 v34, v34, 0x3fb8aa3b, v41
    v_fmamk_f32 v35, v35, 0x3fb8aa3b, v41
    v_fmamk_f32 v36, v36, 0x3fb8aa3b, v41
    v_fmamk_f32 v37, v37, 0x3fb8aa3b, v41
    v_fmamk_f32 v38, v38, 0x3fb8aa3b, v41
    v_fmamk_f32 v39, v39, 0x3fb8aa3b, v41
    v_exp_f32 v28, v28
    v_exp_f32 v29, v29
    v_exp_f32 v30, v30
    v_exp_f32 v31, v31
    v_exp_f32 v32, v32
    v_exp_f32 v33, v33
    v_exp_f32 v34, v34
    v_exp_f32 v35, v35
    v_exp_f32 v36, v36
    v_exp_f32 v37, v37
    v_exp_f32 v38, v38
    v_exp_f32 v39, v39
    s_nop 0
    v_add_f32 v41, v28, v29
    v_add_f32 v41, v41, v30
    v_add_f32 v41, v41, v31
    v_add_f32 v41, v41, v32
    v_add_f32 v41, v41, v33
    v_add_f32 v41, v41, v34
    v_add_f32 v41, v41, v35
    v_add_f32 v41, v41, v36
    v_add_f32 v41, v41, v37
    v_add_f32 v41, v41, v38
    v_add_f32 v41, v41, v39
    v_mov_b32 v42, v41
    s_nop 1
    v_permlane16_swap_b32 v42, v41
    s_nop 1
    v_add_f32 v41, v41, v42
    v_mov_b32 v42, v41
    s_nop 1
    v_permlane32_swap_b32 v42, v41
    s_nop 1
    v_add_f32 v41, v41, v42
    v_rcp_f32 v41, v41
    s_nop 0
    v_mul_f32 v28, v28, v41
    v_mul_f32 v29, v29, v41
    v_mul_f32 v30, v30, v41
    v_mul_f32 v31, v31, v41
    v_mul_f32 v32, v32, v41
    v_mul_f32 v33, v33, v41
    v_mul_f32 v34, v34, v41
    v_mul_f32 v35, v35, v41
    v_mul_f32 v36, v36, v41
    v_mul_f32 v37, v37, v41
    v_mul_f32 v38, v38, v41
    v_mul_f32 v39, v39, v41
    v_cvt_pk_bf16_f32 v44, v28, v29
    v_cvt_pk_bf16_f32 v45, v30, v31
    v_cvt_pk_bf16_f32 v46, v32, v33
    v_cvt_pk_bf16_f32 v47, v34, v35
    v_cvt_pk_bf16_f32 v48, v36, v37
    v_cvt_pk_bf16_f32 v49, v38, v39
    ds_write_b128 v13, v[44:47] offset:1024
    s_mov_b64 exec, s[40:41]
    ds_write_b64 v14, v[48:49] offset:1024
    s_mov_b64 exec, -1
    s_waitcnt lgkmcnt(0)
    s_barrier
    v_lshlrev_b32 v13, 4, v1
    v_lshl_add_u32 v14, v3, 2, v4
    v_lshlrev_b32 v14, 4, v14
    v_add_u32 v14, 8192, v14
    ds_read_b128 v[64:67], v13 offset:0
    ds_read_b128 v[68:71], v13 offset:1024
    ds_read_b128 v[72:75], v13 offset:2048
    ds_read_b128 v[76:79], v13 offset:3072
    ds_read_b128 v[80:83], v13 offset:4096
    ds_read_b128 v[84:87], v13 offset:5120
    ds_read_b128 v[88:91], v13 offset:6144
    ds_read_b128 v[92:95], v13 offset:7168
    ds_read_b128 v[96:99], v14 offset:0
    ds_read_b128 v[100:103], v14 offset:1024
    s_waitcnt lgkmcnt(0) vmcnt(0)
    v_mfma_f32_16x16x32_bf16 v[104:107], a[112:115], v[96:99], 0
    v_mfma_f32_16x16x32_bf16 v[108:111], a[112:115], v[100:103], 0
    v_mfma_f32_16x16x32_bf16 v[112:115], a[116:119], v[96:99], 0
    v_mfma_f32_16x16x32_bf16 v[116:119], a[116:119], v[100:103], 0
    v_mfma_f32_16x16x32_bf16 v[120:123], a[120:123], v[96:99], 0
    v_mfma_f32_16x16x32_bf16 v[124:127], a[120:123], v[100:103], 0
    v_mfma_f32_16x16x32_bf16 v[128:131], a[124:127], v[96:99], 0
    v_mfma_f32_16x16x32_bf16 v[132:135], a[124:127], v[100:103], 0
    v_mfma_f32_16x16x32_bf16 v[136:139], a[128:131], v[96:99], 0
    v_mfma_f32_16x16x32_bf16 v[140:143], a[128:131], v[100:103], 0
    v_mfma_f32_16x16x32_bf16 v[144:147], a[132:135], v[96:99], 0
    v_mfma_f32_16x16x32_bf16 v[148:151], a[132:135], v[100:103], 0
    v_mfma_f32_16x16x32_bf16 v[152:155], a[136:139], v[96:99], 0
    v_mfma_f32_16x16x32_bf16 v[156:159], a[136:139], v[100:103], 0
    v_mfma_f32_16x16x32_bf16 v[104:107], a[0:3], v[64:67], v[104:107]
    v_mfma_f32_16x16x32_bf16 v[108:111], a[0:3], v[68:71], v[108:111]
    v_mfma_f32_16x16x32_bf16 v[112:115], a[4:7], v[64:67], v[112:115]
    v_mfma_f32_16x16x32_bf16 v[116:119], a[4:7], v[68:71], v[116:119]
    v_mfma_f32_16x16x32_bf16 v[120:123], a[8:11], v[64:67], v[120:123]
    v_mfma_f32_16x16x32_bf16 v[124:127], a[8:11], v[68:71], v[124:127]
    v_mfma_f32_16x16x32_bf16 v[128:131], a[12:15], v[64:67], v[128:131]
    v_mfma_f32_16x16x32_bf16 v[132:135], a[12:15], v[68:71], v[132:135]
    v_mfma_f32_16x16x32_bf16 v[136:139], a[16:19], v[64:67], v[136:139]
    v_mfma_f32_16x16x32_bf16 v[140:143], a[16:19], v[68:71], v[140:143]
    v_mfma_f32_16x16x32_bf16 v[144:147], a[20:23], v[64:67], v[144:147]
    v_mfma_f32_16x16x32_bf16 v[148:151], a[20:23], v[68:71], v[148:151]
    v_mfma_f32_16x16x32_bf16 v[152:155], a[24:27], v[64:67], v[152:155]
    v_mfma_f32_16x16x32_bf16 v[156:159], a[24:27], v[68:71], v[156:159]
    v_mfma_f32_16x16x32_bf16 v[104:107], a[28:31], v[72:75], v[104:107]
    v_mfma_f32_16x16x32_bf16 v[108:111], a[28:31], v[76:79], v[108:111]
    v_mfma_f32_16x16x32_bf16 v[112:115], a[32:35], v[72:75], v[112:115]
    v_mfma_f32_16x16x32_bf16 v[116:119], a[32:35], v[76:79], v[116:119]
    v_mfma_f32_16x16x32_bf16 v[120:123], a[36:39], v[72:75], v[120:123]
    v_mfma_f32_16x16x32_bf16 v[124:127], a[36:39], v[76:79], v[124:127]
    v_mfma_f32_16x16x32_bf16 v[128:131], a[40:43], v[72:75], v[128:131]
    v_mfma_f32_16x16x32_bf16 v[132:135], a[40:43], v[76:79], v[132:135]
    v_mfma_f32_16x16x32_bf16 v[136:139], a[44:47], v[72:75], v[136:139]
    v_mfma_f32_16x16x32_bf16 v[140:143], a[44:47], v[76:79], v[140:143]
    v_mfma_f32_16x16x32_bf16 v[144:147], a[48:51], v[72:75], v[144:147]
    v_mfma_f32_16x16x32_bf16 v[148:151], a[48:51], v[76:79], v[148:151]
    v_mfma_f32_16x16x32_bf16 v[152:155], a[52:55], v[72:75], v[152:155]
    v_mfma_f32_16x16x32_bf16 v[156:159], a[52:55], v[76:79], v[156:159]
    v_mfma_f32_16x16x32_bf16 v[104:107], a[56:59], v[80:83], v[104:107]
    v_mfma_f32_16x16x32_bf16 v[108:111], a[56:59], v[84:87], v[108:111]
    v_mfma_f32_16x16x32_bf16 v[112:115], a[60:63], v[80:83], v[112:115]
    v_mfma_f32_16x16x32_bf16 v[116:119], a[60:63], v[84:87], v[116:119]
    v_mfma_f32_16x16x32_bf16 v[120:123], a[64:67], v[80:83], v[120:123]
    v_mfma_f32_16x16x32_bf16 v[124:127], a[64:67], v[84:87], v[124:127]
    v_mfma_f32_16x16x32_bf16 v[128:131], a[68:71], v[80:83], v[128:131]
    v_mfma_f32_16x16x32_bf16 v[132:135], a[68:71], v[84:87], v[132:135]
    v_mfma_f32_16x16x32_bf16 v[136:139], a[72:75], v[80:83], v[136:139]
    v_mfma_f32_16x16x32_bf16 v[140:143], a[72:75], v[84:87], v[140:143]
    v_mfma_f32_16x16x32_bf16 v[144:147], a[76:79], v[80:83], v[144:147]
    v_mfma_f32_16x16x32_bf16 v[148:151], a[76:79], v[84:87], v[148:151]
    v_mfma_f32_16x16x32_bf16 v[152:155], a[80:83], v[80:83], v[152:155]
    v_mfma_f32_16x16x32_bf16 v[156:159], a[80:83], v[84:87], v[156:159]
    v_mfma_f32_16x16x32_bf16 v[104:107], a[84:87], v[88:91], v[104:107]
    v_mfma_f32_16x16x32_bf16 v[108:111], a[84:87], v[92:95], v[108:111]
    v_mfma_f32_16x16x32_bf16 v[112:115], a[88:91], v[88:91], v[112:115]
    v_mfma_f32_16x16x32_bf16 v[116:119], a[88:91], v[92:95], v[116:119]
    v_mfma_f32_16x16x32_bf16 v[120:123], a[92:95], v[88:91], v[120:123]
    v_mfma_f32_16x16x32_bf16 v[124:127], a[92:95], v[92:95], v[124:127]
    v_mfma_f32_16x16x32_bf16 v[128:131], a[96:99], v[88:91], v[128:131]
    v_mfma_f32_16x16x32_bf16 v[132:135], a[96:99], v[92:95], v[132:135]
    v_mfma_f32_16x16x32_bf16 v[136:139], a[100:103], v[88:91], v[136:139]
    v_mfma_f32_16x16x32_bf16 v[140:143], a[100:103], v[92:95], v[140:143]
    v_mfma_f32_16x16x32_bf16 v[144:147], a[104:107], v[88:91], v[144:147]
    v_mfma_f32_16x16x32_bf16 v[148:151], a[104:107], v[92:95], v[148:151]
    v_mfma_f32_16x16x32_bf16 v[152:155], a[108:111], v[88:91], v[152:155]
    v_mfma_f32_16x16x32_bf16 v[156:159], a[108:111], v[92:95], v[156:159]
    s_lshl_b32 s31, s21, 11
    s_lshl_b32 s32, s20, 5
    s_add_u32 s31, s31, s32
    v_add_u32 v5, s31, v3
    v_mul_u32_u24 v5, 1792, v5
    v_mul_u32_u24 v6, 448, v2
    v_add_u32 v5, v5, v6
    v_lshl_add_u32 v5, v4, 4, v5
    s_mov_b32 s33, 100663296
    s_mov_b32 s34, 100691968
    s_nop 4
    buffer_store_dwordx4 v[104:107], v5, s[4:7], s33 offen offset:0 sc0 sc1
    buffer_store_dwordx4 v[108:111], v5, s[4:7], s34 offen offset:0 sc0 sc1
    buffer_store_dwordx4 v[112:115], v5, s[4:7], s33 offen offset:64 sc0 sc1
    buffer_store_dwordx4 v[116:119], v5, s[4:7], s34 offen offset:64 sc0 sc1
    buffer_store_dwordx4 v[120:123], v5, s[4:7], s33 offen offset:128 sc0 sc1
    buffer_store_dwordx4 v[124:127], v5, s[4:7], s34 offen offset:128 sc0 sc1
    buffer_store_dwordx4 v[128:131], v5, s[4:7], s33 offen offset:192 sc0 sc1
    buffer_store_dwordx4 v[132:135], v5, s[4:7], s34 offen offset:192 sc0 sc1
    buffer_store_dwordx4 v[136:139], v5, s[4:7], s33 offen offset:256 sc0 sc1
    buffer_store_dwordx4 v[140:143], v5, s[4:7], s34 offen offset:256 sc0 sc1
    buffer_store_dwordx4 v[144:147], v5, s[4:7], s33 offen offset:320 sc0 sc1
    buffer_store_dwordx4 v[148:151], v5, s[4:7], s34 offen offset:320 sc0 sc1
    buffer_store_dwordx4 v[152:155], v5, s[4:7], s33 offen offset:384 sc0 sc1
    buffer_store_dwordx4 v[156:159], v5, s[4:7], s34 offen offset:384 sc0 sc1
    s_add_u32 s22, s15, 160
    s_waitcnt vmcnt(0) lgkmcnt(0)
    s_barrier
    s_cmp_lg_u32 s14, 0
    s_cbranch_scc1 chain_kernel_sig14
    s_mov_b64 exec, 1
    v_mov_b32 v6, s22
    v_mov_b32 v5, 1
    buffer_atomic_add v5, v6, s[8:11], 0 offen sc1
    s_mov_b64 exec, -1
chain_kernel_sig14:
    v_mov_b32 v241, s22
chain_kernel_wc15:
    buffer_load_dword v240, v241, s[8:11], 0 offen sc0 sc1
    s_add_u32 s48, s48, 1
    s_cmp_gt_u32 s48, 0x400000
    s_cbranch_scc1 chain_kernel_end
    s_sleep 1
    s_waitcnt vmcnt(0)
    v_cmp_gt_u32 vcc, 32, v240
    s_cbranch_vccnz chain_kernel_wc15
    s_lshl_b32 s3, s17, 8
    s_lshl_b32 s23, s16, 3
    s_add_u32 s3, s3, s23
    v_lshlrev_b32 v3, 1, v2
    v_add_u32 v3, s3, v3
    v_mul_u32_u24 v4, 1792, v3
    v_lshl_add_u32 v4, v1, 5, v4
    v_mul_u32_u24 v3, 896, v3
    v_lshl_add_u32 v3, v1, 4, v3
    v_mov_b32 v5, 0x7ffffff0
    v_cmp_gt_u32 vcc, 56, v1
    s_nop 1
    v_cndmask_b32 v3, v5, v3, vcc
    v_cndmask_b32 v4, v5, v4, vcc
    s_mov_b32 s20, 100663296
    s_mov_b32 s21, 104333312
    s_mov_b32 s22, 108003328
    s_mov_b32 s23, 111673344
    s_mov_b32 s24, 117440512
    s_mov_b32 s25, 119537664
    buffer_load_dwordx4 v[40:43], v3, s[84:87], 0 offen offset:0
    buffer_load_dwordx4 v[44:47], v4, s[4:7], s20 offen offset:0 sc0 sc1
    buffer_load_dwordx4 v[48:51], v4, s[4:7], s20 offen offset:16 sc0 sc1
    buffer_load_dwordx4 v[52:55], v4, s[4:7], s21 offen offset:0 sc0 sc1
    buffer_load_dwordx4 v[56:59], v4, s[4:7], s21 offen offset:16 sc0 sc1
    buffer_load_dwordx4 v[60:63], v4, s[4:7], s22 offen offset:0 sc0 sc1
    buffer_load_dwordx4 v[64:67], v4, s[4:7], s22 offen offset:16 sc0 sc1
    buffer_load_dwordx4 v[68:71], v4, s[4:7], s23 offen offset:0 sc0 sc1
    buffer_load_dwordx4 v[72:75], v4, s[4:7], s23 offen offset:16 sc0 sc1
    buffer_load_dwordx4 v[76:79], v3, s[84:87], 0 offen offset:896
    buffer_load_dwordx4 v[80:83], v4, s[4:7], s20 offen offset:1792 sc0 sc1
    buffer_load_dwordx4 v[84:87], v4, s[4:7], s20 offen offset:1808 sc0 sc1
    buffer_load_dwordx4 v[88:91], v4, s[4:7], s21 offen offset:1792 sc0 sc1
    buffer_load_dwordx4 v[92:95], v4, s[4:7], s21 offen offset:1808 sc0 sc1
    buffer_load_dwordx4 v[96:99], v4, s[4:7], s22 offen offset:1792 sc0 sc1
    buffer_load_dwordx4 v[100:103], v4, s[4:7], s22 offen offset:1808 sc0 sc1
    buffer_load_dwordx4 v[104:107], v4, s[4:7], s23 offen offset:1792 sc0 sc1
    buffer_load_dwordx4 v[108:111], v4, s[4:7], s23 offen offset:1808 sc0 sc1
    s_waitcnt vmcnt(9)
    v_add_f32 v44, v44, v52
    v_add_f32 v60, v60, v68
    v_add_f32 v44, v44, v60
    v_add_f32 v45, v45, v53
    v_add_f32 v61, v61, v69
    v_add_f32 v45, v45, v61
    v_add_f32 v46, v46, v54
    v_add_f32 v62, v62, v70
    v_add_f32 v46, v46, v62
    v_add_f32 v47, v47, v55
    v_add_f32 v63, v63, v71
    v_add_f32 v47, v47, v63
    v_add_f32 v48, v48, v56
    v_add_f32 v64, v64, v72
    v_add_f32 v48, v48, v64
    v_add_f32 v49, v49, v57
    v_add_f32 v65, v65, v73
    v_add_f32 v49, v49, v65
    v_add_f32 v50, v50, v58
    v_add_f32 v66, v66, v74
    v_add_f32 v50, v50, v66
    v_add_f32 v51, v51, v59
    v_add_f32 v67, v67, v75
    v_add_f32 v51, v51, v67
    v_cvt_pk_bf16_f32 v8, v44, v45
    v_cvt_pk_bf16_f32 v9, v46, v47
    v_cvt_pk_bf16_f32 v10, v48, v49
    v_cvt_pk_bf16_f32 v11, v50, v51
    v_lshlrev_b32 v16, 16, v8
    v_and_b32 v17, 0xffff0000, v8
    v_lshlrev_b32 v24, 16, v40
    v_and_b32 v25, 0xffff0000, v40
    v_lshlrev_b32 v18, 16, v9
    v_and_b32 v19, 0xffff0000, v9
    v_lshlrev_b32 v26, 16, v41
    v_and_b32 v27, 0xffff0000, v41
    v_lshlrev_b32 v20, 16, v10
    v_and_b32 v21, 0xffff0000, v10
    v_lshlrev_b32 v28, 16, v42
    v_and_b32 v29, 0xffff0000, v42
    v_lshlrev_b32 v22, 16, v11
    v_and_b32 v23, 0xffff0000, v11
    v_lshlrev_b32 v30, 16, v43
    v_and_b32 v31, 0xffff0000, v43
    v_add_f32 v24, v24, v16
    v_add_f32 v25, v25, v17
    v_add_f32 v26, v26, v18
    v_add_f32 v27, v27, v19
    v_add_f32 v28, v28, v20
    v_add_f32 v29, v29, v21
    v_add_f32 v30, v30, v22
    v_add_f32 v31, v31, v23
    v_cvt_pk_bf16_f32 v8, v24, v25
    v_cvt_pk_bf16_f32 v9, v26, v27
    v_cvt_pk_bf16_f32 v10, v28, v29
    v_cvt_pk_bf16_f32 v11, v30, v31
    buffer_store_dwordx4 v[8:11], v3, s[4:7], s24 offen offset:0 sc0 sc1
    v_lshlrev_b32 v24, 16, v8
    v_and_b32 v25, 0xffff0000, v8
    v_lshlrev_b32 v26, 16, v9
    v_and_b32 v27, 0xffff0000, v9
    v_lshlrev_b32 v28, 16, v10
    v_and_b32 v29, 0xffff0000, v10
    v_lshlrev_b32 v30, 16, v11
    v_and_b32 v31, 0xffff0000, v11
    v_add_f32 v32, v24, v25
    v_add_f32 v32, v32, v26
    v_add_f32 v32, v32, v27
    v_add_f32 v32, v32, v28
    v_add_f32 v32, v32, v29
    v_add_f32 v32, v32, v30
    v_add_f32 v32, v32, v31
    s_nop 1
    v_add_f32_dpp v32, v32, v32 quad_perm:[1,0,3,2] row_mask:0xf bank_mask:0xf
    s_nop 1
    v_add_f32_dpp v32, v32, v32 quad_perm:[2,3,0,1] row_mask:0xf bank_mask:0xf
    s_nop 1
    v_add_f32_dpp v32, v32, v32 row_half_mirror row_mask:0xf bank_mask:0xf
    s_nop 1
    v_add_f32_dpp v32, v32, v32 row_mirror row_mask:0xf bank_mask:0xf
    v_mov_b32 v33, v32
    s_nop 1
    v_permlane16_swap_b32 v33, v32
    s_nop 1
    v_add_f32 v32, v32, v33
    v_mov_b32 v33, v32
    s_nop 1
    v_permlane32_swap_b32 v33, v32
    s_nop 1
    v_add_f32 v32, v32, v33
    v_mul_f32 v32, 0.002232142857142857, v32
    v_sub_f32 v24, v24, v32
    v_sub_f32 v25, v25, v32
    v_sub_f32 v26, v26, v32
    v_sub_f32 v27, v27, v32
    v_sub_f32 v28, v28, v32
    v_sub_f32 v29, v29, v32
    v_sub_f32 v30, v30, v32
    v_sub_f32 v31, v31, v32
    v_mul_f32 v34, v24, v24
    v_fma_f32 v34, v25, v25, v34
    v_fma_f32 v34, v26, v26, v34
    v_fma_f32 v34, v27, v27, v34
    v_fma_f32 v34, v28, v28, v34
    v_fma_f32 v34, v29, v29, v34
    v_fma_f32 v34, v30, v30, v34
    v_fma_f32 v34, v31, v31, v34
    v_cndmask_b32 v34, 0, v34, vcc
    s_nop 1
    v_add_f32_dpp v34, v34, v34 quad_perm:[1,0,3,2] row_mask:0xf bank_mask:0xf
    s_nop 1
    v_add_f32_dpp v34, v34, v34 quad_perm:[2,3,0,1] row_mask:0xf bank_mask:0xf
    s_nop 1
    v_add_f32_dpp v34, v34, v34 row_half_mirror row_mask:0xf bank_mask:0xf
    s_nop 1
    v_add_f32_dpp v34, v34, v34 row_mirror row_mask:0xf bank_mask:0xf
    v_mov_b32 v33, v34
    s_nop 1
    v_permlane16_swap_b32 v33, v34
    s_nop 1
    v_add_f32 v34, v34, v33
    v_mov_b32 v33, v34
    s_nop 1
    v_permlane32_swap_b32 v33, v34
    s_nop 1
    v_add_f32 v34, v34, v33
    v_mov_b32 v35, 1e-05
    v_fmac_f32 v35, 0.002232142857142857, v34
    v_rsq_f32 v35, v35
    s_nop 0
    v_mul_f32 v24, v24, v35
    v_mul_f32 v25, v25, v35
    v_mul_f32 v26, v26, v35
    v_mul_f32 v27, v27, v35
    v_mul_f32 v28, v28, v35
    v_mul_f32 v29, v29, v35
    v_mul_f32 v30, v30, v35
    v_mul_f32 v31, v31, v35
    v_cvt_pk_bf16_f32 v12, v24, v25
    v_cvt_pk_bf16_f32 v13, v26, v27
    v_cvt_pk_bf16_f32 v14, v28, v29
    v_cvt_pk_bf16_f32 v15, v30, v31
    buffer_store_dwordx4 v[12:15], v3, s[4:7], s25 offen offset:0 sc0 sc1
    s_waitcnt vmcnt(0)
    v_add_f32 v80, v80, v88
    v_add_f32 v96, v96, v104
    v_add_f32 v80, v80, v96
    v_add_f32 v81, v81, v89
    v_add_f32 v97, v97, v105
    v_add_f32 v81, v81, v97
    v_add_f32 v82, v82, v90
    v_add_f32 v98, v98, v106
    v_add_f32 v82, v82, v98
    v_add_f32 v83, v83, v91
    v_add_f32 v99, v99, v107
    v_add_f32 v83, v83, v99
    v_add_f32 v84, v84, v92
    v_add_f32 v100, v100, v108
    v_add_f32 v84, v84, v100
    v_add_f32 v85, v85, v93
    v_add_f32 v101, v101, v109
    v_add_f32 v85, v85, v101
    v_add_f32 v86, v86, v94
    v_add_f32 v102, v102, v110
    v_add_f32 v86, v86, v102
    v_add_f32 v87, v87, v95
    v_add_f32 v103, v103, v111
    v_add_f32 v87, v87, v103
    v_cvt_pk_bf16_f32 v8, v80, v81
    v_cvt_pk_bf16_f32 v9, v82, v83
    v_cvt_pk_bf16_f32 v10, v84, v85
    v_cvt_pk_bf16_f32 v11, v86, v87
    v_lshlrev_b32 v16, 16, v8
    v_and_b32 v17, 0xffff0000, v8
    v_lshlrev_b32 v24, 16, v76
    v_and_b32 v25, 0xffff0000, v76
    v_lshlrev_b32 v18, 16, v9
    v_and_b32 v19, 0xffff0000, v9
    v_lshlrev_b32 v26, 16, v77
    v_and_b32 v27, 0xffff0000, v77
    v_lshlrev_b32 v20, 16, v10
    v_and_b32 v21, 0xffff0000, v10
    v_lshlrev_b32 v28, 16, v78
    v_and_b32 v29, 0xffff0000, v78
    v_lshlrev_b32 v22, 16, v11
    v_and_b32 v23, 0xffff0000, v11
    v_lshlrev_b32 v30, 16, v79
    v_and_b32 v31, 0xffff0000, v79
    v_add_f32 v24, v24, v16
    v_add_f32 v25, v25, v17
    v_add_f32 v26, v26, v18
    v_add_f32 v27, v27, v19
    v_add_f32 v28, v28, v20
    v_add_f32 v29, v29, v21
    v_add_f32 v30, v30, v22
    v_add_f32 v31, v31, v23
    v_cvt_pk_bf16_f32 v8, v24, v25
    v_cvt_pk_bf16_f32 v9, v26, v27
    v_cvt_pk_bf16_f32 v10, v28, v29
    v_cvt_pk_bf16_f32 v11, v30, v31
    buffer_store_dwordx4 v[8:11], v3, s[4:7], s24 offen offset:896 sc0 sc1
    v_lshlrev_b32 v24, 16, v8
    v_and_b32 v25, 0xffff0000, v8
    v_lshlrev_b32 v26, 16, v9
    v_and_b32 v27, 0xffff0000, v9
    v_lshlrev_b32 v28, 16, v10
    v_and_b32 v29, 0xffff0000, v10
    v_lshlrev_b32 v30, 16, v11
    v_and_b32 v31, 0xffff0000, v11
    v_add_f32 v32, v24, v25
    v_add_f32 v32, v32, v26
    v_add_f32 v32, v32, v27
    v_add_f32 v32, v32, v28
    v_add_f32 v32, v32, v29
    v_add_f32 v32, v32, v30
    v_add_f32 v32, v32, v31
    s_nop 1
    v_add_f32_dpp v32, v32, v32 quad_perm:[1,0,3,2] row_mask:0xf bank_mask:0xf
    s_nop 1
    v_add_f32_dpp v32, v32, v32 quad_perm:[2,3,0,1] row_mask:0xf bank_mask:0xf
    s_nop 1
    v_add_f32_dpp v32, v32, v32 row_half_mirror row_mask:0xf bank_mask:0xf
    s_nop 1
    v_add_f32_dpp v32, v32, v32 row_mirror row_mask:0xf bank_mask:0xf
    v_mov_b32 v33, v32
    s_nop 1
    v_permlane16_swap_b32 v33, v32
    s_nop 1
    v_add_f32 v32, v32, v33
    v_mov_b32 v33, v32
    s_nop 1
    v_permlane32_swap_b32 v33, v32
    s_nop 1
    v_add_f32 v32, v32, v33
    v_mul_f32 v32, 0.002232142857142857, v32
    v_sub_f32 v24, v24, v32
    v_sub_f32 v25, v25, v32
    v_sub_f32 v26, v26, v32
    v_sub_f32 v27, v27, v32
    v_sub_f32 v28, v28, v32
    v_sub_f32 v29, v29, v32
    v_sub_f32 v30, v30, v32
    v_sub_f32 v31, v31, v32
    v_mul_f32 v34, v24, v24
    v_fma_f32 v34, v25, v25, v34
    v_fma_f32 v34, v26, v26, v34
    v_fma_f32 v34, v27, v27, v34
    v_fma_f32 v34, v28, v28, v34
    v_fma_f32 v34, v29, v29, v34
    v_fma_f32 v34, v30, v30, v34
    v_fma_f32 v34, v31, v31, v34
    v_cndmask_b32 v34, 0, v34, vcc
    s_nop 1
    v_add_f32_dpp v34, v34, v34 quad_perm:[1,0,3,2] row_mask:0xf bank_mask:0xf
    s_nop 1
    v_add_f32_dpp v34, v34, v34 quad_perm:[2,3,0,1] row_mask:0xf bank_mask:0xf
    s_nop 1
    v_add_f32_dpp v34, v34, v34 row_half_mirror row_mask:0xf bank_mask:0xf
    s_nop 1
    v_add_f32_dpp v34, v34, v34 row_mirror row_mask:0xf bank_mask:0xf
    v_mov_b32 v33, v34
    s_nop 1
    v_permlane16_swap_b32 v33, v34
    s_nop 1
    v_add_f32 v34, v34, v33
    v_mov_b32 v33, v34
    s_nop 1
    v_permlane32_swap_b32 v33, v34
    s_nop 1
    v_add_f32 v34, v34, v33
    v_mov_b32 v35, 1e-05
    v_fmac_f32 v35, 0.002232142857142857, v34
    v_rsq_f32 v35, v35
    s_nop 0
    v_mul_f32 v24, v24, v35
    v_mul_f32 v25, v25, v35
    v_mul_f32 v26, v26, v35
    v_mul_f32 v27, v27, v35
    v_mul_f32 v28, v28, v35
    v_mul_f32 v29, v29, v35
    v_mul_f32 v30, v30, v35
    v_mul_f32 v31, v31, v35
    v_cvt_pk_bf16_f32 v12, v24, v25
    v_cvt_pk_bf16_f32 v13, v26, v27
    v_cvt_pk_bf16_f32 v14, v28, v29
    v_cvt_pk_bf16_f32 v15, v30, v31
    buffer_store_dwordx4 v[12:15], v3, s[4:7], s25 offen offset:896 sc0 sc1
    v_and_b32 v3, 15, v1
    v_lshrrev_b32 v4, 4, v1
    s_add_u32 s22, s15, 192
    s_waitcnt vmcnt(0) lgkmcnt(0)
    s_barrier
    s_cmp_lg_u32 s14, 0
    s_cbranch_scc1 chain_kernel_sig16
    s_mov_b64 exec, 1
    v_mov_b32 v6, s22
    v_mov_b32 v5, 1
    buffer_atomic_add v5, v6, s[8:11], 0 offen sc1
    s_mov_b64 exec, -1
chain_kernel_sig16:
    s_cmp_ge_u32 s17, 6
    s_cbranch_scc1 chain_kernel_end
    v_mov_b32 v241, s22
chain_kernel_wc17:
    buffer_load_dword v240, v241, s[8:11], 0 offen sc0 sc1
    s_add_u32 s48, s48, 1
    s_cmp_gt_u32 s48, 0x400000
    s_cbranch_scc1 chain_kernel_end
    s_sleep 1
    s_waitcnt vmcnt(0)
    v_cmp_gt_u32 vcc, 32, v240
    s_cbranch_vccnz chain_kernel_wc17
    s_and_b32 s20, s16, 15
    s_lshr_b32 s21, s19, 4
    s_mul_i32 s24, s21, 114688
    s_add_u32 s24, s24, 119537664
    s_mul_i32 s25, s20, 200704
    s_add_u32 s25, s25, 6291456
    v_lshrrev_b32 v6, 3, v1
    v_and_b32 v5, 7, v1
    v_xor_b32 v5, v5, v6
    v_lshl_add_u32 v6, v2, 3, v6
    v_mul_u32_u24 v16, 896, v6
    v_lshl_add_u32 v16, v5, 4, v16
    v_mul_u32_u24 v17, 896, v6
    v_lshl_add_u32 v17, v5, 4, v17
    s_add_u32 s60, s24, 0
    s_add_u32 s61, s24, 28672
    s_add_u32 s62, s24, 57344
    s_add_u32 s63, s24, 86016
    s_add_u32 s64, s25, 0
    s_add_u32 s65, s25, 28672
    s_add_u32 s66, s25, 57344
    s_add_u32 s67, s25, 86016
    s_add_u32 s68, s25, 114688
    s_add_u32 s69, s25, 143360
    s_add_u32 s70, s25, 172032
    s_lshl_b32 s71, s14, 10
    v_and_b32 v7, 7, v3
    v_xor_b32 v7, v7, v4
    v_lshlrev_b32 v7, 4, v7
    v_lshl_add_u32 v7, v3, 7, v7
    v_mov_b32 v8, v2
    v_mov_b32 v9, 0
    v_mul_u32_u24 v10, 4096, v8
    v_mul_u32_u24 v11, 28672, v9
    v_add_u32 v10, v10, v7
    v_add_u32 v11, v11, v7
    v_add_u32 v11, 16384, v11
    v_mov_b32 v18, v10
    v_xor_b32 v20, 64, v10
    v_add_u32 v19, 45056, v18
    v_add_u32 v21, 45056, v20
    v_mov_b32 v22, v11
    v_xor_b32 v24, 64, v11
    v_add_u32 v23, 45056, v22
    v_add_u32 v25, 45056, v24
    s_add_u32 m0, s71, 0
    s_nop 0
    buffer_load_dwordx4 v16, s[4:7], s60 offen sc0 sc1 lds
    s_add_u32 s60, s60, 128
    s_add_u32 m0, s71, 4096
    s_nop 0
    buffer_load_dwordx4 v16, s[4:7], s61 offen sc0 sc1 lds
    s_add_u32 s61, s61, 128
    s_add_u32 m0, s71, 8192
    s_nop 0
    buffer_load_dwordx4 v16, s[4:7], s62 offen sc0 sc1 lds
    s_add_u32 s62, s62, 128
    s_add_u32 m0, s71, 12288
    s_nop 0
    buffer_load_dwordx4 v16, s[4:7], s63 offen sc0 sc1 lds
    s_add_u32 s63, s63, 128
    s_add_u32 m0, s71, 16384
    s_nop 0
    buffer_load_dwordx4 v17, s[4:7], s64 offen sc0 sc1 lds
    s_add_u32 s64, s64, 128
    s_add_u32 m0, s71, 20480
    s_nop 0
    buffer_load_dwordx4 v17, s[4:7], s65 offen sc0 sc1 lds
    s_add_u32 s65, s65, 128
    s_add_u32 m0, s71, 24576
    s_nop 0
    buffer_load_dwordx4 v17, s[4:7], s66 offen sc0 sc1 lds
    s_add_u32 s66, s66, 128
    s_add_u32 m0, s71, 28672
    s_nop 0
    buffer_load_dwordx4 v17, s[4:7], s67 offen sc0 sc1 lds
    s_add_u32 s67, s67, 128
    s_add_u32 m0, s71, 32768
    s_nop 0
    buffer_load_dwordx4 v17, s[4:7], s68 offen sc0 sc1 lds
    s_add_u32 s68, s68, 128
    s_add_u32 m0, s71, 36864
    s_nop 0
    buffer_load_dwordx4 v17, s[4:7], s69 offen sc0 sc1 lds
    s_add_u32 s69, s69, 128
    s_add_u32 m0, s71, 40960
    s_nop 0
    buffer_load_dwordx4 v17, s[4:7], s70 offen sc0 sc1 lds
    s_add_u32 s70, s70, 128
    s_add_u32 m0, s71, 45056
    s_nop 0
    buffer_load_dwordx4 v16, s[4:7], s60 offen sc0 sc1 lds
    s_add_u32 s60, s60, 128
    s_add_u32 m0, s71, 49152
    s_nop 0
    buffer_load_dwordx4 v16, s[4:7], s61 offen sc0 sc1 lds
    s_add_u32 s61, s61, 128
    s_add_u32 m0, s71, 53248
    s_nop 0
    buffer_load_dwordx4 v16, s[4:7], s62 offen sc0 sc1 lds
    s_add_u32 s62, s62, 128
    s_add_u32 m0, s71, 57344
    s_nop 0
    buffer_load_dwordx4 v16, s[4:7], s63 offen sc0 sc1 lds
    s_add_u32 s63, s63, 128
    s_add_u32 m0, s71, 61440
    s_nop 0
    buffer_load_dwordx4 v17, s[4:7], s64 offen sc0 sc1 lds
    s_add_u32 s64, s64, 128
    s_add_u32 m0, s71, 65536
    s_nop 0
    buffer_load_dwordx4 v17, s[4:7], s65 offen sc0 sc1 lds
    s_add_u32 s65, s65, 128
    s_add_u32 m0, s71, 69632
    s_nop 0
    buffer_load_dwordx4 v17, s[4:7], s66 offen sc0 sc1 lds
    s_add_u32 s66, s66, 128
    s_add_u32 m0, s71, 73728
    s_nop 0
    buffer_load_dwordx4 v17, s[4:7], s67 offen sc0 sc1 lds
    s_add_u32 s67, s67, 128
    s_add_u32 m0, s71, 77824
    s_nop 0
    buffer_load_dwordx4 v17, s[4:7], s68 offen sc0 sc1 lds
    s_add_u32 s68, s68, 128
    s_add_u32 m0, s71, 81920
    s_nop 0
    buffer_load_dwordx4 v17, s[4:7], s69 offen sc0 sc1 lds
    s_add_u32 s69, s69, 128
    s_add_u32 m0, s71, 86016
    s_nop 0
    buffer_load_dwordx4 v17, s[4:7], s70 offen sc0 sc1 lds
    s_add_u32 s70, s70, 128
    s_waitcnt vmcnt(11)
    s_barrier
    ds_read_b128 v[36:39], v22 offset:0
    ds_read_b128 v[40:43], v22 offset:2048
    ds_read_b128 v[44:47], v22 offset:4096
    ds_read_b128 v[48:51], v22 offset:6144
    ds_read_b128 v[52:55], v22 offset:8192
    ds_read_b128 v[56:59], v22 offset:10240
    ds_read_b128 v[60:63], v22 offset:12288
    ds_read_b128 v[64:67], v22 offset:14336
    ds_read_b128 v[68:71], v22 offset:16384
    ds_read_b128 v[72:75], v22 offset:18432
    ds_read_b128 v[76:79], v22 offset:20480
    ds_read_b128 v[80:83], v22 offset:22528
    ds_read_b128 v[84:87], v22 offset:24576
    ds_read_b128 v[88:91], v22 offset:26624
    ds_read_b128 v[28:31], v18 offset:0
    ds_read_b128 v[32:35], v18 offset:2048
    s_waitcnt lgkmcnt(0)
    v_mfma_f32_16x16x32_bf16 a[0:3], v[36:39], v[28:31], 0
    v_mfma_f32_16x16x32_bf16 a[4:7], v[40:43], v[28:31], 0
    ds_read_b128 v[100:103], v24 offset:0
    v_mfma_f32_16x16x32_bf16 a[8:11], v[44:47], v[28:31], 0
    v_mfma_f32_16x16x32_bf16 a[12:15], v[48:51], v[28:31], 0
    ds_read_b128 v[104:107], v24 offset:2048
    v_mfma_f32_16x16x32_bf16 a[16:19], v[52:55], v[28:31], 0
    v_mfma_f32_16x16x32_bf16 a[20:23], v[56:59], v[28:31], 0
    ds_read_b128 v[108:111], v24 offset:4096
    v_mfma_f32_16x16x32_bf16 a[24:27], v[60:63], v[28:31], 0
    ds_read_b128 v[112:115], v24 offset:6144
    v_mfma_f32_16x16x32_bf16 a[28:31], v[64:67], v[28:31], 0
    v_mfma_f32_16x16x32_bf16 a[32:35], v[68:71], v[28:31], 0
    ds_read_b128 v[116:119], v24 offset:8192
    v_mfma_f32_16x16x32_bf16 a[36:39], v[72:75], v[28:31], 0
    v_mfma_f32_16x16x32_bf16 a[40:43], v[76:79], v[28:31], 0
    ds_read_b128 v[120:123], v24 offset:10240
    v_mfma_f32_16x16x32_bf16 a[44:47], v[80:83], v[28:31], 0
    v_mfma_f32_16x16x32_bf16 a[48:51], v[84:87], v[28:31], 0
    ds_read_b128 v[124:127], v24 offset:12288
    v_mfma_f32_16x16x32_bf16 a[52:55], v[88:91], v[28:31], 0
    ds_read_b128 v[128:131], v24 offset:14336
    v_mfma_f32_16x16x32_bf16 a[56:59], v[36:39], v[32:35], 0
    v_mfma_f32_16x16x32_bf16 a[60:63], v[40:43], v[32:35], 0
    ds_read_b128 v[132:135], v24 offset:16384
    v_mfma_f32_16x16x32_bf16 a[64:67], v[44:47], v[32:35], 0
    v_mfma_f32_16x16x32_bf16 a[68:71], v[48:51], v[32:35], 0
    ds_read_b128 v[136:139], v24 offset:18432
    v_mfma_f32_16x16x32_bf16 a[72:75], v[52:55], v[32:35], 0
    v_mfma_f32_16x16x32_bf16 a[76:79], v[56:59], v[32:35], 0
    ds_read_b128 v[140:143], v24 offset:20480
    v_mfma_f32_16x16x32_bf16 a[80:83], v[60:63], v[32:35], 0
    ds_read_b128 v[144:147], v24 offset:22528
    v_mfma_f32_16x16x32_bf16 a[84:87], v[64:67], v[32:35], 0
    v_mfma_f32_16x16x32_bf16 a[88:91], v[68:71], v[32:35], 0
    ds_read_b128 v[148:151], v24 offset:24576
    v_mfma_f32_16x16x32_bf16 a[92:95], v[72:75], v[32:35], 0
    v_mfma_f32_16x16x32_bf16 a[96:99], v[76:79], v[32:35], 0
    ds_read_b128 v[152:155], v24 offset:26624
    v_mfma_f32_16x16x32_bf16 a[100:103], v[80:83], v[32:35], 0
    v_mfma_f32_16x16x32_bf16 a[104:107], v[84:87], v[32:35], 0
    ds_read_b128 v[92:95], v20 offset:0
    v_mfma_f32_16x16x32_bf16 a[108:111], v[88:91], v[32:35], 0
    ds_read_b128 v[96:99], v20 offset:2048
    s_waitcnt lgkmcnt(0) vmcnt(0)
    s_barrier
    v_mfma_f32_16x16x32_bf16 a[0:3], v[100:103], v[92:95], a[0:3]
    v_mfma_f32_16x16x32_bf16 a[4:7], v[104:107], v[92:95], a[4:7]
    ds_read_b128 v[36:39], v23 offset:0
    v_mfma_f32_16x16x32_bf16 a[8:11], v[108:111], v[92:95], a[8:11]
    ds_read_b128 v[40:43], v23 offset:2048
    v_mfma_f32_16x16x32_bf16 a[12:15], v[112:115], v[92:95], a[12:15]
    s_add_u32 m0, s71, 0
    s_nop 0
    buffer_load_dwordx4 v16, s[4:7], s60 offen sc0 sc1 lds
    s_add_u32 s60, s60, 128
    v_mfma_f32_16x16x32_bf16 a[16:19], v[116:119], v[92:95], a[16:19]
    ds_read_b128 v[44:47], v23 offset:4096
    v_mfma_f32_16x16x32_bf16 a[20:23], v[120:123], v[92:95], a[20:23]
    s_add_u32 m0, s71, 4096
    s_nop 0
    buffer_load_dwordx4 v16, s[4:7], s61 offen sc0 sc1 lds
    s_add_u32 s61, s61, 128
    v_mfma_f32_16x16x32_bf16 a[24:27], v[124:127], v[92:95], a[24:27]
    ds_read_b128 v[48:51], v23 offset:6144
    v_mfma_f32_16x16x32_bf16 a[28:31], v[128:131], v[92:95], a[28:31]
    ds_read_b128 v[52:55], v23 offset:8192
    v_mfma_f32_16x16x32_bf16 a[32:35], v[132:135], v[92:95], a[32:35]
    s_add_u32 m0, s71, 8192
    s_nop 0
    buffer_load_dwordx4 v16, s[4:7], s62 offen sc0 sc1 lds
    s_add_u32 s62, s62, 128
    v_mfma_f32_16x16x32_bf16 a[36:39], v[136:139], v[92:95], a[36:39]
    ds_read_b128 v[56:59], v23 offset:10240
    v_mfma_f32_16x16x32_bf16 a[40:43], v[140:143], v[92:95], a[40:43]
    s_add_u32 m0, s71, 12288
    s_nop 0
    buffer_load_dwordx4 v16, s[4:7], s63 offen sc0 sc1 lds
    s_add_u32 s63, s63, 128
    v_mfma_f32_16x16x32_bf16 a[44:47], v[144:147], v[92:95], a[44:47]
    ds_read_b128 v[60:63], v23 offset:12288
    v_mfma_f32_16x16x32_bf16 a[48:51], v[148:151], v[92:95], a[48:51]
    ds_read_b128 v[64:67], v23 offset:14336
    v_mfma_f32_16x16x32_bf16 a[52:55], v[152:155], v[92:95], a[52:55]
    s_add_u32 m0, s71, 16384
    s_nop 0
    buffer_load_dwordx4 v17, s[4:7], s64 offen sc0 sc1 lds
    s_add_u32 s64, s64, 128
    v_mfma_f32_16x16x32_bf16 a[56:59], v[100:103], v[96:99], a[56:59]
    ds_read_b128 v[68:71], v23 offset:16384
    v_mfma_f32_16x16x32_bf16 a[60:63], v[104:107], v[96:99], a[60:63]
    s_add_u32 m0, s71, 20480
    s_nop 0
    buffer_load_dwordx4 v17, s[4:7], s65 offen sc0 sc1 lds
    s_add_u32 s65, s65, 128
    v_mfma_f32_16x16x32_bf16 a[64:67], v[108:111], v[96:99], a[64:67]
    ds_read_b128 v[72:75], v23 offset:18432
    v_mfma_f32_16x16x32_bf16 a[68:71], v[112:115], v[96:99], a[68:71]
    ds_read_b128 v[76:79], v23 offset:20480
    v_mfma_f32_16x16x32_bf16 a[72:75], v[116:119], v[96:99], a[72:75]
    s_add_u32 m0, s71, 24576
    s_nop 0
    buffer_load_dwordx4 v17, s[4:7], s66 offen sc0 sc1 lds
    s_add_u32 s66, s66, 128
    v_mfma_f32_16x16x32_bf16 a[76:79], v[120:123], v[96:99], a[76:79]
    ds_read_b128 v[80:83], v23 offset:22528
    v_mfma_f32_16x16x32_bf16 a[80:83], v[124:127], v[96:99], a[80:83]
    s_add_u32 m0, s71, 28672
    s_nop 0
    buffer_load_dwordx4 v17, s[4:7], s67 offen sc0 sc1 lds
    s_add_u32 s67, s67, 128
    v_mfma_f32_16x16x32_bf16 a[84:87], v[128:131], v[96:99], a[84:87]
    ds_read_b128 v[84:87], v23 offset:24576
    v_mfma_f32_16x16x32_bf16 a[88:91], v[132:135], v[96:99], a[88:91]
    ds_read_b128 v[88:91], v23 offset:26624
    v_mfma_f32_16x16x32_bf16 a[92:95], v[136:139], v[96:99], a[92:95]
    s_add_u32 m0, s71, 32768
    s_nop 0
    buffer_load_dwordx4 v17, s[4:7], s68 offen sc0 sc1 lds
    s_add_u32 s68, s68, 128
    v_mfma_f32_16x16x32_bf16 a[96:99], v[140:143], v[96:99], a[96:99]
    ds_read_b128 v[28:31], v19 offset:0
    v_mfma_f32_16x16x32_bf16 a[100:103], v[144:147], v[96:99], a[100:103]
    s_add_u32 m0, s71, 36864
    s_nop 0
    buffer_load_dwordx4 v17, s[4:7], s69 offen sc0 sc1 lds
    s_add_u32 s69, s69, 128
    v_mfma_f32_16x16x32_bf16 a[104:107], v[148:151], v[96:99], a[104:107]
    ds_read_b128 v[32:35], v19 offset:2048
    v_mfma_f32_16x16x32_bf16 a[108:111], v[152:155], v[96:99], a[108:111]
    s_add_u32 m0, s71, 40960
    s_nop 0
    buffer_load_dwordx4 v17, s[4:7], s70 offen sc0 sc1 lds
    s_add_u32 s70, s70, 128
    s_waitcnt lgkmcnt(0)
    v_mfma_f32_16x16x32_bf16 a[0:3], v[36:39], v[28:31], a[0:3]
    v_mfma_f32_16x16x32_bf16 a[4:7], v[40:43], v[28:31], a[4:7]
    ds_read_b128 v[100:103], v25 offset:0
    v_mfma_f32_16x16x32_bf16 a[8:11], v[44:47], v[28:31], a[8:11]
    v_mfma_f32_16x16x32_bf16 a[12:15], v[48:51], v[28:31], a[12:15]
    ds_read_b128 v[104:107], v25 offset:2048
    v_mfma_f32_16x16x32_bf16 a[16:19], v[52:55], v[28:31], a[16:19]
    v_mfma_f32_16x16x32_bf16 a[20:23], v[56:59], v[28:31], a[20:23]
    ds_read_b128 v[108:111], v25 offset:4096
    v_mfma_f32_16x16x32_bf16 a[24:27], v[60:63], v[28:31], a[24:27]
    ds_read_b128 v[112:115], v25 offset:6144
    v_mfma_f32_16x16x32_bf16 a[28:31], v[64:67], v[28:31], a[28:31]
    v_mfma_f32_16x16x32_bf16 a[32:35], v[68:71], v[28:31], a[32:35]
    ds_read_b128 v[116:119], v25 offset:8192
    v_mfma_f32_16x16x32_bf16 a[36:39], v[72:75], v[28:31], a[36:39]
    v_mfma_f32_16x16x32_bf16 a[40:43], v[76:79], v[28:31], a[40:43]
    ds_read_b128 v[120:123], v25 offset:10240
    v_mfma_f32_16x16x32_bf16 a[44:47], v[80:83], v[28:31], a[44:47]
    v_mfma_f32_16x16x32_bf16 a[48:51], v[84:87], v[28:31], a[48:51]
    ds_read_b128 v[124:127], v25 offset:12288
    v_mfma_f32_16x16x32_bf16 a[52:55], v[88:91], v[28:31], a[52:55]
    ds_read_b128 v[128:131], v25 offset:14336
    v_mfma_f32_16x16x32_bf16 a[56:59], v[36:39], v[32:35], a[56:59]
    v_mfma_f32_16x16x32_bf16 a[60:63], v[40:43], v[32:35], a[60:63]
    ds_read_b128 v[132:135], v25 offset:16384
    v_mfma_f32_16x16x32_bf16 a[64:67], v[44:47], v[32:35], a[64:67]
    v_mfma_f32_16x16x32_bf16 a[68:71], v[48:51], v[32:35], a[68:71]
    ds_read_b128 v[136:139], v25 offset:18432
    v_mfma_f32_16x16x32_bf16 a[72:75], v[52:55], v[32:35], a[72:75]
    v_mfma_f32_16x16x32_bf16 a[76:79], v[56:59], v[32:35], a[76:79]
    ds_read_b128 v[140:143], v25 offset:20480
    v_mfma_f32_16x16x32_bf16 a[80:83], v[60:63], v[32:35], a[80:83]
    ds_read_b128 v[144:147], v25 offset:22528
    v_mfma_f32_16x16x32_bf16 a[84:87], v[64:67], v[32:35], a[84:87]
    v_mfma_f32_16x16x32_bf16 a[88:91], v[68:71], v[32:35], a[88:91]
    ds_read_b128 v[148:151], v25 offset:24576
    v_mfma_f32_16x16x32_bf16 a[92:95], v[72:75], v[32:35], a[92:95]
    v_mfma_f32_16x16x32_bf16 a[96:99], v[76:79], v[32:35], a[96:99]
    ds_read_b128 v[152:155], v25 offset:26624
    v_mfma_f32_16x16x32_bf16 a[100:103], v[80:83], v[32:35], a[100:103]
    v_mfma_f32_16x16x32_bf16 a[104:107], v[84:87], v[32:35], a[104:107]
    ds_read_b128 v[92:95], v21 offset:0
    v_mfma_f32_16x16x32_bf16 a[108:111], v[88:91], v[32:35], a[108:111]
    ds_read_b128 v[96:99], v21 offset:2048
    s_waitcnt lgkmcnt(0) vmcnt(0)
    s_barrier
    v_mfma_f32_16x16x32_bf16 a[0:3], v[100:103], v[92:95], a[0:3]
    v_mfma_f32_16x16x32_bf16 a[4:7], v[104:107], v[92:95], a[4:7]
    ds_read_b128 v[36:39], v22 offset:0
    v_mfma_f32_16x16x32_bf16 a[8:11], v[108:111], v[92:95], a[8:11]
    ds_read_b128 v[40:43], v22 offset:2048
    v_mfma_f32_16x16x32_bf16 a[12:15], v[112:115], v[92:95], a[12:15]
    s_add_u32 m0, s71, 45056
    s_nop 0
    buffer_load_dwordx4 v16, s[4:7], s60 offen sc0 sc1 lds
    s_add_u32 s60, s60, 128
    v_mfma_f32_16x16x32_bf16 a[16:19], v[116:119], v[92:95], a[16:19]
    ds_read_b128 v[44:47], v22 offset:4096
    v_mfma_f32_16x16x32_bf16 a[20:23], v[120:123], v[92:95], a[20:23]
    s_add_u32 m0, s71, 49152
    s_nop 0
    buffer_load_dwordx4 v16, s[4:7], s61 offen sc0 sc1 lds
    s_add_u32 s61, s61, 128
    v_mfma_f32_16x16x32_bf16 a[24:27], v[124:127], v[92:95], a[24:27]
    ds_read_b128 v[48:51], v22 offset:6144
    v_mfma_f32_16x16x32_bf16 a[28:31], v[128:131], v[92:95], a[28:31]
    ds_read_b128 v[52:55], v22 offset:8192
    v_mfma_f32_16x16x32_bf16 a[32:35], v[132:135], v[92:95], a[32:35]
    s_add_u32 m0, s71, 53248
    s_nop 0
    buffer_load_dwordx4 v16, s[4:7], s62 offen sc0 sc1 lds
    s_add_u32 s62, s62, 128
    v_mfma_f32_16x16x32_bf16 a[36:39], v[136:139], v[92:95], a[36:39]
    ds_read_b128 v[56:59], v22 offset:10240
    v_mfma_f32_16x16x32_bf16 a[40:43], v[140:143], v[92:95], a[40:43]
    s_add_u32 m0, s71, 57344
    s_nop 0
    buffer_load_dwordx4 v16, s[4:7], s63 offen sc0 sc1 lds
    s_add_u32 s63, s63, 128
    v_mfma_f32_16x16x32_bf16 a[44:47], v[144:147], v[92:95], a[44:47]
    ds_read_b128 v[60:63], v22 offset:12288
    v_mfma_f32_16x16x32_bf16 a[48:51], v[148:151], v[92:95], a[48:51]
    ds_read_b128 v[64:67], v22 offset:14336
    v_mfma_f32_16x16x32_bf16 a[52:55], v[152:155], v[92:95], a[52:55]
    s_add_u32 m0, s71, 61440
    s_nop 0
    buffer_load_dwordx4 v17, s[4:7], s64 offen sc0 sc1 lds
    s_add_u32 s64, s64, 128
    v_mfma_f32_16x16x32_bf16 a[56:59], v[100:103], v[96:99], a[56:59]
    ds_read_b128 v[68:71], v22 offset:16384
    v_mfma_f32_16x16x32_bf16 a[60:63], v[104:107], v[96:99], a[60:63]
    s_add_u32 m0, s71, 65536
    s_nop 0
    buffer_load_dwordx4 v17, s[4:7], s65 offen sc0 sc1 lds
    s_add_u32 s65, s65, 128
    v_mfma_f32_16x16x32_bf16 a[64:67], v[108:111], v[96:99], a[64:67]
    ds_read_b128 v[72:75], v22 offset:18432
    v_mfma_f32_16x16x32_bf16 a[68:71], v[112:115], v[96:99], a[68:71]
    ds_read_b128 v[76:79], v22 offset:20480
    v_mfma_f32_16x16x32_bf16 a[72:75], v[116:119], v[96:99], a[72:75]
    s_add_u32 m0, s71, 69632
    s_nop 0
    buffer_load_dwordx4 v17, s[4:7], s66 offen sc0 sc1 lds
    s_add_u32 s66, s66, 128
    v_mfma_f32_16x16x32_bf16 a[76:79], v[120:123], v[96:99], a[76:79]
    ds_read_b128 v[80:83], v22 offset:22528
    v_mfma_f32_16x16x32_bf16 a[80:83], v[124:127], v[96:99], a[80:83]
    s_add_u32 m0, s71, 73728
    s_nop 0
    buffer_load_dwordx4 v17, s[4:7], s67 offen sc0 sc1 lds
    s_add_u32 s67, s67, 128
    v_mfma_f32_16x16x32_bf16 a[84:87], v[128:131], v[96:99], a[84:87]
    ds_read_b128 v[84:87], v22 offset:24576
    v_mfma_f32_16x16x32_bf16 a[88:91], v[132:135], v[96:99], a[88:91]
    ds_read_b128 v[88:91], v22 offset:26624
    v_mfma_f32_16x16x32_bf16 a[92:95], v[136:139], v[96:99], a[92:95]
    s_add_u32 m0, s71, 77824
    s_nop 0
    buffer_load_dwordx4 v17, s[4:7], s68 offen sc0 sc1 lds
    s_add_u32 s68, s68, 128
    v_mfma_f32_16x16x32_bf16 a[96:99], v[140:143], v[96:99], a[96:99]
    ds_read_b128 v[28:31], v18 offset:0
    v_mfma_f32_16x16x32_bf16 a[100:103], v[144:147], v[96:99], a[100:103]
    s_add_u32 m0, s71, 81920
    s_nop 0
    buffer_load_dwordx4 v17, s[4:7], s69 offen sc0 sc1 lds
    s_add_u32 s69, s69, 128
    v_mfma_f32_16x16x32_bf16 a[104:107], v[148:151], v[96:99], a[104:107]
    ds_read_b128 v[32:35], v18 offset:2048
    v_mfma_f32_16x16x32_bf16 a[108:111], v[152:155], v[96:99], a[108:111]
    s_add_u32 m0, s71, 86016
    s_nop 0
    buffer_load_dwordx4 v17, s[4:7], s70 offen sc0 sc1 lds
    s_add_u32 s70, s70, 128
    s_waitcnt lgkmcnt(0)
    v_mfma_f32_16x16x32_bf16 a[0:3], v[36:39], v[28:31], a[0:3]
    v_mfma_f32_16x16x32_bf16 a[4:7], v[40:43], v[28:31], a[4:7]
    ds_read_b128 v[100:103], v24 offset:0
    v_mfma_f32_16x16x32_bf16 a[8:11], v[44:47], v[28:31], a[8:11]
    v_mfma_f32_16x16x32_bf16 a[12:15], v[48:51], v[28:31], a[12:15]
    ds_read_b128 v[104:107], v24 offset:2048
    v_mfma_f32_16x16x32_bf16 a[16:19], v[52:55], v[28:31], a[16:19]
    v_mfma_f32_16x16x32_bf16 a[20:23], v[56:59], v[28:31], a[20:23]
    ds_read_b128 v[108:111], v24 offset:4096
    v_mfma_f32_16x16x32_bf16 a[24:27], v[60:63], v[28:31], a[24:27]
    ds_read_b128 v[112:115], v24 offset:6144
    v_mfma_f32_16x16x32_bf16 a[28:31], v[64:67], v[28:31], a[28:31]
    v_mfma_f32_16x16x32_bf16 a[32:35], v[68:71], v[28:31], a[32:35]
    ds_read_b128 v[116:119], v24 offset:8192
    v_mfma_f32_16x16x32_bf16 a[36:39], v[72:75], v[28:31], a[36:39]
    v_mfma_f32_16x16x32_bf16 a[40:43], v[76:79], v[28:31], a[40:43]
    ds_read_b128 v[120:123], v24 offset:10240
    v_mfma_f32_16x16x32_bf16 a[44:47], v[80:83], v[28:31], a[44:47]
    v_mfma_f32_16x16x32_bf16 a[48:51], v[84:87], v[28:31], a[48:51]
    ds_read_b128 v[124:127], v24 offset:12288
    v_mfma_f32_16x16x32_bf16 a[52:55], v[88:91], v[28:31], a[52:55]
    ds_read_b128 v[128:131], v24 offset:14336
    v_mfma_f32_16x16x32_bf16 a[56:59], v[36:39], v[32:35], a[56:59]
    v_mfma_f32_16x16x32_bf16 a[60:63], v[40:43], v[32:35], a[60:63]
    ds_read_b128 v[132:135], v24 offset:16384
    v_mfma_f32_16x16x32_bf16 a[64:67], v[44:47], v[32:35], a[64:67]
    v_mfma_f32_16x16x32_bf16 a[68:71], v[48:51], v[32:35], a[68:71]
    ds_read_b128 v[136:139], v24 offset:18432
    v_mfma_f32_16x16x32_bf16 a[72:75], v[52:55], v[32:35], a[72:75]
    v_mfma_f32_16x16x32_bf16 a[76:79], v[56:59], v[32:35], a[76:79]
    ds_read_b128 v[140:143], v24 offset:20480
    v_mfma_f32_16x16x32_bf16 a[80:83], v[60:63], v[32:35], a[80:83]
    ds_read_b128 v[144:147], v24 offset:22528
    v_mfma_f32_16x16x32_bf16 a[84:87], v[64:67], v[32:35], a[84:87]
    v_mfma_f32_16x16x32_bf16 a[88:91], v[68:71], v[32:35], a[88:91]
    ds_read_b128 v[148:151], v24 offset:24576
    v_mfma_f32_16x16x32_bf16 a[92:95], v[72:75], v[32:35], a[92:95]
    v_mfma_f32_16x16x32_bf16 a[96:99], v[76:79], v[32:35], a[96:99]
    ds_read_b128 v[152:155], v24 offset:26624
    v_mfma_f32_16x16x32_bf16 a[100:103], v[80:83], v[32:35], a[100:103]
    v_mfma_f32_16x16x32_bf16 a[104:107], v[84:87], v[32:35], a[104:107]
    ds_read_b128 v[92:95], v20 offset:0
    v_mfma_f32_16x16x32_bf16 a[108:111], v[88:91], v[32:35], a[108:111]
    ds_read_b128 v[96:99], v20 offset:2048
    s_waitcnt lgkmcnt(0) vmcnt(0)
    s_barrier
    v_mfma_f32_16x16x32_bf16 a[0:3], v[100:103], v[92:95], a[0:3]
    v_mfma_f32_16x16x32_bf16 a[4:7], v[104:107], v[92:95], a[4:7]
    ds_read_b128 v[36:39], v23 offset:0
    v_mfma_f32_16x16x32_bf16 a[8:11], v[108:111], v[92:95], a[8:11]
    ds_read_b128 v[40:43], v23 offset:2048
    v_mfma_f32_16x16x32_bf16 a[12:15], v[112:115], v[92:95], a[12:15]
    s_add_u32 m0, s71, 0
    s_nop 0
    buffer_load_dwordx4 v16, s[4:7], s60 offen sc0 sc1 lds
    s_add_u32 s60, s60, 128
    v_mfma_f32_16x16x32_bf16 a[16:19], v[116:119], v[92:95], a[16:19]
    ds_read_b128 v[44:47], v23 offset:4096
    v_mfma_f32_16x16x32_bf16 a[20:23], v[120:123], v[92:95], a[20:23]
    s_add_u32 m0, s71, 4096
    s_nop 0
    buffer_load_dwordx4 v16, s[4:7], s61 offen sc0 sc1 lds
    s_add_u32 s61, s61, 128
    v_mfma_f32_16x16x32_bf16 a[24:27], v[124:127], v[92:95], a[24:27]
    ds_read_b128 v[48:51], v23 offset:6144
    v_mfma_f32_16x16x32_bf16 a[28:31], v[128:131], v[92:95], a[28:31]
    ds_read_b128 v[52:55], v23 offset:8192
    v_mfma_f32_16x16x32_bf16 a[32:35], v[132:135], v[92:95], a[32:35]
    s_add_u32 m0, s71, 8192
    s_nop 0
    buffer_load_dwordx4 v16, s[4:7], s62 offen sc0 sc1 lds
    s_add_u32 s62, s62, 128
    v_mfma_f32_16x16x32_bf16 a[36:39], v[136:139], v[92:95], a[36:39]
    ds_read_b128 v[56:59], v23 offset:10240
    v_mfma_f32_16x16x32_bf16 a[40:43], v[140:143], v[92:95], a[40:43]
    s_add_u32 m0, s71, 12288
    s_nop 0
    buffer_load_dwordx4 v16, s[4:7], s63 offen sc0 sc1 lds
    s_add_u32 s63, s63, 128
    v_mfma_f32_16x16x32_bf16 a[44:47], v[144:147], v[92:95], a[44:47]
    ds_read_b128 v[60:63], v23 offset:12288
    v_mfma_f32_16x16x32_bf16 a[48:51], v[148:151], v[92:95], a[48:51]
    ds_read_b128 v[64:67], v23 offset:14336
    v_mfma_f32_16x16x32_bf16 a[52:55], v[152:155], v[92:95], a[52:55]
    s_add_u32 m0, s71, 16384
    s_nop 0
    buffer_load_dwordx4 v17, s[4:7], s64 offen sc0 sc1 lds
    s_add_u32 s64, s64, 128
    v_mfma_f32_16x16x32_bf16 a[56:59], v[100:103], v[96:99], a[56:59]
    ds_read_b128 v[68:71], v23 offset:16384
    v_mfma_f32_16x16x32_bf16 a[60:63], v[104:107], v[96:99], a[60:63]
    s_add_u32 m0, s71, 20480
    s_nop 0
    buffer_load_dwordx4 v17, s[4:7], s65 offen sc0 sc1 lds
    s_add_u32 s65, s65, 128
    v_mfma_f32_16x16x32_bf16 a[64:67], v[108:111], v[96:99], a[64:67]
    ds_read_b128 v[72:75], v23 offset:18432
    v_mfma_f32_16x16x32_bf16 a[68:71], v[112:115], v[96:99], a[68:71]
    ds_read_b128 v[76:79], v23 offset:20480
    v_mfma_f32_16x16x32_bf16 a[72:75], v[116:119], v[96:99], a[72:75]
    s_add_u32 m0, s71, 24576
    s_nop 0
    buffer_load_dwordx4 v17, s[4:7], s66 offen sc0 sc1 lds
    s_add_u32 s66, s66, 128
    v_mfma_f32_16x16x32_bf16 a[76:79], v[120:123], v[96:99], a[76:79]
    ds_read_b128 v[80:83], v23 offset:22528
    v_mfma_f32_16x16x32_bf16 a[80:83], v[124:127], v[96:99], a[80:83]
    s_add_u32 m0, s71, 28672
    s_nop 0
    buffer_load_dwordx4 v17, s[4:7], s67 offen sc0 sc1 lds
    s_add_u32 s67, s67, 128
    v_mfma_f32_16x16x32_bf16 a[84:87], v[128:131], v[96:99], a[84:87]
    ds_read_b128 v[84:87], v23 offset:24576
    v_mfma_f32_16x16x32_bf16 a[88:91], v[132:135], v[96:99], a[88:91]
    ds_read_b128 v[88:91], v23 offset:26624
    v_mfma_f32_16x16x32_bf16 a[92:95], v[136:139], v[96:99], a[92:95]
    s_add_u32 m0, s71, 32768
    s_nop 0
    buffer_load_dwordx4 v17, s[4:7], s68 offen sc0 sc1 lds
    s_add_u32 s68, s68, 128
    v_mfma_f32_16x16x32_bf16 a[96:99], v[140:143], v[96:99], a[96:99]
    ds_read_b128 v[28:31], v19 offset:0
    v_mfma_f32_16x16x32_bf16 a[100:103], v[144:147], v[96:99], a[100:103]
    s_add_u32 m0, s71, 36864
    s_nop 0
    buffer_load_dwordx4 v17, s[4:7], s69 offen sc0 sc1 lds
    s_add_u32 s69, s69, 128
    v_mfma_f32_16x16x32_bf16 a[104:107], v[148:151], v[96:99], a[104:107]
    ds_read_b128 v[32:35], v19 offset:2048
    v_mfma_f32_16x16x32_bf16 a[108:111], v[152:155], v[96:99], a[108:111]
    s_add_u32 m0, s71, 40960
    s_nop 0
    buffer_load_dwordx4 v17, s[4:7], s70 offen sc0 sc1 lds
    s_add_u32 s70, s70, 128
    s_waitcnt lgkmcnt(0)
    v_mfma_f32_16x16x32_bf16 a[0:3], v[36:39], v[28:31], a[0:3]
    v_mfma_f32_16x16x32_bf16 a[4:7], v[40:43], v[28:31], a[4:7]
    ds_read_b128 v[100:103], v25 offset:0
    v_mfma_f32_16x16x32_bf16 a[8:11], v[44:47], v[28:31], a[8:11]
    v_mfma_f32_16x16x32_bf16 a[12:15], v[48:51], v[28:31], a[12:15]
    ds_read_b128 v[104:107], v25 offset:2048
    v_mfma_f32_16x16x32_bf16 a[16:19], v[52:55], v[28:31], a[16:19]
    v_mfma_f32_16x16x32_bf16 a[20:23], v[56:59], v[28:31], a[20:23]
    ds_read_b128 v[108:111], v25 offset:4096
    v_mfma_f32_16x16x32_bf16 a[24:27], v[60:63], v[28:31], a[24:27]
    ds_read_b128 v[112:115], v25 offset:6144
    v_mfma_f32_16x16x32_bf16 a[28:31], v[64:67], v[28:31], a[28:31]
    v_mfma_f32_16x16x32_bf16 a[32:35], v[68:71], v[28:31], a[32:35]
    ds_read_b128 v[116:119], v25 offset:8192
    v_mfma_f32_16x16x32_bf16 a[36:39], v[72:75], v[28:31], a[36:39]
    v_mfma_f32_16x16x32_bf16 a[40:43], v[76:79], v[28:31], a[40:43]
    ds_read_b128 v[120:123], v25 offset:10240
    v_mfma_f32_16x16x32_bf16 a[44:47], v[80:83], v[28:31], a[44:47]
    v_mfma_f32_16x16x32_bf16 a[48:51], v[84:87], v[28:31], a[48:51]
    ds_read_b128 v[124:127], v25 offset:12288
    v_mfma_f32_16x16x32_bf16 a[52:55], v[88:91], v[28:31], a[52:55]
    ds_read_b128 v[128:131], v25 offset:14336
    v_mfma_f32_16x16x32_bf16 a[56:59], v[36:39], v[32:35], a[56:59]
    v_mfma_f32_16x16x32_bf16 a[60:63], v[40:43], v[32:35], a[60:63]
    ds_read_b128 v[132:135], v25 offset:16384
    v_mfma_f32_16x16x32_bf16 a[64:67], v[44:47], v[32:35], a[64:67]
    v_mfma_f32_16x16x32_bf16 a[68:71], v[48:51], v[32:35], a[68:71]
    ds_read_b128 v[136:139], v25 offset:18432
    v_mfma_f32_16x16x32_bf16 a[72:75], v[52:55], v[32:35], a[72:75]
    v_mfma_f32_16x16x32_bf16 a[76:79], v[56:59], v[32:35], a[76:79]
    ds_read_b128 v[140:143], v25 offset:20480
    v_mfma_f32_16x16x32_bf16 a[80:83], v[60:63], v[32:35], a[80:83]
    ds_read_b128 v[144:147], v25 offset:22528
    v_mfma_f32_16x16x32_bf16 a[84:87], v[64:67], v[32:35], a[84:87]
    v_mfma_f32_16x16x32_bf16 a[88:91], v[68:71], v[32:35], a[88:91]
    ds_read_b128 v[148:151], v25 offset:24576
    v_mfma_f32_16x16x32_bf16 a[92:95], v[72:75], v[32:35], a[92:95]
    v_mfma_f32_16x16x32_bf16 a[96:99], v[76:79], v[32:35], a[96:99]
    ds_read_b128 v[152:155], v25 offset:26624
    v_mfma_f32_16x16x32_bf16 a[100:103], v[80:83], v[32:35], a[100:103]
    v_mfma_f32_16x16x32_bf16 a[104:107], v[84:87], v[32:35], a[104:107]
    ds_read_b128 v[92:95], v21 offset:0
    v_mfma_f32_16x16x32_bf16 a[108:111], v[88:91], v[32:35], a[108:111]
    ds_read_b128 v[96:99], v21 offset:2048
    s_waitcnt lgkmcnt(0) vmcnt(0)
    s_barrier
    v_mfma_f32_16x16x32_bf16 a[0:3], v[100:103], v[92:95], a[0:3]
    v_mfma_f32_16x16x32_bf16 a[4:7], v[104:107], v[92:95], a[4:7]
    ds_read_b128 v[36:39], v22 offset:0
    v_mfma_f32_16x16x32_bf16 a[8:11], v[108:111], v[92:95], a[8:11]
    ds_read_b128 v[40:43], v22 offset:2048
    v_mfma_f32_16x16x32_bf16 a[12:15], v[112:115], v[92:95], a[12:15]
    s_add_u32 m0, s71, 45056
    s_nop 0
    buffer_load_dwordx4 v16, s[4:7], s60 offen sc0 sc1 lds
    s_add_u32 s60, s60, 128
    v_mfma_f32_16x16x32_bf16 a[16:19], v[116:119], v[92:95], a[16:19]
    ds_read_b128 v[44:47], v22 offset:4096
    v_mfma_f32_16x16x32_bf16 a[20:23], v[120:123], v[92:95], a[20:23]
    s_add_u32 m0, s71, 49152
    s_nop 0
    buffer_load_dwordx4 v16, s[4:7], s61 offen sc0 sc1 lds
    s_add_u32 s61, s61, 128
    v_mfma_f32_16x16x32_bf16 a[24:27], v[124:127], v[92:95], a[24:27]
    ds_read_b128 v[48:51], v22 offset:6144
    v_mfma_f32_16x16x32_bf16 a[28:31], v[128:131], v[92:95], a[28:31]
    ds_read_b128 v[52:55], v22 offset:8192
    v_mfma_f32_16x16x32_bf16 a[32:35], v[132:135], v[92:95], a[32:35]
    s_add_u32 m0, s71, 53248
    s_nop 0
    buffer_load_dwordx4 v16, s[4:7], s62 offen sc0 sc1 lds
    s_add_u32 s62, s62, 128
    v_mfma_f32_16x16x32_bf16 a[36:39], v[136:139], v[92:95], a[36:39]
    ds_read_b128 v[56:59], v22 offset:10240
    v_mfma_f32_16x16x32_bf16 a[40:43], v[140:143], v[92:95], a[40:43]
    s_add_u32 m0, s71, 57344
    s_nop 0
    buffer_load_dwordx4 v16, s[4:7], s63 offen sc0 sc1 lds
    s_add_u32 s63, s63, 128
    v_mfma_f32_16x16x32_bf16 a[44:47], v[144:147], v[92:95], a[44:47]
    ds_read_b128 v[60:63], v22 offset:12288
    v_mfma_f32_16x16x32_bf16 a[48:51], v[148:151], v[92:95], a[48:51]
    ds_read_b128 v[64:67], v22 offset:14336
    v_mfma_f32_16x16x32_bf16 a[52:55], v[152:155], v[92:95], a[52:55]
    s_add_u32 m0, s71, 61440
    s_nop 0
    buffer_load_dwordx4 v17, s[4:7], s64 offen sc0 sc1 lds
    s_add_u32 s64, s64, 128
    v_mfma_f32_16x16x32_bf16 a[56:59], v[100:103], v[96:99], a[56:59]
    ds_read_b128 v[68:71], v22 offset:16384
    v_mfma_f32_16x16x32_bf16 a[60:63], v[104:107], v[96:99], a[60:63]
    s_add_u32 m0, s71, 65536
    s_nop 0
    buffer_load_dwordx4 v17, s[4:7], s65 offen sc0 sc1 lds
    s_add_u32 s65, s65, 128
    v_mfma_f32_16x16x32_bf16 a[64:67], v[108:111], v[96:99], a[64:67]
    ds_read_b128 v[72:75], v22 offset:18432
    v_mfma_f32_16x16x32_bf16 a[68:71], v[112:115], v[96:99], a[68:71]
    ds_read_b128 v[76:79], v22 offset:20480
    v_mfma_f32_16x16x32_bf16 a[72:75], v[116:119], v[96:99], a[72:75]
    s_add_u32 m0, s71, 69632
    s_nop 0
    buffer_load_dwordx4 v17, s[4:7], s66 offen sc0 sc1 lds
    s_add_u32 s66, s66, 128
    v_mfma_f32_16x16x32_bf16 a[76:79], v[120:123], v[96:99], a[76:79]
    ds_read_b128 v[80:83], v22 offset:22528
    v_mfma_f32_16x16x32_bf16 a[80:83], v[124:127], v[96:99], a[80:83]
    s_add_u32 m0, s71, 73728
    s_nop 0
    buffer_load_dwordx4 v17, s[4:7], s67 offen sc0 sc1 lds
    s_add_u32 s67, s67, 128
    v_mfma_f32_16x16x32_bf16 a[84:87], v[128:131], v[96:99], a[84:87]
    ds_read_b128 v[84:87], v22 offset:24576
    v_mfma_f32_16x16x32_bf16 a[88:91], v[132:135], v[96:99], a[88:91]
    ds_read_b128 v[88:91], v22 offset:26624
    v_mfma_f32_16x16x32_bf16 a[92:95], v[136:139], v[96:99], a[92:95]
    s_add_u32 m0, s71, 77824
    s_nop 0
    buffer_load_dwordx4 v17, s[4:7], s68 offen sc0 sc1 lds
    s_add_u32 s68, s68, 128
    v_mfma_f32_16x16x32_bf16 a[96:99], v[140:143], v[96:99], a[96:99]
    ds_read_b128 v[28:31], v18 offset:0
    v_mfma_f32_16x16x32_bf16 a[100:103], v[144:147], v[96:99], a[100:103]
    s_add_u32 m0, s71, 81920
    s_nop 0
    buffer_load_dwordx4 v17, s[4:7], s69 offen sc0 sc1 lds
    s_add_u32 s69, s69, 128
    v_mfma_f32_16x16x32_bf16 a[104:107], v[148:151], v[96:99], a[104:107]
    ds_read_b128 v[32:35], v18 offset:2048
    v_mfma_f32_16x16x32_bf16 a[108:111], v[152:155], v[96:99], a[108:111]
    s_add_u32 m0, s71, 86016
    s_nop 0
    buffer_load_dwordx4 v17, s[4:7], s70 offen sc0 sc1 lds
    s_add_u32 s70, s70, 128
    s_waitcnt lgkmcnt(0)
    v_mfma_f32_16x16x32_bf16 a[0:3], v[36:39], v[28:31], a[0:3]
    v_mfma_f32_16x16x32_bf16 a[4:7], v[40:43], v[28:31], a[4:7]
    ds_read_b128 v[100:103], v24 offset:0
    v_mfma_f32_16x16x32_bf16 a[8:11], v[44:47], v[28:31], a[8:11]
    v_mfma_f32_16x16x32_bf16 a[12:15], v[48:51], v[28:31], a[12:15]
    ds_read_b128 v[104:107], v24 offset:2048
    v_mfma_f32_16x16x32_bf16 a[16:19], v[52:55], v[28:31], a[16:19]
    v_mfma_f32_16x16x32_bf16 a[20:23], v[56:59], v[28:31], a[20:23]
    ds_read_b128 v[108:111], v24 offset:4096
    v_mfma_f32_16x16x32_bf16 a[24:27], v[60:63], v[28:31], a[24:27]
    ds_read_b128 v[112:115], v24 offset:6144
    v_mfma_f32_16x16x32_bf16 a[28:31], v[64:67], v[28:31], a[28:31]
    v_mfma_f32_16x16x32_bf16 a[32:35], v[68:71], v[28:31], a[32:35]
    ds_read_b128 v[116:119], v24 offset:8192
    v_mfma_f32_16x16x32_bf16 a[36:39], v[72:75], v[28:31], a[36:39]
    v_mfma_f32_16x16x32_bf16 a[40:43], v[76:79], v[28:31], a[40:43]
    ds_read_b128 v[120:123], v24 offset:10240
    v_mfma_f32_16x16x32_bf16 a[44:47], v[80:83], v[28:31], a[44:47]
    v_mfma_f32_16x16x32_bf16 a[48:51], v[84:87], v[28:31], a[48:51]
    ds_read_b128 v[124:127], v24 offset:12288
    v_mfma_f32_16x16x32_bf16 a[52:55], v[88:91], v[28:31], a[52:55]
    ds_read_b128 v[128:131], v24 offset:14336
    v_mfma_f32_16x16x32_bf16 a[56:59], v[36:39], v[32:35], a[56:59]
    v_mfma_f32_16x16x32_bf16 a[60:63], v[40:43], v[32:35], a[60:63]
    ds_read_b128 v[132:135], v24 offset:16384
    v_mfma_f32_16x16x32_bf16 a[64:67], v[44:47], v[32:35], a[64:67]
    v_mfma_f32_16x16x32_bf16 a[68:71], v[48:51], v[32:35], a[68:71]
    ds_read_b128 v[136:139], v24 offset:18432
    v_mfma_f32_16x16x32_bf16 a[72:75], v[52:55], v[32:35], a[72:75]
    v_mfma_f32_16x16x32_bf16 a[76:79], v[56:59], v[32:35], a[76:79]
    ds_read_b128 v[140:143], v24 offset:20480
    v_mfma_f32_16x16x32_bf16 a[80:83], v[60:63], v[32:35], a[80:83]
    ds_read_b128 v[144:147], v24 offset:22528
    v_mfma_f32_16x16x32_bf16 a[84:87], v[64:67], v[32:35], a[84:87]
    v_mfma_f32_16x16x32_bf16 a[88:91], v[68:71], v[32:35], a[88:91]
    ds_read_b128 v[148:151], v24 offset:24576
    v_mfma_f32_16x16x32_bf16 a[92:95], v[72:75], v[32:35], a[92:95]
    v_mfma_f32_16x16x32_bf16 a[96:99], v[76:79], v[32:35], a[96:99]
    ds_read_b128 v[152:155], v24 offset:26624
    v_mfma_f32_16x16x32_bf16 a[100:103], v[80:83], v[32:35], a[100:103]
    v_mfma_f32_16x16x32_bf16 a[104:107], v[84:87], v[32:35], a[104:107]
    ds_read_b128 v[92:95], v20 offset:0
    v_mfma_f32_16x16x32_bf16 a[108:111], v[88:91], v[32:35], a[108:111]
    ds_read_b128 v[96:99], v20 offset:2048
    s_waitcnt lgkmcnt(0) vmcnt(0)
    s_barrier
    v_mfma_f32_16x16x32_bf16 a[0:3], v[100:103], v[92:95], a[0:3]
    v_mfma_f32_16x16x32_bf16 a[4:7], v[104:107], v[92:95], a[4:7]
    ds_read_b128 v[36:39], v23 offset:0
    v_mfma_f32_16x16x32_bf16 a[8:11], v[108:111], v[92:95], a[8:11]
    ds_read_b128 v[40:43], v23 offset:2048
    v_mfma_f32_16x16x32_bf16 a[12:15], v[112:115], v[92:95], a[12:15]
    s_add_u32 m0, s71, 0
    s_nop 0
    buffer_load_dwordx4 v16, s[4:7], s60 offen sc0 sc1 lds
    s_add_u32 s60, s60, 128
    v_mfma_f32_16x16x32_bf16 a[16:19], v[116:119], v[92:95], a[16:19]
    ds_read_b128 v[44:47], v23 offset:4096
    v_mfma_f32_16x16x32_bf16 a[20:23], v[120:123], v[92:95], a[20:23]
    s_add_u32 m0, s71, 4096
    s_nop 0
    buffer_load_dwordx4 v16, s[4:7], s61 offen sc0 sc1 lds
    s_add_u32 s61, s61, 128
    v_mfma_f32_16x16x32_bf16 a[24:27], v[124:127], v[92:95], a[24:27]
    ds_read_b128 v[48:51], v23 offset:6144
    v_mfma_f32_16x16x32_bf16 a[28:31], v[128:131], v[92:95], a[28:31]
    ds_read_b128 v[52:55], v23 offset:8192
    v_mfma_f32_16x16x32_bf16 a[32:35], v[132:135], v[92:95], a[32:35]
    s_add_u32 m0, s71, 8192
    s_nop 0
    buffer_load_dwordx4 v16, s[4:7], s62 offen sc0 sc1 lds
    s_add_u32 s62, s62, 128
    v_mfma_f32_16x16x32_bf16 a[36:39], v[136:139], v[92:95], a[36:39]
    ds_read_b128 v[56:59], v23 offset:10240
    v_mfma_f32_16x16x32_bf16 a[40:43], v[140:143], v[92:95], a[40:43]
    s_add_u32 m0, s71, 12288
    s_nop 0
    buffer_load_dwordx4 v16, s[4:7], s63 offen sc0 sc1 lds
    s_add_u32 s63, s63, 128
    v_mfma_f32_16x16x32_bf16 a[44:47], v[144:147], v[92:95], a[44:47]
    ds_read_b128 v[60:63], v23 offset:12288
    v_mfma_f32_16x16x32_bf16 a[48:51], v[148:151], v[92:95], a[48:51]
    ds_read_b128 v[64:67], v23 offset:14336
    v_mfma_f32_16x16x32_bf16 a[52:55], v[152:155], v[92:95], a[52:55]
    s_add_u32 m0, s71, 16384
    s_nop 0
    buffer_load_dwordx4 v17, s[4:7], s64 offen sc0 sc1 lds
    s_add_u32 s64, s64, 128
    v_mfma_f32_16x16x32_bf16 a[56:59], v[100:103], v[96:99], a[56:59]
    ds_read_b128 v[68:71], v23 offset:16384
    v_mfma_f32_16x16x32_bf16 a[60:63], v[104:107], v[96:99], a[60:63]
    s_add_u32 m0, s71, 20480
    s_nop 0
    buffer_load_dwordx4 v17, s[4:7], s65 offen sc0 sc1 lds
    s_add_u32 s65, s65, 128
    v_mfma_f32_16x16x32_bf16 a[64:67], v[108:111], v[96:99], a[64:67]
    ds_read_b128 v[72:75], v23 offset:18432
    v_mfma_f32_16x16x32_bf16 a[68:71], v[112:115], v[96:99], a[68:71]
    ds_read_b128 v[76:79], v23 offset:20480
    v_mfma_f32_16x16x32_bf16 a[72:75], v[116:119], v[96:99], a[72:75]
    s_add_u32 m0, s71, 24576
    s_nop 0
    buffer_load_dwordx4 v17, s[4:7], s66 offen sc0 sc1 lds
    s_add_u32 s66, s66, 128
    v_mfma_f32_16x16x32_bf16 a[76:79], v[120:123], v[96:99], a[76:79]
    ds_read_b128 v[80:83], v23 offset:22528
    v_mfma_f32_16x16x32_bf16 a[80:83], v[124:127], v[96:99], a[80:83]
    s_add_u32 m0, s71, 28672
    s_nop 0
    buffer_load_dwordx4 v17, s[4:7], s67 offen sc0 sc1 lds
    s_add_u32 s67, s67, 128
    v_mfma_f32_16x16x32_bf16 a[84:87], v[128:131], v[96:99], a[84:87]
    ds_read_b128 v[84:87], v23 offset:24576
    v_mfma_f32_16x16x32_bf16 a[88:91], v[132:135], v[96:99], a[88:91]
    ds_read_b128 v[88:91], v23 offset:26624
    v_mfma_f32_16x16x32_bf16 a[92:95], v[136:139], v[96:99], a[92:95]
    s_add_u32 m0, s71, 32768
    s_nop 0
    buffer_load_dwordx4 v17, s[4:7], s68 offen sc0 sc1 lds
    s_add_u32 s68, s68, 128
    v_mfma_f32_16x16x32_bf16 a[96:99], v[140:143], v[96:99], a[96:99]
    ds_read_b128 v[28:31], v19 offset:0
    v_mfma_f32_16x16x32_bf16 a[100:103], v[144:147], v[96:99], a[100:103]
    s_add_u32 m0, s71, 36864
    s_nop 0
    buffer_load_dwordx4 v17, s[4:7], s69 offen sc0 sc1 lds
    s_add_u32 s69, s69, 128
    v_mfma_f32_16x16x32_bf16 a[104:107], v[148:151], v[96:99], a[104:107]
    ds_read_b128 v[32:35], v19 offset:2048
    v_mfma_f32_16x16x32_bf16 a[108:111], v[152:155], v[96:99], a[108:111]
    s_add_u32 m0, s71, 40960
    s_nop 0
    buffer_load_dwordx4 v17, s[4:7], s70 offen sc0 sc1 lds
    s_add_u32 s70, s70, 128
    s_waitcnt lgkmcnt(0)
    v_mfma_f32_16x16x32_bf16 a[0:3], v[36:39], v[28:31], a[0:3]
    v_mfma_f32_16x16x32_bf16 a[4:7], v[40:43], v[28:31], a[4:7]
    ds_read_b128 v[100:103], v25 offset:0
    v_mfma_f32_16x16x32_bf16 a[8:11], v[44:47], v[28:31], a[8:11]
    v_mfma_f32_16x16x32_bf16 a[12:15], v[48:51], v[28:31], a[12:15]
    ds_read_b128 v[104:107], v25 offset:2048
    v_mfma_f32_16x16x32_bf16 a[16:19], v[52:55], v[28:31], a[16:19]
    v_mfma_f32_16x16x32_bf16 a[20:23], v[56:59], v[28:31], a[20:23]
    ds_read_b128 v[108:111], v25 offset:4096
    v_mfma_f32_16x16x32_bf16 a[24:27], v[60:63], v[28:31], a[24:27]
    ds_read_b128 v[112:115], v25 offset:6144
    v_mfma_f32_16x16x32_bf16 a[28:31], v[64:67], v[28:31], a[28:31]
    v_mfma_f32_16x16x32_bf16 a[32:35], v[68:71], v[28:31], a[32:35]
    ds_read_b128 v[116:119], v25 offset:8192
    v_mfma_f32_16x16x32_bf16 a[36:39], v[72:75], v[28:31], a[36:39]
    v_mfma_f32_16x16x32_bf16 a[40:43], v[76:79], v[28:31], a[40:43]
    ds_read_b128 v[120:123], v25 offset:10240
    v_mfma_f32_16x16x32_bf16 a[44:47], v[80:83], v[28:31], a[44:47]
    v_mfma_f32_16x16x32_bf16 a[48:51], v[84:87], v[28:31], a[48:51]
    ds_read_b128 v[124:127], v25 offset:12288
    v_mfma_f32_16x16x32_bf16 a[52:55], v[88:91], v[28:31], a[52:55]
    ds_read_b128 v[128:131], v25 offset:14336
    v_mfma_f32_16x16x32_bf16 a[56:59], v[36:39], v[32:35], a[56:59]
    v_mfma_f32_16x16x32_bf16 a[60:63], v[40:43], v[32:35], a[60:63]
    ds_read_b128 v[132:135], v25 offset:16384
    v_mfma_f32_16x16x32_bf16 a[64:67], v[44:47], v[32:35], a[64:67]
    v_mfma_f32_16x16x32_bf16 a[68:71], v[48:51], v[32:35], a[68:71]
    ds_read_b128 v[136:139], v25 offset:18432
    v_mfma_f32_16x16x32_bf16 a[72:75], v[52:55], v[32:35], a[72:75]
    v_mfma_f32_16x16x32_bf16 a[76:79], v[56:59], v[32:35], a[76:79]
    ds_read_b128 v[140:143], v25 offset:20480
    v_mfma_f32_16x16x32_bf16 a[80:83], v[60:63], v[32:35], a[80:83]
    ds_read_b128 v[144:147], v25 offset:22528
    v_mfma_f32_16x16x32_bf16 a[84:87], v[64:67], v[32:35], a[84:87]
    v_mfma_f32_16x16x32_bf16 a[88:91], v[68:71], v[32:35], a[88:91]
    ds_read_b128 v[148:151], v25 offset:24576
    v_mfma_f32_16x16x32_bf16 a[92:95], v[72:75], v[32:35], a[92:95]
    v_mfma_f32_16x16x32_bf16 a[96:99], v[76:79], v[32:35], a[96:99]
    ds_read_b128 v[152:155], v25 offset:26624
    v_mfma_f32_16x16x32_bf16 a[100:103], v[80:83], v[32:35], a[100:103]
    v_mfma_f32_16x16x32_bf16 a[104:107], v[84:87], v[32:35], a[104:107]
    ds_read_b128 v[92:95], v21 offset:0
    v_mfma_f32_16x16x32_bf16 a[108:111], v[88:91], v[32:35], a[108:111]
    ds_read_b128 v[96:99], v21 offset:2048
    s_waitcnt lgkmcnt(0) vmcnt(0)
    s_barrier
    v_mfma_f32_16x16x32_bf16 a[0:3], v[100:103], v[92:95], a[0:3]
    v_mfma_f32_16x16x32_bf16 a[4:7], v[104:107], v[92:95], a[4:7]
    ds_read_b128 v[36:39], v22 offset:0
    v_mfma_f32_16x16x32_bf16 a[8:11], v[108:111], v[92:95], a[8:11]
    v_mfma_f32_16x16x32_bf16 a[12:15], v[112:115], v[92:95], a[12:15]
    ds_read_b128 v[40:43], v22 offset:2048
    v_mfma_f32_16x16x32_bf16 a[16:19], v[116:119], v[92:95], a[16:19]
    v_mfma_f32_16x16x32_bf16 a[20:23], v[120:123], v[92:95], a[20:23]
    ds_read_b128 v[44:47], v22 offset:4096
    v_mfma_f32_16x16x32_bf16 a[24:27], v[124:127], v[92:95], a[24:27]
    ds_read_b128 v[48:51], v22 offset:6144
    v_mfma_f32_16x16x32_bf16 a[28:31], v[128:131], v[92:95], a[28:31]
    v_mfma_f32_16x16x32_bf16 a[32:35], v[132:135], v[92:95], a[32:35]
    ds_read_b128 v[52:55], v22 offset:8192
    v_mfma_f32_16x16x32_bf16 a[36:39], v[136:139], v[92:95], a[36:39]
    v_mfma_f32_16x16x32_bf16 a[40:43], v[140:143], v[92:95], a[40:43]
    ds_read_b128 v[56:59], v22 offset:10240
    v_mfma_f32_16x16x32_bf16 a[44:47], v[144:147], v[92:95], a[44:47]
    v_mfma_f32_16x16x32_bf16 a[48:51], v[148:151], v[92:95], a[48:51]
    ds_read_b128 v[60:63], v22 offset:12288
    v_mfma_f32_16x16x32_bf16 a[52:55], v[152:155], v[92:95], a[52:55]
    ds_read_b128 v[64:67], v22 offset:14336
    v_mfma_f32_16x16x32_bf16 a[56:59], v[100:103], v[96:99], a[56:59]
    v_mfma_f32_16x16x32_bf16 a[60:63], v[104:107], v[96:99], a[60:63]
    ds_read_b128 v[68:71], v22 offset:16384
    v_mfma_f32_16x16x32_bf16 a[64:67], v[108:111], v[96:99], a[64:67]
    v_mfma_f32_16x16x32_bf16 a[68:71], v[112:115], v[96:99], a[68:71]
    ds_read_b128 v[72:75], v22 offset:18432
    v_mfma_f32_16x16x32_bf16 a[72:75], v[116:119], v[96:99], a[72:75]
    v_mfma_f32_16x16x32_bf16 a[76:79], v[120:123], v[96:99], a[76:79]
    ds_read_b128 v[76:79], v22 offset:20480
    v_mfma_f32_16x16x32_bf16 a[80:83], v[124:127], v[96:99], a[80:83]
    ds_read_b128 v[80:83], v22 offset:22528
    v_mfma_f32_16x16x32_bf16 a[84:87], v[128:131], v[96:99], a[84:87]
    v_mfma_f32_16x16x32_bf16 a[88:91], v[132:135], v[96:99], a[88:91]
    ds_read_b128 v[84:87], v22 offset:24576
    v_mfma_f32_16x16x32_bf16 a[92:95], v[136:139], v[96:99], a[92:95]
    v_mfma_f32_16x16x32_bf16 a[96:99], v[140:143], v[96:99], a[96:99]
    ds_read_b128 v[88:91], v22 offset:26624
    v_mfma_f32_16x16x32_bf16 a[100:103], v[144:147], v[96:99], a[100:103]
    v_mfma_f32_16x16x32_bf16 a[104:107], v[148:151], v[96:99], a[104:107]
    ds_read_b128 v[28:31], v18 offset:0
    v_mfma_f32_16x16x32_bf16 a[108:111], v[152:155], v[96:99], a[108:111]
    ds_read_b128 v[32:35], v18 offset:2048
    s_waitcnt lgkmcnt(0)
    v_mfma_f32_16x16x32_bf16 a[0:3], v[36:39], v[28:31], a[0:3]
    v_mfma_f32_16x16x32_bf16 a[4:7], v[40:43], v[28:31], a[4:7]
    ds_read_b128 v[100:103], v24 offset:0
    v_mfma_f32_16x16x32_bf16 a[8:11], v[44:47], v[28:31], a[8:11]
    v_mfma_f32_16x16x32_bf16 a[12:15], v[48:51], v[28:31], a[12:15]
    ds_read_b128 v[104:107], v24 offset:2048
    v_mfma_f32_16x16x32_bf16 a[16:19], v[52:55], v[28:31], a[16:19]
    v_mfma_f32_16x16x32_bf16 a[20:23], v[56:59], v[28:31], a[20:23]
    ds_read_b128 v[108:111], v24 offset:4096
    v_mfma_f32_16x16x32_bf16 a[24:27], v[60:63], v[28:31], a[24:27]
    ds_read_b128 v[112:115], v24 offset:6144
    v_mfma_f32_16x16x32_bf16 a[28:31], v[64:67], v[28:31], a[28:31]
    v_mfma_f32_16x16x32_bf16 a[32:35], v[68:71], v[28:31], a[32:35]
    ds_read_b128 v[116:119], v24 offset:8192
    v_mfma_f32_16x16x32_bf16 a[36:39], v[72:75], v[28:31], a[36:39]
    v_mfma_f32_16x16x32_bf16 a[40:43], v[76:79], v[28:31], a[40:43]
    ds_read_b128 v[120:123], v24 offset:10240
    v_mfma_f32_16x16x32_bf16 a[44:47], v[80:83], v[28:31], a[44:47]
    v_mfma_f32_16x16x32_bf16 a[48:51], v[84:87], v[28:31], a[48:51]
    ds_read_b128 v[124:127], v24 offset:12288
    v_mfma_f32_16x16x32_bf16 a[52:55], v[88:91], v[28:31], a[52:55]
    ds_read_b128 v[128:131], v24 offset:14336
    v_mfma_f32_16x16x32_bf16 a[56:59], v[36:39], v[32:35], a[56:59]
    v_mfma_f32_16x16x32_bf16 a[60:63], v[40:43], v[32:35], a[60:63]
    ds_read_b128 v[132:135], v24 offset:16384
    v_mfma_f32_16x16x32_bf16 a[64:67], v[44:47], v[32:35], a[64:67]
    v_mfma_f32_16x16x32_bf16 a[68:71], v[48:51], v[32:35], a[68:71]
    ds_read_b128 v[136:139], v24 offset:18432
    v_mfma_f32_16x16x32_bf16 a[72:75], v[52:55], v[32:35], a[72:75]
    v_mfma_f32_16x16x32_bf16 a[76:79], v[56:59], v[32:35], a[76:79]
    ds_read_b128 v[140:143], v24 offset:20480
    v_mfma_f32_16x16x32_bf16 a[80:83], v[60:63], v[32:35], a[80:83]
    ds_read_b128 v[144:147], v24 offset:22528
    v_mfma_f32_16x16x32_bf16 a[84:87], v[64:67], v[32:35], a[84:87]
    v_mfma_f32_16x16x32_bf16 a[88:91], v[68:71], v[32:35], a[88:91]
    ds_read_b128 v[148:151], v24 offset:24576
    v_mfma_f32_16x16x32_bf16 a[92:95], v[72:75], v[32:35], a[92:95]
    v_mfma_f32_16x16x32_bf16 a[96:99], v[76:79], v[32:35], a[96:99]
    ds_read_b128 v[152:155], v24 offset:26624
    v_mfma_f32_16x16x32_bf16 a[100:103], v[80:83], v[32:35], a[100:103]
    v_mfma_f32_16x16x32_bf16 a[104:107], v[84:87], v[32:35], a[104:107]
    ds_read_b128 v[92:95], v20 offset:0
    v_mfma_f32_16x16x32_bf16 a[108:111], v[88:91], v[32:35], a[108:111]
    ds_read_b128 v[96:99], v20 offset:2048
    s_waitcnt lgkmcnt(0)
    v_mfma_f32_16x16x32_bf16 a[0:3], v[100:103], v[92:95], a[0:3]
    v_mfma_f32_16x16x32_bf16 a[4:7], v[104:107], v[92:95], a[4:7]
    v_mfma_f32_16x16x32_bf16 a[8:11], v[108:111], v[92:95], a[8:11]
    v_mfma_f32_16x16x32_bf16 a[12:15], v[112:115], v[92:95], a[12:15]
    v_mfma_f32_16x16x32_bf16 a[16:19], v[116:119], v[92:95], a[16:19]
    v_mfma_f32_16x16x32_bf16 a[20:23], v[120:123], v[92:95], a[20:23]
    v_mfma_f32_16x16x32_bf16 a[24:27], v[124:127], v[92:95], a[24:27]
    v_mfma_f32_16x16x32_bf16 a[28:31], v[128:131], v[92:95], a[28:31]
    v_mfma_f32_16x16x32_bf16 a[32:35], v[132:135], v[92:95], a[32:35]
    v_mfma_f32_16x16x32_bf16 a[36:39], v[136:139], v[92:95], a[36:39]
    v_mfma_f32_16x16x32_bf16 a[40:43], v[140:143], v[92:95], a[40:43]
    v_mfma_f32_16x16x32_bf16 a[44:47], v[144:147], v[92:95], a[44:47]
    v_mfma_f32_16x16x32_bf16 a[48:51], v[148:151], v[92:95], a[48:51]
    v_mfma_f32_16x16x32_bf16 a[52:55], v[152:155], v[92:95], a[52:55]
    v_mfma_f32_16x16x32_bf16 a[56:59], v[100:103], v[96:99], a[56:59]
    v_mfma_f32_16x16x32_bf16 a[60:63], v[104:107], v[96:99], a[60:63]
    v_mfma_f32_16x16x32_bf16 a[64:67], v[108:111], v[96:99], a[64:67]
    v_mfma_f32_16x16x32_bf16 a[68:71], v[112:115], v[96:99], a[68:71]
    v_mfma_f32_16x16x32_bf16 a[72:75], v[116:119], v[96:99], a[72:75]
    v_mfma_f32_16x16x32_bf16 a[76:79], v[120:123], v[96:99], a[76:79]
    v_mfma_f32_16x16x32_bf16 a[80:83], v[124:127], v[96:99], a[80:83]
    v_mfma_f32_16x16x32_bf16 a[84:87], v[128:131], v[96:99], a[84:87]
    v_mfma_f32_16x16x32_bf16 a[88:91], v[132:135], v[96:99], a[88:91]
    v_mfma_f32_16x16x32_bf16 a[92:95], v[136:139], v[96:99], a[92:95]
    v_mfma_f32_16x16x32_bf16 a[96:99], v[140:143], v[96:99], a[96:99]
    v_mfma_f32_16x16x32_bf16 a[100:103], v[144:147], v[96:99], a[100:103]
    v_mfma_f32_16x16x32_bf16 a[104:107], v[148:151], v[96:99], a[104:107]
    v_mfma_f32_16x16x32_bf16 a[108:111], v[152:155], v[96:99], a[108:111]
    s_nop 7
    s_nop 7
    s_barrier
    v_mul_u32_u24 v12, 240, v3
    v_lshl_add_u32 v12, v4, 3, v12
    v_mul_u32_u24 v13, 7680, v2
    v_add_u32 v12, v12, v13
    v_accvgpr_read_b32 v28, a0
    v_accvgpr_read_b32 v32, a4
    v_accvgpr_read_b32 v29, a1
    v_accvgpr_read_b32 v33, a5
    v_accvgpr_read_b32 v30, a2
    v_accvgpr_read_b32 v34, a6
    v_accvgpr_read_b32 v31, a3
    v_accvgpr_read_b32 v35, a7
    v_cvt_pk_bf16_f32 v36, v28, v29
    v_cvt_pk_bf16_f32 v37, v30, v31
    v_cvt_pk_bf16_f32 v38, v32, v33
    v_cvt_pk_bf16_f32 v39, v34, v35
    v_lshlrev_b32 v28, 16, v36
    v_and_b32 v29, 0xffff0000, v36
    v_lshlrev_b32 v32, 16, v38
    v_and_b32 v33, 0xffff0000, v38
    v_lshlrev_b32 v30, 16, v37
    v_and_b32 v31, 0xffff0000, v37
    v_lshlrev_b32 v34, 16, v39
    v_and_b32 v35, 0xffff0000, v39
    v_mul_f32 v28, v28, v32
    v_mul_f32 v29, v29, v33
    v_mul_f32 v30, v30, v34
    v_mul_f32 v31, v31, v35
    v_cvt_pk_bf16_f32 v40, v28, v29
    v_cvt_pk_bf16_f32 v41, v30, v31
    ds_write_b64 v12, v[40:41] offset:0
    v_accvgpr_read_b32 v44, a8
    v_accvgpr_read_b32 v48, a12
    v_accvgpr_read_b32 v45, a9
    v_accvgpr_read_b32 v49, a13
    v_accvgpr_read_b32 v46, a10
    v_accvgpr_read_b32 v50, a14
    v_accvgpr_read_b32 v47, a11
    v_accvgpr_read_b32 v51, a15
    v_cvt_pk_bf16_f32 v52, v44, v45
    v_cvt_pk_bf16_f32 v53, v46, v47
    v_cvt_pk_bf16_f32 v54, v48, v49
    v_cvt_pk_bf16_f32 v55, v50, v51
    v_lshlrev_b32 v44, 16, v52
    v_and_b32 v45, 0xffff0000, v52
    v_lshlrev_b32 v48, 16, v54
    v_and_b32 v49, 0xffff0000, v54
    v_lshlrev_b32 v46, 16, v53
    v_and_b32 v47, 0xffff0000, v53
    v_lshlrev_b32 v50, 16, v55
    v_and_b32 v51, 0xffff0000, v55
    v_mul_f32 v44, v44, v48
    v_mul_f32 v45, v45, v49
    v_mul_f32 v46, v46, v50
    v_mul_f32 v47, v47, v51
    v_cvt_pk_bf16_f32 v56, v44, v45
    v_cvt_pk_bf16_f32 v57, v46, v47
    ds_write_b64 v12, v[56:57] offset:32
    v_accvgpr_read_b32 v60, a16
    v_accvgpr_read_b32 v64, a20
    v_accvgpr_read_b32 v61, a17
    v_accvgpr_read_b32 v65, a21
    v_accvgpr_read_b32 v62, a18
    v_accvgpr_read_b32 v66, a22
    v_accvgpr_read_b32 v63, a19
    v_accvgpr_read_b32 v67, a23
    v_cvt_pk_bf16_f32 v68, v60, v61
    v_cvt_pk_bf16_f32 v69, v62, v63
    v_cvt_pk_bf16_f32 v70, v64, v65
    v_cvt_pk_bf16_f32 v71, v66, v67
    v_lshlrev_b32 v60, 16, v68
    v_and_b32 v61, 0xffff0000, v68
    v_lshlrev_b32 v64, 16, v70
    v_and_b32 v65, 0xffff0000, v70
    v_lshlrev_b32 v62, 16, v69
    v_and_b32 v63, 0xffff0000, v69
    v_lshlrev_b32 v66, 16, v71
    v_and_b32 v67, 0xffff0000, v71
    v_mul_f32 v60, v60, v64
    v_mul_f32 v61, v61, v65
    v_mul_f32 v62, v62, v66
    v_mul_f32 v63, v63, v67
    v_cvt_pk_bf16_f32 v72, v60, v61
    v_cvt_pk_bf16_f32 v73, v62, v63
    ds_write_b64 v12, v[72:73] offset:64
    v_accvgpr_read_b32 v76, a24
    v_accvgpr_read_b32 v80, a28
    v_accvgpr_read_b32 v77, a25
    v_accvgpr_read_b32 v81, a29
    v_accvgpr_read_b32 v78, a26
    v_accvgpr_read_b32 v82, a30
    v_accvgpr_read_b32 v79, a27
    v_accvgpr_read_b32 v83, a31
    v_cvt_pk_bf16_f32 v84, v76, v77
    v_cvt_pk_bf16_f32 v85, v78, v79
    v_cvt_pk_bf16_f32 v86, v80, v81
    v_cvt_pk_bf16_f32 v87, v82, v83
    v_lshlrev_b32 v76, 16, v84
    v_and_b32 v77, 0xffff0000, v84
    v_lshlrev_b32 v80, 16, v86
    v_and_b32 v81, 0xffff0000, v86
    v_lshlrev_b32 v78, 16, v85
    v_and_b32 v79, 0xffff0000, v85
    v_lshlrev_b32 v82, 16, v87
    v_and_b32 v83, 0xffff0000, v87
    v_mul_f32 v76, v76, v80
    v_mul_f32 v77, v77, v81
    v_mul_f32 v78, v78, v82
    v_mul_f32 v79, v79, v83
    v_cvt_pk_bf16_f32 v88, v76, v77
    v_cvt_pk_bf16_f32 v89, v78, v79
    ds_write_b64 v12, v[88:89] offset:96
    v_accvgpr_read_b32 v28, a32
    v_accvgpr_read_b32 v32, a36
    v_accvgpr_read_b32 v29, a33
    v_accvgpr_read_b32 v33, a37
    v_accvgpr_read_b32 v30, a34
    v_accvgpr_read_b32 v34, a38
    v_accvgpr_read_b32 v31, a35
    v_accvgpr_read_b32 v35, a39
    v_cvt_pk_bf16_f32 v36, v28, v29
    v_cvt_pk_bf16_f32 v37, v30, v31
    v_cvt_pk_bf16_f32 v38, v32, v33
    v_cvt_pk_bf16_f32 v39, v34, v35
    v_lshlrev_b32 v28, 16, v36
    v_and_b32 v29, 0xffff0000, v36
    v_lshlrev_b32 v32, 16, v38
    v_and_b32 v33, 0xffff0000, v38
    v_lshlrev_b32 v30, 16, v37
    v_and_b32 v31, 0xffff0000, v37
    v_lshlrev_b32 v34, 16, v39
    v_and_b32 v35, 0xffff0000, v39
    v_mul_f32 v28, v28, v32
    v_mul_f32 v29, v29, v33
    v_mul_f32 v30, v30, v34
    v_mul_f32 v31, v31, v35
    v_cvt_pk_bf16_f32 v40, v28, v29
    v_cvt_pk_bf16_f32 v41, v30, v31
    ds_write_b64 v12, v[40:41] offset:128
    v_accvgpr_read_b32 v44, a40
    v_accvgpr_read_b32 v48, a44
    v_accvgpr_read_b32 v45, a41
    v_accvgpr_read_b32 v49, a45
    v_accvgpr_read_b32 v46, a42
    v_accvgpr_read_b32 v50, a46
    v_accvgpr_read_b32 v47, a43
    v_accvgpr_read_b32 v51, a47
    v_cvt_pk_bf16_f32 v52, v44, v45
    v_cvt_pk_bf16_f32 v53, v46, v47
    v_cvt_pk_bf16_f32 v54, v48, v49
    v_cvt_pk_bf16_f32 v55, v50, v51
    v_lshlrev_b32 v44, 16, v52
    v_and_b32 v45, 0xffff0000, v52
    v_lshlrev_b32 v48, 16, v54
    v_and_b32 v49, 0xffff0000, v54
    v_lshlrev_b32 v46, 16, v53
    v_and_b32 v47, 0xffff0000, v53
    v_lshlrev_b32 v50, 16, v55
    v_and_b32 v51, 0xffff0000, v55
    v_mul_f32 v44, v44, v48
    v_mul_f32 v45, v45, v49
    v_mul_f32 v46, v46, v50
    v_mul_f32 v47, v47, v51
    v_cvt_pk_bf16_f32 v56, v44, v45
    v_cvt_pk_bf16_f32 v57, v46, v47
    ds_write_b64 v12, v[56:57] offset:160
    v_accvgpr_read_b32 v60, a48
    v_accvgpr_read_b32 v64, a52
    v_accvgpr_read_b32 v61, a49
    v_accvgpr_read_b32 v65, a53
    v_accvgpr_read_b32 v62, a50
    v_accvgpr_read_b32 v66, a54
    v_accvgpr_read_b32 v63, a51
    v_accvgpr_read_b32 v67, a55
    v_cvt_pk_bf16_f32 v68, v60, v61
    v_cvt_pk_bf16_f32 v69, v62, v63
    v_cvt_pk_bf16_f32 v70, v64, v65
    v_cvt_pk_bf16_f32 v71, v66, v67
    v_lshlrev_b32 v60, 16, v68
    v_and_b32 v61, 0xffff0000, v68
    v_lshlrev_b32 v64, 16, v70
    v_and_b32 v65, 0xffff0000, v70
    v_lshlrev_b32 v62, 16, v69
    v_and_b32 v63, 0xffff0000, v69
    v_lshlrev_b32 v66, 16, v71
    v_and_b32 v67, 0xffff0000, v71
    v_mul_f32 v60, v60, v64
    v_mul_f32 v61, v61, v65
    v_mul_f32 v62, v62, v66
    v_mul_f32 v63, v63, v67
    v_cvt_pk_bf16_f32 v72, v60, v61
    v_cvt_pk_bf16_f32 v73, v62, v63
    ds_write_b64 v12, v[72:73] offset:192
    v_accvgpr_read_b32 v76, a56
    v_accvgpr_read_b32 v80, a60
    v_accvgpr_read_b32 v77, a57
    v_accvgpr_read_b32 v81, a61
    v_accvgpr_read_b32 v78, a58
    v_accvgpr_read_b32 v82, a62
    v_accvgpr_read_b32 v79, a59
    v_accvgpr_read_b32 v83, a63
    v_cvt_pk_bf16_f32 v84, v76, v77
    v_cvt_pk_bf16_f32 v85, v78, v79
    v_cvt_pk_bf16_f32 v86, v80, v81
    v_cvt_pk_bf16_f32 v87, v82, v83
    v_lshlrev_b32 v76, 16, v84
    v_and_b32 v77, 0xffff0000, v84
    v_lshlrev_b32 v80, 16, v86
    v_and_b32 v81, 0xffff0000, v86
    v_lshlrev_b32 v78, 16, v85
    v_and_b32 v79, 0xffff0000, v85
    v_lshlrev_b32 v82, 16, v87
    v_and_b32 v83, 0xffff0000, v87
    v_mul_f32 v76, v76, v80
    v_mul_f32 v77, v77, v81
    v_mul_f32 v78, v78, v82
    v_mul_f32 v79, v79, v83
    v_cvt_pk_bf16_f32 v88, v76, v77
    v_cvt_pk_bf16_f32 v89, v78, v79
    ds_write_b64 v12, v[88:89] offset:3840
    v_accvgpr_read_b32 v28, a64
    v_accvgpr_read_b32 v32, a68
    v_accvgpr_read_b32 v29, a65
    v_accvgpr_read_b32 v33, a69
    v_accvgpr_read_b32 v30, a66
    v_accvgpr_read_b32 v34, a70
    v_accvgpr_read_b32 v31, a67
    v_accvgpr_read_b32 v35, a71
    v_cvt_pk_bf16_f32 v36, v28, v29
    v_cvt_pk_bf16_f32 v37, v30, v31
    v_cvt_pk_bf16_f32 v38, v32, v33
    v_cvt_pk_bf16_f32 v39, v34, v35
    v_lshlrev_b32 v28, 16, v36
    v_and_b32 v29, 0xffff0000, v36
    v_lshlrev_b32 v32, 16, v38
    v_and_b32 v33, 0xffff0000, v38
    v_lshlrev_b32 v30, 16, v37
    v_and_b32 v31, 0xffff0000, v37
    v_lshlrev_b32 v34, 16, v39
    v_and_b32 v35, 0xffff0000, v39
    v_mul_f32 v28, v28, v32
    v_mul_f32 v29, v29, v33
    v_mul_f32 v30, v30, v34
    v_mul_f32 v31, v31, v35
    v_cvt_pk_bf16_f32 v40, v28, v29
    v_cvt_pk_bf16_f32 v41, v30, v31
    ds_write_b64 v12, v[40:41] offset:3872
    v_accvgpr_read_b32 v44, a72
    v_accvgpr_read_b32 v48, a76
    v_accvgpr_read_b32 v45, a73
    v_accvgpr_read_b32 v49, a77
    v_accvgpr_read_b32 v46, a74
    v_accvgpr_read_b32 v50, a78
    v_accvgpr_read_b32 v47, a75
    v_accvgpr_read_b32 v51, a79
    v_cvt_pk_bf16_f32 v52, v44, v45
    v_cvt_pk_bf16_f32 v53, v46, v47
    v_cvt_pk_bf16_f32 v54, v48, v49
    v_cvt_pk_bf16_f32 v55, v50, v51
    v_lshlrev_b32 v44, 16, v52
    v_and_b32 v45, 0xffff0000, v52
    v_lshlrev_b32 v48, 16, v54
    v_and_b32 v49, 0xffff0000, v54
    v_lshlrev_b32 v46, 16, v53
    v_and_b32 v47, 0xffff0000, v53
    v_lshlrev_b32 v50, 16, v55
    v_and_b32 v51, 0xffff0000, v55
    v_mul_f32 v44, v44, v48
    v_mul_f32 v45, v45, v49
    v_mul_f32 v46, v46, v50
    v_mul_f32 v47, v47, v51
    v_cvt_pk_bf16_f32 v56, v44, v45
    v_cvt_pk_bf16_f32 v57, v46, v47
    ds_write_b64 v12, v[56:57] offset:3904
    v_accvgpr_read_b32 v60, a80
    v_accvgpr_read_b32 v64, a84
    v_accvgpr_read_b32 v61, a81
    v_accvgpr_read_b32 v65, a85
    v_accvgpr_read_b32 v62, a82
    v_accvgpr_read_b32 v66, a86
    v_accvgpr_read_b32 v63, a83
    v_accvgpr_read_b32 v67, a87
    v_cvt_pk_bf16_f32 v68, v60, v61
    v_cvt_pk_bf16_f32 v69, v62, v63
    v_cvt_pk_bf16_f32 v70, v64, v65
    v_cvt_pk_bf16_f32 v71, v66, v67
    v_lshlrev_b32 v60, 16, v68
    v_and_b32 v61, 0xffff0000, v68
    v_lshlrev_b32 v64, 16, v70
    v_and_b32 v65, 0xffff0000, v70
    v_lshlrev_b32 v62, 16, v69
    v_and_b32 v63, 0xffff0000, v69
    v_lshlrev_b32 v66, 16, v71
    v_and_b32 v67, 0xffff0000, v71
    v_mul_f32 v60, v60, v64
    v_mul_f32 v61, v61, v65
    v_mul_f32 v62, v62, v66
    v_mul_f32 v63, v63, v67
    v_cvt_pk_bf16_f32 v72, v60, v61
    v_cvt_pk_bf16_f32 v73, v62, v63
    ds_write_b64 v12, v[72:73] offset:3936
    v_accvgpr_read_b32 v76, a88
    v_accvgpr_read_b32 v80, a92
    v_accvgpr_read_b32 v77, a89
    v_accvgpr_read_b32 v81, a93
    v_accvgpr_read_b32 v78, a90
    v_accvgpr_read_b32 v82, a94
    v_accvgpr_read_b32 v79, a91
    v_accvgpr_read_b32 v83, a95
    v_cvt_pk_bf16_f32 v84, v76, v77
    v_cvt_pk_bf16_f32 v85, v78, v79
    v_cvt_pk_bf16_f32 v86, v80, v81
    v_cvt_pk_bf16_f32 v87, v82, v83
    v_lshlrev_b32 v76, 16, v84
    v_and_b32 v77, 0xffff0000, v84
    v_lshlrev_b32 v80, 16, v86
    v_and_b32 v81, 0xffff0000, v86
    v_lshlrev_b32 v78, 16, v85
    v_and_b32 v79, 0xffff0000, v85
    v_lshlrev_b32 v82, 16, v87
    v_and_b32 v83, 0xffff0000, v87
    v_mul_f32 v76, v76, v80
    v_mul_f32 v77, v77, v81
    v_mul_f32 v78, v78, v82
    v_mul_f32 v79, v79, v83
    v_cvt_pk_bf16_f32 v88, v76, v77
    v_cvt_pk_bf16_f32 v89, v78, v79
    ds_write_b64 v12, v[88:89] offset:3968
    v_accvgpr_read_b32 v28, a96
    v_accvgpr_read_b32 v32, a100
    v_accvgpr_read_b32 v29, a97
    v_accvgpr_read_b32 v33, a101
    v_accvgpr_read_b32 v30, a98
    v_accvgpr_read_b32 v34, a102
    v_accvgpr_read_b32 v31, a99
    v_accvgpr_read_b32 v35, a103
    v_cvt_pk_bf16_f32 v36, v28, v29
    v_cvt_pk_bf16_f32 v37, v30, v31
    v_cvt_pk_bf16_f32 v38, v32, v33
    v_cvt_pk_bf16_f32 v39, v34, v35
    v_lshlrev_b32 v28, 16, v36
    v_and_b32 v29, 0xffff0000, v36
    v_lshlrev_b32 v32, 16, v38
    v_and_b32 v33, 0xffff0000, v38
    v_lshlrev_b32 v30, 16, v37
    v_and_b32 v31, 0xffff0000, v37
    v_lshlrev_b32 v34, 16, v39
    v_and_b32 v35, 0xffff0000, v39
    v_mul_f32 v28, v28, v32
    v_mul_f32 v29, v29, v33
    v_mul_f32 v30, v30, v34
    v_mul_f32 v31, v31, v35
    v_cvt_pk_bf16_f32 v40, v28, v29
    v_cvt_pk_bf16_f32 v41, v30, v31
    ds_write_b64 v12, v[40:41] offset:4000
    v_accvgpr_read_b32 v44, a104
    v_accvgpr_read_b32 v48, a108
    v_accvgpr_read_b32 v45, a105
    v_accvgpr_read_b32 v49, a109
    v_accvgpr_read_b32 v46, a106
    v_accvgpr_read_b32 v50, a110
    v_accvgpr_read_b32 v47, a107
    v_accvgpr_read_b32 v51, a111
    v_cvt_pk_bf16_f32 v52, v44, v45
    v_cvt_pk_bf16_f32 v53, v46, v47
    v_cvt_pk_bf16_f32 v54, v48, v49
    v_cvt_pk_bf16_f32 v55, v50, v51
    v_lshlrev_b32 v44, 16, v52
    v_and_b32 v45, 0xffff0000, v52
    v_lshlrev_b32 v48, 16, v54
    v_and_b32 v49, 0xffff0000, v54
    v_lshlrev_b32 v46, 16, v53
    v_and_b32 v47, 0xffff0000, v53
    v_lshlrev_b32 v50, 16, v55
    v_and_b32 v51, 0xffff0000, v55
    v_mul_f32 v44, v44, v48
    v_mul_f32 v45, v45, v49
    v_mul_f32 v46, v46, v50
    v_mul_f32 v47, v47, v51
    v_cvt_pk_bf16_f32 v56, v44, v45
    v_cvt_pk_bf16_f32 v57, v46, v47
    ds_write_b64 v12, v[56:57] offset:4032
    s_lshl_b32 s26, s21, 7
    v_lshlrev_b32 v10, 5, v8
    v_add_u32 v10, s26, v10
    v_mul_u32_u24 v10, 3584, v10
    s_mul_i32 s27, s20, 224
    v_add_u32 v10, s27, v10
    s_mov_b32 s28, 121634816
    v_mul_u32_u24 v5, 4682, v1
    v_lshrrev_b32 v5, 16, v5
    v_mul_u32_u24 v6, 14, v5
    v_sub_u32 v6, v1, v6
    v_mul_u32_u24 v7, 240, v5
    v_lshl_add_u32 v7, v6, 4, v7
    v_mul_u32_u24 v13, 7680, v2
    v_add_u32 v7, v7, v13
    v_mul_u32_u24 v5, 3584, v5
    v_lshl_add_u32 v5, v6, 4, v5
    v_add_u32 v5, v5, v10
    v_cmp_gt_u32 vcc, 56, v1
    s_waitcnt lgkmcnt(0)
    s_and_saveexec_b64 s[44:45], vcc
    ds_read_b128 v[28:31], v7 offset:0
    ds_read_b128 v[32:35], v7 offset:960
    ds_read_b128 v[36:39], v7 offset:1920
    ds_read_b128 v[40:43], v7 offset:2880
    ds_read_b128 v[44:47], v7 offset:3840
    ds_read_b128 v[48:51], v7 offset:4800
    ds_read_b128 v[52:55], v7 offset:5760
    ds_read_b128 v[56:59], v7 offset:6720
    s_waitcnt lgkmcnt(7)
    s_add_u32 s46, s28, 0
    buffer_store_dwordx4 v[28:31], v5, s[4:7], s46 offen sc0 sc1
    s_waitcnt lgkmcnt(6)
    s_add_u32 s46, s28, 14336
    buffer_store_dwordx4 v[32:35], v5, s[4:7], s46 offen sc0 sc1
    s_waitcnt lgkmcnt(5)
    s_add_u32 s46, s28, 28672
    buffer_store_dwordx4 v[36:39], v5, s[4:7], s46 offen sc0 sc1
    s_waitcnt lgkmcnt(4)
    s_add_u32 s46, s28, 43008
    buffer_store_dwordx4 v[40:43], v5, s[4:7], s46 offen sc0 sc1
    s_waitcnt lgkmcnt(3)
    s_add_u32 s46, s28, 57344
    buffer_store_dwordx4 v[44:47], v5, s[4:7], s46 offen sc0 sc1
    s_waitcnt lgkmcnt(2)
    s_add_u32 s46, s28, 71680
    buffer_store_dwordx4 v[48:51], v5, s[4:7], s46 offen sc0 sc1
    s_waitcnt lgkmcnt(1)
    s_add_u32 s46, s28, 86016
    buffer_store_dwordx4 v[52:55], v5, s[4:7], s46 offen sc0 sc1
    s_waitcnt lgkmcnt(0)
    s_add_u32 s46, s28, 100352
    buffer_store_dwordx4 v[56:59], v5, s[4:7], s46 offen sc0 sc1
    s_mov_b64 exec, s[44:45]
    s_add_u32 s22, s15, 224
    s_waitcnt vmcnt(0) lgkmcnt(0)
    s_barrier
    s_cmp_lg_u32 s14, 0
    s_cbranch_scc1 chain_kernel_sig18
    s_mov_b64 exec, 1
    v_mov_b32 v6, s22
    v_mov_b32 v5, 1
    buffer_atomic_add v5, v6, s[8:11], 0 offen sc1
    s_mov_b64 exec, -1
chain_kernel_sig18:
    s_cmp_ge_u32 s16, 28
    s_cbranch_scc1 chain_kernel_wnext
    v_mov_b32 v241, s22
chain_kernel_wc19:
    buffer_load_dword v240, v241, s[8:11], 0 offen sc0 sc1
    s_add_u32 s48, s48, 1
    s_cmp_gt_u32 s48, 0x400000
    s_cbranch_scc1 chain_kernel_end
    s_sleep 1
    s_waitcnt vmcnt(0)
    v_cmp_gt_u32 vcc, 32, v240
    s_cbranch_vccnz chain_kernel_wc19
    s_mov_b32 s21, 613566757
    s_mul_hi_u32 s21, s16, s21
    s_mul_i32 s20, s21, 7
    s_sub_u32 s20, s16, s20
    s_lshl_b32 s23, s17, 2
    s_add_u32 s21, s21, s23
    s_mul_i32 s24, s21, 229376
    s_add_u32 s24, s24, 121634816
    s_mul_i32 s25, s20, 229376
    s_add_u32 s25, s25, 10485760
    v_lshrrev_b32 v6, 3, v1
    v_and_b32 v5, 7, v1
    v_xor_b32 v5, v5, v6
    v_lshl_add_u32 v6, v2, 3, v6
    v_mul_u32_u24 v16, 3584, v6
    v_lshl_add_u32 v16, v5, 4, v16
    v_mul_u32_u24 v17, 3584, v6
    v_lshl_add_u32 v17, v5, 4, v17
    s_add_u32 s60, s24, 0
    s_add_u32 s61, s24, 114688
    s_add_u32 s62, s25, 0
    s_add_u32 s63, s25, 114688
    s_lshl_b32 s64, s14, 10
    v_and_b32 v7, 7, v3
    v_xor_b32 v7, v7, v4
    v_lshlrev_b32 v7, 4, v7
    v_lshl_add_u32 v7, v3, 7, v7
    v_lshrrev_b32 v8, 1, v2
    v_and_b32 v9, 1, v2
    v_mul_u32_u24 v10, 4096, v8
    v_mul_u32_u24 v11, 4096, v9
    v_add_u32 v10, v10, v7
    v_add_u32 v11, v11, v7
    v_add_u32 v11, 8192, v11
    v_mov_b32 v18, v10
    v_xor_b32 v26, 64, v10
    v_add_u32 v19, 16384, v18
    v_add_u32 v27, 16384, v26
    v_add_u32 v20, 32768, v18
    v_add_u32 v28, 32768, v26
    v_add_u32 v21, 49152, v18
    v_add_u32 v29, 49152, v26
    v_add_u32 v22, 65536, v18
    v_add_u32 v30, 65536, v26
    v_add_u32 v23, 81920, v18
    v_add_u32 v31, 81920, v26
    v_add_u32 v24, 98304, v18
    v_add_u32 v32, 98304, v26
    v_add_u32 v25, 114688, v18
    v_add_u32 v33, 114688, v26
    v_mov_b32 v34, v11
    v_xor_b32 v42, 64, v11
    v_add_u32 v35, 16384, v34
    v_add_u32 v43, 16384, v42
    v_add_u32 v36, 32768, v34
    v_add_u32 v44, 32768, v42
    v_add_u32 v37, 49152, v34
    v_add_u32 v45, 49152, v42
    v_add_u32 v38, 65536, v34
    v_add_u32 v46, 65536, v42
    v_add_u32 v39, 81920, v34
    v_add_u32 v47, 81920, v42
    v_add_u32 v40, 98304, v34
    v_add_u32 v48, 98304, v42
    v_add_u32 v41, 114688, v34
    v_add_u32 v49, 114688, v42
    s_add_u32 m0, s64, 0
    s_nop 0
    buffer_load_dwordx4 v16, s[4:7], s60 offen sc0 sc1 lds
    s_add_u32 s60, s60, 128
    s_add_u32 m0, s64, 4096
    s_nop 0
    buffer_load_dwordx4 v16, s[4:7], s61 offen sc0 sc1 lds
    s_add_u32 s61, s61, 128
    s_add_u32 m0, s64, 8192
    s_nop 0
    buffer_load_dwordx4 v17, s[4:7], s62 offen sc0 sc1 lds
    s_add_u32 s62, s62, 128
    s_add_u32 m0, s64, 12288
    s_nop 0
    buffer_load_dwordx4 v17, s[4:7], s63 offen sc0 sc1 lds
    s_add_u32 s63, s63, 128
    s_add_u32 m0, s64, 16384
    s_nop 0
    buffer_load_dwordx4 v16, s[4:7], s60 offen sc0 sc1 lds
    s_add_u32 s60, s60, 128
    s_add_u32 m0, s64, 20480
    s_nop 0
    buffer_load_dwordx4 v16, s[4:7], s61 offen sc0 sc1 lds
    s_add_u32 s61, s61, 128
    s_add_u32 m0, s64, 24576
    s_nop 0
    buffer_load_dwordx4 v17, s[4:7], s62 offen sc0 sc1 lds
    s_add_u32 s62, s62, 128
    s_add_u32 m0, s64, 28672
    s_nop 0
    buffer_load_dwordx4 v17, s[4:7], s63 offen sc0 sc1 lds
    s_add_u32 s63, s63, 128
    s_add_u32 m0, s64, 32768
    s_nop 0
    buffer_load_dwordx4 v16, s[4:7], s60 offen sc0 sc1 lds
    s_add_u32 s60, s60, 128
    s_add_u32 m0, s64, 36864
    s_nop 0
    buffer_load_dwordx4 v16, s[4:7], s61 offen sc0 sc1 lds
    s_add_u32 s61, s61, 128
    s_add_u32 m0, s64, 40960
    s_nop 0
    buffer_load_dwordx4 v17, s[4:7], s62 offen sc0 sc1 lds
    s_add_u32 s62, s62, 128
    s_add_u32 m0, s64, 45056
    s_nop 0
    buffer_load_dwordx4 v17, s[4:7], s63 offen sc0 sc1 lds
    s_add_u32 s63, s63, 128
    s_add_u32 m0, s64, 49152
    s_nop 0
    buffer_load_dwordx4 v16, s[4:7], s60 offen sc0 sc1 lds
    s_add_u32 s60, s60, 128
    s_add_u32 m0, s64, 53248
    s_nop 0
    buffer_load_dwordx4 v16, s[4:7], s61 offen sc0 sc1 lds
    s_add_u32 s61, s61, 128
    s_add_u32 m0, s64, 57344
    s_nop 0
    buffer_load_dwordx4 v17, s[4:7], s62 offen sc0 sc1 lds
    s_add_u32 s62, s62, 128
    s_add_u32 m0, s64, 61440
    s_nop 0
    buffer_load_dwordx4 v17, s[4:7], s63 offen sc0 sc1 lds
    s_add_u32 s63, s63, 128
    s_add_u32 m0, s64, 65536
    s_nop 0
    buffer_load_dwordx4 v16, s[4:7], s60 offen sc0 sc1 lds
    s_add_u32 s60, s60, 128
    s_add_u32 m0, s64, 69632
    s_nop 0
    buffer_load_dwordx4 v16, s[4:7], s61 offen sc0 sc1 lds
    s_add_u32 s61, s61, 128
    s_add_u32 m0, s64, 73728
    s_nop 0
    buffer_load_dwordx4 v17, s[4:7], s62 offen sc0 sc1 lds
    s_add_u32 s62, s62, 128
    s_add_u32 m0, s64, 77824
    s_nop 0
    buffer_load_dwordx4 v17, s[4:7], s63 offen sc0 sc1 lds
    s_add_u32 s63, s63, 128
    s_add_u32 m0, s64, 81920
    s_nop 0
    buffer_load_dwordx4 v16, s[4:7], s60 offen sc0 sc1 lds
    s_add_u32 s60, s60, 128
    s_add_u32 m0, s64, 86016
    s_nop 0
    buffer_load_dwordx4 v16, s[4:7], s61 offen sc0 sc1 lds
    s_add_u32 s61, s61, 128
    s_add_u32 m0, s64, 90112
    s_nop 0
    buffer_load_dwordx4 v17, s[4:7], s62 offen sc0 sc1 lds
    s_add_u32 s62, s62, 128
    s_add_u32 m0, s64, 94208
    s_nop 0
    buffer_load_dwordx4 v17, s[4:7], s63 offen sc0 sc1 lds
    s_add_u32 s63, s63, 128
    s_add_u32 m0, s64, 98304
    s_nop 0
    buffer_load_dwordx4 v16, s[4:7], s60 offen sc0 sc1 lds
    s_add_u32 s60, s60, 128
    s_add_u32 m0, s64, 102400
    s_nop 0
    buffer_load_dwordx4 v16, s[4:7], s61 offen sc0 sc1 lds
    s_add_u32 s61, s61, 128
    s_add_u32 m0, s64, 106496
    s_nop 0
    buffer_load_dwordx4 v17, s[4:7], s62 offen sc0 sc1 lds
    s_add_u32 s62, s62, 128
    s_add_u32 m0, s64, 110592
    s_nop 0
    buffer_load_dwordx4 v17, s[4:7], s63 offen sc0 sc1 lds
    s_add_u32 s63, s63, 128
    s_add_u32 m0, s64, 114688
    s_nop 0
    buffer_load_dwordx4 v16, s[4:7], s60 offen sc0 sc1 lds
    s_add_u32 s60, s60, 128
    s_add_u32 m0, s64, 118784
    s_nop 0
    buffer_load_dwordx4 v16, s[4:7], s61 offen sc0 sc1 lds
    s_add_u32 s61, s61, 128
    s_add_u32 m0, s64, 122880
    s_nop 0
    buffer_load_dwordx4 v17, s[4:7], s62 offen sc0 sc1 lds
    s_add_u32 s62, s62, 128
    s_add_u32 m0, s64, 126976
    s_nop 0
    buffer_load_dwordx4 v17, s[4:7], s63 offen sc0 sc1 lds
    s_add_u32 s63, s63, 128
    s_waitcnt vmcnt(28)
    s_barrier
    ds_read_b128 v[60:63], v34 offset:0
    ds_read_b128 v[64:67], v34 offset:2048
    ds_read_b128 v[52:55], v18 offset:0
    ds_read_b128 v[56:59], v18 offset:2048
    s_waitcnt lgkmcnt(0)
    v_mfma_f32_16x16x32_bf16 a[0:3], v[60:63], v[52:55], 0
    ds_read_b128 v[76:79], v42 offset:0
    v_mfma_f32_16x16x32_bf16 a[4:7], v[64:67], v[52:55], 0
    ds_read_b128 v[80:83], v42 offset:2048
    v_mfma_f32_16x16x32_bf16 a[8:11], v[60:63], v[56:59], 0
    ds_read_b128 v[68:71], v26 offset:0
    v_mfma_f32_16x16x32_bf16 a[12:15], v[64:67], v[56:59], 0
    ds_read_b128 v[72:75], v26 offset:2048
    s_waitcnt lgkmcnt(0) vmcnt(24)
    s_barrier
    v_mfma_f32_16x16x32_bf16 a[0:3], v[76:79], v[68:71], a[0:3]
    ds_read_b128 v[60:63], v35 offset:0
    s_add_u32 m0, s64, 0
    s_nop 0
    buffer_load_dwordx4 v16, s[4:7], s60 offen sc0 sc1 lds
    s_add_u32 s60, s60, 128
    v_mfma_f32_16x16x32_bf16 a[4:7], v[80:83], v[68:71], a[4:7]
    ds_read_b128 v[64:67], v35 offset:2048
    s_add_u32 m0, s64, 4096
    s_nop 0
    buffer_load_dwordx4 v16, s[4:7], s61 offen sc0 sc1 lds
    s_add_u32 s61, s61, 128
    v_mfma_f32_16x16x32_bf16 a[8:11], v[76:79], v[72:75], a[8:11]
    ds_read_b128 v[52:55], v19 offset:0
    s_add_u32 m0, s64, 8192
    s_nop 0
    buffer_load_dwordx4 v17, s[4:7], s62 offen sc0 sc1 lds
    s_add_u32 s62, s62, 128
    v_mfma_f32_16x16x32_bf16 a[12:15], v[80:83], v[72:75], a[12:15]
    ds_read_b128 v[56:59], v19 offset:2048
    s_add_u32 m0, s64, 12288
    s_nop 0
    buffer_load_dwordx4 v17, s[4:7], s63 offen sc0 sc1 lds
    s_add_u32 s63, s63, 128
    s_waitcnt lgkmcnt(0)
    v_mfma_f32_16x16x32_bf16 a[0:3], v[60:63], v[52:55], a[0:3]
    ds_read_b128 v[76:79], v43 offset:0
    v_mfma_f32_16x16x32_bf16 a[4:7], v[64:67], v[52:55], a[4:7]
    ds_read_b128 v[80:83], v43 offset:2048
    v_mfma_f32_16x16x32_bf16 a[8:11], v[60:63], v[56:59], a[8:11]
    ds_read_b128 v[68:71], v27 offset:0
    v_mfma_f32_16x16x32_bf16 a[12:15], v[64:67], v[56:59], a[12:15]
    ds_read_b128 v[72:75], v27 offset:2048
    s_waitcnt lgkmcnt(0) vmcnt(24)
    s_barrier
    v_mfma_f32_16x16x32_bf16 a[0:3], v[76:79], v[68:71], a[0:3]
    ds_read_b128 v[60:63], v36 offset:0
    s_add_u32 m0, s64, 16384
    s_nop 0
    buffer_load_dwordx4 v16, s[4:7], s60 offen sc0 sc1 lds
    s_add_u32 s60, s60, 128
    v_mfma_f32_16x16x32_bf16 a[4:7], v[80:83], v[68:71], a[4:7]
    ds_read_b128 v[64:67], v36 offset:2048
    s_add_u32 m0, s64, 20480
    s_nop 0
    buffer_load_dwordx4 v16, s[4:7], s61 offen sc0 sc1 lds
    s_add_u32 s61, s61, 128
    v_mfma_f32_16x16x32_bf16 a[8:11], v[76:79], v[72:75], a[8:11]
    ds_read_b128 v[52:55], v20 offset:0
    s_add_u32 m0, s64, 24576
    s_nop 0
    buffer_load_dwordx4 v17, s[4:7], s62 offen sc0 sc1 lds
    s_add_u32 s62, s62, 128
    v_mfma_f32_16x16x32_bf16 a[12:15], v[80:83], v[72:75], a[12:15]
    ds_read_b128 v[56:59], v20 offset:2048
    s_add_u32 m0, s64, 28672
    s_nop 0
    buffer_load_dwordx4 v17, s[4:7], s63 offen sc0 sc1 lds
    s_add_u32 s63, s63, 128
    s_waitcnt lgkmcnt(0)
    v_mfma_f32_16x16x32_bf16 a[0:3], v[60:63], v[52:55], a[0:3]
    ds_read_b128 v[76:79], v44 offset:0
    v_mfma_f32_16x16x32_bf16 a[4:7], v[64:67], v[52:55], a[4:7]
    ds_read_b128 v[80:83], v44 offset:2048
    v_mfma_f32_16x16x32_bf16 a[8:11], v[60:63], v[56:59], a[8:11]
    ds_read_b128 v[68:71], v28 offset:0
    v_mfma_f32_16x16x32_bf16 a[12:15], v[64:67], v[56:59], a[12:15]
    ds_read_b128 v[72:75], v28 offset:2048
    s_waitcnt lgkmcnt(0) vmcnt(24)
    s_barrier
    v_mfma_f32_16x16x32_bf16 a[0:3], v[76:79], v[68:71], a[0:3]
    ds_read_b128 v[60:63], v37 offset:0
    s_add_u32 m0, s64, 32768
    s_nop 0
    buffer_load_dwordx4 v16, s[4:7], s60 offen sc0 sc1 lds
    s_add_u32 s60, s60, 128
    v_mfma_f32_16x16x32_bf16 a[4:7], v[80:83], v[68:71], a[4:7]
    ds_read_b128 v[64:67], v37 offset:2048
    s_add_u32 m0, s64, 36864
    s_nop 0
    buffer_load_dwordx4 v16, s[4:7], s61 offen sc0 sc1 lds
    s_add_u32 s61, s61, 128
    v_mfma_f32_16x16x32_bf16 a[8:11], v[76:79], v[72:75], a[8:11]
    ds_read_b128 v[52:55], v21 offset:0
    s_add_u32 m0, s64, 40960
    s_nop 0
    buffer_load_dwordx4 v17, s[4:7], s62 offen sc0 sc1 lds
    s_add_u32 s62, s62, 128
    v_mfma_f32_16x16x32_bf16 a[12:15], v[80:83], v[72:75], a[12:15]
    ds_read_b128 v[56:59], v21 offset:2048
    s_add_u32 m0, s64, 45056
    s_nop 0
    buffer_load_dwordx4 v17, s[4:7], s63 offen sc0 sc1 lds
    s_add_u32 s63, s63, 128
    s_waitcnt lgkmcnt(0)
    v_mfma_f32_16x16x32_bf16 a[0:3], v[60:63], v[52:55], a[0:3]
    ds_read_b128 v[76:79], v45 offset:0
    v_mfma_f32_16x16x32_bf16 a[4:7], v[64:67], v[52:55], a[4:7]
    ds_read_b128 v[80:83], v45 offset:2048
    v_mfma_f32_16x16x32_bf16 a[8:11], v[60:63], v[56:59], a[8:11]
    ds_read_b128 v[68:71], v29 offset:0
    v_mfma_f32_16x16x32_bf16 a[12:15], v[64:67], v[56:59], a[12:15]
    ds_read_b128 v[72:75], v29 offset:2048
    s_waitcnt lgkmcnt(0) vmcnt(24)
    s_barrier
    v_mfma_f32_16x16x32_bf16 a[0:3], v[76:79], v[68:71], a[0:3]
    ds_read_b128 v[60:63], v38 offset:0
    s_add_u32 m0, s64, 49152
    s_nop 0
    buffer_load_dwordx4 v16, s[4:7], s60 offen sc0 sc1 lds
    s_add_u32 s60, s60, 128
    v_mfma_f32_16x16x32_bf16 a[4:7], v[80:83], v[68:71], a[4:7]
    ds_read_b128 v[64:67], v38 offset:2048
    s_add_u32 m0, s64, 53248
    s_nop 0
    buffer_load_dwordx4 v16, s[4:7], s61 offen sc0 sc1 lds
    s_add_u32 s61, s61, 128
    v_mfma_f32_16x16x32_bf16 a[8:11], v[76:79], v[72:75], a[8:11]
    ds_read_b128 v[52:55], v22 offset:0
    s_add_u32 m0, s64, 57344
    s_nop 0
    buffer_load_dwordx4 v17, s[4:7], s62 offen sc0 sc1 lds
    s_add_u32 s62, s62, 128
    v_mfma_f32_16x16x32_bf16 a[12:15], v[80:83], v[72:75], a[12:15]
    ds_read_b128 v[56:59], v22 offset:2048
    s_add_u32 m0, s64, 61440
    s_nop 0
    buffer_load_dwordx4 v17, s[4:7], s63 offen sc0 sc1 lds
    s_add_u32 s63, s63, 128
    s_waitcnt lgkmcnt(0)
    v_mfma_f32_16x16x32_bf16 a[0:3], v[60:63], v[52:55], a[0:3]
    ds_read_b128 v[76:79], v46 offset:0
    v_mfma_f32_16x16x32_bf16 a[4:7], v[64:67], v[52:55], a[4:7]
    ds_read_b128 v[80:83], v46 offset:2048
    v_mfma_f32_16x16x32_bf16 a[8:11], v[60:63], v[56:59], a[8:11]
    ds_read_b128 v[68:71], v30 offset:0
    v_mfma_f32_16x16x32_bf16 a[12:15], v[64:67], v[56:59], a[12:15]
    ds_read_b128 v[72:75], v30 offset:2048
    s_waitcnt lgkmcnt(0) vmcnt(24)
    s_barrier
    v_mfma_f32_16x16x32_bf16 a[0:3], v[76:79], v[68:71], a[0:3]
    ds_read_b128 v[60:63], v39 offset:0
    s_add_u32 m0, s64, 65536
    s_nop 0
    buffer_load_dwordx4 v16, s[4:7], s60 offen sc0 sc1 lds
    s_add_u32 s60, s60, 128
    v_mfma_f32_16x16x32_bf16 a[4:7], v[80:83], v[68:71], a[4:7]
    ds_read_b128 v[64:67], v39 offset:2048
    s_add_u32 m0, s64, 69632
    s_nop 0
    buffer_load_dwordx4 v16, s[4:7], s61 offen sc0 sc1 lds
    s_add_u32 s61, s61, 128
    v_mfma_f32_16x16x32_bf16 a[8:11], v[76:79], v[72:75], a[8:11]
    ds_read_b128 v[52:55], v23 offset:0
    s_add_u32 m0, s64, 73728
    s_nop 0
    buffer_load_dwordx4 v17, s[4:7], s62 offen sc0 sc1 lds
    s_add_u32 s62, s62, 128
    v_mfma_f32_16x16x32_bf16 a[12:15], v[80:83], v[72:75], a[12:15]
    ds_read_b128 v[56:59], v23 offset:2048
    s_add_u32 m0, s64, 77824
    s_nop 0
    buffer_load_dwordx4 v17, s[4:7], s63 offen sc0 sc1 lds
    s_add_u32 s63, s63, 128
    s_waitcnt lgkmcnt(0)
    v_mfma_f32_16x16x32_bf16 a[0:3], v[60:63], v[52:55], a[0:3]
    ds_read_b128 v[76:79], v47 offset:0
    v_mfma_f32_16x16x32_bf16 a[4:7], v[64:67], v[52:55], a[4:7]
    ds_read_b128 v[80:83], v47 offset:2048
    v_mfma_f32_16x16x32_bf16 a[8:11], v[60:63], v[56:59], a[8:11]
    ds_read_b128 v[68:71], v31 offset:0
    v_mfma_f32_16x16x32_bf16 a[12:15], v[64:67], v[56:59], a[12:15]
    ds_read_b128 v[72:75], v31 offset:2048
    s_waitcnt lgkmcnt(0) vmcnt(24)
    s_barrier
    v_mfma_f32_16x16x32_bf16 a[0:3], v[76:79], v[68:71], a[0:3]
    ds_read_b128 v[60:63], v40 offset:0
    s_add_u32 m0, s64, 81920
    s_nop 0
    buffer_load_dwordx4 v16, s[4:7], s60 offen sc0 sc1 lds
    s_add_u32 s60, s60, 128
    v_mfma_f32_16x16x32_bf16 a[4:7], v[80:83], v[68:71], a[4:7]
    ds_read_b128 v[64:67], v40 offset:2048
    s_add_u32 m0, s64, 86016
    s_nop 0
    buffer_load_dwordx4 v16, s[4:7], s61 offen sc0 sc1 lds
    s_add_u32 s61, s61, 128
    v_mfma_f32_16x16x32_bf16 a[8:11], v[76:79], v[72:75], a[8:11]
    ds_read_b128 v[52:55], v24 offset:0
    s_add_u32 m0, s64, 90112
    s_nop 0
    buffer_load_dwordx4 v17, s[4:7], s62 offen sc0 sc1 lds
    s_add_u32 s62, s62, 128
    v_mfma_f32_16x16x32_bf16 a[12:15], v[80:83], v[72:75], a[12:15]
    ds_read_b128 v[56:59], v24 offset:2048
    s_add_u32 m0, s64, 94208
    s_nop 0
    buffer_load_dwordx4 v17, s[4:7], s63 offen sc0 sc1 lds
    s_add_u32 s63, s63, 128
    s_waitcnt lgkmcnt(0)
    v_mfma_f32_16x16x32_bf16 a[0:3], v[60:63], v[52:55], a[0:3]
    ds_read_b128 v[76:79], v48 offset:0
    v_mfma_f32_16x16x32_bf16 a[4:7], v[64:67], v[52:55], a[4:7]
    ds_read_b128 v[80:83], v48 offset:2048
    v_mfma_f32_16x16x32_bf16 a[8:11], v[60:63], v[56:59], a[8:11]
    ds_read_b128 v[68:71], v32 offset:0
    v_mfma_f32_16x16x32_bf16 a[12:15], v[64:67], v[56:59], a[12:15]
    ds_read_b128 v[72:75], v32 offset:2048
    s_waitcnt lgkmcnt(0) vmcnt(24)
    s_barrier
    v_mfma_f32_16x16x32_bf16 a[0:3], v[76:79], v[68:71], a[0:3]
    ds_read_b128 v[60:63], v41 offset:0
    s_add_u32 m0, s64, 98304
    s_nop 0
    buffer_load_dwordx4 v16, s[4:7], s60 offen sc0 sc1 lds
    s_add_u32 s60, s60, 128
    v_mfma_f32_16x16x32_bf16 a[4:7], v[80:83], v[68:71], a[4:7]
    ds_read_b128 v[64:67], v41 offset:2048
    s_add_u32 m0, s64, 102400
    s_nop 0
    buffer_load_dwordx4 v16, s[4:7], s61 offen sc0 sc1 lds
    s_add_u32 s61, s61, 128
    v_mfma_f32_16x16x32_bf16 a[8:11], v[76:79], v[72:75], a[8:11]
    ds_read_b128 v[52:55], v25 offset:0
    s_add_u32 m0, s64, 106496
    s_nop 0
    buffer_load_dwordx4 v17, s[4:7], s62 offen sc0 sc1 lds
    s_add_u32 s62, s62, 128
    v_mfma_f32_16x16x32_bf16 a[12:15], v[80:83], v[72:75], a[12:15]
    ds_read_b128 v[56:59], v25 offset:2048
    s_add_u32 m0, s64, 110592
    s_nop 0
    buffer_load_dwordx4 v17, s[4:7], s63 offen sc0 sc1 lds
    s_add_u32 s63, s63, 128
    s_waitcnt lgkmcnt(0)
    v_mfma_f32_16x16x32_bf16 a[0:3], v[60:63], v[52:55], a[0:3]
    ds_read_b128 v[76:79], v49 offset:0
    v_mfma_f32_16x16x32_bf16 a[4:7], v[64:67], v[52:55], a[4:7]
    ds_read_b128 v[80:83], v49 offset:2048
    v_mfma_f32_16x16x32_bf16 a[8:11], v[60:63], v[56:59], a[8:11]
    ds_read_b128 v[68:71], v33 offset:0
    v_mfma_f32_16x16x32_bf16 a[12:15], v[64:67], v[56:59], a[12:15]
    ds_read_b128 v[72:75], v33 offset:2048
    s_waitcnt lgkmcnt(0) vmcnt(24)
    s_barrier
    v_mfma_f32_16x16x32_bf16 a[0:3], v[76:79], v[68:71], a[0:3]
    ds_read_b128 v[60:63], v34 offset:0
    s_add_u32 m0, s64, 114688
    s_nop 0
    buffer_load_dwordx4 v16, s[4:7], s60 offen sc0 sc1 lds
    s_add_u32 s60, s60, 128
    v_mfma_f32_16x16x32_bf16 a[4:7], v[80:83], v[68:71], a[4:7]
    ds_read_b128 v[64:67], v34 offset:2048
    s_add_u32 m0, s64, 118784
    s_nop 0
    buffer_load_dwordx4 v16, s[4:7], s61 offen sc0 sc1 lds
    s_add_u32 s61, s61, 128
    v_mfma_f32_16x16x32_bf16 a[8:11], v[76:79], v[72:75], a[8:11]
    ds_read_b128 v[52:55], v18 offset:0
    s_add_u32 m0, s64, 122880
    s_nop 0
    buffer_load_dwordx4 v17, s[4:7], s62 offen sc0 sc1 lds
    s_add_u32 s62, s62, 128
    v_mfma_f32_16x16x32_bf16 a[12:15], v[80:83], v[72:75], a[12:15]
    ds_read_b128 v[56:59], v18 offset:2048
    s_add_u32 m0, s64, 126976
    s_nop 0
    buffer_load_dwordx4 v17, s[4:7], s63 offen sc0 sc1 lds
    s_add_u32 s63, s63, 128
    s_waitcnt lgkmcnt(0)
    v_mfma_f32_16x16x32_bf16 a[0:3], v[60:63], v[52:55], a[0:3]
    ds_read_b128 v[76:79], v42 offset:0
    v_mfma_f32_16x16x32_bf16 a[4:7], v[64:67], v[52:55], a[4:7]
    ds_read_b128 v[80:83], v42 offset:2048
    v_mfma_f32_16x16x32_bf16 a[8:11], v[60:63], v[56:59], a[8:11]
    ds_read_b128 v[68:71], v26 offset:0
    v_mfma_f32_16x16x32_bf16 a[12:15], v[64:67], v[56:59], a[12:15]
    ds_read_b128 v[72:75], v26 offset:2048
    s_waitcnt lgkmcnt(0) vmcnt(24)
    s_barrier
    v_mfma_f32_16x16x32_bf16 a[0:3], v[76:79], v[68:71], a[0:3]
    ds_read_b128 v[60:63], v35 offset:0
    s_add_u32 m0, s64, 0
    s_nop 0
    buffer_load_dwordx4 v16, s[4:7], s60 offen sc0 sc1 lds
    s_add_u32 s60, s60, 128
    v_mfma_f32_16x16x32_bf16 a[4:7], v[80:83], v[68:71], a[4:7]
    ds_read_b128 v[64:67], v35 offset:2048
    s_add_u32 m0, s64, 4096
    s_nop 0
    buffer_load_dwordx4 v16, s[4:7], s61 offen sc0 sc1 lds
    s_add_u32 s61, s61, 128
    v_mfma_f32_16x16x32_bf16 a[8:11], v[76:79], v[72:75], a[8:11]
    ds_read_b128 v[52:55], v19 offset:0
    s_add_u32 m0, s64, 8192
    s_nop 0
    buffer_load_dwordx4 v17, s[4:7], s62 offen sc0 sc1 lds
    s_add_u32 s62, s62, 128
    v_mfma_f32_16x16x32_bf16 a[12:15], v[80:83], v[72:75], a[12:15]
    ds_read_b128 v[56:59], v19 offset:2048
    s_add_u32 m0, s64, 12288
    s_nop 0
    buffer_load_dwordx4 v17, s[4:7], s63 offen sc0 sc1 lds
    s_add_u32 s63, s63, 128
    s_waitcnt lgkmcnt(0)
    v_mfma_f32_16x16x32_bf16 a[0:3], v[60:63], v[52:55], a[0:3]
    ds_read_b128 v[76:79], v43 offset:0
    v_mfma_f32_16x16x32_bf16 a[4:7], v[64:67], v[52:55], a[4:7]
    ds_read_b128 v[80:83], v43 offset:2048
    v_mfma_f32_16x16x32_bf16 a[8:11], v[60:63], v[56:59], a[8:11]
    ds_read_b128 v[68:71], v27 offset:0
    v_mfma_f32_16x16x32_bf16 a[12:15], v[64:67], v[56:59], a[12:15]
    ds_read_b128 v[72:75], v27 offset:2048
    s_waitcnt lgkmcnt(0) vmcnt(24)
    s_barrier
    v_mfma_f32_16x16x32_bf16 a[0:3], v[76:79], v[68:71], a[0:3]
    ds_read_b128 v[60:63], v36 offset:0
    s_add_u32 m0, s64, 16384
    s_nop 0
    buffer_load_dwordx4 v16, s[4:7], s60 offen sc0 sc1 lds
    s_add_u32 s60, s60, 128
    v_mfma_f32_16x16x32_bf16 a[4:7], v[80:83], v[68:71], a[4:7]
    ds_read_b128 v[64:67], v36 offset:2048
    s_add_u32 m0, s64, 20480
    s_nop 0
    buffer_load_dwordx4 v16, s[4:7], s61 offen sc0 sc1 lds
    s_add_u32 s61, s61, 128
    v_mfma_f32_16x16x32_bf16 a[8:11], v[76:79], v[72:75], a[8:11]
    ds_read_b128 v[52:55], v20 offset:0
    s_add_u32 m0, s64, 24576
    s_nop 0
    buffer_load_dwordx4 v17, s[4:7], s62 offen sc0 sc1 lds
    s_add_u32 s62, s62, 128
    v_mfma_f32_16x16x32_bf16 a[12:15], v[80:83], v[72:75], a[12:15]
    ds_read_b128 v[56:59], v20 offset:2048
    s_add_u32 m0, s64, 28672
    s_nop 0
    buffer_load_dwordx4 v17, s[4:7], s63 offen sc0 sc1 lds
    s_add_u32 s63, s63, 128
    s_waitcnt lgkmcnt(0)
    v_mfma_f32_16x16x32_bf16 a[0:3], v[60:63], v[52:55], a[0:3]
    ds_read_b128 v[76:79], v44 offset:0
    v_mfma_f32_16x16x32_bf16 a[4:7], v[64:67], v[52:55], a[4:7]
    ds_read_b128 v[80:83], v44 offset:2048
    v_mfma_f32_16x16x32_bf16 a[8:11], v[60:63], v[56:59], a[8:11]
    ds_read_b128 v[68:71], v28 offset:0
    v_mfma_f32_16x16x32_bf16 a[12:15], v[64:67], v[56:59], a[12:15]
    ds_read_b128 v[72:75], v28 offset:2048
    s_waitcnt lgkmcnt(0) vmcnt(24)
    s_barrier
    v_mfma_f32_16x16x32_bf16 a[0:3], v[76:79], v[68:71], a[0:3]
    ds_read_b128 v[60:63], v37 offset:0
    s_add_u32 m0, s64, 32768
    s_nop 0
    buffer_load_dwordx4 v16, s[4:7], s60 offen sc0 sc1 lds
    s_add_u32 s60, s60, 128
    v_mfma_f32_16x16x32_bf16 a[4:7], v[80:83], v[68:71], a[4:7]
    ds_read_b128 v[64:67], v37 offset:2048
    s_add_u32 m0, s64, 36864
    s_nop 0
    buffer_load_dwordx4 v16, s[4:7], s61 offen sc0 sc1 lds
    s_add_u32 s61, s61, 128
    v_mfma_f32_16x16x32_bf16 a[8:11], v[76:79], v[72:75], a[8:11]
    ds_read_b128 v[52:55], v21 offset:0
    s_add_u32 m0, s64, 40960
    s_nop 0
    buffer_load_dwordx4 v17, s[4:7], s62 offen sc0 sc1 lds
    s_add_u32 s62, s62, 128
    v_mfma_f32_16x16x32_bf16 a[12:15], v[80:83], v[72:75], a[12:15]
    ds_read_b128 v[56:59], v21 offset:2048
    s_add_u32 m0, s64, 45056
    s_nop 0
    buffer_load_dwordx4 v17, s[4:7], s63 offen sc0 sc1 lds
    s_add_u32 s63, s63, 128
    s_waitcnt lgkmcnt(0)
    v_mfma_f32_16x16x32_bf16 a[0:3], v[60:63], v[52:55], a[0:3]
    ds_read_b128 v[76:79], v45 offset:0
    v_mfma_f32_16x16x32_bf16 a[4:7], v[64:67], v[52:55], a[4:7]
    ds_read_b128 v[80:83], v45 offset:2048
    v_mfma_f32_16x16x32_bf16 a[8:11], v[60:63], v[56:59], a[8:11]
    ds_read_b128 v[68:71], v29 offset:0
    v_mfma_f32_16x16x32_bf16 a[12:15], v[64:67], v[56:59], a[12:15]
    ds_read_b128 v[72:75], v29 offset:2048
    s_waitcnt lgkmcnt(0) vmcnt(24)
    s_barrier
    v_mfma_f32_16x16x32_bf16 a[0:3], v[76:79], v[68:71], a[0:3]
    ds_read_b128 v[60:63], v38 offset:0
    s_add_u32 m0, s64, 49152
    s_nop 0
    buffer_load_dwordx4 v16, s[4:7], s60 offen sc0 sc1 lds
    s_add_u32 s60, s60, 128
    v_mfma_f32_16x16x32_bf16 a[4:7], v[80:83], v[68:71], a[4:7]
    ds_read_b128 v[64:67], v38 offset:2048
    s_add_u32 m0, s64, 53248
    s_nop 0
    buffer_load_dwordx4 v16, s[4:7], s61 offen sc0 sc1 lds
    s_add_u32 s61, s61, 128
    v_mfma_f32_16x16x32_bf16 a[8:11], v[76:79], v[72:75], a[8:11]
    ds_read_b128 v[52:55], v22 offset:0
    s_add_u32 m0, s64, 57344
    s_nop 0
    buffer_load_dwordx4 v17, s[4:7], s62 offen sc0 sc1 lds
    s_add_u32 s62, s62, 128
    v_mfma_f32_16x16x32_bf16 a[12:15], v[80:83], v[72:75], a[12:15]
    ds_read_b128 v[56:59], v22 offset:2048
    s_add_u32 m0, s64, 61440
    s_nop 0
    buffer_load_dwordx4 v17, s[4:7], s63 offen sc0 sc1 lds
    s_add_u32 s63, s63, 128
    s_waitcnt lgkmcnt(0)
    v_mfma_f32_16x16x32_bf16 a[0:3], v[60:63], v[52:55], a[0:3]
    ds_read_b128 v[76:79], v46 offset:0
    v_mfma_f32_16x16x32_bf16 a[4:7], v[64:67], v[52:55], a[4:7]
    ds_read_b128 v[80:83], v46 offset:2048
    v_mfma_f32_16x16x32_bf16 a[8:11], v[60:63], v[56:59], a[8:11]
    ds_read_b128 v[68:71], v30 offset:0
    v_mfma_f32_16x16x32_bf16 a[12:15], v[64:67], v[56:59], a[12:15]
    ds_read_b128 v[72:75], v30 offset:2048
    s_waitcnt lgkmcnt(0) vmcnt(24)
    s_barrier
    v_mfma_f32_16x16x32_bf16 a[0:3], v[76:79], v[68:71], a[0:3]
    ds_read_b128 v[60:63], v39 offset:0
    s_add_u32 m0, s64, 65536
    s_nop 0
    buffer_load_dwordx4 v16, s[4:7], s60 offen sc0 sc1 lds
    s_add_u32 s60, s60, 128
    v_mfma_f32_16x16x32_bf16 a[4:7], v[80:83], v[68:71], a[4:7]
    ds_read_b128 v[64:67], v39 offset:2048
    s_add_u32 m0, s64, 69632
    s_nop 0
    buffer_load_dwordx4 v16, s[4:7], s61 offen sc0 sc1 lds
    s_add_u32 s61, s61, 128
    v_mfma_f32_16x16x32_bf16 a[8:11], v[76:79], v[72:75], a[8:11]
    ds_read_b128 v[52:55], v23 offset:0
    s_add_u32 m0, s64, 73728
    s_nop 0
    buffer_load_dwordx4 v17, s[4:7], s62 offen sc0 sc1 lds
    s_add_u32 s62, s62, 128
    v_mfma_f32_16x16x32_bf16 a[12:15], v[80:83], v[72:75], a[12:15]
    ds_read_b128 v[56:59], v23 offset:2048
    s_add_u32 m0, s64, 77824
    s_nop 0
    buffer_load_dwordx4 v17, s[4:7], s63 offen sc0 sc1 lds
    s_add_u32 s63, s63, 128
    s_waitcnt lgkmcnt(0)
    v_mfma_f32_16x16x32_bf16 a[0:3], v[60:63], v[52:55], a[0:3]
    ds_read_b128 v[76:79], v47 offset:0
    v_mfma_f32_16x16x32_bf16 a[4:7], v[64:67], v[52:55], a[4:7]
    ds_read_b128 v[80:83], v47 offset:2048
    v_mfma_f32_16x16x32_bf16 a[8:11], v[60:63], v[56:59], a[8:11]
    ds_read_b128 v[68:71], v31 offset:0
    v_mfma_f32_16x16x32_bf16 a[12:15], v[64:67], v[56:59], a[12:15]
    ds_read_b128 v[72:75], v31 offset:2048
    s_waitcnt lgkmcnt(0) vmcnt(24)
    s_barrier
    v_mfma_f32_16x16x32_bf16 a[0:3], v[76:79], v[68:71], a[0:3]
    ds_read_b128 v[60:63], v40 offset:0
    s_add_u32 m0, s64, 81920
    s_nop 0
    buffer_load_dwordx4 v16, s[4:7], s60 offen sc0 sc1 lds
    s_add_u32 s60, s60, 128
    v_mfma_f32_16x16x32_bf16 a[4:7], v[80:83], v[68:71], a[4:7]
    ds_read_b128 v[64:67], v40 offset:2048
    s_add_u32 m0, s64, 86016
    s_nop 0
    buffer_load_dwordx4 v16, s[4:7], s61 offen sc0 sc1 lds
    s_add_u32 s61, s61, 128
    v_mfma_f32_16x16x32_bf16 a[8:11], v[76:79], v[72:75], a[8:11]
    ds_read_b128 v[52:55], v24 offset:0
    s_add_u32 m0, s64, 90112
    s_nop 0
    buffer_load_dwordx4 v17, s[4:7], s62 offen sc0 sc1 lds
    s_add_u32 s62, s62, 128
    v_mfma_f32_16x16x32_bf16 a[12:15], v[80:83], v[72:75], a[12:15]
    ds_read_b128 v[56:59], v24 offset:2048
    s_add_u32 m0, s64, 94208
    s_nop 0
    buffer_load_dwordx4 v17, s[4:7], s63 offen sc0 sc1 lds
    s_add_u32 s63, s63, 128
    s_waitcnt lgkmcnt(0)
    v_mfma_f32_16x16x32_bf16 a[0:3], v[60:63], v[52:55], a[0:3]
    ds_read_b128 v[76:79], v48 offset:0
    v_mfma_f32_16x16x32_bf16 a[4:7], v[64:67], v[52:55], a[4:7]
    ds_read_b128 v[80:83], v48 offset:2048
    v_mfma_f32_16x16x32_bf16 a[8:11], v[60:63], v[56:59], a[8:11]
    ds_read_b128 v[68:71], v32 offset:0
    v_mfma_f32_16x16x32_bf16 a[12:15], v[64:67], v[56:59], a[12:15]
    ds_read_b128 v[72:75], v32 offset:2048
    s_waitcnt lgkmcnt(0) vmcnt(24)
    s_barrier
    v_mfma_f32_16x16x32_bf16 a[0:3], v[76:79], v[68:71], a[0:3]
    ds_read_b128 v[60:63], v41 offset:0
    s_add_u32 m0, s64, 98304
    s_nop 0
    buffer_load_dwordx4 v16, s[4:7], s60 offen sc0 sc1 lds
    s_add_u32 s60, s60, 128
    v_mfma_f32_16x16x32_bf16 a[4:7], v[80:83], v[68:71], a[4:7]
    ds_read_b128 v[64:67], v41 offset:2048
    s_add_u32 m0, s64, 102400
    s_nop 0
    buffer_load_dwordx4 v16, s[4:7], s61 offen sc0 sc1 lds
    s_add_u32 s61, s61, 128
    v_mfma_f32_16x16x32_bf16 a[8:11], v[76:79], v[72:75], a[8:11]
    ds_read_b128 v[52:55], v25 offset:0
    s_add_u32 m0, s64, 106496
    s_nop 0
    buffer_load_dwordx4 v17, s[4:7], s62 offen sc0 sc1 lds
    s_add_u32 s62, s62, 128
    v_mfma_f32_16x16x32_bf16 a[12:15], v[80:83], v[72:75], a[12:15]
    ds_read_b128 v[56:59], v25 offset:2048
    s_add_u32 m0, s64, 110592
    s_nop 0
    buffer_load_dwordx4 v17, s[4:7], s63 offen sc0 sc1 lds
    s_add_u32 s63, s63, 128
    s_waitcnt lgkmcnt(0)
    v_mfma_f32_16x16x32_bf16 a[0:3], v[60:63], v[52:55], a[0:3]
    ds_read_b128 v[76:79], v49 offset:0
    v_mfma_f32_16x16x32_bf16 a[4:7], v[64:67], v[52:55], a[4:7]
    ds_read_b128 v[80:83], v49 offset:2048
    v_mfma_f32_16x16x32_bf16 a[8:11], v[60:63], v[56:59], a[8:11]
    ds_read_b128 v[68:71], v33 offset:0
    v_mfma_f32_16x16x32_bf16 a[12:15], v[64:67], v[56:59], a[12:15]
    ds_read_b128 v[72:75], v33 offset:2048
    s_waitcnt lgkmcnt(0) vmcnt(24)
    s_barrier
    v_mfma_f32_16x16x32_bf16 a[0:3], v[76:79], v[68:71], a[0:3]
    ds_read_b128 v[60:63], v34 offset:0
    s_add_u32 m0, s64, 114688
    s_nop 0
    buffer_load_dwordx4 v16, s[4:7], s60 offen sc0 sc1 lds
    s_add_u32 s60, s60, 128
    v_mfma_f32_16x16x32_bf16 a[4:7], v[80:83], v[68:71], a[4:7]
    ds_read_b128 v[64:67], v34 offset:2048
    s_add_u32 m0, s64, 118784
    s_nop 0
    buffer_load_dwordx4 v16, s[4:7], s61 offen sc0 sc1 lds
    s_add_u32 s61, s61, 128
    v_mfma_f32_16x16x32_bf16 a[8:11], v[76:79], v[72:75], a[8:11]
    ds_read_b128 v[52:55], v18 offset:0
    s_add_u32 m0, s64, 122880
    s_nop 0
    buffer_load_dwordx4 v17, s[4:7], s62 offen sc0 sc1 lds
    s_add_u32 s62, s62, 128
    v_mfma_f32_16x16x32_bf16 a[12:15], v[80:83], v[72:75], a[12:15]
    ds_read_b128 v[56:59], v18 offset:2048
    s_add_u32 m0, s64, 126976
    s_nop 0
    buffer_load_dwordx4 v17, s[4:7], s63 offen sc0 sc1 lds
    s_add_u32 s63, s63, 128
    s_waitcnt lgkmcnt(0)
    v_mfma_f32_16x16x32_bf16 a[0:3], v[60:63], v[52:55], a[0:3]
    ds_read_b128 v[76:79], v42 offset:0
    v_mfma_f32_16x16x32_bf16 a[4:7], v[64:67], v[52:55], a[4:7]
    ds_read_b128 v[80:83], v42 offset:2048
    v_mfma_f32_16x16x32_bf16 a[8:11], v[60:63], v[56:59], a[8:11]
    ds_read_b128 v[68:71], v26 offset:0
    v_mfma_f32_16x16x32_bf16 a[12:15], v[64:67], v[56:59], a[12:15]
    ds_read_b128 v[72:75], v26 offset:2048
    s_waitcnt lgkmcnt(0) vmcnt(24)
    s_barrier
    v_mfma_f32_16x16x32_bf16 a[0:3], v[76:79], v[68:71], a[0:3]
    ds_read_b128 v[60:63], v35 offset:0
    s_add_u32 m0, s64, 0
    s_nop 0
    buffer_load_dwordx4 v16, s[4:7], s60 offen sc0 sc1 lds
    s_add_u32 s60, s60, 128
    v_mfma_f32_16x16x32_bf16 a[4:7], v[80:83], v[68:71], a[4:7]
    ds_read_b128 v[64:67], v35 offset:2048
    s_add_u32 m0, s64, 4096
    s_nop 0
    buffer_load_dwordx4 v16, s[4:7], s61 offen sc0 sc1 lds
    s_add_u32 s61, s61, 128
    v_mfma_f32_16x16x32_bf16 a[8:11], v[76:79], v[72:75], a[8:11]
    ds_read_b128 v[52:55], v19 offset:0
    s_add_u32 m0, s64, 8192
    s_nop 0
    buffer_load_dwordx4 v17, s[4:7], s62 offen sc0 sc1 lds
    s_add_u32 s62, s62, 128
    v_mfma_f32_16x16x32_bf16 a[12:15], v[80:83], v[72:75], a[12:15]
    ds_read_b128 v[56:59], v19 offset:2048
    s_add_u32 m0, s64, 12288
    s_nop 0
    buffer_load_dwordx4 v17, s[4:7], s63 offen sc0 sc1 lds
    s_add_u32 s63, s63, 128
    s_waitcnt lgkmcnt(0)
    v_mfma_f32_16x16x32_bf16 a[0:3], v[60:63], v[52:55], a[0:3]
    ds_read_b128 v[76:79], v43 offset:0
    v_mfma_f32_16x16x32_bf16 a[4:7], v[64:67], v[52:55], a[4:7]
    ds_read_b128 v[80:83], v43 offset:2048
    v_mfma_f32_16x16x32_bf16 a[8:11], v[60:63], v[56:59], a[8:11]
    ds_read_b128 v[68:71], v27 offset:0
    v_mfma_f32_16x16x32_bf16 a[12:15], v[64:67], v[56:59], a[12:15]
    ds_read_b128 v[72:75], v27 offset:2048
    s_waitcnt lgkmcnt(0) vmcnt(24)
    s_barrier
    v_mfma_f32_16x16x32_bf16 a[0:3], v[76:79], v[68:71], a[0:3]
    ds_read_b128 v[60:63], v36 offset:0
    s_add_u32 m0, s64, 16384
    s_nop 0
    buffer_load_dwordx4 v16, s[4:7], s60 offen sc0 sc1 lds
    s_add_u32 s60, s60, 128
    v_mfma_f32_16x16x32_bf16 a[4:7], v[80:83], v[68:71], a[4:7]
    ds_read_b128 v[64:67], v36 offset:2048
    s_add_u32 m0, s64, 20480
    s_nop 0
    buffer_load_dwordx4 v16, s[4:7], s61 offen sc0 sc1 lds
    s_add_u32 s61, s61, 128
    v_mfma_f32_16x16x32_bf16 a[8:11], v[76:79], v[72:75], a[8:11]
    ds_read_b128 v[52:55], v20 offset:0
    s_add_u32 m0, s64, 24576
    s_nop 0
    buffer_load_dwordx4 v17, s[4:7], s62 offen sc0 sc1 lds
    s_add_u32 s62, s62, 128
    v_mfma_f32_16x16x32_bf16 a[12:15], v[80:83], v[72:75], a[12:15]
    ds_read_b128 v[56:59], v20 offset:2048
    s_add_u32 m0, s64, 28672
    s_nop 0
    buffer_load_dwordx4 v17, s[4:7], s63 offen sc0 sc1 lds
    s_add_u32 s63, s63, 128
    s_waitcnt lgkmcnt(0)
    v_mfma_f32_16x16x32_bf16 a[0:3], v[60:63], v[52:55], a[0:3]
    ds_read_b128 v[76:79], v44 offset:0
    v_mfma_f32_16x16x32_bf16 a[4:7], v[64:67], v[52:55], a[4:7]
    ds_read_b128 v[80:83], v44 offset:2048
    v_mfma_f32_16x16x32_bf16 a[8:11], v[60:63], v[56:59], a[8:11]
    ds_read_b128 v[68:71], v28 offset:0
    v_mfma_f32_16x16x32_bf16 a[12:15], v[64:67], v[56:59], a[12:15]
    ds_read_b128 v[72:75], v28 offset:2048
    s_waitcnt lgkmcnt(0) vmcnt(24)
    s_barrier
    v_mfma_f32_16x16x32_bf16 a[0:3], v[76:79], v[68:71], a[0:3]
    ds_read_b128 v[60:63], v37 offset:0
    s_add_u32 m0, s64, 32768
    s_nop 0
    buffer_load_dwordx4 v16, s[4:7], s60 offen sc0 sc1 lds
    s_add_u32 s60, s60, 128
    v_mfma_f32_16x16x32_bf16 a[4:7], v[80:83], v[68:71], a[4:7]
    ds_read_b128 v[64:67], v37 offset:2048
    s_add_u32 m0, s64, 36864
    s_nop 0
    buffer_load_dwordx4 v16, s[4:7], s61 offen sc0 sc1 lds
    s_add_u32 s61, s61, 128
    v_mfma_f32_16x16x32_bf16 a[8:11], v[76:79], v[72:75], a[8:11]
    ds_read_b128 v[52:55], v21 offset:0
    s_add_u32 m0, s64, 40960
    s_nop 0
    buffer_load_dwordx4 v17, s[4:7], s62 offen sc0 sc1 lds
    s_add_u32 s62, s62, 128
    v_mfma_f32_16x16x32_bf16 a[12:15], v[80:83], v[72:75], a[12:15]
    ds_read_b128 v[56:59], v21 offset:2048
    s_add_u32 m0, s64, 45056
    s_nop 0
    buffer_load_dwordx4 v17, s[4:7], s63 offen sc0 sc1 lds
    s_add_u32 s63, s63, 128
    s_waitcnt lgkmcnt(0)
    v_mfma_f32_16x16x32_bf16 a[0:3], v[60:63], v[52:55], a[0:3]
    ds_read_b128 v[76:79], v45 offset:0
    v_mfma_f32_16x16x32_bf16 a[4:7], v[64:67], v[52:55], a[4:7]
    ds_read_b128 v[80:83], v45 offset:2048
    v_mfma_f32_16x16x32_bf16 a[8:11], v[60:63], v[56:59], a[8:11]
    ds_read_b128 v[68:71], v29 offset:0
    v_mfma_f32_16x16x32_bf16 a[12:15], v[64:67], v[56:59], a[12:15]
    ds_read_b128 v[72:75], v29 offset:2048
    s_waitcnt lgkmcnt(0) vmcnt(24)
    s_barrier
    v_mfma_f32_16x16x32_bf16 a[0:3], v[76:79], v[68:71], a[0:3]
    ds_read_b128 v[60:63], v38 offset:0
    s_add_u32 m0, s64, 49152
    s_nop 0
    buffer_load_dwordx4 v16, s[4:7], s60 offen sc0 sc1 lds
    s_add_u32 s60, s60, 128
    v_mfma_f32_16x16x32_bf16 a[4:7], v[80:83], v[68:71], a[4:7]
    ds_read_b128 v[64:67], v38 offset:2048
    s_add_u32 m0, s64, 53248
    s_nop 0
    buffer_load_dwordx4 v16, s[4:7], s61 offen sc0 sc1 lds
    s_add_u32 s61, s61, 128
    v_mfma_f32_16x16x32_bf16 a[8:11], v[76:79], v[72:75], a[8:11]
    ds_read_b128 v[52:55], v22 offset:0
    s_add_u32 m0, s64, 57344
    s_nop 0
    buffer_load_dwordx4 v17, s[4:7], s62 offen sc0 sc1 lds
    s_add_u32 s62, s62, 128
    v_mfma_f32_16x16x32_bf16 a[12:15], v[80:83], v[72:75], a[12:15]
    ds_read_b128 v[56:59], v22 offset:2048
    s_add_u32 m0, s64, 61440
    s_nop 0
    buffer_load_dwordx4 v17, s[4:7], s63 offen sc0 sc1 lds
    s_add_u32 s63, s63, 128
    s_waitcnt lgkmcnt(0)
    v_mfma_f32_16x16x32_bf16 a[0:3], v[60:63], v[52:55], a[0:3]
    ds_read_b128 v[76:79], v46 offset:0
    v_mfma_f32_16x16x32_bf16 a[4:7], v[64:67], v[52:55], a[4:7]
    ds_read_b128 v[80:83], v46 offset:2048
    v_mfma_f32_16x16x32_bf16 a[8:11], v[60:63], v[56:59], a[8:11]
    ds_read_b128 v[68:71], v30 offset:0
    v_mfma_f32_16x16x32_bf16 a[12:15], v[64:67], v[56:59], a[12:15]
    ds_read_b128 v[72:75], v30 offset:2048
    s_waitcnt lgkmcnt(0) vmcnt(24)
    s_barrier
    v_mfma_f32_16x16x32_bf16 a[0:3], v[76:79], v[68:71], a[0:3]
    ds_read_b128 v[60:63], v39 offset:0
    v_mfma_f32_16x16x32_bf16 a[4:7], v[80:83], v[68:71], a[4:7]
    ds_read_b128 v[64:67], v39 offset:2048
    v_mfma_f32_16x16x32_bf16 a[8:11], v[76:79], v[72:75], a[8:11]
    ds_read_b128 v[52:55], v23 offset:0
    v_mfma_f32_16x16x32_bf16 a[12:15], v[80:83], v[72:75], a[12:15]
    ds_read_b128 v[56:59], v23 offset:2048
    s_waitcnt lgkmcnt(0)
    v_mfma_f32_16x16x32_bf16 a[0:3], v[60:63], v[52:55], a[0:3]
    ds_read_b128 v[76:79], v47 offset:0
    v_mfma_f32_16x16x32_bf16 a[4:7], v[64:67], v[52:55], a[4:7]
    ds_read_b128 v[80:83], v47 offset:2048
    v_mfma_f32_16x16x32_bf16 a[8:11], v[60:63], v[56:59], a[8:11]
    ds_read_b128 v[68:71], v31 offset:0
    v_mfma_f32_16x16x32_bf16 a[12:15], v[64:67], v[56:59], a[12:15]
    ds_read_b128 v[72:75], v31 offset:2048
    s_waitcnt lgkmcnt(0) vmcnt(20)
    s_barrier
    v_mfma_f32_16x16x32_bf16 a[0:3], v[76:79], v[68:71], a[0:3]
    ds_read_b128 v[60:63], v40 offset:0
    v_mfma_f32_16x16x32_bf16 a[4:7], v[80:83], v[68:71], a[4:7]
    ds_read_b128 v[64:67], v40 offset:2048
    v_mfma_f32_16x16x32_bf16 a[8:11], v[76:79], v[72:75], a[8:11]
    ds_read_b128 v[52:55], v24 offset:0
    v_mfma_f32_16x16x32_bf16 a[12:15], v[80:83], v[72:75], a[12:15]
    ds_read_b128 v[56:59], v24 offset:2048
    s_waitcnt lgkmcnt(0)
    v_mfma_f32_16x16x32_bf16 a[0:3], v[60:63], v[52:55], a[0:3]
    ds_read_b128 v[76:79], v48 offset:0
    v_mfma_f32_16x16x32_bf16 a[4:7], v[64:67], v[52:55], a[4:7]
    ds_read_b128 v[80:83], v48 offset:2048
    v_mfma_f32_16x16x32_bf16 a[8:11], v[60:63], v[56:59], a[8:11]
    ds_read_b128 v[68:71], v32 offset:0
    v_mfma_f32_16x16x32_bf16 a[12:15], v[64:67], v[56:59], a[12:15]
    ds_read_b128 v[72:75], v32 offset:2048
    s_waitcnt lgkmcnt(0) vmcnt(16)
    s_barrier
    v_mfma_f32_16x16x32_bf16 a[0:3], v[76:79], v[68:71], a[0:3]
    ds_read_b128 v[60:63], v41 offset:0
    v_mfma_f32_16x16x32_bf16 a[4:7], v[80:83], v[68:71], a[4:7]
    ds_read_b128 v[64:67], v41 offset:2048
    v_mfma_f32_16x16x32_bf16 a[8:11], v[76:79], v[72:75], a[8:11]
    ds_read_b128 v[52:55], v25 offset:0
    v_mfma_f32_16x16x32_bf16 a[12:15], v[80:83], v[72:75], a[12:15]
    ds_read_b128 v[56:59], v25 offset:2048
    s_waitcnt lgkmcnt(0)
    v_mfma_f32_16x16x32_bf16 a[0:3], v[60:63], v[52:55], a[0:3]
    ds_read_b128 v[76:79], v49 offset:0
    v_mfma_f32_16x16x32_bf16 a[4:7], v[64:67], v[52:55], a[4:7]
    ds_read_b128 v[80:83], v49 offset:2048
    v_mfma_f32_16x16x32_bf16 a[8:11], v[60:63], v[56:59], a[8:11]
    ds_read_b128 v[68:71], v33 offset:0
    v_mfma_f32_16x16x32_bf16 a[12:15], v[64:67], v[56:59], a[12:15]
    ds_read_b128 v[72:75], v33 offset:2048
    s_waitcnt lgkmcnt(0) vmcnt(12)
    s_barrier
    v_mfma_f32_16x16x32_bf16 a[0:3], v[76:79], v[68:71], a[0:3]
    ds_read_b128 v[60:63], v34 offset:0
    v_mfma_f32_16x16x32_bf16 a[4:7], v[80:83], v[68:71], a[4:7]
    ds_read_b128 v[64:67], v34 offset:2048
    v_mfma_f32_16x16x32_bf16 a[8:11], v[76:79], v[72:75], a[8:11]
    ds_read_b128 v[52:55], v18 offset:0
    v_mfma_f32_16x16x32_bf16 a[12:15], v[80:83], v[72:75], a[12:15]
    ds_read_b128 v[56:59], v18 offset:2048
    s_waitcnt lgkmcnt(0)
    v_mfma_f32_16x16x32_bf16 a[0:3], v[60:63], v[52:55], a[0:3]
    ds_read_b128 v[76:79], v42 offset:0
    v_mfma_f32_16x16x32_bf16 a[4:7], v[64:67], v[52:55], a[4:7]
    ds_read_b128 v[80:83], v42 offset:2048
    v_mfma_f32_16x16x32_bf16 a[8:11], v[60:63], v[56:59], a[8:11]
    ds_read_b128 v[68:71], v26 offset:0
    v_mfma_f32_16x16x32_bf16 a[12:15], v[64:67], v[56:59], a[12:15]
    ds_read_b128 v[72:75], v26 offset:2048
    s_waitcnt lgkmcnt(0) vmcnt(8)
    s_barrier
    v_mfma_f32_16x16x32_bf16 a[0:3], v[76:79], v[68:71], a[0:3]
    ds_read_b128 v[60:63], v35 offset:0
    v_mfma_f32_16x16x32_bf16 a[4:7], v[80:83], v[68:71], a[4:7]
    ds_read_b128 v[64:67], v35 offset:2048
    v_mfma_f32_16x16x32_bf16 a[8:11], v[76:79], v[72:75], a[8:11]
    ds_read_b128 v[52:55], v19 offset:0
    v_mfma_f32_16x16x32_bf16 a[12:15], v[80:83], v[72:75], a[12:15]
    ds_read_b128 v[56:59], v19 offset:2048
    s_waitcnt lgkmcnt(0)
    v_mfma_f32_16x16x32_bf16 a[0:3], v[60:63], v[52:55], a[0:3]
    ds_read_b128 v[76:79], v43 offset:0
    v_mfma_f32_16x16x32_bf16 a[4:7], v[64:67], v[52:55], a[4:7]
    ds_read_b128 v[80:83], v43 offset:2048
    v_mfma_f32_16x16x32_bf16 a[8:11], v[60:63], v[56:59], a[8:11]
    ds_read_b128 v[68:71], v27 offset:0
    v_mfma_f32_16x16x32_bf16 a[12:15], v[64:67], v[56:59], a[12:15]
    ds_read_b128 v[72:75], v27 offset:2048
    s_waitcnt lgkmcnt(0) vmcnt(4)
    s_barrier
    v_mfma_f32_16x16x32_bf16 a[0:3], v[76:79], v[68:71], a[0:3]
    ds_read_b128 v[60:63], v36 offset:0
    v_mfma_f32_16x16x32_bf16 a[4:7], v[80:83], v[68:71], a[4:7]
    ds_read_b128 v[64:67], v36 offset:2048
    v_mfma_f32_16x16x32_bf16 a[8:11], v[76:79], v[72:75], a[8:11]
    ds_read_b128 v[52:55], v20 offset:0
    v_mfma_f32_16x16x32_bf16 a[12:15], v[80:83], v[72:75], a[12:15]
    ds_read_b128 v[56:59], v20 offset:2048
    s_waitcnt lgkmcnt(0)
    v_mfma_f32_16x16x32_bf16 a[0:3], v[60:63], v[52:55], a[0:3]
    ds_read_b128 v[76:79], v44 offset:0
    v_mfma_f32_16x16x32_bf16 a[4:7], v[64:67], v[52:55], a[4:7]
    ds_read_b128 v[80:83], v44 offset:2048
    v_mfma_f32_16x16x32_bf16 a[8:11], v[60:63], v[56:59], a[8:11]
    ds_read_b128 v[68:71], v28 offset:0
    v_mfma_f32_16x16x32_bf16 a[12:15], v[64:67], v[56:59], a[12:15]
    ds_read_b128 v[72:75], v28 offset:2048
    s_waitcnt lgkmcnt(0) vmcnt(0)
    s_barrier
    v_mfma_f32_16x16x32_bf16 a[0:3], v[76:79], v[68:71], a[0:3]
    ds_read_b128 v[60:63], v37 offset:0
    v_mfma_f32_16x16x32_bf16 a[4:7], v[80:83], v[68:71], a[4:7]
    ds_read_b128 v[64:67], v37 offset:2048
    v_mfma_f32_16x16x32_bf16 a[8:11], v[76:79], v[72:75], a[8:11]
    ds_read_b128 v[52:55], v21 offset:0
    v_mfma_f32_16x16x32_bf16 a[12:15], v[80:83], v[72:75], a[12:15]
    ds_read_b128 v[56:59], v21 offset:2048
    s_waitcnt lgkmcnt(0)
    v_mfma_f32_16x16x32_bf16 a[0:3], v[60:63], v[52:55], a[0:3]
    ds_read_b128 v[76:79], v45 offset:0
    v_mfma_f32_16x16x32_bf16 a[4:7], v[64:67], v[52:55], a[4:7]
    ds_read_b128 v[80:83], v45 offset:2048
    v_mfma_f32_16x16x32_bf16 a[8:11], v[60:63], v[56:59], a[8:11]
    ds_read_b128 v[68:71], v29 offset:0
    v_mfma_f32_16x16x32_bf16 a[12:15], v[64:67], v[56:59], a[12:15]
    ds_read_b128 v[72:75], v29 offset:2048
    s_waitcnt lgkmcnt(0)
    v_mfma_f32_16x16x32_bf16 a[0:3], v[76:79], v[68:71], a[0:3]
    v_mfma_f32_16x16x32_bf16 a[4:7], v[80:83], v[68:71], a[4:7]
    v_mfma_f32_16x16x32_bf16 a[8:11], v[76:79], v[72:75], a[8:11]
    v_mfma_f32_16x16x32_bf16 a[12:15], v[80:83], v[72:75], a[12:15]
    s_nop 7
    s_nop 7
    s_barrier
    s_mul_i32 s26, s21, 64
    v_mul_u32_u24 v10, 32, v8
    v_add3_u32 v10, v10, v3, s26
    v_mul_u32_u24 v10, 896, v10
    s_mul_i32 s27, s20, 128
    v_lshl_add_u32 v10, v4, 3, v10
    v_mul_u32_u24 v11, 64, v9
    v_add3_u32 v10, v10, v11, s27
    s_mov_b32 s28, 117440512
    s_mov_b32 s29, 117454848
    s_mov_b32 s30, 0
    s_mov_b32 s31, 14336
    buffer_load_dwordx2 v[52:53], v10, s[4:7], s28 offen offset:0 sc0 sc1
    buffer_load_dwordx2 v[54:55], v10, s[4:7], s28 offen offset:32 sc0 sc1
    buffer_load_dwordx2 v[56:57], v10, s[4:7], s29 offen offset:0 sc0 sc1
    buffer_load_dwordx2 v[58:59], v10, s[4:7], s29 offen offset:32 sc0 sc1
    s_waitcnt vmcnt(0)
    v_accvgpr_read_b32 v60, a0
    v_accvgpr_read_b32 v61, a1
    v_accvgpr_read_b32 v62, a2
    v_accvgpr_read_b32 v63, a3
    v_cvt_pk_bf16_f32 v68, v60, v61
    v_cvt_pk_bf16_f32 v69, v62, v63
    v_lshlrev_b32 v60, 16, v68
    v_and_b32 v61, 0xffff0000, v68
    v_lshlrev_b32 v64, 16, v52
    v_and_b32 v65, 0xffff0000, v52
    v_lshlrev_b32 v62, 16, v69
    v_and_b32 v63, 0xffff0000, v69
    v_lshlrev_b32 v66, 16, v53
    v_and_b32 v67, 0xffff0000, v53
    v_add_f32 v60, v60, v64
    v_add_f32 v61, v61, v65
    v_add_f32 v62, v62, v66
    v_add_f32 v63, v63, v67
    v_cvt_pk_bf16_f32 v70, v60, v61
    v_cvt_pk_bf16_f32 v71, v62, v63
    buffer_store_dwordx2 v[70:71], v10, s[88:91], s30 offen offset:0
    v_accvgpr_read_b32 v72, a4
    v_accvgpr_read_b32 v73, a5
    v_accvgpr_read_b32 v74, a6
    v_accvgpr_read_b32 v75, a7
    v_cvt_pk_bf16_f32 v80, v72, v73
    v_cvt_pk_bf16_f32 v81, v74, v75
    v_lshlrev_b32 v72, 16, v80
    v_and_b32 v73, 0xffff0000, v80
    v_lshlrev_b32 v76, 16, v54
    v_and_b32 v77, 0xffff0000, v54
    v_lshlrev_b32 v74, 16, v81
    v_and_b32 v75, 0xffff0000, v81
    v_lshlrev_b32 v78, 16, v55
    v_and_b32 v79, 0xffff0000, v55
    v_add_f32 v72, v72, v76
    v_add_f32 v73, v73, v77
    v_add_f32 v74, v74, v78
    v_add_f32 v75, v75, v79
    v_cvt_pk_bf16_f32 v82, v72, v73
    v_cvt_pk_bf16_f32 v83, v74, v75
    buffer_store_dwordx2 v[82:83], v10, s[88:91], s30 offen offset:32
    v_accvgpr_read_b32 v60, a8
    v_accvgpr_read_b32 v61, a9
    v_accvgpr_read_b32 v62, a10
    v_accvgpr_read_b32 v63, a11
    v_cvt_pk_bf16_f32 v68, v60, v61
    v_cvt_pk_bf16_f32 v69, v62, v63
    v_lshlrev_b32 v60, 16, v68
    v_and_b32 v61, 0xffff0000, v68
    v_lshlrev_b32 v64, 16, v56
    v_and_b32 v65, 0xffff0000, v56
    v_lshlrev_b32 v62, 16, v69
    v_and_b32 v63, 0xffff0000, v69
    v_lshlrev_b32 v66, 16, v57
    v_and_b32 v67, 0xffff0000, v57
    v_add_f32 v60, v60, v64
    v_add_f32 v61, v61, v65
    v_add_f32 v62, v62, v66
    v_add_f32 v63, v63, v67
    v_cvt_pk_bf16_f32 v70, v60, v61
    v_cvt_pk_bf16_f32 v71, v62, v63
    buffer_store_dwordx2 v[70:71], v10, s[88:91], s31 offen offset:0
    v_accvgpr_read_b32 v72, a12
    v_accvgpr_read_b32 v73, a13
    v_accvgpr_read_b32 v74, a14
    v_accvgpr_read_b32 v75, a15
    v_cvt_pk_bf16_f32 v80, v72, v73
    v_cvt_pk_bf16_f32 v81, v74, v75
    v_lshlrev_b32 v72, 16, v80
    v_and_b32 v73, 0xffff0000, v80
    v_lshlrev_b32 v76, 16, v58
    v_and_b32 v77, 0xffff0000, v58
    v_lshlrev_b32 v74, 16, v81
    v_and_b32 v75, 0xffff0000, v81
    v_lshlrev_b32 v78, 16, v59
    v_and_b32 v79, 0xffff0000, v59
    v_add_f32 v72, v72, v76
    v_add_f32 v73, v73, v77
    v_add_f32 v74, v74, v78
    v_add_f32 v75, v75, v79
    v_cvt_pk_bf16_f32 v82, v72, v73
    v_cvt_pk_bf16_f32 v83, v74, v75
    buffer_store_dwordx2 v[82:83], v10, s[88:91], s31 offen offset:32
    s_waitcnt lgkmcnt(0)
    s_barrier
chain_kernel_wnext:
    s_cmp_lg_u32 s17, 0
    s_cbranch_scc1 chain_kernel_wpool
    s_mov_b32 s17, 7
    s_branch chain_kernel_wteam
chain_kernel_wpool:
    s_sub_u32 s16, s19, 32
    s_cmp_ge_u32 s16, 112
    s_cbranch_scc1 chain_kernel_end
    s_mov_b32 s17, 6
chain_kernel_wpool2:
    s_lshl_b32 s15, s17, 2
    s_add_u32 s22, s15, 192
    v_mov_b32 v241, s22
chain_kernel_wc20:
    buffer_load_dword v240, v241, s[8:11], 0 offen sc0 sc1
    s_add_u32 s48, s48, 1
    s_cmp_gt_u32 s48, 0x400000
    s_cbranch_scc1 chain_kernel_end
    s_sleep 1
    s_waitcnt vmcnt(0)
    v_cmp_gt_u32 vcc, 32, v240
    s_cbranch_vccnz chain_kernel_wc20
    s_mov_b32 s21, 76695845
    s_mul_hi_u32 s21, s16, s21
    s_mul_i32 s20, s21, 56
    s_sub_u32 s20, s16, s20
    s_lshl_b32 s23, s17, 1
    s_add_u32 s21, s21, s23
    s_mul_i32 s24, s21, 114688
    s_add_u32 s24, s24, 119537664
    s_mul_i32 s25, s20, 57344
    s_add_u32 s25, s25, 6291456
    v_lshrrev_b32 v6, 3, v1
    v_and_b32 v5, 7, v1
    v_xor_b32 v5, v5, v6
    v_lshl_add_u32 v6, v2, 3, v6
    v_mul_u32_u24 v16, 896, v6
    v_lshl_add_u32 v16, v5, 4, v16
    v_mul_u32_u24 v17, 896, v6
    v_lshl_add_u32 v17, v5, 4, v17
    s_add_u32 s60, s24, 0
    s_add_u32 s61, s24, 28672
    s_add_u32 s62, s24, 57344
    s_add_u32 s63, s24, 86016
    s_add_u32 s64, s25, 0
    s_add_u32 s65, s25, 28672
    s_lshl_b32 s66, s14, 10
    v_and_b32 v7, 7, v3
    v_xor_b32 v7, v7, v4
    v_lshlrev_b32 v7, 4, v7
    v_lshl_add_u32 v7, v3, 7, v7
    v_mov_b32 v8, v2
    v_mov_b32 v9, 0
    v_mul_u32_u24 v10, 4096, v8
    v_mul_u32_u24 v11, 8192, v9
    v_add_u32 v10, v10, v7
    v_add_u32 v11, v11, v7
    v_add_u32 v11, 16384, v11
    v_mov_b32 v18, v10
    v_xor_b32 v22, 64, v10
    v_add_u32 v19, 24576, v18
    v_add_u32 v23, 24576, v22
    v_add_u32 v20, 49152, v18
    v_add_u32 v24, 49152, v22
    v_add_u32 v21, 73728, v18
    v_add_u32 v25, 73728, v22
    v_mov_b32 v26, v11
    v_xor_b32 v30, 64, v11
    v_add_u32 v27, 24576, v26
    v_add_u32 v31, 24576, v30
    v_add_u32 v28, 49152, v26
    v_add_u32 v32, 49152, v30
    v_add_u32 v29, 73728, v26
    v_add_u32 v33, 73728, v30
    s_add_u32 m0, s66, 0
    s_nop 0
    buffer_load_dwordx4 v16, s[4:7], s60 offen sc0 sc1 lds
    s_add_u32 s60, s60, 128
    s_add_u32 m0, s66, 4096
    s_nop 0
    buffer_load_dwordx4 v16, s[4:7], s61 offen sc0 sc1 lds
    s_add_u32 s61, s61, 128
    s_add_u32 m0, s66, 8192
    s_nop 0
    buffer_load_dwordx4 v16, s[4:7], s62 offen sc0 sc1 lds
    s_add_u32 s62, s62, 128
    s_add_u32 m0, s66, 12288
    s_nop 0
    buffer_load_dwordx4 v16, s[4:7], s63 offen sc0 sc1 lds
    s_add_u32 s63, s63, 128
    s_add_u32 m0, s66, 16384
    s_nop 0
    buffer_load_dwordx4 v17, s[4:7], s64 offen sc0 sc1 lds
    s_add_u32 s64, s64, 128
    s_add_u32 m0, s66, 20480
    s_nop 0
    buffer_load_dwordx4 v17, s[4:7], s65 offen sc0 sc1 lds
    s_add_u32 s65, s65, 128
    s_add_u32 m0, s66, 24576
    s_nop 0
    buffer_load_dwordx4 v16, s[4:7], s60 offen sc0 sc1 lds
    s_add_u32 s60, s60, 128
    s_add_u32 m0, s66, 28672
    s_nop 0
    buffer_load_dwordx4 v16, s[4:7], s61 offen sc0 sc1 lds
    s_add_u32 s61, s61, 128
    s_add_u32 m0, s66, 32768
    s_nop 0
    buffer_load_dwordx4 v16, s[4:7], s62 offen sc0 sc1 lds
    s_add_u32 s62, s62, 128
    s_add_u32 m0, s66, 36864
    s_nop 0
    buffer_load_dwordx4 v16, s[4:7], s63 offen sc0 sc1 lds
    s_add_u32 s63, s63, 128
    s_add_u32 m0, s66, 40960
    s_nop 0
    buffer_load_dwordx4 v17, s[4:7], s64 offen sc0 sc1 lds
    s_add_u32 s64, s64, 128
    s_add_u32 m0, s66, 45056
    s_nop 0
    buffer_load_dwordx4 v17, s[4:7], s65 offen sc0 sc1 lds
    s_add_u32 s65, s65, 128
    s_add_u32 m0, s66, 49152
    s_nop 0
    buffer_load_dwordx4 v16, s[4:7], s60 offen sc0 sc1 lds
    s_add_u32 s60, s60, 128
    s_add_u32 m0, s66, 53248
    s_nop 0
    buffer_load_dwordx4 v16, s[4:7], s61 offen sc0 sc1 lds
    s_add_u32 s61, s61, 128
    s_add_u32 m0, s66, 57344
    s_nop 0
    buffer_load_dwordx4 v16, s[4:7], s62 offen sc0 sc1 lds
    s_add_u32 s62, s62, 128
    s_add_u32 m0, s66, 61440
    s_nop 0
    buffer_load_dwordx4 v16, s[4:7], s63 offen sc0 sc1 lds
    s_add_u32 s63, s63, 128
    s_add_u32 m0, s66, 65536
    s_nop 0
    buffer_load_dwordx4 v17, s[4:7], s64 offen sc0 sc1 lds
    s_add_u32 s64, s64, 128
    s_add_u32 m0, s66, 69632
    s_nop 0
    buffer_load_dwordx4 v17, s[4:7], s65 offen sc0 sc1 lds
    s_add_u32 s65, s65, 128
    s_add_u32 m0, s66, 73728
    s_nop 0
    buffer_load_dwordx4 v16, s[4:7], s60 offen sc0 sc1 lds
    s_add_u32 s60, s60, 128
    s_add_u32 m0, s66, 77824
    s_nop 0
    buffer_load_dwordx4 v16, s[4:7], s61 offen sc0 sc1 lds
    s_add_u32 s61, s61, 128
    s_add_u32 m0, s66, 81920
    s_nop 0
    buffer_load_dwordx4 v16, s[4:7], s62 offen sc0 sc1 lds
    s_add_u32 s62, s62, 128
    s_add_u32 m0, s66, 86016
    s_nop 0
    buffer_load_dwordx4 v16, s[4:7], s63 offen sc0 sc1 lds
    s_add_u32 s63, s63, 128
    s_add_u32 m0, s66, 90112
    s_nop 0
    buffer_load_dwordx4 v17, s[4:7], s64 offen sc0 sc1 lds
    s_add_u32 s64, s64, 128
    s_add_u32 m0, s66, 94208
    s_nop 0
    buffer_load_dwordx4 v17, s[4:7], s65 offen sc0 sc1 lds
    s_add_u32 s65, s65, 128
    s_waitcnt vmcnt(18)
    s_barrier
    ds_read_b128 v[44:47], v26 offset:0
    ds_read_b128 v[48:51], v26 offset:2048
    ds_read_b128 v[52:55], v26 offset:4096
    ds_read_b128 v[56:59], v26 offset:6144
    ds_read_b128 v[36:39], v18 offset:0
    ds_read_b128 v[40:43], v18 offset:2048
    s_waitcnt lgkmcnt(0)
    v_mfma_f32_16x16x32_bf16 a[0:3], v[44:47], v[36:39], 0
    v_mfma_f32_16x16x32_bf16 a[4:7], v[48:51], v[36:39], 0
    ds_read_b128 v[68:71], v30 offset:0
    v_mfma_f32_16x16x32_bf16 a[8:11], v[52:55], v[36:39], 0
    ds_read_b128 v[72:75], v30 offset:2048
    v_mfma_f32_16x16x32_bf16 a[12:15], v[56:59], v[36:39], 0
    ds_read_b128 v[76:79], v30 offset:4096
    v_mfma_f32_16x16x32_bf16 a[16:19], v[44:47], v[40:43], 0
    v_mfma_f32_16x16x32_bf16 a[20:23], v[48:51], v[40:43], 0
    ds_read_b128 v[80:83], v30 offset:6144
    v_mfma_f32_16x16x32_bf16 a[24:27], v[52:55], v[40:43], 0
    ds_read_b128 v[60:63], v22 offset:0
    v_mfma_f32_16x16x32_bf16 a[28:31], v[56:59], v[40:43], 0
    ds_read_b128 v[64:67], v22 offset:2048
    s_waitcnt lgkmcnt(0) vmcnt(12)
    s_barrier
    v_mfma_f32_16x16x32_bf16 a[0:3], v[68:71], v[60:63], a[0:3]
    ds_read_b128 v[44:47], v27 offset:0
    v_mfma_f32_16x16x32_bf16 a[4:7], v[72:75], v[60:63], a[4:7]
    s_add_u32 m0, s66, 0
    s_nop 0
    buffer_load_dwordx4 v16, s[4:7], s60 offen sc0 sc1 lds
    s_add_u32 s60, s60, 128
    ds_read_b128 v[48:51], v27 offset:2048
    v_mfma_f32_16x16x32_bf16 a[8:11], v[76:79], v[60:63], a[8:11]
    s_add_u32 m0, s66, 4096
    s_nop 0
    buffer_load_dwordx4 v16, s[4:7], s61 offen sc0 sc1 lds
    s_add_u32 s61, s61, 128
    v_mfma_f32_16x16x32_bf16 a[12:15], v[80:83], v[60:63], a[12:15]
    ds_read_b128 v[52:55], v27 offset:4096
    s_add_u32 m0, s66, 8192
    s_nop 0
    buffer_load_dwordx4 v16, s[4:7], s62 offen sc0 sc1 lds
    s_add_u32 s62, s62, 128
    v_mfma_f32_16x16x32_bf16 a[16:19], v[68:71], v[64:67], a[16:19]
    ds_read_b128 v[56:59], v27 offset:6144
    v_mfma_f32_16x16x32_bf16 a[20:23], v[72:75], v[64:67], a[20:23]
    s_add_u32 m0, s66, 12288
    s_nop 0
    buffer_load_dwordx4 v16, s[4:7], s63 offen sc0 sc1 lds
    s_add_u32 s63, s63, 128
    ds_read_b128 v[36:39], v19 offset:0
    v_mfma_f32_16x16x32_bf16 a[24:27], v[76:79], v[64:67], a[24:27]
    s_add_u32 m0, s66, 16384
    s_nop 0
    buffer_load_dwordx4 v17, s[4:7], s64 offen sc0 sc1 lds
    s_add_u32 s64, s64, 128
    v_mfma_f32_16x16x32_bf16 a[28:31], v[80:83], v[64:67], a[28:31]
    ds_read_b128 v[40:43], v19 offset:2048
    s_add_u32 m0, s66, 20480
    s_nop 0
    buffer_load_dwordx4 v17, s[4:7], s65 offen sc0 sc1 lds
    s_add_u32 s65, s65, 128
    s_waitcnt lgkmcnt(0)
    v_mfma_f32_16x16x32_bf16 a[0:3], v[44:47], v[36:39], a[0:3]
    v_mfma_f32_16x16x32_bf16 a[4:7], v[48:51], v[36:39], a[4:7]
    ds_read_b128 v[68:71], v31 offset:0
    v_mfma_f32_16x16x32_bf16 a[8:11], v[52:55], v[36:39], a[8:11]
    ds_read_b128 v[72:75], v31 offset:2048
    v_mfma_f32_16x16x32_bf16 a[12:15], v[56:59], v[36:39], a[12:15]
    ds_read_b128 v[76:79], v31 offset:4096
    v_mfma_f32_16x16x32_bf16 a[16:19], v[44:47], v[40:43], a[16:19]
    v_mfma_f32_16x16x32_bf16 a[20:23], v[48:51], v[40:43], a[20:23]
    ds_read_b128 v[80:83], v31 offset:6144
    v_mfma_f32_16x16x32_bf16 a[24:27], v[52:55], v[40:43], a[24:27]
    ds_read_b128 v[60:63], v23 offset:0
    v_mfma_f32_16x16x32_bf16 a[28:31], v[56:59], v[40:43], a[28:31]
    ds_read_b128 v[64:67], v23 offset:2048
    s_waitcnt lgkmcnt(0) vmcnt(12)
    s_barrier
    v_mfma_f32_16x16x32_bf16 a[0:3], v[68:71], v[60:63], a[0:3]
    ds_read_b128 v[44:47], v28 offset:0
    v_mfma_f32_16x16x32_bf16 a[4:7], v[72:75], v[60:63], a[4:7]
    s_add_u32 m0, s66, 24576
    s_nop 0
    buffer_load_dwordx4 v16, s[4:7], s60 offen sc0 sc1 lds
    s_add_u32 s60, s60, 128
    ds_read_b128 v[48:51], v28 offset:2048
    v_mfma_f32_16x16x32_bf16 a[8:11], v[76:79], v[60:63], a[8:11]
    s_add_u32 m0, s66, 28672
    s_nop 0
    buffer_load_dwordx4 v16, s[4:7], s61 offen sc0 sc1 lds
    s_add_u32 s61, s61, 128
    v_mfma_f32_16x16x32_bf16 a[12:15], v[80:83], v[60:63], a[12:15]
    ds_read_b128 v[52:55], v28 offset:4096
    s_add_u32 m0, s66, 32768
    s_nop 0
    buffer_load_dwordx4 v16, s[4:7], s62 offen sc0 sc1 lds
    s_add_u32 s62, s62, 128
    v_mfma_f32_16x16x32_bf16 a[16:19], v[68:71], v[64:67], a[16:19]
    ds_read_b128 v[56:59], v28 offset:6144
    v_mfma_f32_16x16x32_bf16 a[20:23], v[72:75], v[64:67], a[20:23]
    s_add_u32 m0, s66, 36864
    s_nop 0
    buffer_load_dwordx4 v16, s[4:7], s63 offen sc0 sc1 lds
    s_add_u32 s63, s63, 128
    ds_read_b128 v[36:39], v20 offset:0
    v_mfma_f32_16x16x32_bf16 a[24:27], v[76:79], v[64:67], a[24:27]
    s_add_u32 m0, s66, 40960
    s_nop 0
    buffer_load_dwordx4 v17, s[4:7], s64 offen sc0 sc1 lds
    s_add_u32 s64, s64, 128
    v_mfma_f32_16x16x32_bf16 a[28:31], v[80:83], v[64:67], a[28:31]
    ds_read_b128 v[40:43], v20 offset:2048
    s_add_u32 m0, s66, 45056
    s_nop 0
    buffer_load_dwordx4 v17, s[4:7], s65 offen sc0 sc1 lds
    s_add_u32 s65, s65, 128
    s_waitcnt lgkmcnt(0)
    v_mfma_f32_16x16x32_bf16 a[0:3], v[44:47], v[36:39], a[0:3]
    v_mfma_f32_16x16x32_bf16 a[4:7], v[48:51], v[36:39], a[4:7]
    ds_read_b128 v[68:71], v32 offset:0
    v_mfma_f32_16x16x32_bf16 a[8:11], v[52:55], v[36:39], a[8:11]
    ds_read_b128 v[72:75], v32 offset:2048
    v_mfma_f32_16x16x32_bf16 a[12:15], v[56:59], v[36:39], a[12:15]
    ds_read_b128 v[76:79], v32 offset:4096
    v_mfma_f32_16x16x32_bf16 a[16:19], v[44:47], v[40:43], a[16:19]
    v_mfma_f32_16x16x32_bf16 a[20:23], v[48:51], v[40:43], a[20:23]
    ds_read_b128 v[80:83], v32 offset:6144
    v_mfma_f32_16x16x32_bf16 a[24:27], v[52:55], v[40:43], a[24:27]
    ds_read_b128 v[60:63], v24 offset:0
    v_mfma_f32_16x16x32_bf16 a[28:31], v[56:59], v[40:43], a[28:31]
    ds_read_b128 v[64:67], v24 offset:2048
    s_waitcnt lgkmcnt(0) vmcnt(12)
    s_barrier
    v_mfma_f32_16x16x32_bf16 a[0:3], v[68:71], v[60:63], a[0:3]
    ds_read_b128 v[44:47], v29 offset:0
    v_mfma_f32_16x16x32_bf16 a[4:7], v[72:75], v[60:63], a[4:7]
    s_add_u32 m0, s66, 49152
    s_nop 0
    buffer_load_dwordx4 v16, s[4:7], s60 offen sc0 sc1 lds
    s_add_u32 s60, s60, 128
    ds_read_b128 v[48:51], v29 offset:2048
    v_mfma_f32_16x16x32_bf16 a[8:11], v[76:79], v[60:63], a[8:11]
    s_add_u32 m0, s66, 53248
    s_nop 0
    buffer_load_dwordx4 v16, s[4:7], s61 offen sc0 sc1 lds
    s_add_u32 s61, s61, 128
    v_mfma_f32_16x16x32_bf16 a[12:15], v[80:83], v[60:63], a[12:15]
    ds_read_b128 v[52:55], v29 offset:4096
    s_add_u32 m0, s66, 57344
    s_nop 0
    buffer_load_dwordx4 v16, s[4:7], s62 offen sc0 sc1 lds
    s_add_u32 s62, s62, 128
    v_mfma_f32_16x16x32_bf16 a[16:19], v[68:71], v[64:67], a[16:19]
    ds_read_b128 v[56:59], v29 offset:6144
    v_mfma_f32_16x16x32_bf16 a[20:23], v[72:75], v[64:67], a[20:23]
    s_add_u32 m0, s66, 61440
    s_nop 0
    buffer_load_dwordx4 v16, s[4:7], s63 offen sc0 sc1 lds
    s_add_u32 s63, s63, 128
    ds_read_b128 v[36:39], v21 offset:0
    v_mfma_f32_16x16x32_bf16 a[24:27], v[76:79], v[64:67], a[24:27]
    s_add_u32 m0, s66, 65536
    s_nop 0
    buffer_load_dwordx4 v17, s[4:7], s64 offen sc0 sc1 lds
    s_add_u32 s64, s64, 128
    v_mfma_f32_16x16x32_bf16 a[28:31], v[80:83], v[64:67], a[28:31]
    ds_read_b128 v[40:43], v21 offset:2048
    s_add_u32 m0, s66, 69632
    s_nop 0
    buffer_load_dwordx4 v17, s[4:7], s65 offen sc0 sc1 lds
    s_add_u32 s65, s65, 128
    s_waitcnt lgkmcnt(0)
    v_mfma_f32_16x16x32_bf16 a[0:3], v[44:47], v[36:39], a[0:3]
    v_mfma_f32_16x16x32_bf16 a[4:7], v[48:51], v[36:39], a[4:7]
    ds_read_b128 v[68:71], v33 offset:0
    v_mfma_f32_16x16x32_bf16 a[8:11], v[52:55], v[36:39], a[8:11]
    ds_read_b128 v[72:75], v33 offset:2048
    v_mfma_f32_16x16x32_bf16 a[12:15], v[56:59], v[36:39], a[12:15]
    ds_read_b128 v[76:79], v33 offset:4096
    v_mfma_f32_16x16x32_bf16 a[16:19], v[44:47], v[40:43], a[16:19]
    v_mfma_f32_16x16x32_bf16 a[20:23], v[48:51], v[40:43], a[20:23]
    ds_read_b128 v[80:83], v33 offset:6144
    v_mfma_f32_16x16x32_bf16 a[24:27], v[52:55], v[40:43], a[24:27]
    ds_read_b128 v[60:63], v25 offset:0
    v_mfma_f32_16x16x32_bf16 a[28:31], v[56:59], v[40:43], a[28:31]
    ds_read_b128 v[64:67], v25 offset:2048
    s_waitcnt lgkmcnt(0) vmcnt(12)
    s_barrier
    v_mfma_f32_16x16x32_bf16 a[0:3], v[68:71], v[60:63], a[0:3]
    v_mfma_f32_16x16x32_bf16 a[4:7], v[72:75], v[60:63], a[4:7]
    ds_read_b128 v[44:47], v26 offset:0
    v_mfma_f32_16x16x32_bf16 a[8:11], v[76:79], v[60:63], a[8:11]
    ds_read_b128 v[48:51], v26 offset:2048
    v_mfma_f32_16x16x32_bf16 a[12:15], v[80:83], v[60:63], a[12:15]
    ds_read_b128 v[52:55], v26 offset:4096
    v_mfma_f32_16x16x32_bf16 a[16:19], v[68:71], v[64:67], a[16:19]
    v_mfma_f32_16x16x32_bf16 a[20:23], v[72:75], v[64:67], a[20:23]
    ds_read_b128 v[56:59], v26 offset:6144
    v_mfma_f32_16x16x32_bf16 a[24:27], v[76:79], v[64:67], a[24:27]
    ds_read_b128 v[36:39], v18 offset:0
    v_mfma_f32_16x16x32_bf16 a[28:31], v[80:83], v[64:67], a[28:31]
    ds_read_b128 v[40:43], v18 offset:2048
    s_waitcnt lgkmcnt(0)
    v_mfma_f32_16x16x32_bf16 a[0:3], v[44:47], v[36:39], a[0:3]
    v_mfma_f32_16x16x32_bf16 a[4:7], v[48:51], v[36:39], a[4:7]
    ds_read_b128 v[68:71], v30 offset:0
    v_mfma_f32_16x16x32_bf16 a[8:11], v[52:55], v[36:39], a[8:11]
    ds_read_b128 v[72:75], v30 offset:2048
    v_mfma_f32_16x16x32_bf16 a[12:15], v[56:59], v[36:39], a[12:15]
    ds_read_b128 v[76:79], v30 offset:4096
    v_mfma_f32_16x16x32_bf16 a[16:19], v[44:47], v[40:43], a[16:19]
    v_mfma_f32_16x16x32_bf16 a[20:23], v[48:51], v[40:43], a[20:23]
    ds_read_b128 v[80:83], v30 offset:6144
    v_mfma_f32_16x16x32_bf16 a[24:27], v[52:55], v[40:43], a[24:27]
    ds_read_b128 v[60:63], v22 offset:0
    v_mfma_f32_16x16x32_bf16 a[28:31], v[56:59], v[40:43], a[28:31]
    ds_read_b128 v[64:67], v22 offset:2048
    s_waitcnt lgkmcnt(0) vmcnt(6)
    s_barrier
    v_mfma_f32_16x16x32_bf16 a[0:3], v[68:71], v[60:63], a[0:3]
    v_mfma_f32_16x16x32_bf16 a[4:7], v[72:75], v[60:63], a[4:7]
    ds_read_b128 v[44:47], v27 offset:0
    v_mfma_f32_16x16x32_bf16 a[8:11], v[76:79], v[60:63], a[8:11]
    ds_read_b128 v[48:51], v27 offset:2048
    v_mfma_f32_16x16x32_bf16 a[12:15], v[80:83], v[60:63], a[12:15]
    ds_read_b128 v[52:55], v27 offset:4096
    v_mfma_f32_16x16x32_bf16 a[16:19], v[68:71], v[64:67], a[16:19]
    v_mfma_f32_16x16x32_bf16 a[20:23], v[72:75], v[64:67], a[20:23]
    ds_read_b128 v[56:59], v27 offset:6144
    v_mfma_f32_16x16x32_bf16 a[24:27], v[76:79], v[64:67], a[24:27]
    ds_read_b128 v[36:39], v19 offset:0
    v_mfma_f32_16x16x32_bf16 a[28:31], v[80:83], v[64:67], a[28:31]
    ds_read_b128 v[40:43], v19 offset:2048
    s_waitcnt lgkmcnt(0)
    v_mfma_f32_16x16x32_bf16 a[0:3], v[44:47], v[36:39], a[0:3]
    v_mfma_f32_16x16x32_bf16 a[4:7], v[48:51], v[36:39], a[4:7]
    ds_read_b128 v[68:71], v31 offset:0
    v_mfma_f32_16x16x32_bf16 a[8:11], v[52:55], v[36:39], a[8:11]
    ds_read_b128 v[72:75], v31 offset:2048
    v_mfma_f32_16x16x32_bf16 a[12:15], v[56:59], v[36:39], a[12:15]
    ds_read_b128 v[76:79], v31 offset:4096
    v_mfma_f32_16x16x32_bf16 a[16:19], v[44:47], v[40:43], a[16:19]
    v_mfma_f32_16x16x32_bf16 a[20:23], v[48:51], v[40:43], a[20:23]
    ds_read_b128 v[80:83], v31 offset:6144
    v_mfma_f32_16x16x32_bf16 a[24:27], v[52:55], v[40:43], a[24:27]
    ds_read_b128 v[60:63], v23 offset:0
    v_mfma_f32_16x16x32_bf16 a[28:31], v[56:59], v[40:43], a[28:31]
    ds_read_b128 v[64:67], v23 offset:2048
    s_waitcnt lgkmcnt(0) vmcnt(0)
    s_barrier
    v_mfma_f32_16x16x32_bf16 a[0:3], v[68:71], v[60:63], a[0:3]
    v_mfma_f32_16x16x32_bf16 a[4:7], v[72:75], v[60:63], a[4:7]
    ds_read_b128 v[44:47], v28 offset:0
    v_mfma_f32_16x16x32_bf16 a[8:11], v[76:79], v[60:63], a[8:11]
    ds_read_b128 v[48:51], v28 offset:2048
    v_mfma_f32_16x16x32_bf16 a[12:15], v[80:83], v[60:63], a[12:15]
    ds_read_b128 v[52:55], v28 offset:4096
    v_mfma_f32_16x16x32_bf16 a[16:19], v[68:71], v[64:67], a[16:19]
    v_mfma_f32_16x16x32_bf16 a[20:23], v[72:75], v[64:67], a[20:23]
    ds_read_b128 v[56:59], v28 offset:6144
    v_mfma_f32_16x16x32_bf16 a[24:27], v[76:79], v[64:67], a[24:27]
    ds_read_b128 v[36:39], v20 offset:0
    v_mfma_f32_16x16x32_bf16 a[28:31], v[80:83], v[64:67], a[28:31]
    ds_read_b128 v[40:43], v20 offset:2048
    s_waitcnt lgkmcnt(0)
    v_mfma_f32_16x16x32_bf16 a[0:3], v[44:47], v[36:39], a[0:3]
    v_mfma_f32_16x16x32_bf16 a[4:7], v[48:51], v[36:39], a[4:7]
    ds_read_b128 v[68:71], v32 offset:0
    v_mfma_f32_16x16x32_bf16 a[8:11], v[52:55], v[36:39], a[8:11]
    ds_read_b128 v[72:75], v32 offset:2048
    v_mfma_f32_16x16x32_bf16 a[12:15], v[56:59], v[36:39], a[12:15]
    ds_read_b128 v[76:79], v32 offset:4096
    v_mfma_f32_16x16x32_bf16 a[16:19], v[44:47], v[40:43], a[16:19]
    v_mfma_f32_16x16x32_bf16 a[20:23], v[48:51], v[40:43], a[20:23]
    ds_read_b128 v[80:83], v32 offset:6144
    v_mfma_f32_16x16x32_bf16 a[24:27], v[52:55], v[40:43], a[24:27]
    ds_read_b128 v[60:63], v24 offset:0
    v_mfma_f32_16x16x32_bf16 a[28:31], v[56:59], v[40:43], a[28:31]
    ds_read_b128 v[64:67], v24 offset:2048
    s_waitcnt lgkmcnt(0)
    v_mfma_f32_16x16x32_bf16 a[0:3], v[68:71], v[60:63], a[0:3]
    v_mfma_f32_16x16x32_bf16 a[4:7], v[72:75], v[60:63], a[4:7]
    v_mfma_f32_16x16x32_bf16 a[8:11], v[76:79], v[60:63], a[8:11]
    v_mfma_f32_16x16x32_bf16 a[12:15], v[80:83], v[60:63], a[12:15]
    v_mfma_f32_16x16x32_bf16 a[16:19], v[68:71], v[64:67], a[16:19]
    v_mfma_f32_16x16x32_bf16 a[20:23], v[72:75], v[64:67], a[20:23]
    v_mfma_f32_16x16x32_bf16 a[24:27], v[76:79], v[64:67], a[24:27]
    v_mfma_f32_16x16x32_bf16 a[28:31], v[80:83], v[64:67], a[28:31]
    s_nop 7
    s_nop 7
    s_barrier
    v_mul_u32_u24 v12, 80, v3
    v_lshl_add_u32 v12, v4, 3, v12
    v_mul_u32_u24 v13, 2560, v2
    v_add_u32 v12, v12, v13
    v_accvgpr_read_b32 v36, a0
    v_accvgpr_read_b32 v40, a4
    v_accvgpr_read_b32 v37, a1
    v_accvgpr_read_b32 v41, a5
    v_accvgpr_read_b32 v38, a2
    v_accvgpr_read_b32 v42, a6
    v_accvgpr_read_b32 v39, a3
    v_accvgpr_read_b32 v43, a7
    v_cvt_pk_bf16_f32 v44, v36, v37
    v_cvt_pk_bf16_f32 v45, v38, v39
    v_cvt_pk_bf16_f32 v46, v40, v41
    v_cvt_pk_bf16_f32 v47, v42, v43
    v_lshlrev_b32 v36, 16, v44
    v_and_b32 v37, 0xffff0000, v44
    v_lshlrev_b32 v40, 16, v46
    v_and_b32 v41, 0xffff0000, v46
    v_lshlrev_b32 v38, 16, v45
    v_and_b32 v39, 0xffff0000, v45
    v_lshlrev_b32 v42, 16, v47
    v_and_b32 v43, 0xffff0000, v47
    v_mul_f32 v36, v36, v40
    v_mul_f32 v37, v37, v41
    v_mul_f32 v38, v38, v42
    v_mul_f32 v39, v39, v43
    v_cvt_pk_bf16_f32 v48, v36, v37
    v_cvt_pk_bf16_f32 v49, v38, v39
    ds_write_b64 v12, v[48:49] offset:0
    v_accvgpr_read_b32 v52, a8
    v_accvgpr_read_b32 v56, a12
    v_accvgpr_read_b32 v53, a9
    v_accvgpr_read_b32 v57, a13
    v_accvgpr_read_b32 v54, a10
    v_accvgpr_read_b32 v58, a14
    v_accvgpr_read_b32 v55, a11
    v_accvgpr_read_b32 v59, a15
    v_cvt_pk_bf16_f32 v60, v52, v53
    v_cvt_pk_bf16_f32 v61, v54, v55
    v_cvt_pk_bf16_f32 v62, v56, v57
    v_cvt_pk_bf16_f32 v63, v58, v59
    v_lshlrev_b32 v52, 16, v60
    v_and_b32 v53, 0xffff0000, v60
    v_lshlrev_b32 v56, 16, v62
    v_and_b32 v57, 0xffff0000, v62
    v_lshlrev_b32 v54, 16, v61
    v_and_b32 v55, 0xffff0000, v61
    v_lshlrev_b32 v58, 16, v63
    v_and_b32 v59, 0xffff0000, v63
    v_mul_f32 v52, v52, v56
    v_mul_f32 v53, v53, v57
    v_mul_f32 v54, v54, v58
    v_mul_f32 v55, v55, v59
    v_cvt_pk_bf16_f32 v64, v52, v53
    v_cvt_pk_bf16_f32 v65, v54, v55
    ds_write_b64 v12, v[64:65] offset:32
    v_accvgpr_read_b32 v68, a16
    v_accvgpr_read_b32 v72, a20
    v_accvgpr_read_b32 v69, a17
    v_accvgpr_read_b32 v73, a21
    v_accvgpr_read_b32 v70, a18
    v_accvgpr_read_b32 v74, a22
    v_accvgpr_read_b32 v71, a19
    v_accvgpr_read_b32 v75, a23
    v_cvt_pk_bf16_f32 v76, v68, v69
    v_cvt_pk_bf16_f32 v77, v70, v71
    v_cvt_pk_bf16_f32 v78, v72, v73
    v_cvt_pk_bf16_f32 v79, v74, v75
    v_lshlrev_b32 v68, 16, v76
    v_and_b32 v69, 0xffff0000, v76
    v_lshlrev_b32 v72, 16, v78
    v_and_b32 v73, 0xffff0000, v78
    v_lshlrev_b32 v70, 16, v77
    v_and_b32 v71, 0xffff0000, v77
    v_lshlrev_b32 v74, 16, v79
    v_and_b32 v75, 0xffff0000, v79
    v_mul_f32 v68, v68, v72
    v_mul_f32 v69, v69, v73
    v_mul_f32 v70, v70, v74
    v_mul_f32 v71, v71, v75
    v_cvt_pk_bf16_f32 v80, v68, v69
    v_cvt_pk_bf16_f32 v81, v70, v71
    ds_write_b64 v12, v[80:81] offset:1280
    v_accvgpr_read_b32 v84, a24
    v_accvgpr_read_b32 v88, a28
    v_accvgpr_read_b32 v85, a25
    v_accvgpr_read_b32 v89, a29
    v_accvgpr_read_b32 v86, a26
    v_accvgpr_read_b32 v90, a30
    v_accvgpr_read_b32 v87, a27
    v_accvgpr_read_b32 v91, a31
    v_cvt_pk_bf16_f32 v92, v84, v85
    v_cvt_pk_bf16_f32 v93, v86, v87
    v_cvt_pk_bf16_f32 v94, v88, v89
    v_cvt_pk_bf16_f32 v95, v90, v91
    v_lshlrev_b32 v84, 16, v92
    v_and_b32 v85, 0xffff0000, v92
    v_lshlrev_b32 v88, 16, v94
    v_and_b32 v89, 0xffff0000, v94
    v_lshlrev_b32 v86, 16, v93
    v_and_b32 v87, 0xffff0000, v93
    v_lshlrev_b32 v90, 16, v95
    v_and_b32 v91, 0xffff0000, v95
    v_mul_f32 v84, v84, v88
    v_mul_f32 v85, v85, v89
    v_mul_f32 v86, v86, v90
    v_mul_f32 v87, v87, v91
    v_cvt_pk_bf16_f32 v96, v84, v85
    v_cvt_pk_bf16_f32 v97, v86, v87
    ds_write_b64 v12, v[96:97] offset:1312
    s_lshl_b32 s26, s21, 7
    v_lshlrev_b32 v10, 5, v8
    v_add_u32 v10, s26, v10
    v_mul_u32_u24 v10, 3584, v10
    s_mul_i32 s27, s20, 64
    v_add_u32 v10, s27, v10
    s_mov_b32 s28, 121634816
    v_mul_u32_u24 v5, 16384, v1
    v_lshrrev_b32 v5, 16, v5
    v_mul_u32_u24 v6, 4, v5
    v_sub_u32 v6, v1, v6
    v_mul_u32_u24 v7, 80, v5
    v_lshl_add_u32 v7, v6, 4, v7
    v_mul_u32_u24 v13, 2560, v2
    v_add_u32 v7, v7, v13
    v_mul_u32_u24 v5, 3584, v5
    v_lshl_add_u32 v5, v6, 4, v5
    v_add_u32 v5, v5, v10
    v_cmp_gt_u32 vcc, 64, v1
    s_waitcnt lgkmcnt(0)
    s_and_saveexec_b64 s[44:45], vcc
    ds_read_b128 v[36:39], v7 offset:0
    ds_read_b128 v[40:43], v7 offset:1280
    s_waitcnt lgkmcnt(1)
    s_add_u32 s46, s28, 0
    buffer_store_dwordx4 v[36:39], v5, s[4:7], s46 offen sc0 sc1
    s_waitcnt lgkmcnt(0)
    s_add_u32 s46, s28, 57344
    buffer_store_dwordx4 v[40:43], v5, s[4:7], s46 offen sc0 sc1
    s_mov_b64 exec, s[44:45]
    s_add_u32 s22, s15, 224
    s_waitcnt vmcnt(0) lgkmcnt(0)
    s_barrier
    s_cmp_lg_u32 s14, 0
    s_cbranch_scc1 chain_kernel_sig21
    s_mov_b64 exec, 1
    v_mov_b32 v6, s22
    v_mov_b32 v5, 1
    buffer_atomic_add v5, v6, s[8:11], 0 offen sc1
    s_mov_b64 exec, -1
chain_kernel_sig21:
    v_mov_b32 v241, s22
chain_kernel_wc22:
    buffer_load_dword v240, v241, s[8:11], 0 offen sc0 sc1
    s_add_u32 s48, s48, 1
    s_cmp_gt_u32 s48, 0x400000
    s_cbranch_scc1 chain_kernel_end
    s_sleep 1
    s_waitcnt vmcnt(0)
    v_cmp_gt_u32 vcc, 112, v240
    s_cbranch_vccnz chain_kernel_wc22
    s_mov_b32 s21, 306783379
    s_mul_hi_u32 s21, s16, s21
    s_mul_i32 s20, s21, 14
    s_sub_u32 s20, s16, s20
    s_lshl_b32 s23, s17, 3
    s_add_u32 s21, s21, s23
    s_mul_i32 s24, s21, 114688
    s_add_u32 s24, s24, 121634816
    s_mul_i32 s25, s20, 114688
    s_add_u32 s25, s25, 10485760
    v_lshrrev_b32 v6, 3, v1
    v_and_b32 v5, 7, v1
    v_xor_b32 v5, v5, v6
    v_lshl_add_u32 v6, v2, 3, v6
    v_mul_u32_u24 v16, 3584, v6
    v_lshl_add_u32 v16, v5, 4, v16
    v_mul_u32_u24 v17, 3584, v6
    v_lshl_add_u32 v17, v5, 4, v17
    s_add_u32 s60, s24, 0
    s_add_u32 s61, s25, 0
    s_lshl_b32 s62, s14, 10
    v_and_b32 v7, 7, v3
    v_xor_b32 v7, v7, v4
    v_lshlrev_b32 v7, 4, v7
    v_lshl_add_u32 v7, v3, 7, v7
    v_lshrrev_b32 v8, 1, v2
    v_and_b32 v9, 1, v2
    v_mul_u32_u24 v10, 2048, v8
    v_mul_u32_u24 v11, 2048, v9
    v_add_u32 v10, v10, v7
    v_add_u32 v11, v11, v7
    v_add_u32 v11, 4096, v11
    v_mov_b32 v18, v10
    v_xor_b32 v34, 64, v10
    v_add_u32 v19, 8192, v18
    v_add_u32 v35, 8192, v34
    v_add_u32 v20, 16384, v18
    v_add_u32 v36, 16384, v34
    v_add_u32 v21, 24576, v18
    v_add_u32 v37, 24576, v34
    v_add_u32 v22, 32768, v18
    v_add_u32 v38, 32768, v34
    v_add_u32 v23, 40960, v18
    v_add_u32 v39, 40960, v34
    v_add_u32 v24, 49152, v18
    v_add_u32 v40, 49152, v34
    v_add_u32 v25, 57344, v18
    v_add_u32 v41, 57344, v34
    v_add_u32 v26, 65536, v18
    v_add_u32 v42, 65536, v34
    v_add_u32 v27, 73728, v18
    v_add_u32 v43, 73728, v34
    v_add_u32 v28, 81920, v18
    v_add_u32 v44, 81920, v34
    v_add_u32 v29, 90112, v18
    v_add_u32 v45, 90112, v34
    v_add_u32 v30, 98304, v18
    v_add_u32 v46, 98304, v34
    v_add_u32 v31, 106496, v18
    v_add_u32 v47, 106496, v34
    v_add_u32 v32, 114688, v18
    v_add_u32 v48, 114688, v34
    v_add_u32 v33, 122880, v18
    v_add_u32 v49, 122880, v34
    v_mov_b32 v50, v11
    v_xor_b32 v66, 64, v11
    v_add_u32 v51, 8192, v50
    v_add_u32 v67, 8192, v66
    v_add_u32 v52, 16384, v50
    v_add_u32 v68, 16384, v66
    v_add_u32 v53, 24576, v50
    v_add_u32 v69, 24576, v66
    v_add_u32 v54, 32768, v50
    v_add_u32 v70, 32768, v66
    v_add_u32 v55, 40960, v50
    v_add_u32 v71, 40960, v66
    v_add_u32 v56, 49152, v50
    v_add_u32 v72, 49152, v66
    v_add_u32 v57, 57344, v50
    v_add_u32 v73, 57344, v66
    v_add_u32 v58, 65536, v50
    v_add_u32 v74, 65536, v66
    v_add_u32 v59, 73728, v50
    v_add_u32 v75, 73728, v66
    v_add_u32 v60, 81920, v50
    v_add_u32 v76, 81920, v66
    v_add_u32 v61, 90112, v50
    v_add_u32 v77, 90112, v66
    v_add_u32 v62, 98304, v50
    v_add_u32 v78, 98304, v66
    v_add_u32 v63, 106496, v50
    v_add_u32 v79, 106496, v66
    v_add_u32 v64, 114688, v50
    v_add_u32 v80, 114688, v66
    v_add_u32 v65, 122880, v50
    v_add_u32 v81, 122880, v66
    s_add_u32 m0, s62, 0
    s_nop 0
    buffer_load_dwordx4 v16, s[4:7], s60 offen sc0 sc1 lds
    s_add_u32 s60, s60, 128
    s_add_u32 m0, s62, 4096
    s_nop 0
    buffer_load_dwordx4 v17, s[4:7], s61 offen sc0 sc1 lds
    s_add_u32 s61, s61, 128
    s_add_u32 m0, s62, 8192
    s_nop 0
    buffer_load_dwordx4 v16, s[4:7], s60 offen sc0 sc1 lds
    s_add_u32 s60, s60, 128
    s_add_u32 m0, s62, 12288
    s_nop 0
    buffer_load_dwordx4 v17, s[4:7], s61 offen sc0 sc1 lds
    s_add_u32 s61, s61, 128
    s_add_u32 m0, s62, 16384
    s_nop 0
    buffer_load_dwordx4 v16, s[4:7], s60 offen sc0 sc1 lds
    s_add_u32 s60, s60, 128
    s_add_u32 m0, s62, 20480
    s_nop 0
    buffer_load_dwordx4 v17, s[4:7], s61 offen sc0 sc1 lds
    s_add_u32 s61, s61, 128
    s_add_u32 m0, s62, 24576
    s_nop 0
    buffer_load_dwordx4 v16, s[4:7], s60 offen sc0 sc1 lds
    s_add_u32 s60, s60, 128
    s_add_u32 m0, s62, 28672
    s_nop 0
    buffer_load_dwordx4 v17, s[4:7], s61 offen sc0 sc1 lds
    s_add_u32 s61, s61, 128
    s_add_u32 m0, s62, 32768
    s_nop 0
    buffer_load_dwordx4 v16, s[4:7], s60 offen sc0 sc1 lds
    s_add_u32 s60, s60, 128
    s_add_u32 m0, s62, 36864
    s_nop 0
    buffer_load_dwordx4 v17, s[4:7], s61 offen sc0 sc1 lds
    s_add_u32 s61, s61, 128
    s_add_u32 m0, s62, 40960
    s_nop 0
    buffer_load_dwordx4 v16, s[4:7], s60 offen sc0 sc1 lds
    s_add_u32 s60, s60, 128
    s_add_u32 m0, s62, 45056
    s_nop 0
    buffer_load_dwordx4 v17, s[4:7], s61 offen sc0 sc1 lds
    s_add_u32 s61, s61, 128
    s_add_u32 m0, s62, 49152
    s_nop 0
    buffer_load_dwordx4 v16, s[4:7], s60 offen sc0 sc1 lds
    s_add_u32 s60, s60, 128
    s_add_u32 m0, s62, 53248
    s_nop 0
    buffer_load_dwordx4 v17, s[4:7], s61 offen sc0 sc1 lds
    s_add_u32 s61, s61, 128
    s_add_u32 m0, s62, 57344
    s_nop 0
    buffer_load_dwordx4 v16, s[4:7], s60 offen sc0 sc1 lds
    s_add_u32 s60, s60, 128
    s_add_u32 m0, s62, 61440
    s_nop 0
    buffer_load_dwordx4 v17, s[4:7], s61 offen sc0 sc1 lds
    s_add_u32 s61, s61, 128
    s_add_u32 m0, s62, 65536
    s_nop 0
    buffer_load_dwordx4 v16, s[4:7], s60 offen sc0 sc1 lds
    s_add_u32 s60, s60, 128
    s_add_u32 m0, s62, 69632
    s_nop 0
    buffer_load_dwordx4 v17, s[4:7], s61 offen sc0 sc1 lds
    s_add_u32 s61, s61, 128
    s_add_u32 m0, s62, 73728
    s_nop 0
    buffer_load_dwordx4 v16, s[4:7], s60 offen sc0 sc1 lds
    s_add_u32 s60, s60, 128
    s_add_u32 m0, s62, 77824
    s_nop 0
    buffer_load_dwordx4 v17, s[4:7], s61 offen sc0 sc1 lds
    s_add_u32 s61, s61, 128
    s_add_u32 m0, s62, 81920
    s_nop 0
    buffer_load_dwordx4 v16, s[4:7], s60 offen sc0 sc1 lds
    s_add_u32 s60, s60, 128
    s_add_u32 m0, s62, 86016
    s_nop 0
    buffer_load_dwordx4 v17, s[4:7], s61 offen sc0 sc1 lds
    s_add_u32 s61, s61, 128
    s_add_u32 m0, s62, 90112
    s_nop 0
    buffer_load_dwordx4 v16, s[4:7], s60 offen sc0 sc1 lds
    s_add_u32 s60, s60, 128
    s_add_u32 m0, s62, 94208
    s_nop 0
    buffer_load_dwordx4 v17, s[4:7], s61 offen sc0 sc1 lds
    s_add_u32 s61, s61, 128
    s_add_u32 m0, s62, 98304
    s_nop 0
    buffer_load_dwordx4 v16, s[4:7], s60 offen sc0 sc1 lds
    s_add_u32 s60, s60, 128
    s_add_u32 m0, s62, 102400
    s_nop 0
    buffer_load_dwordx4 v17, s[4:7], s61 offen sc0 sc1 lds
    s_add_u32 s61, s61, 128
    s_add_u32 m0, s62, 106496
    s_nop 0
    buffer_load_dwordx4 v16, s[4:7], s60 offen sc0 sc1 lds
    s_add_u32 s60, s60, 128
    s_add_u32 m0, s62, 110592
    s_nop 0
    buffer_load_dwordx4 v17, s[4:7], s61 offen sc0 sc1 lds
    s_add_u32 s61, s61, 128
    s_add_u32 m0, s62, 114688
    s_nop 0
    buffer_load_dwordx4 v16, s[4:7], s60 offen sc0 sc1 lds
    s_add_u32 s60, s60, 128
    s_add_u32 m0, s62, 118784
    s_nop 0
    buffer_load_dwordx4 v17, s[4:7], s61 offen sc0 sc1 lds
    s_add_u32 s61, s61, 128
    s_add_u32 m0, s62, 122880
    s_nop 0
    buffer_load_dwordx4 v16, s[4:7], s60 offen sc0 sc1 lds
    s_add_u32 s60, s60, 128
    s_add_u32 m0, s62, 126976
    s_nop 0
    buffer_load_dwordx4 v17, s[4:7], s61 offen sc0 sc1 lds
    s_add_u32 s61, s61, 128
    s_waitcnt vmcnt(30)
    s_barrier
    ds_read_b128 v[88:91], v50 offset:0
    ds_read_b128 v[84:87], v18 offset:0
    s_waitcnt lgkmcnt(0)
    v_mfma_f32_16x16x32_bf16 a[0:3], v[88:91], v[84:87], 0
    ds_read_b128 v[96:99], v66 offset:0
    ds_read_b128 v[92:95], v34 offset:0
    s_waitcnt lgkmcnt(0) vmcnt(28)
    s_barrier
    v_mfma_f32_16x16x32_bf16 a[0:3], v[96:99], v[92:95], a[0:3]
    ds_read_b128 v[88:91], v51 offset:0
    s_add_u32 m0, s62, 0
    s_nop 0
    buffer_load_dwordx4 v16, s[4:7], s60 offen sc0 sc1 lds
    s_add_u32 s60, s60, 128
    ds_read_b128 v[84:87], v19 offset:0
    s_add_u32 m0, s62, 4096
    s_nop 0
    buffer_load_dwordx4 v17, s[4:7], s61 offen sc0 sc1 lds
    s_add_u32 s61, s61, 128
    s_waitcnt lgkmcnt(0)
    v_mfma_f32_16x16x32_bf16 a[0:3], v[88:91], v[84:87], a[0:3]
    ds_read_b128 v[96:99], v67 offset:0
    ds_read_b128 v[92:95], v35 offset:0
    s_waitcnt lgkmcnt(0) vmcnt(28)
    s_barrier
    v_mfma_f32_16x16x32_bf16 a[0:3], v[96:99], v[92:95], a[0:3]
    ds_read_b128 v[88:91], v52 offset:0
    s_add_u32 m0, s62, 8192
    s_nop 0
    buffer_load_dwordx4 v16, s[4:7], s60 offen sc0 sc1 lds
    s_add_u32 s60, s60, 128
    ds_read_b128 v[84:87], v20 offset:0
    s_add_u32 m0, s62, 12288
    s_nop 0
    buffer_load_dwordx4 v17, s[4:7], s61 offen sc0 sc1 lds
    s_add_u32 s61, s61, 128
    s_waitcnt lgkmcnt(0)
    v_mfma_f32_16x16x32_bf16 a[0:3], v[88:91], v[84:87], a[0:3]
    ds_read_b128 v[96:99], v68 offset:0
    ds_read_b128 v[92:95], v36 offset:0
    s_waitcnt lgkmcnt(0) vmcnt(28)
    s_barrier
    v_mfma_f32_16x16x32_bf16 a[0:3], v[96:99], v[92:95], a[0:3]
    ds_read_b128 v[88:91], v53 offset:0
    s_add_u32 m0, s62, 16384
    s_nop 0
    buffer_load_dwordx4 v16, s[4:7], s60 offen sc0 sc1 lds
    s_add_u32 s60, s60, 128
    ds_read_b128 v[84:87], v21 offset:0
    s_add_u32 m0, s62, 20480
    s_nop 0
    buffer_load_dwordx4 v17, s[4:7], s61 offen sc0 sc1 lds
    s_add_u32 s61, s61, 128
    s_waitcnt lgkmcnt(0)
    v_mfma_f32_16x16x32_bf16 a[0:3], v[88:91], v[84:87], a[0:3]
    ds_read_b128 v[96:99], v69 offset:0
    ds_read_b128 v[92:95], v37 offset:0
    s_waitcnt lgkmcnt(0) vmcnt(28)
    s_barrier
    v_mfma_f32_16x16x32_bf16 a[0:3], v[96:99], v[92:95], a[0:3]
    ds_read_b128 v[88:91], v54 offset:0
    s_add_u32 m0, s62, 24576
    s_nop 0
    buffer_load_dwordx4 v16, s[4:7], s60 offen sc0 sc1 lds
    s_add_u32 s60, s60, 128
    ds_read_b128 v[84:87], v22 offset:0
    s_add_u32 m0, s62, 28672
    s_nop 0
    buffer_load_dwordx4 v17, s[4:7], s61 offen sc0 sc1 lds
    s_add_u32 s61, s61, 128
    s_waitcnt lgkmcnt(0)
    v_mfma_f32_16x16x32_bf16 a[0:3], v[88:91], v[84:87], a[0:3]
    ds_read_b128 v[96:99], v70 offset:0
    ds_read_b128 v[92:95], v38 offset:0
    s_waitcnt lgkmcnt(0) vmcnt(28)
    s_barrier
    v_mfma_f32_16x16x32_bf16 a[0:3], v[96:99], v[92:95], a[0:3]
    ds_read_b128 v[88:91], v55 offset:0
    s_add_u32 m0, s62, 32768
    s_nop 0
    buffer_load_dwordx4 v16, s[4:7], s60 offen sc0 sc1 lds
    s_add_u32 s60, s60, 128
    ds_read_b128 v[84:87], v23 offset:0
    s_add_u32 m0, s62, 36864
    s_nop 0
    buffer_load_dwordx4 v17, s[4:7], s61 offen sc0 sc1 lds
    s_add_u32 s61, s61, 128
    s_waitcnt lgkmcnt(0)
    v_mfma_f32_16x16x32_bf16 a[0:3], v[88:91], v[84:87], a[0:3]
    ds_read_b128 v[96:99], v71 offset:0
    ds_read_b128 v[92:95], v39 offset:0
    s_waitcnt lgkmcnt(0) vmcnt(28)
    s_barrier
    v_mfma_f32_16x16x32_bf16 a[0:3], v[96:99], v[92:95], a[0:3]
    ds_read_b128 v[88:91], v56 offset:0
    s_add_u32 m0, s62, 40960
    s_nop 0
    buffer_load_dwordx4 v16, s[4:7], s60 offen sc0 sc1 lds
    s_add_u32 s60, s60, 128
    ds_read_b128 v[84:87], v24 offset:0
    s_add_u32 m0, s62, 45056
    s_nop 0
    buffer_load_dwordx4 v17, s[4:7], s61 offen sc0 sc1 lds
    s_add_u32 s61, s61, 128
    s_waitcnt lgkmcnt(0)
    v_mfma_f32_16x16x32_bf16 a[0:3], v[88:91], v[84:87], a[0:3]
    ds_read_b128 v[96:99], v72 offset:0
    ds_read_b128 v[92:95], v40 offset:0
    s_waitcnt lgkmcnt(0) vmcnt(28)
    s_barrier
    v_mfma_f32_16x16x32_bf16 a[0:3], v[96:99], v[92:95], a[0:3]
    ds_read_b128 v[88:91], v57 offset:0
    s_add_u32 m0, s62, 49152
    s_nop 0
    buffer_load_dwordx4 v16, s[4:7], s60 offen sc0 sc1 lds
    s_add_u32 s60, s60, 128
    ds_read_b128 v[84:87], v25 offset:0
    s_add_u32 m0, s62, 53248
    s_nop 0
    buffer_load_dwordx4 v17, s[4:7], s61 offen sc0 sc1 lds
    s_add_u32 s61, s61, 128
    s_waitcnt lgkmcnt(0)
    v_mfma_f32_16x16x32_bf16 a[0:3], v[88:91], v[84:87], a[0:3]
    ds_read_b128 v[96:99], v73 offset:0
    ds_read_b128 v[92:95], v41 offset:0
    s_waitcnt lgkmcnt(0) vmcnt(28)
    s_barrier
    v_mfma_f32_16x16x32_bf16 a[0:3], v[96:99], v[92:95], a[0:3]
    ds_read_b128 v[88:91], v58 offset:0
    s_add_u32 m0, s62, 57344
    s_nop 0
    buffer_load_dwordx4 v16, s[4:7], s60 offen sc0 sc1 lds
    s_add_u32 s60, s60, 128
    ds_read_b128 v[84:87], v26 offset:0
    s_add_u32 m0, s62, 61440
    s_nop 0
    buffer_load_dwordx4 v17, s[4:7], s61 offen sc0 sc1 lds
    s_add_u32 s61, s61, 128
    s_waitcnt lgkmcnt(0)
    v_mfma_f32_16x16x32_bf16 a[0:3], v[88:91], v[84:87], a[0:3]
    ds_read_b128 v[96:99], v74 offset:0
    ds_read_b128 v[92:95], v42 offset:0
    s_waitcnt lgkmcnt(0) vmcnt(28)
    s_barrier
    v_mfma_f32_16x16x32_bf16 a[0:3], v[96:99], v[92:95], a[0:3]
    ds_read_b128 v[88:91], v59 offset:0
    s_add_u32 m0, s62, 65536
    s_nop 0
    buffer_load_dwordx4 v16, s[4:7], s60 offen sc0 sc1 lds
    s_add_u32 s60, s60, 128
    ds_read_b128 v[84:87], v27 offset:0
    s_add_u32 m0, s62, 69632
    s_nop 0
    buffer_load_dwordx4 v17, s[4:7], s61 offen sc0 sc1 lds
    s_add_u32 s61, s61, 128
    s_waitcnt lgkmcnt(0)
    v_mfma_f32_16x16x32_bf16 a[0:3], v[88:91], v[84:87], a[0:3]
    ds_read_b128 v[96:99], v75 offset:0
    ds_read_b128 v[92:95], v43 offset:0
    s_waitcnt lgkmcnt(0) vmcnt(28)
    s_barrier
    v_mfma_f32_16x16x32_bf16 a[0:3], v[96:99], v[92:95], a[0:3]
    ds_read_b128 v[88:91], v60 offset:0
    s_add_u32 m0, s62, 73728
    s_nop 0
    buffer_load_dwordx4 v16, s[4:7], s60 offen sc0 sc1 lds
    s_add_u32 s60, s60, 128
    ds_read_b128 v[84:87], v28 offset:0
    s_add_u32 m0, s62, 77824
    s_nop 0
    buffer_load_dwordx4 v17, s[4:7], s61 offen sc0 sc1 lds
    s_add_u32 s61, s61, 128
    s_waitcnt lgkmcnt(0)
    v_mfma_f32_16x16x32_bf16 a[0:3], v[88:91], v[84:87], a[0:3]
    ds_read_b128 v[96:99], v76 offset:0
    ds_read_b128 v[92:95], v44 offset:0
    s_waitcnt lgkmcnt(0) vmcnt(28)
    s_barrier
    v_mfma_f32_16x16x32_bf16 a[0:3], v[96:99], v[92:95], a[0:3]
    ds_read_b128 v[88:91], v61 offset:0
    s_add_u32 m0, s62, 81920
    s_nop 0
    buffer_load_dwordx4 v16, s[4:7], s60 offen sc0 sc1 lds
    s_add_u32 s60, s60, 128
    ds_read_b128 v[84:87], v29 offset:0
    s_add_u32 m0, s62, 86016
    s_nop 0
    buffer_load_dwordx4 v17, s[4:7], s61 offen sc0 sc1 lds
    s_add_u32 s61, s61, 128
    s_waitcnt lgkmcnt(0)
    v_mfma_f32_16x16x32_bf16 a[0:3], v[88:91], v[84:87], a[0:3]
    ds_read_b128 v[96:99], v77 offset:0
    ds_read_b128 v[92:95], v45 offset:0
    s_waitcnt lgkmcnt(0) vmcnt(28)
    s_barrier
    v_mfma_f32_16x16x32_bf16 a[0:3], v[96:99], v[92:95], a[0:3]
    ds_read_b128 v[88:91], v62 offset:0
    s_add_u32 m0, s62, 90112
    s_nop 0
    buffer_load_dwordx4 v16, s[4:7], s60 offen sc0 sc1 lds
    s_add_u32 s60, s60, 128
    ds_read_b128 v[84:87], v30 offset:0
    s_add_u32 m0, s62, 94208
    s_nop 0
    buffer_load_dwordx4 v17, s[4:7], s61 offen sc0 sc1 lds
    s_add_u32 s61, s61, 128
    s_waitcnt lgkmcnt(0)
    v_mfma_f32_16x16x32_bf16 a[0:3], v[88:91], v[84:87], a[0:3]
    ds_read_b128 v[96:99], v78 offset:0
    ds_read_b128 v[92:95], v46 offset:0
    s_waitcnt lgkmcnt(0) vmcnt(28)
    s_barrier
    v_mfma_f32_16x16x32_bf16 a[0:3], v[96:99], v[92:95], a[0:3]
    ds_read_b128 v[88:91], v63 offset:0
    ds_read_b128 v[84:87], v31 offset:0
    s_waitcnt lgkmcnt(0)
    v_mfma_f32_16x16x32_bf16 a[0:3], v[88:91], v[84:87], a[0:3]
    ds_read_b128 v[96:99], v79 offset:0
    ds_read_b128 v[92:95], v47 offset:0
    s_waitcnt lgkmcnt(0) vmcnt(26)
    s_barrier
    v_mfma_f32_16x16x32_bf16 a[0:3], v[96:99], v[92:95], a[0:3]
    ds_read_b128 v[88:91], v64 offset:0
    ds_read_b128 v[84:87], v32 offset:0
    s_waitcnt lgkmcnt(0)
    v_mfma_f32_16x16x32_bf16 a[0:3], v[88:91], v[84:87], a[0:3]
    ds_read_b128 v[96:99], v80 offset:0
    ds_read_b128 v[92:95], v48 offset:0
    s_waitcnt lgkmcnt(0) vmcnt(24)
    s_barrier
    v_mfma_f32_16x16x32_bf16 a[0:3], v[96:99], v[92:95], a[0:3]
    ds_read_b128 v[88:91], v65 offset:0
    ds_read_b128 v[84:87], v33 offset:0
    s_waitcnt lgkmcnt(0)
    v_mfma_f32_16x16x32_bf16 a[0:3], v[88:91], v[84:87], a[0:3]
    ds_read_b128 v[96:99], v81 offset:0
    ds_read_b128 v[92:95], v49 offset:0
    s_waitcnt lgkmcnt(0) vmcnt(22)
    s_barrier
    v_mfma_f32_16x16x32_bf16 a[0:3], v[96:99], v[92:95], a[0:3]
    ds_read_b128 v[88:91], v50 offset:0
    ds_read_b128 v[84:87], v18 offset:0
    s_waitcnt lgkmcnt(0)
    v_mfma_f32_16x16x32_bf16 a[0:3], v[88:91], v[84:87], a[0:3]
    ds_read_b128 v[96:99], v66 offset:0
    ds_read_b128 v[92:95], v34 offset:0
    s_waitcnt lgkmcnt(0) vmcnt(20)
    s_barrier
    v_mfma_f32_16x16x32_bf16 a[0:3], v[96:99], v[92:95], a[0:3]
    ds_read_b128 v[88:91], v51 offset:0
    ds_read_b128 v[84:87], v19 offset:0
    s_waitcnt lgkmcnt(0)
    v_mfma_f32_16x16x32_bf16 a[0:3], v[88:91], v[84:87], a[0:3]
    ds_read_b128 v[96:99], v67 offset:0
    ds_read_b128 v[92:95], v35 offset:0
    s_waitcnt lgkmcnt(0) vmcnt(18)
    s_barrier
    v_mfma_f32_16x16x32_bf16 a[0:3], v[96:99], v[92:95], a[0:3]
    ds_read_b128 v[88:91], v52 offset:0
    ds_read_b128 v[84:87], v20 offset:0
    s_waitcnt lgkmcnt(0)
    v_mfma_f32_16x16x32_bf16 a[0:3], v[88:91], v[84:87], a[0:3]
    ds_read_b128 v[96:99], v68 offset:0
    ds_read_b128 v[92:95], v36 offset:0
    s_waitcnt lgkmcnt(0) vmcnt(16)
    s_barrier
    v_mfma_f32_16x16x32_bf16 a[0:3], v[96:99], v[92:95], a[0:3]
    ds_read_b128 v[88:91], v53 offset:0
    ds_read_b128 v[84:87], v21 offset:0
    s_waitcnt lgkmcnt(0)
    v_mfma_f32_16x16x32_bf16 a[0:3], v[88:91], v[84:87], a[0:3]
    ds_read_b128 v[96:99], v69 offset:0
    ds_read_b128 v[92:95], v37 offset:0
    s_waitcnt lgkmcnt(0) vmcnt(14)
    s_barrier
    v_mfma_f32_16x16x32_bf16 a[0:3], v[96:99], v[92:95], a[0:3]
    ds_read_b128 v[88:91], v54 offset:0
    ds_read_b128 v[84:87], v22 offset:0
    s_waitcnt lgkmcnt(0)
    v_mfma_f32_16x16x32_bf16 a[0:3], v[88:91], v[84:87], a[0:3]
    ds_read_b128 v[96:99], v70 offset:0
    ds_read_b128 v[92:95], v38 offset:0
    s_waitcnt lgkmcnt(0) vmcnt(12)
    s_barrier
    v_mfma_f32_16x16x32_bf16 a[0:3], v[96:99], v[92:95], a[0:3]
    ds_read_b128 v[88:91], v55 offset:0
    ds_read_b128 v[84:87], v23 offset:0
    s_waitcnt lgkmcnt(0)
    v_mfma_f32_16x16x32_bf16 a[0:3], v[88:91], v[84:87], a[0:3]
    ds_read_b128 v[96:99], v71 offset:0
    ds_read_b128 v[92:95], v39 offset:0
    s_waitcnt lgkmcnt(0) vmcnt(10)
    s_barrier
    v_mfma_f32_16x16x32_bf16 a[0:3], v[96:99], v[92:95], a[0:3]
    ds_read_b128 v[88:91], v56 offset:0
    ds_read_b128 v[84:87], v24 offset:0
    s_waitcnt lgkmcnt(0)
    v_mfma_f32_16x16x32_bf16 a[0:3], v[88:91], v[84:87], a[0:3]
    ds_read_b128 v[96:99], v72 offset:0
    ds_read_b128 v[92:95], v40 offset:0
    s_waitcnt lgkmcnt(0) vmcnt(8)
    s_barrier
    v_mfma_f32_16x16x32_bf16 a[0:3], v[96:99], v[92:95], a[0:3]
    ds_read_b128 v[88:91], v57 offset:0
    ds_read_b128 v[84:87], v25 offset:0
    s_waitcnt lgkmcnt(0)
    v_mfma_f32_16x16x32_bf16 a[0:3], v[88:91], v[84:87], a[0:3]
    ds_read_b128 v[96:99], v73 offset:0
    ds_read_b128 v[92:95], v41 offset:0
    s_waitcnt lgkmcnt(0) vmcnt(6)
    s_barrier
    v_mfma_f32_16x16x32_bf16 a[0:3], v[96:99], v[92:95], a[0:3]
    ds_read_b128 v[88:91], v58 offset:0
    ds_read_b128 v[84:87], v26 offset:0
    s_waitcnt lgkmcnt(0)
    v_mfma_f32_16x16x32_bf16 a[0:3], v[88:91], v[84:87], a[0:3]
    ds_read_b128 v[96:99], v74 offset:0
    ds_read_b128 v[92:95], v42 offset:0
    s_waitcnt lgkmcnt(0) vmcnt(4)
    s_barrier
    v_mfma_f32_16x16x32_bf16 a[0:3], v[96:99], v[92:95], a[0:3]
    ds_read_b128 v[88:91], v59 offset:0
    ds_read_b128 v[84:87], v27 offset:0
    s_waitcnt lgkmcnt(0)
    v_mfma_f32_16x16x32_bf16 a[0:3], v[88:91], v[84:87], a[0:3]
    ds_read_b128 v[96:99], v75 offset:0
    ds_read_b128 v[92:95], v43 offset:0
    s_waitcnt lgkmcnt(0) vmcnt(2)
    s_barrier
    v_mfma_f32_16x16x32_bf16 a[0:3], v[96:99], v[92:95], a[0:3]
    ds_read_b128 v[88:91], v60 offset:0
    ds_read_b128 v[84:87], v28 offset:0
    s_waitcnt lgkmcnt(0)
    v_mfma_f32_16x16x32_bf16 a[0:3], v[88:91], v[84:87], a[0:3]
    ds_read_b128 v[96:99], v76 offset:0
    ds_read_b128 v[92:95], v44 offset:0
    s_waitcnt lgkmcnt(0) vmcnt(0)
    s_barrier
    v_mfma_f32_16x16x32_bf16 a[0:3], v[96:99], v[92:95], a[0:3]
    ds_read_b128 v[88:91], v61 offset:0
    ds_read_b128 v[84:87], v29 offset:0
    s_waitcnt lgkmcnt(0)
    v_mfma_f32_16x16x32_bf16 a[0:3], v[88:91], v[84:87], a[0:3]
    ds_read_b128 v[96:99], v77 offset:0
    ds_read_b128 v[92:95], v45 offset:0
    s_waitcnt lgkmcnt(0)
    v_mfma_f32_16x16x32_bf16 a[0:3], v[96:99], v[92:95], a[0:3]
    s_nop 7
    s_nop 7
    s_barrier
    s_mul_i32 s26, s21, 32
    v_mul_u32_u24 v10, 16, v8
    v_add3_u32 v10, v10, v3, s26
    v_mul_u32_u24 v10, 896, v10
    s_mul_i32 s27, s20, 64
    v_lshl_add_u32 v10, v4, 3, v10
    v_mul_u32_u24 v11, 32, v9
    v_add3_u32 v10, v10, v11, s27
    s_mov_b32 s28, 117440512
    s_mov_b32 s29, 117454848
    s_mov_b32 s30, 0
    s_mov_b32 s31, 14336
    buffer_load_dwordx2 v[84:85], v10, s[4:7], s28 offen offset:0 sc0 sc1
    s_waitcnt vmcnt(0)
    v_accvgpr_read_b32 v92, a0
    v_accvgpr_read_b32 v93, a1
    v_accvgpr_read_b32 v94, a2
    v_accvgpr_read_b32 v95, a3
    v_cvt_pk_bf16_f32 v100, v92, v93
    v_cvt_pk_bf16_f32 v101, v94, v95
    v_lshlrev_b32 v92, 16, v100
    v_and_b32 v93, 0xffff0000, v100
    v_lshlrev_b32 v96, 16, v84
    v_and_b32 v97, 0xffff0000, v84
    v_lshlrev_b32 v94, 16, v101
    v_and_b32 v95, 0xffff0000, v101
    v_lshlrev_b32 v98, 16, v85
    v_and_b32 v99, 0xffff0000, v85
    v_add_f32 v92, v92, v96
    v_add_f32 v93, v93, v97
    v_add_f32 v94, v94, v98
    v_add_f32 v95, v95, v99
    v_cvt_pk_bf16_f32 v102, v92, v93
    v_cvt_pk_bf16_f32 v103, v94, v95
    buffer_store_dwordx2 v[102:103], v10, s[88:91], s30 offen offset:0
    s_waitcnt vmcnt(0)
    s_waitcnt lgkmcnt(0)
    s_barrier
    s_add_u32 s17, s17, 1
    s_cmp_lt_u32 s17, 8
    s_cbranch_scc1 chain_kernel_wpool2
chain_kernel_end:
    s_endpgm
.section .rodata,"a"
.p2align 6
.amdhsa_kernel prep2_kernel
  .amdhsa_next_free_vgpr 344
  .amdhsa_next_free_sgpr 102
  .amdhsa_accum_offset 148
  .amdhsa_group_segment_fixed_size 0
  .amdhsa_kernarg_size 112
  .amdhsa_user_sgpr_count 2
  .amdhsa_user_sgpr_kernarg_segment_ptr 1
  .amdhsa_system_sgpr_workgroup_id_x 1
.end_amdhsa_kernel
.p2align 6
.amdhsa_kernel chain_kernel
  .amdhsa_next_free_vgpr 512
  .amdhsa_next_free_sgpr 102
  .amdhsa_accum_offset 256
  .amdhsa_group_segment_fixed_size 0
  .amdhsa_kernarg_size 112
  .amdhsa_user_sgpr_count 2
  .amdhsa_user_sgpr_kernarg_segment_ptr 1
  .amdhsa_system_sgpr_workgroup_id_x 1
.end_amdhsa_kernel
```
